```python
import torch

def _softmax(x, axis=-1):
    return torch.softmax(x, dim=axis)

def _gelu(x):
    return torch.nn.functional.gelu(x, approximate='tanh')

def _silu(x):
    return torch.nn.functional.silu(x)

def _sigmoid(x):
    return torch.sigmoid(x)

def _layernorm(x, axis=-1, eps=1e-05):
    m = x.mean(dim=axis, keepdim=True)
    v = x.var(dim=axis, keepdim=True, unbiased=False)
    return (x - m) / torch.sqrt(v + eps)

def _scatter_add(tgt, idx, src, axis=0):
    return tgt.clone().index_add_(axis, idx, src)

def _segment_sum(src, seg, n):
    out = torch.zeros((n,) + src.shape[1:], dtype=src.dtype)
    return out.index_add_(0, seg, src)

def _pad(x, pw):
    flat = tuple((v for pair in reversed(pw) for v in pair))
    return torch.nn.functional.pad(x, flat)
kernel_name = 'recurrent_scan__memory_aug_recurrent_mem_tr__glu_gated_swiglu__prompt'

def setup_inputs():

    _w = lambda a: (lambda t: t.to(torch.bfloat16) if t.is_floating_point() else t)(torch.as_tensor(a))

    def _A_setup():
        B, S, Dm = (1, 2048, 448)
        H, Dh = (16, 256)
        M, seg = (8, 32)
        seg = min(seg, S)
        S = S // seg * seg
        return {'x': _w((lambda *s: torch.randn(*s, dtype=torch.bfloat16) * 0.1)(B, S, Dm)), 'mem0': _w((lambda *s: torch.randn(*s, dtype=torch.bfloat16) * 1.6)(B, M, Dm)), 'Wq': _w((lambda *s: torch.randn(*s, dtype=torch.bfloat16) * 0.8)(Dm, H, Dh) * Dm ** (-0.5)), 'Wk': _w((lambda *s: torch.randn(*s, dtype=torch.bfloat16) * 0.8)(Dm, H, Dh) * Dm ** (-0.5)), 'Wv': _w((lambda *s: torch.randn(*s, dtype=torch.bfloat16) * 1.6)(Dm, H, Dh) * Dm ** (-0.5)), 'Wo': _w((lambda *s: torch.randn(*s, dtype=torch.bfloat16) * 1.6)(H, Dh, Dm) * (H * Dh) ** (-0.5)), 'seg_len': seg}
    _A_in = _A_setup()

    def _B_setup():
        B, S, D, F = (1, 2048, 448, 1792)
        return {'x': _w((lambda *s: torch.randn(*s, dtype=torch.bfloat16) * 0.1)(B, S, D)), 'w1': _w((lambda *s: torch.randn(*s, dtype=torch.bfloat16) * 0.4)(D, F) * (2.0 / D) ** 0.5), 'w3': _w((lambda *s: torch.randn(*s, dtype=torch.bfloat16) * 0.4)(D, F) * (2.0 / D) ** 0.5), 'w2': _w((lambda *s: torch.randn(*s, dtype=torch.bfloat16) * 0.4)(F, D) * (2.0 / F) ** 0.5)}
    _B_in = _B_setup()
    return {'A_x': _A_in['x'], 'A_mem0': _A_in['mem0'], 'A_Wq': _A_in['Wq'], 'A_Wk': _A_in['Wk'], 'A_Wv': _A_in['Wv'], 'A_Wo': _A_in['Wo'], 'A_seg_len': _A_in['seg_len'], 'B_x': _B_in['x'], 'B_w1': _B_in['w1'], 'B_w3': _B_in['w3'], 'B_w2': _B_in['w2']}

def reference(A_x, A_mem0, A_Wq, A_Wk, A_Wv, A_Wo, A_seg_len, B_x, B_w1, B_w3, B_w2):

    def _A_ref(x, mem0, Wq, Wk, Wv, Wo, seg_len):
        B, S, Dm = x.shape
        H, Dh = (Wq.shape[1], Wq.shape[2])
        M = mem0.shape[1]
        scale = Dh ** (-0.5)
        n_seg = S // seg_len
        L = M + seg_len
        idx = torch.arange(L)
        mask = (idx[:, None] < M) | (idx[:, None] >= idx[None, :])
        mem = mem0
        outs = []
        for s in range(n_seg):
            xs = x[:, s * seg_len:(s + 1) * seg_len, :].clone()
            h = torch.concatenate([mem, xs], axis=1)
            q = torch.einsum('btd,dhe->bhte', h, Wq)
            k = torch.einsum('btd,dhe->bhte', h, Wk)
            v = torch.einsum('btd,dhe->bhte', h, Wv)
            scores = torch.einsum('bhqe,bhke->bhqk', q, k) * scale
            scores = torch.where(mask[None, None], scores, -1000000000.0)
            p = _softmax(scores, axis=-1)
            o = torch.einsum('bhqk,bhke->bhqe', p, v)
            o = torch.einsum('bhte,hed->btd', o, Wo)
            mem = o[:, :M, :].clone()
            outs.append(o[:, M:, :])
        return torch.concatenate(outs, axis=1)

    def _B_ref(x, w1, w3, w2):
        gate = torch.einsum('bsd,df->bsf', x, w1)
        up = torch.einsum('bsd,df->bsf', x, w3)
        h = _silu(gate) * up
        out = torch.einsum('bsf,fd->bsd', h, w2)
        return out
    x = A_x
    xn = _layernorm(x, axis=-1)
    s = _A_ref(xn, A_mem0, A_Wq, A_Wk, A_Wv, A_Wo, A_seg_len)
    g = _silu(_B_ref(xn, B_w1, B_w3, B_w2))
    return x + s * g
```

```asm
; @launch kernel=k2_kernel grid=(256,1,1) block=(256,1,1) lds=163840
.amdgcn_target "amdgcn-amd-amdhsa--gfx950"
.text
.globl k2_kernel
.type k2_kernel,@function
.p2align 8
k2_kernel:
    s_cmp_ge_u32 s2, 256
    s_cbranch_scc1 k2_end
    s_load_dwordx2 s[4:5], s[0:1], 104
    s_mov_b32 s6, 78315520
    s_mov_b32 s7, 0x00020000
    v_lshrrev_b32 v1, 6, v0
    v_and_b32 v0, 63, v0
    v_readfirstlane_b32 s3, v1
    v_lshlrev_b32 v1, 4, v0
    s_waitcnt lgkmcnt(0)
    s_and_b32 s16, s2, 7
    s_lshr_b32 s15, s2, 3
    s_cmp_lg_u32 s16, 0
    s_cbranch_scc1 k2_worker
    s_load_dwordx2 s[36:37], s[0:1], 0
    s_mov_b32 s38, 1835008
    s_mov_b32 s39, 0x00020000
    s_lshl_b32 s32, s15, 2
    s_add_u32 s32, s32, s3
    v_lshrrev_b32 v2, 4, v0
    v_and_b32 v3, 15, v0
    v_lshlrev_b32 v4, 4, v0
    s_mov_b32 s20, 0x05040100
    s_mov_b32 s21, 0x07060302
    s_mov_b32 s16, s32
    s_mul_i32 s17, s16, 14336
    v_mul_u32_u24 v5, 896, v3
    v_lshl_add_u32 v5, v2, 4, v5
    s_waitcnt lgkmcnt(0)
    buffer_load_dwordx4 v[8:11], v5, s[36:39], s17 offen offset:0
    buffer_load_dwordx4 v[12:15], v5, s[36:39], s17 offen offset:64
    buffer_load_dwordx4 v[16:19], v5, s[36:39], s17 offen offset:128
    buffer_load_dwordx4 v[20:23], v5, s[36:39], s17 offen offset:192
    buffer_load_dwordx4 v[24:27], v5, s[36:39], s17 offen offset:256
    buffer_load_dwordx4 v[28:31], v5, s[36:39], s17 offen offset:320
    buffer_load_dwordx4 v[32:35], v5, s[36:39], s17 offen offset:384
    buffer_load_dwordx4 v[36:39], v5, s[36:39], s17 offen offset:448
    buffer_load_dwordx4 v[40:43], v5, s[36:39], s17 offen offset:512
    buffer_load_dwordx4 v[44:47], v5, s[36:39], s17 offen offset:576
    buffer_load_dwordx4 v[48:51], v5, s[36:39], s17 offen offset:640
    buffer_load_dwordx4 v[52:55], v5, s[36:39], s17 offen offset:704
    buffer_load_dwordx4 v[56:59], v5, s[36:39], s17 offen offset:768
    buffer_load_dwordx4 v[60:63], v5, s[36:39], s17 offen offset:832
    s_lshl_b32 s18, s3, 10
    v_lshlrev_b32 v188, 4, v0
    v_add_u32 v188, s18, v188
    v_mov_b32 v184, 0
    v_mov_b32 v185, 0
    v_mov_b32 v186, 0
    v_mov_b32 v187, 0
    s_lshl_b32 s17, s15, 12
    s_add_u32 s17, s17, 73957376
k1_fillc:
    s_cmp_ge_u32 s17, 74121216
    s_cbranch_scc1 k1_fillec
    buffer_store_dwordx4 v[184:187], v188, s[4:7], s17 offen sc1
    s_add_u32 s17, s17, 131072
    s_branch k1_fillc
k1_fillec:
    s_waitcnt vmcnt(0)
    s_barrier
    s_load_dwordx2 s[8:9], s[0:1], 96
    s_mov_b32 s10, 256
    s_mov_b32 s11, 0x00020000
    s_getreg_b32 s12, hwreg(HW_REG_XCC_ID)
    s_and_b32 s12, s12, 15
    s_add_u32 s12, s12, 1
    v_mov_b32 v184, s12
    s_lshl_b32 s13, s15, 2
    v_mov_b32 v185, s13
    s_waitcnt lgkmcnt(0)
    buffer_store_dword v184, v185, s[8:11], 0 offen sc1
    s_waitcnt vmcnt(0)
    s_mov_b32 s27, 0xffff0000
    v_mov_b64 v[92:93], 0
    s_mov_b32 s25, 0
lnl_1:
    s_set_gpr_idx_on s25, gpr_idx(SRC0)
    s_nop 0
    v_mov_b32 v64, v8
    v_mov_b32 v65, v9
    v_mov_b32 v66, v10
    v_mov_b32 v67, v11
    v_mov_b32 v68, v12
    v_mov_b32 v69, v13
    v_mov_b32 v70, v14
    v_mov_b32 v71, v15
    s_set_gpr_idx_off
    v_lshlrev_b32 v72, 16, v64
    v_and_b32 v73, s27, v64
    v_lshlrev_b32 v74, 16, v65
    v_and_b32 v75, s27, v65
    v_lshlrev_b32 v76, 16, v66
    v_and_b32 v77, s27, v66
    v_lshlrev_b32 v78, 16, v67
    v_and_b32 v79, s27, v67
    v_lshlrev_b32 v80, 16, v68
    v_and_b32 v81, s27, v68
    v_lshlrev_b32 v82, 16, v69
    v_and_b32 v83, s27, v69
    v_lshlrev_b32 v84, 16, v70
    v_and_b32 v85, s27, v70
    v_lshlrev_b32 v86, 16, v71
    v_and_b32 v87, s27, v71
    v_pk_add_f32 v[92:93], v[92:93], v[72:73]
    v_pk_add_f32 v[92:93], v[92:93], v[74:75]
    v_pk_add_f32 v[92:93], v[92:93], v[76:77]
    v_pk_add_f32 v[92:93], v[92:93], v[78:79]
    v_pk_add_f32 v[92:93], v[92:93], v[80:81]
    v_pk_add_f32 v[92:93], v[92:93], v[82:83]
    v_pk_add_f32 v[92:93], v[92:93], v[84:85]
    v_pk_add_f32 v[92:93], v[92:93], v[86:87]
    s_add_u32 s25, s25, 8
    s_cmp_lt_u32 s25, 56
    s_cbranch_scc1 lnl_1
    v_add_f32 v92, v92, v93
    v_mov_b32 v93, v92
    s_nop 1
    v_permlane16_swap_b32 v92, v93
    s_nop 1
    v_add_f32 v92, v92, v93
    v_mov_b32 v93, v92
    s_nop 1
    v_permlane32_swap_b32 v92, v93
    s_nop 1
    v_add_f32 v92, v92, v93
    v_mul_f32 v94, 0xbb124925, v92
    v_mov_b64 v[92:93], 0
    s_mov_b32 s25, 0
lnl_2:
    s_set_gpr_idx_on s25, gpr_idx(SRC0)
    s_nop 0
    v_mov_b32 v64, v8
    v_mov_b32 v65, v9
    v_mov_b32 v66, v10
    v_mov_b32 v67, v11
    v_mov_b32 v68, v12
    v_mov_b32 v69, v13
    v_mov_b32 v70, v14
    v_mov_b32 v71, v15
    s_set_gpr_idx_off
    v_lshlrev_b32 v72, 16, v64
    v_and_b32 v73, s27, v64
    v_lshlrev_b32 v74, 16, v65
    v_and_b32 v75, s27, v65
    v_lshlrev_b32 v76, 16, v66
    v_and_b32 v77, s27, v66
    v_lshlrev_b32 v78, 16, v67
    v_and_b32 v79, s27, v67
    v_lshlrev_b32 v80, 16, v68
    v_and_b32 v81, s27, v68
    v_lshlrev_b32 v82, 16, v69
    v_and_b32 v83, s27, v69
    v_lshlrev_b32 v84, 16, v70
    v_and_b32 v85, s27, v70
    v_lshlrev_b32 v86, 16, v71
    v_and_b32 v87, s27, v71
    v_pk_add_f32 v[72:73], v[72:73], v[94:95] op_sel_hi:[1,0]
    v_pk_add_f32 v[74:75], v[74:75], v[94:95] op_sel_hi:[1,0]
    v_pk_add_f32 v[76:77], v[76:77], v[94:95] op_sel_hi:[1,0]
    v_pk_add_f32 v[78:79], v[78:79], v[94:95] op_sel_hi:[1,0]
    v_pk_add_f32 v[80:81], v[80:81], v[94:95] op_sel_hi:[1,0]
    v_pk_add_f32 v[82:83], v[82:83], v[94:95] op_sel_hi:[1,0]
    v_pk_add_f32 v[84:85], v[84:85], v[94:95] op_sel_hi:[1,0]
    v_pk_add_f32 v[86:87], v[86:87], v[94:95] op_sel_hi:[1,0]
    v_pk_fma_f32 v[92:93], v[72:73], v[72:73], v[92:93]
    v_pk_fma_f32 v[92:93], v[74:75], v[74:75], v[92:93]
    v_pk_fma_f32 v[92:93], v[76:77], v[76:77], v[92:93]
    v_pk_fma_f32 v[92:93], v[78:79], v[78:79], v[92:93]
    v_pk_fma_f32 v[92:93], v[80:81], v[80:81], v[92:93]
    v_pk_fma_f32 v[92:93], v[82:83], v[82:83], v[92:93]
    v_pk_fma_f32 v[92:93], v[84:85], v[84:85], v[92:93]
    v_pk_fma_f32 v[92:93], v[86:87], v[86:87], v[92:93]
    s_add_u32 s25, s25, 8
    s_cmp_lt_u32 s25, 56
    s_cbranch_scc1 lnl_2
    v_add_f32 v92, v92, v93
    v_mov_b32 v93, v92
    s_nop 1
    v_permlane16_swap_b32 v92, v93
    s_nop 1
    v_add_f32 v92, v92, v93
    v_mov_b32 v93, v92
    s_nop 1
    v_permlane32_swap_b32 v92, v93
    s_nop 1
    v_add_f32 v92, v92, v93
    v_mul_f32 v92, 0x3b124925, v92
    v_cvt_pk_bf16_f32 v94, v94, v92
    v_and_b32 v92, s27, v94
    v_lshlrev_b32 v94, 16, v94
    v_add_f32 v92, 0x3727c5ac, v92
    v_cvt_pk_bf16_f32 v92, v92, v92
    v_and_b32 v92, s27, v92
    v_sqrt_f32 v92, v92
    s_nop 0
    v_cvt_pk_bf16_f32 v92, v92, v92
    v_and_b32 v92, s27, v92
    v_rcp_f32 v96, v92
    s_nop 0
    v_fma_f32 v93, -v92, v96, 1.0
    v_fma_f32 v96, v93, v96, v96
    s_mul_i32 s18, s16, 14336
    s_add_u32 s18, s18, 1835008
    v_and_b32 v5, 1, v2
    v_lshlrev_b32 v5, 9, v5
    v_lshrrev_b32 v6, 1, v2
    v_lshl_add_u32 v5, v6, 8, v5
    v_lshrrev_b32 v6, 1, v3
    v_lshl_add_u32 v6, v6, 4, v5
    v_and_b32 v7, 1, v3
    v_lshl_add_u32 v6, v7, 10, v6
    v_cmp_eq_u32 s[22:23], 1, v7
    v_lshl_add_u32 v5, v3, 4, v5
    s_lshr_b32 s19, s16, 1
    s_mul_i32 s19, s19, 28672
    s_and_b32 s24, s16, 1
    s_lshl_b32 s24, s24, 7
    s_add_u32 s19, s19, s24
    s_add_u32 s19, s19, 3670016
    s_mov_b32 s25, 0
lnl_3:
    s_set_gpr_idx_on s25, gpr_idx(SRC0)
    s_nop 0
    v_mov_b32 v64, v8
    v_mov_b32 v65, v9
    v_mov_b32 v66, v10
    v_mov_b32 v67, v11
    v_mov_b32 v68, v12
    v_mov_b32 v69, v13
    v_mov_b32 v70, v14
    v_mov_b32 v71, v15
    s_set_gpr_idx_off
    v_lshlrev_b32 v72, 16, v64
    v_and_b32 v73, s27, v64
    v_lshlrev_b32 v74, 16, v65
    v_and_b32 v75, s27, v65
    v_lshlrev_b32 v76, 16, v66
    v_and_b32 v77, s27, v66
    v_lshlrev_b32 v78, 16, v67
    v_and_b32 v79, s27, v67
    v_lshlrev_b32 v80, 16, v68
    v_and_b32 v81, s27, v68
    v_lshlrev_b32 v82, 16, v69
    v_and_b32 v83, s27, v69
    v_lshlrev_b32 v84, 16, v70
    v_and_b32 v85, s27, v70
    v_lshlrev_b32 v86, 16, v71
    v_and_b32 v87, s27, v71
    v_pk_add_f32 v[72:73], v[72:73], v[94:95] op_sel_hi:[1,0]
    v_pk_add_f32 v[74:75], v[74:75], v[94:95] op_sel_hi:[1,0]
    v_pk_add_f32 v[76:77], v[76:77], v[94:95] op_sel_hi:[1,0]
    v_pk_add_f32 v[78:79], v[78:79], v[94:95] op_sel_hi:[1,0]
    v_pk_add_f32 v[80:81], v[80:81], v[94:95] op_sel_hi:[1,0]
    v_pk_add_f32 v[82:83], v[82:83], v[94:95] op_sel_hi:[1,0]
    v_pk_add_f32 v[84:85], v[84:85], v[94:95] op_sel_hi:[1,0]
    v_pk_add_f32 v[86:87], v[86:87], v[94:95] op_sel_hi:[1,0]
    v_cvt_pk_bf16_f32 v64, v72, v73
    v_cvt_pk_bf16_f32 v65, v74, v75
    v_cvt_pk_bf16_f32 v66, v76, v77
    v_cvt_pk_bf16_f32 v67, v78, v79
    v_cvt_pk_bf16_f32 v68, v80, v81
    v_cvt_pk_bf16_f32 v69, v82, v83
    v_cvt_pk_bf16_f32 v70, v84, v85
    v_cvt_pk_bf16_f32 v71, v86, v87
    v_lshlrev_b32 v72, 16, v64
    v_and_b32 v73, s27, v64
    v_lshlrev_b32 v74, 16, v65
    v_and_b32 v75, s27, v65
    v_lshlrev_b32 v76, 16, v66
    v_and_b32 v77, s27, v66
    v_lshlrev_b32 v78, 16, v67
    v_and_b32 v79, s27, v67
    v_lshlrev_b32 v80, 16, v68
    v_and_b32 v81, s27, v68
    v_lshlrev_b32 v82, 16, v69
    v_and_b32 v83, s27, v69
    v_lshlrev_b32 v84, 16, v70
    v_and_b32 v85, s27, v70
    v_lshlrev_b32 v86, 16, v71
    v_and_b32 v87, s27, v71
    v_pk_mul_f32 v[72:73], v[72:73], v[96:97] op_sel_hi:[1,0]
    v_pk_mul_f32 v[74:75], v[74:75], v[96:97] op_sel_hi:[1,0]
    v_pk_mul_f32 v[76:77], v[76:77], v[96:97] op_sel_hi:[1,0]
    v_pk_mul_f32 v[78:79], v[78:79], v[96:97] op_sel_hi:[1,0]
    v_pk_mul_f32 v[80:81], v[80:81], v[96:97] op_sel_hi:[1,0]
    v_pk_mul_f32 v[82:83], v[82:83], v[96:97] op_sel_hi:[1,0]
    v_pk_mul_f32 v[84:85], v[84:85], v[96:97] op_sel_hi:[1,0]
    v_pk_mul_f32 v[86:87], v[86:87], v[96:97] op_sel_hi:[1,0]
    v_cvt_pk_bf16_f32 v112, v72, v73
    v_cvt_pk_bf16_f32 v113, v74, v75
    v_cvt_pk_bf16_f32 v114, v76, v77
    v_cvt_pk_bf16_f32 v115, v78, v79
    v_cvt_pk_bf16_f32 v116, v80, v81
    v_cvt_pk_bf16_f32 v117, v82, v83
    v_cvt_pk_bf16_f32 v118, v84, v85
    v_cvt_pk_bf16_f32 v119, v86, v87
    s_nop 1
    v_permlane32_swap_b32 v112, v114
    v_permlane32_swap_b32 v113, v115
    v_permlane32_swap_b32 v116, v118
    v_permlane32_swap_b32 v117, v119
    s_nop 1
    buffer_store_dwordx4 v[112:115], v5, s[4:7], s18 offen offset:0 sc1
    v_cndmask_b32 v108, v114, v112, s[22:23]
    v_cndmask_b32 v109, v115, v113, s[22:23]
    s_nop 1
    v_mov_b32_dpp v110, v108 quad_perm:[1,0,3,2] row_mask:0xf bank_mask:0xf
    v_mov_b32_dpp v111, v109 quad_perm:[1,0,3,2] row_mask:0xf bank_mask:0xf
    v_cndmask_b32 v100, v112, v110, s[22:23]
    v_cndmask_b32 v101, v110, v114, s[22:23]
    v_cndmask_b32 v102, v113, v111, s[22:23]
    v_cndmask_b32 v103, v111, v115, s[22:23]
    buffer_store_dwordx4 v[100:103], v6, s[4:7], s19 offen offset:0 sc1
    buffer_store_dwordx4 v[116:119], v5, s[4:7], s18 offen offset:1024 sc1
    v_cndmask_b32 v108, v118, v116, s[22:23]
    v_cndmask_b32 v109, v119, v117, s[22:23]
    s_nop 1
    v_mov_b32_dpp v110, v108 quad_perm:[1,0,3,2] row_mask:0xf bank_mask:0xf
    v_mov_b32_dpp v111, v109 quad_perm:[1,0,3,2] row_mask:0xf bank_mask:0xf
    v_cndmask_b32 v104, v116, v110, s[22:23]
    v_cndmask_b32 v105, v110, v118, s[22:23]
    v_cndmask_b32 v106, v117, v111, s[22:23]
    v_cndmask_b32 v107, v111, v119, s[22:23]
    buffer_store_dwordx4 v[104:107], v6, s[4:7], s19 offen offset:2048 sc1
    s_add_u32 s18, s18, 2048
    s_add_u32 s19, s19, 4096
    s_add_u32 s25, s25, 8
    s_cmp_lt_u32 s25, 56
    s_cbranch_scc1 lnl_3
    v_and_b32 v5, 31, v0
    v_lshlrev_b32 v5, 2, v5
    s_mov_b32 s35, 400000
ww_4:
    buffer_load_dword v1, v5, s[8:11], 0 offen sc1
    s_waitcnt vmcnt(0)
    v_cmp_eq_u32 vcc, 0, v1
    s_cbranch_vccz wwo_5
    s_sleep 4
    s_sub_u32 s35, s35, 1
    s_cmp_lg_u32 s35, 0
    s_cbranch_scc1 ww_4
    s_branch k2_end
wwo_5:
    s_lshl_b32 s17, s16, 2
    s_add_u32 s17, s17, 74051584
    v_mov_b32 v1, 1
    v_mov_b32 v5, 0
    s_mov_b64 exec, 1
    buffer_store_dword v1, v5, s[4:7], s17 offen sc1
    s_mov_b64 exec, -1
    v_lshlrev_b32 v1, 4, v0
    s_cmp_lt_u32 s15, 30
    s_cbranch_scc1 ch_noinit
    v_lshrrev_b32 v2, 4, v0
    v_and_b32 v3, 15, v0
    v_lshlrev_b32 v4, 4, v0
    s_mov_b32 s20, 0x05040100
    s_mov_b32 s21, 0x07060302
    s_load_dwordx2 s[36:37], s[0:1], 8
    s_mov_b32 s38, 7168
    s_mov_b32 s39, 0x00020000
    s_lshl_b32 s16, s3, 6
    v_add_u32 v5, s16, v0
    v_mov_b32 v8, -1
    v_mov_b32 v9, -1
    v_mov_b32 v10, -1
    v_mov_b32 v11, -1
    v_lshlrev_b32 v6, 4, v5
    s_sub_u32 s22, s15, 30
    s_waitcnt lgkmcnt(0)
    s_cmp_lg_u32 s22, 0
    s_cbranch_scc1 k1_iend
    v_add_u32 v7, 0, v5
    v_and_b32 v16, 7, v7
    v_mul_u32_u24 v16, 896, v16
    v_lshrrev_b32 v17, 3, v7
    v_lshl_add_u32 v16, v17, 4, v16
    v_lshlrev_b32 v17, 4, v7
    v_cmp_gt_u32 vcc, 448, v7
    s_and_saveexec_b64 s[18:19], vcc
    s_cbranch_execz k1_skip_6
    buffer_load_dwordx4 v[20:23], v16, s[36:39], 0 offen
    s_waitcnt vmcnt(0)
    v_min_u32 v20, 0xfffffffe, v20
    v_min_u32 v21, 0xfffffffe, v21
    v_min_u32 v22, 0xfffffffe, v22
    v_min_u32 v23, 0xfffffffe, v23
    s_mov_b32 s17, 73760768
    buffer_store_dwordx4 v[20:23], v17, s[4:7], s17 offen sc1
    s_mov_b32 s17, 73768960
    buffer_store_dwordx4 v[20:23], v17, s[4:7], s17 offen sc1
    s_mov_b32 s17, 62226432
    buffer_store_dwordx4 v[20:23], v17, s[4:7], s17 offen sc1
    s_mov_b32 s17, 62750720
    buffer_store_dwordx4 v[20:23], v17, s[4:7], s17 offen sc1
    s_waitcnt vmcnt(0)
k1_skip_6:
    s_mov_b64 exec, s[18:19]
    v_add_u32 v7, 256, v5
    v_and_b32 v16, 7, v7
    v_mul_u32_u24 v16, 896, v16
    v_lshrrev_b32 v17, 3, v7
    v_lshl_add_u32 v16, v17, 4, v16
    v_lshlrev_b32 v17, 4, v7
    v_cmp_gt_u32 vcc, 448, v7
    s_and_saveexec_b64 s[18:19], vcc
    s_cbranch_execz k1_skip_7
    buffer_load_dwordx4 v[20:23], v16, s[36:39], 0 offen
    s_waitcnt vmcnt(0)
    v_min_u32 v20, 0xfffffffe, v20
    v_min_u32 v21, 0xfffffffe, v21
    v_min_u32 v22, 0xfffffffe, v22
    v_min_u32 v23, 0xfffffffe, v23
    s_mov_b32 s17, 73760768
    buffer_store_dwordx4 v[20:23], v17, s[4:7], s17 offen sc1
    s_mov_b32 s17, 73768960
    buffer_store_dwordx4 v[20:23], v17, s[4:7], s17 offen sc1
    s_mov_b32 s17, 62226432
    buffer_store_dwordx4 v[20:23], v17, s[4:7], s17 offen sc1
    s_mov_b32 s17, 62750720
    buffer_store_dwordx4 v[20:23], v17, s[4:7], s17 offen sc1
    s_waitcnt vmcnt(0)
k1_skip_7:
    s_mov_b64 exec, s[18:19]
k1_iend:
    v_lshlrev_b32 v1, 4, v0
    s_sub_u32 s16, s15, 30
    s_lshl_b32 s16, s16, 2
    s_add_u32 s16, s16, s3
    s_min_u32 s16, s16, 6
    s_lshl_b32 s16, s16, 9
    s_add_u32 s17, s16, 73977856
    v_lshlrev_b32 v16, 2, v0
    v_add_u32 v16, s17, v16
    s_mov_b32 s35, 400000
ww_8:
    buffer_load_dword v17, v16, s[4:7], 0 offen sc1
    s_waitcnt vmcnt(0)
    v_cmp_eq_u32 vcc, 0, v17
    s_cbranch_vccz wwo_9
    s_sleep 16
    s_sub_u32 s35, s35, 1
    s_cmp_lg_u32 s35, 0
    s_cbranch_scc1 ww_8
    s_branch k2_end
wwo_9:
    s_add_u32 s17, s16, 73978112
    v_lshlrev_b32 v16, 2, v0
    v_add_u32 v16, s17, v16
    s_mov_b32 s35, 400000
ww_10:
    buffer_load_dword v17, v16, s[4:7], 0 offen sc1
    s_waitcnt vmcnt(0)
    v_cmp_eq_u32 vcc, 0, v17
    s_cbranch_vccz wwo_11
    s_sleep 16
    s_sub_u32 s35, s35, 1
    s_cmp_lg_u32 s35, 0
    s_cbranch_scc1 ww_10
    s_branch k2_end
wwo_11:
    s_barrier
    v_mov_b32 v16, 1
    s_add_u32 s13, s13, 128
    v_mov_b32 v17, s13
    buffer_store_dword v16, v17, s[8:11], 0 offen sc1
ch_noinit:
    v_and_b32 v11, 8, v0
    v_cmp_eq_u32 vcc, 0, v11
    v_mov_b32 v2, 0xeeee
    v_mov_b32 v11, 0x4444
    v_cndmask_b32 v2, v2, v11, vcc
    v_lshrrev_b32 v11, 4, v0
    v_lshlrev_b32 v8, 7, v11
    v_and_b32 v11, 7, v0
    v_lshl_add_u32 v8, v11, 4, v8
    s_mul_i32 s16, s3, 112
    v_add_u32 v3, s16, v0
    v_lshlrev_b32 v3, 4, v3
    v_min_u32 v4, 47, v0
    v_add_u32 v4, s16, v4
    v_add_u32 v4, 64, v4
    v_lshlrev_b32 v4, 4, v4
    v_min_u32 v5, 13, v0
    v_lshlrev_b32 v5, 2, v5
    s_mov_b32 s40, 73965568
    s_mov_b32 s41, 73957376
    s_lshl_b32 s16, s15, 8
    s_add_u32 s46, s40, s16
    s_add_u32 s47, s41, s16
    s_mov_b64 s[42:43], 0xffff
    s_mov_b32 s72, 0
    s_mov_b32 s73, 0x0fffffff
    v_min_u32 v1, 31, v0
    v_lshlrev_b32 v1, 2, v1
    s_mov_b32 s30, 200000
mg_12:
    buffer_load_dword v11, v1, s[8:11], 0 offen sc1
    s_sub_u32 s30, s30, 1
    s_cmp_eq_u32 s30, 0
    s_cbranch_scc1 k2_end
    s_waitcnt vmcnt(0)
    v_cmp_eq_u32 vcc, 0, v11
    s_cbranch_vccnz mg_12
    v_cmp_ne_u32 vcc, s12, v11
    s_cmp_eq_u64 vcc, 0
    s_cselect_b32 s14, 1, 0
    v_lshlrev_b32 v1, 4, v0
    s_cmp_lt_u32 s15, 30
    s_cbranch_scc1 ch_main
    v_and_b32 v13, 1, v0
    v_lshlrev_b32 v13, 2, v13
    v_add_u32 v13, 248, v13
    s_mov_b32 s30, 400000
ww_13:
    buffer_load_dword v11, v13, s[8:11], 0 offen sc1
    s_waitcnt vmcnt(0)
    v_cmp_eq_u32 vcc, 0, v11
    s_cbranch_vccz wwo_14
    s_sleep 4
    s_sub_u32 s30, s30, 1
    s_cmp_lg_u32 s30, 0
    s_cbranch_scc1 ww_13
    s_branch k2_end
wwo_14:
    s_sub_u32 s17, s15, 30
    s_lshl_b32 s17, s17, 2
    s_add_u32 s17, s17, s3
    v_lshlrev_b32 v6, 7, v0
    v_lshlrev_b32 v12, 4, v0
    s_cmp_lg_u32 s17, 0
    s_cbranch_scc1 fw_pf
    s_mov_b32 s20, 1
    s_mov_b32 s22, 73990144
fw_m_loop:
    s_lshl_b32 s24, s20, 13
    s_add_u32 s26, s24, 62750720
    s_add_u32 s24, s24, 62226432
    s_add_u32 s25, s24, 4096
    s_add_u32 s27, s26, 4096
    s_mov_b32 s30, 800000
fw_m_poll:
    buffer_load_dwordx4 v[16:19], v12, s[4:7], s24 offen offset:0 sc1
    buffer_load_dwordx4 v[20:23], v12, s[4:7], s24 offen offset:1024 sc1
    buffer_load_dwordx4 v[24:27], v12, s[4:7], s24 offen offset:2048 sc1
    buffer_load_dwordx4 v[28:31], v12, s[4:7], s24 offen offset:3072 sc1
    buffer_load_dwordx4 v[32:35], v12, s[4:7], s25 offen offset:0 sc1
    buffer_load_dwordx4 v[36:39], v12, s[4:7], s25 offen offset:1024 sc1
    buffer_load_dwordx4 v[40:43], v12, s[4:7], s25 offen offset:2048 sc1
    s_sub_u32 s30, s30, 1
    s_cmp_eq_u32 s30, 0
    s_cbranch_scc1 k2_end
    s_waitcnt vmcnt(0)
    v_max_u32 v1, v16, v17
    v_max3_u32 v1, v1, v18, v19
    v_max3_u32 v1, v1, v20, v21
    v_max3_u32 v1, v1, v22, v23
    v_max3_u32 v1, v1, v24, v25
    v_max3_u32 v1, v1, v26, v27
    v_max3_u32 v1, v1, v28, v29
    v_max3_u32 v1, v1, v30, v31
    v_max3_u32 v1, v1, v32, v33
    v_max3_u32 v1, v1, v34, v35
    v_max3_u32 v1, v1, v36, v37
    v_max3_u32 v1, v1, v38, v39
    v_max3_u32 v1, v1, v40, v41
    v_max3_u32 v1, v1, v42, v43
    v_cmp_eq_u32 vcc, -1, v1
    s_cbranch_vccz fw_m_ok
    s_sleep 2
    s_branch fw_m_poll
fw_m_ok:
    buffer_store_dwordx4 v[16:19], v12, s[4:7], s26 offen offset:0 sc1
    buffer_store_dwordx4 v[20:23], v12, s[4:7], s26 offen offset:1024 sc1
    buffer_store_dwordx4 v[24:27], v12, s[4:7], s26 offen offset:2048 sc1
    buffer_store_dwordx4 v[28:31], v12, s[4:7], s26 offen offset:3072 sc1
    buffer_store_dwordx4 v[32:35], v12, s[4:7], s27 offen offset:0 sc1
    buffer_store_dwordx4 v[36:39], v12, s[4:7], s27 offen offset:1024 sc1
    buffer_store_dwordx4 v[40:43], v12, s[4:7], s27 offen offset:2048 sc1
    s_waitcnt vmcnt(0)
    v_mov_b32 v1, s20
    s_mov_b64 exec, 0xffff
    buffer_store_dword v1, v6, s[4:7], s22 offen sc1
    s_mov_b64 exec, -1
    s_add_u32 s20, s20, 1
    s_cmp_lt_u32 s20, 64
    s_cbranch_scc1 fw_m_loop
    s_branch k2_end
fw_pf:
    s_cmp_lg_u32 s17, 4
    s_cbranch_scc1 k2_end
    v_mov_b32 v13, 0
    v_lshlrev_b32 v14, 3, v0
    v_add_u32 v14, 74051584, v14
    s_mov_b32 s30, 400000
ww_15:
    buffer_load_dword v11, v13, s[8:11], 0 offen sc1
    buffer_load_dwordx2 v[16:17], v14, s[4:7], 0 offen sc1
    s_waitcnt vmcnt(0)
    v_min3_u32 v11, v11, v16, v17
    v_cmp_eq_u32 vcc, 0, v11
    s_cbranch_vccz wwo_16
    s_sleep 16
    s_sub_u32 s30, s30, 1
    s_cmp_lg_u32 s30, 0
    s_cbranch_scc1 ww_15
    s_branch k2_end
wwo_16:
    s_mov_b32 s30, 800000
    s_mov_b32 s20, 0
    v_mov_b32 v7, 0
fw_pf_loop:
    s_mov_b64 exec, 1
    buffer_load_dword v16, v7, s[4:7], s46 offen sc1
    s_mov_b64 exec, -1
    s_waitcnt vmcnt(0)
    v_readfirstlane_b32 s21, v16
    s_cmp_ge_u32 s20, 63
    s_cbranch_scc1 k2_end
    s_add_u32 s22, s21, 3
    s_cmp_gt_u32 s20, s22
    s_cbranch_scc1 fw_pf_idle
    s_mul_i32 s24, s20, 28672
    s_add_u32 s24, s24, 3670016
    buffer_load_dwordx4 v[16:19], v12, s[4:7], s24 offen offset:0
    buffer_load_dwordx4 v[20:23], v12, s[4:7], s24 offen offset:1024
    buffer_load_dwordx4 v[24:27], v12, s[4:7], s24 offen offset:2048
    buffer_load_dwordx4 v[28:31], v12, s[4:7], s24 offen offset:3072
    s_add_u32 s24, s24, 4096
    buffer_load_dwordx4 v[16:19], v12, s[4:7], s24 offen offset:0
    buffer_load_dwordx4 v[20:23], v12, s[4:7], s24 offen offset:1024
    buffer_load_dwordx4 v[24:27], v12, s[4:7], s24 offen offset:2048
    buffer_load_dwordx4 v[28:31], v12, s[4:7], s24 offen offset:3072
    s_add_u32 s24, s24, 4096
    buffer_load_dwordx4 v[16:19], v12, s[4:7], s24 offen offset:0
    buffer_load_dwordx4 v[20:23], v12, s[4:7], s24 offen offset:1024
    buffer_load_dwordx4 v[24:27], v12, s[4:7], s24 offen offset:2048
    buffer_load_dwordx4 v[28:31], v12, s[4:7], s24 offen offset:3072
    s_add_u32 s24, s24, 4096
    buffer_load_dwordx4 v[16:19], v12, s[4:7], s24 offen offset:0
    buffer_load_dwordx4 v[20:23], v12, s[4:7], s24 offen offset:1024
    buffer_load_dwordx4 v[24:27], v12, s[4:7], s24 offen offset:2048
    buffer_load_dwordx4 v[28:31], v12, s[4:7], s24 offen offset:3072
    s_add_u32 s24, s24, 4096
    buffer_load_dwordx4 v[16:19], v12, s[4:7], s24 offen offset:0
    buffer_load_dwordx4 v[20:23], v12, s[4:7], s24 offen offset:1024
    buffer_load_dwordx4 v[24:27], v12, s[4:7], s24 offen offset:2048
    buffer_load_dwordx4 v[28:31], v12, s[4:7], s24 offen offset:3072
    s_add_u32 s24, s24, 4096
    buffer_load_dwordx4 v[16:19], v12, s[4:7], s24 offen offset:0
    buffer_load_dwordx4 v[20:23], v12, s[4:7], s24 offen offset:1024
    buffer_load_dwordx4 v[24:27], v12, s[4:7], s24 offen offset:2048
    buffer_load_dwordx4 v[28:31], v12, s[4:7], s24 offen offset:3072
    s_add_u32 s24, s24, 4096
    buffer_load_dwordx4 v[16:19], v12, s[4:7], s24 offen offset:0
    buffer_load_dwordx4 v[20:23], v12, s[4:7], s24 offen offset:1024
    buffer_load_dwordx4 v[24:27], v12, s[4:7], s24 offen offset:2048
    buffer_load_dwordx4 v[28:31], v12, s[4:7], s24 offen offset:3072
    s_add_u32 s24, s24, 4096
    s_add_u32 s20, s20, 1
    s_branch fw_pf_loop
fw_pf_idle:
    s_sleep 8
    s_sub_u32 s30, s30, 1
    s_cmp_eq_u32 s30, 0
    s_cbranch_scc1 k2_end
    s_branch fw_pf_loop
ch_main:
    s_cmp_ge_u32 s15, 16
    s_cbranch_scc1 ch_value
    s_mov_b32 s17, s15
    s_mul_i32 s18, s17, 401408
    s_add_u32 s18, s18, 5505024
    s_mul_i32 s19, s3, 57344
    s_add_u32 s18, s18, s19
    s_cmp_eq_u32 s3, 3
    s_cbranch_scc1 w3_17
    s_lshl_b32 s19, s17, 3
    s_add_u32 s19, s19, s3
    s_add_u32 s19, s19, 0
    s_lshl_b32 s19, s19, 7
    v_and_b32 v13, 31, v0
    v_min_u32 v13, 27, v13
    v_lshlrev_b32 v13, 2, v13
    s_add_u32 s19, s19, 74055680
    v_add_u32 v13, s19, v13
    s_mov_b32 s35, 400000
ww_19:
    buffer_load_dword v11, v13, s[4:7], 0 offen sc1
    s_waitcnt vmcnt(0)
    v_cmp_eq_u32 vcc, 0, v11
    s_cbranch_vccz wwo_20
    s_sleep 16
    s_sub_u32 s35, s35, 1
    s_cmp_lg_u32 s35, 0
    s_cbranch_scc1 ww_19
    s_branch k2_end
wwo_20:
    s_add_u32 s22, s18, 0
    s_add_u32 s23, s18, 28672
    buffer_load_dwordx4 v[64:67], v1, s[4:7], s22 offen offset:0
    buffer_load_dwordx4 v[68:71], v1, s[4:7], s23 offen offset:0
    buffer_load_dwordx4 v[72:75], v1, s[4:7], s22 offen offset:1024
    buffer_load_dwordx4 v[76:79], v1, s[4:7], s23 offen offset:1024
    buffer_load_dwordx4 v[80:83], v1, s[4:7], s22 offen offset:2048
    buffer_load_dwordx4 v[84:87], v1, s[4:7], s23 offen offset:2048
    buffer_load_dwordx4 v[88:91], v1, s[4:7], s22 offen offset:3072
    buffer_load_dwordx4 v[92:95], v1, s[4:7], s23 offen offset:3072
    s_add_u32 s22, s18, 4096
    s_add_u32 s23, s18, 32768
    buffer_load_dwordx4 v[96:99], v1, s[4:7], s22 offen offset:0
    buffer_load_dwordx4 v[100:103], v1, s[4:7], s23 offen offset:0
    buffer_load_dwordx4 v[104:107], v1, s[4:7], s22 offen offset:1024
    buffer_load_dwordx4 v[108:111], v1, s[4:7], s23 offen offset:1024
    buffer_load_dwordx4 v[112:115], v1, s[4:7], s22 offen offset:2048
    buffer_load_dwordx4 v[116:119], v1, s[4:7], s23 offen offset:2048
    buffer_load_dwordx4 v[120:123], v1, s[4:7], s22 offen offset:3072
    buffer_load_dwordx4 v[124:127], v1, s[4:7], s23 offen offset:3072
    s_add_u32 s22, s18, 8192
    s_add_u32 s23, s18, 36864
    buffer_load_dwordx4 v[128:131], v1, s[4:7], s22 offen offset:0
    buffer_load_dwordx4 v[132:135], v1, s[4:7], s23 offen offset:0
    buffer_load_dwordx4 v[136:139], v1, s[4:7], s22 offen offset:1024
    buffer_load_dwordx4 v[140:143], v1, s[4:7], s23 offen offset:1024
    buffer_load_dwordx4 v[144:147], v1, s[4:7], s22 offen offset:2048
    buffer_load_dwordx4 v[148:151], v1, s[4:7], s23 offen offset:2048
    buffer_load_dwordx4 v[152:155], v1, s[4:7], s22 offen offset:3072
    buffer_load_dwordx4 v[156:159], v1, s[4:7], s23 offen offset:3072
    s_add_u32 s22, s18, 12288
    s_add_u32 s23, s18, 40960
    buffer_load_dwordx4 v[160:163], v1, s[4:7], s22 offen offset:0
    buffer_load_dwordx4 v[164:167], v1, s[4:7], s23 offen offset:0
    buffer_load_dwordx4 v[168:171], v1, s[4:7], s22 offen offset:1024
    buffer_load_dwordx4 v[172:175], v1, s[4:7], s23 offen offset:1024
    s_add_u32 s22, s18, 14336
    s_add_u32 s23, s18, 43008
    buffer_load_dwordx4 v[176:179], v1, s[4:7], s22 offen offset:0
    buffer_load_dwordx4 v[180:183], v1, s[4:7], s23 offen offset:0
    buffer_load_dwordx4 v[184:187], v1, s[4:7], s22 offen offset:1024
    buffer_load_dwordx4 v[188:191], v1, s[4:7], s23 offen offset:1024
    buffer_load_dwordx4 v[192:195], v1, s[4:7], s22 offen offset:2048
    buffer_load_dwordx4 v[196:199], v1, s[4:7], s23 offen offset:2048
    buffer_load_dwordx4 v[200:203], v1, s[4:7], s22 offen offset:3072
    buffer_load_dwordx4 v[204:207], v1, s[4:7], s23 offen offset:3072
    s_add_u32 s22, s18, 18432
    s_add_u32 s23, s18, 47104
    buffer_load_dwordx4 v[208:211], v1, s[4:7], s22 offen offset:0
    buffer_load_dwordx4 v[212:215], v1, s[4:7], s23 offen offset:0
    buffer_load_dwordx4 v[216:219], v1, s[4:7], s22 offen offset:1024
    buffer_load_dwordx4 v[220:223], v1, s[4:7], s23 offen offset:1024
    buffer_load_dwordx4 v[224:227], v1, s[4:7], s22 offen offset:2048
    buffer_load_dwordx4 v[228:231], v1, s[4:7], s23 offen offset:2048
    buffer_load_dwordx4 v[232:235], v1, s[4:7], s22 offen offset:3072
    buffer_load_dwordx4 v[236:239], v1, s[4:7], s23 offen offset:3072
    s_add_u32 s22, s18, 22528
    s_add_u32 s23, s18, 51200
    buffer_load_dwordx4 v[240:243], v1, s[4:7], s22 offen offset:0
    buffer_load_dwordx4 v[244:247], v1, s[4:7], s23 offen offset:0
    buffer_load_dwordx4 v[248:251], v1, s[4:7], s22 offen offset:1024
    buffer_load_dwordx4 v[252:255], v1, s[4:7], s23 offen offset:1024
    buffer_load_dwordx4 a[0:3], v1, s[4:7], s22 offen offset:2048
    buffer_load_dwordx4 a[4:7], v1, s[4:7], s23 offen offset:2048
    buffer_load_dwordx4 a[8:11], v1, s[4:7], s22 offen offset:3072
    buffer_load_dwordx4 a[12:15], v1, s[4:7], s23 offen offset:3072
    s_add_u32 s22, s18, 26624
    s_add_u32 s23, s18, 55296
    buffer_load_dwordx4 a[16:19], v1, s[4:7], s22 offen offset:0
    buffer_load_dwordx4 a[20:23], v1, s[4:7], s23 offen offset:0
    buffer_load_dwordx4 a[24:27], v1, s[4:7], s22 offen offset:1024
    buffer_load_dwordx4 a[28:31], v1, s[4:7], s23 offen offset:1024
    s_lshl_b32 s19, s17, 3
    s_add_u32 s19, s19, s3
    s_add_u32 s19, s19, 4
    s_lshl_b32 s19, s19, 7
    v_and_b32 v13, 31, v0
    v_min_u32 v13, 27, v13
    v_lshlrev_b32 v13, 2, v13
    s_add_u32 s19, s19, 74055680
    v_add_u32 v13, s19, v13
    s_mov_b32 s35, 400000
ww_21:
    buffer_load_dword v11, v13, s[4:7], 0 offen sc1
    s_waitcnt vmcnt(0)
    v_cmp_eq_u32 vcc, 0, v11
    s_cbranch_vccz wwo_22
    s_sleep 16
    s_sub_u32 s35, s35, 1
    s_cmp_lg_u32 s35, 0
    s_cbranch_scc1 ww_21
    s_branch k2_end
wwo_22:
    s_add_u32 s22, s18, 229376
    s_add_u32 s23, s18, 243712
    buffer_load_dwordx4 a[32:35], v1, s[4:7], s22 offen offset:0
    buffer_load_dwordx4 a[36:39], v1, s[4:7], s23 offen offset:0
    buffer_load_dwordx4 a[40:43], v1, s[4:7], s22 offen offset:1024
    buffer_load_dwordx4 a[44:47], v1, s[4:7], s23 offen offset:1024
    buffer_load_dwordx4 a[48:51], v1, s[4:7], s22 offen offset:2048
    buffer_load_dwordx4 a[52:55], v1, s[4:7], s23 offen offset:2048
    s_waitcnt vmcnt(60)
    v_swap_b32 v65, v68
    v_swap_b32 v66, v68
    v_swap_b32 v67, v69
    v_swap_b32 v69, v70
    buffer_load_dwordx4 a[56:59], v1, s[4:7], s22 offen offset:3072
    buffer_load_dwordx4 a[60:63], v1, s[4:7], s23 offen offset:3072
    s_waitcnt vmcnt(60)
    v_swap_b32 v73, v76
    v_swap_b32 v74, v76
    v_swap_b32 v75, v77
    v_swap_b32 v77, v78
    s_add_u32 s22, s18, 233472
    s_add_u32 s23, s18, 247808
    buffer_load_dwordx4 a[64:67], v1, s[4:7], s22 offen offset:0
    buffer_load_dwordx4 a[68:71], v1, s[4:7], s23 offen offset:0
    s_waitcnt vmcnt(60)
    v_swap_b32 v81, v84
    v_swap_b32 v82, v84
    v_swap_b32 v83, v85
    v_swap_b32 v85, v86
    buffer_load_dwordx4 a[72:75], v1, s[4:7], s22 offen offset:1024
    buffer_load_dwordx4 a[76:79], v1, s[4:7], s23 offen offset:1024
    s_waitcnt vmcnt(60)
    v_swap_b32 v89, v92
    v_swap_b32 v90, v92
    v_swap_b32 v91, v93
    v_swap_b32 v93, v94
    buffer_load_dwordx4 a[80:83], v1, s[4:7], s22 offen offset:2048
    buffer_load_dwordx4 a[84:87], v1, s[4:7], s23 offen offset:2048
    s_waitcnt vmcnt(60)
    v_swap_b32 v97, v100
    v_swap_b32 v98, v100
    v_swap_b32 v99, v101
    v_swap_b32 v101, v102
    buffer_load_dwordx4 a[88:91], v1, s[4:7], s22 offen offset:3072
    buffer_load_dwordx4 a[92:95], v1, s[4:7], s23 offen offset:3072
    s_waitcnt vmcnt(60)
    v_swap_b32 v105, v108
    v_swap_b32 v106, v108
    v_swap_b32 v107, v109
    v_swap_b32 v109, v110
    s_add_u32 s22, s18, 237568
    s_add_u32 s23, s18, 251904
    buffer_load_dwordx4 a[96:99], v1, s[4:7], s22 offen offset:0
    buffer_load_dwordx4 a[100:103], v1, s[4:7], s23 offen offset:0
    s_waitcnt vmcnt(60)
    v_swap_b32 v113, v116
    v_swap_b32 v114, v116
    v_swap_b32 v115, v117
    v_swap_b32 v117, v118
    buffer_load_dwordx4 a[104:107], v1, s[4:7], s22 offen offset:1024
    buffer_load_dwordx4 a[108:111], v1, s[4:7], s23 offen offset:1024
    s_waitcnt vmcnt(60)
    v_swap_b32 v121, v124
    v_swap_b32 v122, v124
    v_swap_b32 v123, v125
    v_swap_b32 v125, v126
    buffer_load_dwordx4 a[112:115], v1, s[4:7], s22 offen offset:2048
    buffer_load_dwordx4 a[116:119], v1, s[4:7], s23 offen offset:2048
    s_waitcnt vmcnt(60)
    v_swap_b32 v129, v132
    v_swap_b32 v130, v132
    v_swap_b32 v131, v133
    v_swap_b32 v133, v134
    buffer_load_dwordx4 a[120:123], v1, s[4:7], s22 offen offset:3072
    buffer_load_dwordx4 a[124:127], v1, s[4:7], s23 offen offset:3072
    s_waitcnt vmcnt(60)
    v_swap_b32 v137, v140
    v_swap_b32 v138, v140
    v_swap_b32 v139, v141
    v_swap_b32 v141, v142
    s_add_u32 s22, s18, 241664
    s_add_u32 s23, s18, 256000
    buffer_load_dwordx4 a[128:131], v1, s[4:7], s22 offen offset:0
    buffer_load_dwordx4 a[132:135], v1, s[4:7], s23 offen offset:0
    s_waitcnt vmcnt(60)
    v_swap_b32 v145, v148
    v_swap_b32 v146, v148
    v_swap_b32 v147, v149
    v_swap_b32 v149, v150
    buffer_load_dwordx4 a[136:139], v1, s[4:7], s22 offen offset:1024
    buffer_load_dwordx4 a[140:143], v1, s[4:7], s23 offen offset:1024
    s_waitcnt vmcnt(60)
    v_swap_b32 v153, v156
    v_swap_b32 v154, v156
    v_swap_b32 v155, v157
    v_swap_b32 v157, v158
    s_add_u32 s22, s18, 258048
    s_add_u32 s23, s18, 272384
    buffer_load_dwordx4 a[144:147], v1, s[4:7], s22 offen offset:0
    buffer_load_dwordx4 a[148:151], v1, s[4:7], s23 offen offset:0
    s_waitcnt vmcnt(60)
    v_swap_b32 v161, v164
    v_swap_b32 v162, v164
    v_swap_b32 v163, v165
    v_swap_b32 v165, v166
    buffer_load_dwordx4 a[152:155], v1, s[4:7], s22 offen offset:1024
    buffer_load_dwordx4 a[156:159], v1, s[4:7], s23 offen offset:1024
    s_waitcnt vmcnt(60)
    v_swap_b32 v169, v172
    v_swap_b32 v170, v172
    v_swap_b32 v171, v173
    v_swap_b32 v173, v174
    buffer_load_dwordx4 a[160:163], v1, s[4:7], s22 offen offset:2048
    buffer_load_dwordx4 a[164:167], v1, s[4:7], s23 offen offset:2048
    s_waitcnt vmcnt(60)
    v_swap_b32 v177, v180
    v_swap_b32 v178, v180
    v_swap_b32 v179, v181
    v_swap_b32 v181, v182
    buffer_load_dwordx4 a[168:171], v1, s[4:7], s22 offen offset:3072
    buffer_load_dwordx4 a[172:175], v1, s[4:7], s23 offen offset:3072
    s_waitcnt vmcnt(60)
    v_swap_b32 v185, v188
    v_swap_b32 v186, v188
    v_swap_b32 v187, v189
    v_swap_b32 v189, v190
    s_add_u32 s22, s18, 262144
    s_add_u32 s23, s18, 276480
    buffer_load_dwordx4 a[176:179], v1, s[4:7], s22 offen offset:0
    buffer_load_dwordx4 a[180:183], v1, s[4:7], s23 offen offset:0
    s_waitcnt vmcnt(60)
    v_swap_b32 v193, v196
    v_swap_b32 v194, v196
    v_swap_b32 v195, v197
    v_swap_b32 v197, v198
    buffer_load_dwordx4 a[184:187], v1, s[4:7], s22 offen offset:1024
    buffer_load_dwordx4 a[188:191], v1, s[4:7], s23 offen offset:1024
    s_waitcnt vmcnt(60)
    v_swap_b32 v201, v204
    v_swap_b32 v202, v204
    v_swap_b32 v203, v205
    v_swap_b32 v205, v206
    buffer_load_dwordx4 a[192:195], v1, s[4:7], s22 offen offset:2048
    buffer_load_dwordx4 a[196:199], v1, s[4:7], s23 offen offset:2048
    s_waitcnt vmcnt(60)
    v_swap_b32 v209, v212
    v_swap_b32 v210, v212
    v_swap_b32 v211, v213
    v_swap_b32 v213, v214
    buffer_load_dwordx4 a[200:203], v1, s[4:7], s22 offen offset:3072
    buffer_load_dwordx4 a[204:207], v1, s[4:7], s23 offen offset:3072
    s_waitcnt vmcnt(60)
    v_swap_b32 v217, v220
    v_swap_b32 v218, v220
    v_swap_b32 v219, v221
    v_swap_b32 v221, v222
    s_add_u32 s22, s18, 266240
    s_add_u32 s23, s18, 280576
    buffer_load_dwordx4 a[208:211], v1, s[4:7], s22 offen offset:0
    buffer_load_dwordx4 a[212:215], v1, s[4:7], s23 offen offset:0
    s_waitcnt vmcnt(60)
    v_swap_b32 v225, v228
    v_swap_b32 v226, v228
    v_swap_b32 v227, v229
    v_swap_b32 v229, v230
    buffer_load_dwordx4 a[216:219], v1, s[4:7], s22 offen offset:1024
    buffer_load_dwordx4 a[220:223], v1, s[4:7], s23 offen offset:1024
    s_waitcnt vmcnt(60)
    v_swap_b32 v233, v236
    v_swap_b32 v234, v236
    v_swap_b32 v235, v237
    v_swap_b32 v237, v238
    buffer_load_dwordx4 a[224:227], v1, s[4:7], s22 offen offset:2048
    buffer_load_dwordx4 a[228:231], v1, s[4:7], s23 offen offset:2048
    s_waitcnt vmcnt(60)
    v_swap_b32 v241, v244
    v_swap_b32 v242, v244
    v_swap_b32 v243, v245
    v_swap_b32 v245, v246
    buffer_load_dwordx4 a[232:235], v1, s[4:7], s22 offen offset:3072
    buffer_load_dwordx4 a[236:239], v1, s[4:7], s23 offen offset:3072
    s_waitcnt vmcnt(60)
    v_swap_b32 v249, v252
    v_swap_b32 v250, v252
    v_swap_b32 v251, v253
    v_swap_b32 v253, v254
    s_add_u32 s22, s18, 270336
    s_add_u32 s23, s18, 284672
    buffer_load_dwordx4 a[240:243], v1, s[4:7], s22 offen offset:0
    buffer_load_dwordx4 a[244:247], v1, s[4:7], s23 offen offset:0
    s_waitcnt vmcnt(60)
    v_accvgpr_read_b32 v11, a1
    v_accvgpr_mov_b32 a1, a4
    v_accvgpr_mov_b32 a4, a2
    v_accvgpr_write_b32 a2, v11
    v_accvgpr_read_b32 v11, a3
    v_accvgpr_mov_b32 a3, a5
    v_accvgpr_mov_b32 a5, a6
    v_accvgpr_write_b32 a6, v11
    buffer_load_dwordx4 a[248:251], v1, s[4:7], s22 offen offset:1024
    buffer_load_dwordx4 a[252:255], v1, s[4:7], s23 offen offset:1024
    s_waitcnt vmcnt(60)
    v_accvgpr_read_b32 v11, a9
    v_accvgpr_mov_b32 a9, a12
    v_accvgpr_mov_b32 a12, a10
    v_accvgpr_write_b32 a10, v11
    v_accvgpr_read_b32 v11, a11
    v_accvgpr_mov_b32 a11, a13
    v_accvgpr_mov_b32 a13, a14
    v_accvgpr_write_b32 a14, v11
    s_waitcnt vmcnt(58)
    v_accvgpr_read_b32 v11, a17
    v_accvgpr_mov_b32 a17, a20
    v_accvgpr_mov_b32 a20, a18
    v_accvgpr_write_b32 a18, v11
    v_accvgpr_read_b32 v11, a19
    v_accvgpr_mov_b32 a19, a21
    v_accvgpr_mov_b32 a21, a22
    v_accvgpr_write_b32 a22, v11
    s_waitcnt vmcnt(56)
    v_accvgpr_read_b32 v11, a25
    v_accvgpr_mov_b32 a25, a28
    v_accvgpr_mov_b32 a28, a26
    v_accvgpr_write_b32 a26, v11
    v_accvgpr_read_b32 v11, a27
    v_accvgpr_mov_b32 a27, a29
    v_accvgpr_mov_b32 a29, a30
    v_accvgpr_write_b32 a30, v11
    s_waitcnt vmcnt(54)
    v_accvgpr_read_b32 v11, a33
    v_accvgpr_mov_b32 a33, a36
    v_accvgpr_mov_b32 a36, a34
    v_accvgpr_write_b32 a34, v11
    v_accvgpr_read_b32 v11, a35
    v_accvgpr_mov_b32 a35, a37
    v_accvgpr_mov_b32 a37, a38
    v_accvgpr_write_b32 a38, v11
    s_waitcnt vmcnt(52)
    v_accvgpr_read_b32 v11, a41
    v_accvgpr_mov_b32 a41, a44
    v_accvgpr_mov_b32 a44, a42
    v_accvgpr_write_b32 a42, v11
    v_accvgpr_read_b32 v11, a43
    v_accvgpr_mov_b32 a43, a45
    v_accvgpr_mov_b32 a45, a46
    v_accvgpr_write_b32 a46, v11
    s_waitcnt vmcnt(50)
    v_accvgpr_read_b32 v11, a49
    v_accvgpr_mov_b32 a49, a52
    v_accvgpr_mov_b32 a52, a50
    v_accvgpr_write_b32 a50, v11
    v_accvgpr_read_b32 v11, a51
    v_accvgpr_mov_b32 a51, a53
    v_accvgpr_mov_b32 a53, a54
    v_accvgpr_write_b32 a54, v11
    s_waitcnt vmcnt(48)
    v_accvgpr_read_b32 v11, a57
    v_accvgpr_mov_b32 a57, a60
    v_accvgpr_mov_b32 a60, a58
    v_accvgpr_write_b32 a58, v11
    v_accvgpr_read_b32 v11, a59
    v_accvgpr_mov_b32 a59, a61
    v_accvgpr_mov_b32 a61, a62
    v_accvgpr_write_b32 a62, v11
    s_waitcnt vmcnt(46)
    v_accvgpr_read_b32 v11, a65
    v_accvgpr_mov_b32 a65, a68
    v_accvgpr_mov_b32 a68, a66
    v_accvgpr_write_b32 a66, v11
    v_accvgpr_read_b32 v11, a67
    v_accvgpr_mov_b32 a67, a69
    v_accvgpr_mov_b32 a69, a70
    v_accvgpr_write_b32 a70, v11
    s_waitcnt vmcnt(44)
    v_accvgpr_read_b32 v11, a73
    v_accvgpr_mov_b32 a73, a76
    v_accvgpr_mov_b32 a76, a74
    v_accvgpr_write_b32 a74, v11
    v_accvgpr_read_b32 v11, a75
    v_accvgpr_mov_b32 a75, a77
    v_accvgpr_mov_b32 a77, a78
    v_accvgpr_write_b32 a78, v11
    s_waitcnt vmcnt(42)
    v_accvgpr_read_b32 v11, a81
    v_accvgpr_mov_b32 a81, a84
    v_accvgpr_mov_b32 a84, a82
    v_accvgpr_write_b32 a82, v11
    v_accvgpr_read_b32 v11, a83
    v_accvgpr_mov_b32 a83, a85
    v_accvgpr_mov_b32 a85, a86
    v_accvgpr_write_b32 a86, v11
    s_waitcnt vmcnt(40)
    v_accvgpr_read_b32 v11, a89
    v_accvgpr_mov_b32 a89, a92
    v_accvgpr_mov_b32 a92, a90
    v_accvgpr_write_b32 a90, v11
    v_accvgpr_read_b32 v11, a91
    v_accvgpr_mov_b32 a91, a93
    v_accvgpr_mov_b32 a93, a94
    v_accvgpr_write_b32 a94, v11
    s_waitcnt vmcnt(38)
    v_accvgpr_read_b32 v11, a97
    v_accvgpr_mov_b32 a97, a100
    v_accvgpr_mov_b32 a100, a98
    v_accvgpr_write_b32 a98, v11
    v_accvgpr_read_b32 v11, a99
    v_accvgpr_mov_b32 a99, a101
    v_accvgpr_mov_b32 a101, a102
    v_accvgpr_write_b32 a102, v11
    s_waitcnt vmcnt(36)
    v_accvgpr_read_b32 v11, a105
    v_accvgpr_mov_b32 a105, a108
    v_accvgpr_mov_b32 a108, a106
    v_accvgpr_write_b32 a106, v11
    v_accvgpr_read_b32 v11, a107
    v_accvgpr_mov_b32 a107, a109
    v_accvgpr_mov_b32 a109, a110
    v_accvgpr_write_b32 a110, v11
    s_waitcnt vmcnt(34)
    v_accvgpr_read_b32 v11, a113
    v_accvgpr_mov_b32 a113, a116
    v_accvgpr_mov_b32 a116, a114
    v_accvgpr_write_b32 a114, v11
    v_accvgpr_read_b32 v11, a115
    v_accvgpr_mov_b32 a115, a117
    v_accvgpr_mov_b32 a117, a118
    v_accvgpr_write_b32 a118, v11
    s_waitcnt vmcnt(32)
    v_accvgpr_read_b32 v11, a121
    v_accvgpr_mov_b32 a121, a124
    v_accvgpr_mov_b32 a124, a122
    v_accvgpr_write_b32 a122, v11
    v_accvgpr_read_b32 v11, a123
    v_accvgpr_mov_b32 a123, a125
    v_accvgpr_mov_b32 a125, a126
    v_accvgpr_write_b32 a126, v11
    s_waitcnt vmcnt(30)
    v_accvgpr_read_b32 v11, a129
    v_accvgpr_mov_b32 a129, a132
    v_accvgpr_mov_b32 a132, a130
    v_accvgpr_write_b32 a130, v11
    v_accvgpr_read_b32 v11, a131
    v_accvgpr_mov_b32 a131, a133
    v_accvgpr_mov_b32 a133, a134
    v_accvgpr_write_b32 a134, v11
    s_waitcnt vmcnt(28)
    v_accvgpr_read_b32 v11, a137
    v_accvgpr_mov_b32 a137, a140
    v_accvgpr_mov_b32 a140, a138
    v_accvgpr_write_b32 a138, v11
    v_accvgpr_read_b32 v11, a139
    v_accvgpr_mov_b32 a139, a141
    v_accvgpr_mov_b32 a141, a142
    v_accvgpr_write_b32 a142, v11
    s_waitcnt vmcnt(26)
    v_accvgpr_read_b32 v11, a145
    v_accvgpr_mov_b32 a145, a148
    v_accvgpr_mov_b32 a148, a146
    v_accvgpr_write_b32 a146, v11
    v_accvgpr_read_b32 v11, a147
    v_accvgpr_mov_b32 a147, a149
    v_accvgpr_mov_b32 a149, a150
    v_accvgpr_write_b32 a150, v11
    s_waitcnt vmcnt(24)
    v_accvgpr_read_b32 v11, a153
    v_accvgpr_mov_b32 a153, a156
    v_accvgpr_mov_b32 a156, a154
    v_accvgpr_write_b32 a154, v11
    v_accvgpr_read_b32 v11, a155
    v_accvgpr_mov_b32 a155, a157
    v_accvgpr_mov_b32 a157, a158
    v_accvgpr_write_b32 a158, v11
    s_waitcnt vmcnt(22)
    v_accvgpr_read_b32 v11, a161
    v_accvgpr_mov_b32 a161, a164
    v_accvgpr_mov_b32 a164, a162
    v_accvgpr_write_b32 a162, v11
    v_accvgpr_read_b32 v11, a163
    v_accvgpr_mov_b32 a163, a165
    v_accvgpr_mov_b32 a165, a166
    v_accvgpr_write_b32 a166, v11
    s_waitcnt vmcnt(20)
    v_accvgpr_read_b32 v11, a169
    v_accvgpr_mov_b32 a169, a172
    v_accvgpr_mov_b32 a172, a170
    v_accvgpr_write_b32 a170, v11
    v_accvgpr_read_b32 v11, a171
    v_accvgpr_mov_b32 a171, a173
    v_accvgpr_mov_b32 a173, a174
    v_accvgpr_write_b32 a174, v11
    s_waitcnt vmcnt(18)
    v_accvgpr_read_b32 v11, a177
    v_accvgpr_mov_b32 a177, a180
    v_accvgpr_mov_b32 a180, a178
    v_accvgpr_write_b32 a178, v11
    v_accvgpr_read_b32 v11, a179
    v_accvgpr_mov_b32 a179, a181
    v_accvgpr_mov_b32 a181, a182
    v_accvgpr_write_b32 a182, v11
    s_waitcnt vmcnt(16)
    v_accvgpr_read_b32 v11, a185
    v_accvgpr_mov_b32 a185, a188
    v_accvgpr_mov_b32 a188, a186
    v_accvgpr_write_b32 a186, v11
    v_accvgpr_read_b32 v11, a187
    v_accvgpr_mov_b32 a187, a189
    v_accvgpr_mov_b32 a189, a190
    v_accvgpr_write_b32 a190, v11
    s_waitcnt vmcnt(14)
    v_accvgpr_read_b32 v11, a193
    v_accvgpr_mov_b32 a193, a196
    v_accvgpr_mov_b32 a196, a194
    v_accvgpr_write_b32 a194, v11
    v_accvgpr_read_b32 v11, a195
    v_accvgpr_mov_b32 a195, a197
    v_accvgpr_mov_b32 a197, a198
    v_accvgpr_write_b32 a198, v11
    s_waitcnt vmcnt(12)
    v_accvgpr_read_b32 v11, a201
    v_accvgpr_mov_b32 a201, a204
    v_accvgpr_mov_b32 a204, a202
    v_accvgpr_write_b32 a202, v11
    v_accvgpr_read_b32 v11, a203
    v_accvgpr_mov_b32 a203, a205
    v_accvgpr_mov_b32 a205, a206
    v_accvgpr_write_b32 a206, v11
    s_waitcnt vmcnt(10)
    v_accvgpr_read_b32 v11, a209
    v_accvgpr_mov_b32 a209, a212
    v_accvgpr_mov_b32 a212, a210
    v_accvgpr_write_b32 a210, v11
    v_accvgpr_read_b32 v11, a211
    v_accvgpr_mov_b32 a211, a213
    v_accvgpr_mov_b32 a213, a214
    v_accvgpr_write_b32 a214, v11
    s_waitcnt vmcnt(8)
    v_accvgpr_read_b32 v11, a217
    v_accvgpr_mov_b32 a217, a220
    v_accvgpr_mov_b32 a220, a218
    v_accvgpr_write_b32 a218, v11
    v_accvgpr_read_b32 v11, a219
    v_accvgpr_mov_b32 a219, a221
    v_accvgpr_mov_b32 a221, a222
    v_accvgpr_write_b32 a222, v11
    s_waitcnt vmcnt(6)
    v_accvgpr_read_b32 v11, a225
    v_accvgpr_mov_b32 a225, a228
    v_accvgpr_mov_b32 a228, a226
    v_accvgpr_write_b32 a226, v11
    v_accvgpr_read_b32 v11, a227
    v_accvgpr_mov_b32 a227, a229
    v_accvgpr_mov_b32 a229, a230
    v_accvgpr_write_b32 a230, v11
    s_waitcnt vmcnt(4)
    v_accvgpr_read_b32 v11, a233
    v_accvgpr_mov_b32 a233, a236
    v_accvgpr_mov_b32 a236, a234
    v_accvgpr_write_b32 a234, v11
    v_accvgpr_read_b32 v11, a235
    v_accvgpr_mov_b32 a235, a237
    v_accvgpr_mov_b32 a237, a238
    v_accvgpr_write_b32 a238, v11
    s_waitcnt vmcnt(2)
    v_accvgpr_read_b32 v11, a241
    v_accvgpr_mov_b32 a241, a244
    v_accvgpr_mov_b32 a244, a242
    v_accvgpr_write_b32 a242, v11
    v_accvgpr_read_b32 v11, a243
    v_accvgpr_mov_b32 a243, a245
    v_accvgpr_mov_b32 a245, a246
    v_accvgpr_write_b32 a246, v11
    s_waitcnt vmcnt(0)
    v_accvgpr_read_b32 v11, a249
    v_accvgpr_mov_b32 a249, a252
    v_accvgpr_mov_b32 a252, a250
    v_accvgpr_write_b32 a250, v11
    v_accvgpr_read_b32 v11, a251
    v_accvgpr_mov_b32 a251, a253
    v_accvgpr_mov_b32 a253, a254
    v_accvgpr_write_b32 a254, v11
    s_branch wd_18
w3_17:
    s_lshl_b32 s19, s17, 3
    s_add_u32 s19, s19, s3
    s_add_u32 s19, s19, 0
    s_lshl_b32 s19, s19, 7
    v_and_b32 v13, 31, v0
    v_min_u32 v13, 27, v13
    v_lshlrev_b32 v13, 2, v13
    s_add_u32 s19, s19, 74055680
    v_add_u32 v13, s19, v13
    s_mov_b32 s35, 400000
ww_23:
    buffer_load_dword v11, v13, s[4:7], 0 offen sc1
    s_waitcnt vmcnt(0)
    v_cmp_eq_u32 vcc, 0, v11
    s_cbranch_vccz wwo_24
    s_sleep 16
    s_sub_u32 s35, s35, 1
    s_cmp_lg_u32 s35, 0
    s_cbranch_scc1 ww_23
    s_branch k2_end
wwo_24:
    s_add_u32 s22, s18, 0
    s_add_u32 s23, s18, 28672
    buffer_load_dwordx4 a[0:3], v1, s[4:7], s22 offen offset:0
    buffer_load_dwordx4 a[4:7], v1, s[4:7], s23 offen offset:0
    buffer_load_dwordx4 a[8:11], v1, s[4:7], s22 offen offset:1024
    buffer_load_dwordx4 a[12:15], v1, s[4:7], s23 offen offset:1024
    buffer_load_dwordx4 a[16:19], v1, s[4:7], s22 offen offset:2048
    buffer_load_dwordx4 a[20:23], v1, s[4:7], s23 offen offset:2048
    buffer_load_dwordx4 a[24:27], v1, s[4:7], s22 offen offset:3072
    buffer_load_dwordx4 a[28:31], v1, s[4:7], s23 offen offset:3072
    s_add_u32 s22, s18, 4096
    s_add_u32 s23, s18, 32768
    buffer_load_dwordx4 a[32:35], v1, s[4:7], s22 offen offset:0
    buffer_load_dwordx4 a[36:39], v1, s[4:7], s23 offen offset:0
    buffer_load_dwordx4 a[40:43], v1, s[4:7], s22 offen offset:1024
    buffer_load_dwordx4 a[44:47], v1, s[4:7], s23 offen offset:1024
    buffer_load_dwordx4 a[48:51], v1, s[4:7], s22 offen offset:2048
    buffer_load_dwordx4 a[52:55], v1, s[4:7], s23 offen offset:2048
    buffer_load_dwordx4 a[56:59], v1, s[4:7], s22 offen offset:3072
    buffer_load_dwordx4 a[60:63], v1, s[4:7], s23 offen offset:3072
    s_add_u32 s22, s18, 8192
    s_add_u32 s23, s18, 36864
    buffer_load_dwordx4 a[64:67], v1, s[4:7], s22 offen offset:0
    buffer_load_dwordx4 a[68:71], v1, s[4:7], s23 offen offset:0
    buffer_load_dwordx4 a[72:75], v1, s[4:7], s22 offen offset:1024
    buffer_load_dwordx4 a[76:79], v1, s[4:7], s23 offen offset:1024
    buffer_load_dwordx4 a[80:83], v1, s[4:7], s22 offen offset:2048
    buffer_load_dwordx4 a[84:87], v1, s[4:7], s23 offen offset:2048
    buffer_load_dwordx4 a[88:91], v1, s[4:7], s22 offen offset:3072
    buffer_load_dwordx4 a[92:95], v1, s[4:7], s23 offen offset:3072
    s_add_u32 s22, s18, 12288
    s_add_u32 s23, s18, 40960
    buffer_load_dwordx4 a[96:99], v1, s[4:7], s22 offen offset:0
    buffer_load_dwordx4 a[100:103], v1, s[4:7], s23 offen offset:0
    buffer_load_dwordx4 a[104:107], v1, s[4:7], s22 offen offset:1024
    buffer_load_dwordx4 a[108:111], v1, s[4:7], s23 offen offset:1024
    s_add_u32 s22, s18, 14336
    s_add_u32 s23, s18, 43008
    buffer_load_dwordx4 a[112:115], v1, s[4:7], s22 offen offset:0
    buffer_load_dwordx4 a[116:119], v1, s[4:7], s23 offen offset:0
    buffer_load_dwordx4 a[120:123], v1, s[4:7], s22 offen offset:1024
    buffer_load_dwordx4 a[124:127], v1, s[4:7], s23 offen offset:1024
    buffer_load_dwordx4 a[128:131], v1, s[4:7], s22 offen offset:2048
    buffer_load_dwordx4 a[132:135], v1, s[4:7], s23 offen offset:2048
    buffer_load_dwordx4 a[136:139], v1, s[4:7], s22 offen offset:3072
    buffer_load_dwordx4 a[140:143], v1, s[4:7], s23 offen offset:3072
    s_add_u32 s22, s18, 18432
    s_add_u32 s23, s18, 47104
    buffer_load_dwordx4 a[144:147], v1, s[4:7], s22 offen offset:0
    buffer_load_dwordx4 a[148:151], v1, s[4:7], s23 offen offset:0
    buffer_load_dwordx4 a[152:155], v1, s[4:7], s22 offen offset:1024
    buffer_load_dwordx4 a[156:159], v1, s[4:7], s23 offen offset:1024
    buffer_load_dwordx4 a[160:163], v1, s[4:7], s22 offen offset:2048
    buffer_load_dwordx4 a[164:167], v1, s[4:7], s23 offen offset:2048
    buffer_load_dwordx4 a[168:171], v1, s[4:7], s22 offen offset:3072
    buffer_load_dwordx4 a[172:175], v1, s[4:7], s23 offen offset:3072
    s_add_u32 s22, s18, 22528
    s_add_u32 s23, s18, 51200
    buffer_load_dwordx4 a[176:179], v1, s[4:7], s22 offen offset:0
    buffer_load_dwordx4 a[180:183], v1, s[4:7], s23 offen offset:0
    buffer_load_dwordx4 a[184:187], v1, s[4:7], s22 offen offset:1024
    buffer_load_dwordx4 a[188:191], v1, s[4:7], s23 offen offset:1024
    buffer_load_dwordx4 a[192:195], v1, s[4:7], s22 offen offset:2048
    buffer_load_dwordx4 a[196:199], v1, s[4:7], s23 offen offset:2048
    buffer_load_dwordx4 a[200:203], v1, s[4:7], s22 offen offset:3072
    buffer_load_dwordx4 a[204:207], v1, s[4:7], s23 offen offset:3072
    s_add_u32 s22, s18, 26624
    s_add_u32 s23, s18, 55296
    buffer_load_dwordx4 a[208:211], v1, s[4:7], s22 offen offset:0
    buffer_load_dwordx4 a[212:215], v1, s[4:7], s23 offen offset:0
    buffer_load_dwordx4 a[216:219], v1, s[4:7], s22 offen offset:1024
    buffer_load_dwordx4 a[220:223], v1, s[4:7], s23 offen offset:1024
    s_waitcnt vmcnt(54)
    v_accvgpr_read_b32 v11, a1
    v_accvgpr_mov_b32 a1, a4
    v_accvgpr_mov_b32 a4, a2
    v_accvgpr_write_b32 a2, v11
    v_accvgpr_read_b32 v11, a3
    v_accvgpr_mov_b32 a3, a5
    v_accvgpr_mov_b32 a5, a6
    v_accvgpr_write_b32 a6, v11
    s_waitcnt vmcnt(52)
    v_accvgpr_read_b32 v11, a9
    v_accvgpr_mov_b32 a9, a12
    v_accvgpr_mov_b32 a12, a10
    v_accvgpr_write_b32 a10, v11
    v_accvgpr_read_b32 v11, a11
    v_accvgpr_mov_b32 a11, a13
    v_accvgpr_mov_b32 a13, a14
    v_accvgpr_write_b32 a14, v11
    s_waitcnt vmcnt(50)
    v_accvgpr_read_b32 v11, a17
    v_accvgpr_mov_b32 a17, a20
    v_accvgpr_mov_b32 a20, a18
    v_accvgpr_write_b32 a18, v11
    v_accvgpr_read_b32 v11, a19
    v_accvgpr_mov_b32 a19, a21
    v_accvgpr_mov_b32 a21, a22
    v_accvgpr_write_b32 a22, v11
    s_waitcnt vmcnt(48)
    v_accvgpr_read_b32 v11, a25
    v_accvgpr_mov_b32 a25, a28
    v_accvgpr_mov_b32 a28, a26
    v_accvgpr_write_b32 a26, v11
    v_accvgpr_read_b32 v11, a27
    v_accvgpr_mov_b32 a27, a29
    v_accvgpr_mov_b32 a29, a30
    v_accvgpr_write_b32 a30, v11
    s_waitcnt vmcnt(46)
    v_accvgpr_read_b32 v11, a33
    v_accvgpr_mov_b32 a33, a36
    v_accvgpr_mov_b32 a36, a34
    v_accvgpr_write_b32 a34, v11
    v_accvgpr_read_b32 v11, a35
    v_accvgpr_mov_b32 a35, a37
    v_accvgpr_mov_b32 a37, a38
    v_accvgpr_write_b32 a38, v11
    s_waitcnt vmcnt(44)
    v_accvgpr_read_b32 v11, a41
    v_accvgpr_mov_b32 a41, a44
    v_accvgpr_mov_b32 a44, a42
    v_accvgpr_write_b32 a42, v11
    v_accvgpr_read_b32 v11, a43
    v_accvgpr_mov_b32 a43, a45
    v_accvgpr_mov_b32 a45, a46
    v_accvgpr_write_b32 a46, v11
    s_waitcnt vmcnt(42)
    v_accvgpr_read_b32 v11, a49
    v_accvgpr_mov_b32 a49, a52
    v_accvgpr_mov_b32 a52, a50
    v_accvgpr_write_b32 a50, v11
    v_accvgpr_read_b32 v11, a51
    v_accvgpr_mov_b32 a51, a53
    v_accvgpr_mov_b32 a53, a54
    v_accvgpr_write_b32 a54, v11
    s_waitcnt vmcnt(40)
    v_accvgpr_read_b32 v11, a57
    v_accvgpr_mov_b32 a57, a60
    v_accvgpr_mov_b32 a60, a58
    v_accvgpr_write_b32 a58, v11
    v_accvgpr_read_b32 v11, a59
    v_accvgpr_mov_b32 a59, a61
    v_accvgpr_mov_b32 a61, a62
    v_accvgpr_write_b32 a62, v11
    s_waitcnt vmcnt(38)
    v_accvgpr_read_b32 v11, a65
    v_accvgpr_mov_b32 a65, a68
    v_accvgpr_mov_b32 a68, a66
    v_accvgpr_write_b32 a66, v11
    v_accvgpr_read_b32 v11, a67
    v_accvgpr_mov_b32 a67, a69
    v_accvgpr_mov_b32 a69, a70
    v_accvgpr_write_b32 a70, v11
    s_waitcnt vmcnt(36)
    v_accvgpr_read_b32 v11, a73
    v_accvgpr_mov_b32 a73, a76
    v_accvgpr_mov_b32 a76, a74
    v_accvgpr_write_b32 a74, v11
    v_accvgpr_read_b32 v11, a75
    v_accvgpr_mov_b32 a75, a77
    v_accvgpr_mov_b32 a77, a78
    v_accvgpr_write_b32 a78, v11
    s_waitcnt vmcnt(34)
    v_accvgpr_read_b32 v11, a81
    v_accvgpr_mov_b32 a81, a84
    v_accvgpr_mov_b32 a84, a82
    v_accvgpr_write_b32 a82, v11
    v_accvgpr_read_b32 v11, a83
    v_accvgpr_mov_b32 a83, a85
    v_accvgpr_mov_b32 a85, a86
    v_accvgpr_write_b32 a86, v11
    s_waitcnt vmcnt(32)
    v_accvgpr_read_b32 v11, a89
    v_accvgpr_mov_b32 a89, a92
    v_accvgpr_mov_b32 a92, a90
    v_accvgpr_write_b32 a90, v11
    v_accvgpr_read_b32 v11, a91
    v_accvgpr_mov_b32 a91, a93
    v_accvgpr_mov_b32 a93, a94
    v_accvgpr_write_b32 a94, v11
    s_waitcnt vmcnt(30)
    v_accvgpr_read_b32 v11, a97
    v_accvgpr_mov_b32 a97, a100
    v_accvgpr_mov_b32 a100, a98
    v_accvgpr_write_b32 a98, v11
    v_accvgpr_read_b32 v11, a99
    v_accvgpr_mov_b32 a99, a101
    v_accvgpr_mov_b32 a101, a102
    v_accvgpr_write_b32 a102, v11
    s_waitcnt vmcnt(28)
    v_accvgpr_read_b32 v11, a105
    v_accvgpr_mov_b32 a105, a108
    v_accvgpr_mov_b32 a108, a106
    v_accvgpr_write_b32 a106, v11
    v_accvgpr_read_b32 v11, a107
    v_accvgpr_mov_b32 a107, a109
    v_accvgpr_mov_b32 a109, a110
    v_accvgpr_write_b32 a110, v11
    s_waitcnt vmcnt(26)
    v_accvgpr_read_b32 v11, a113
    v_accvgpr_mov_b32 a113, a116
    v_accvgpr_mov_b32 a116, a114
    v_accvgpr_write_b32 a114, v11
    v_accvgpr_read_b32 v11, a115
    v_accvgpr_mov_b32 a115, a117
    v_accvgpr_mov_b32 a117, a118
    v_accvgpr_write_b32 a118, v11
    s_waitcnt vmcnt(24)
    v_accvgpr_read_b32 v11, a121
    v_accvgpr_mov_b32 a121, a124
    v_accvgpr_mov_b32 a124, a122
    v_accvgpr_write_b32 a122, v11
    v_accvgpr_read_b32 v11, a123
    v_accvgpr_mov_b32 a123, a125
    v_accvgpr_mov_b32 a125, a126
    v_accvgpr_write_b32 a126, v11
    s_waitcnt vmcnt(22)
    v_accvgpr_read_b32 v11, a129
    v_accvgpr_mov_b32 a129, a132
    v_accvgpr_mov_b32 a132, a130
    v_accvgpr_write_b32 a130, v11
    v_accvgpr_read_b32 v11, a131
    v_accvgpr_mov_b32 a131, a133
    v_accvgpr_mov_b32 a133, a134
    v_accvgpr_write_b32 a134, v11
    s_waitcnt vmcnt(20)
    v_accvgpr_read_b32 v11, a137
    v_accvgpr_mov_b32 a137, a140
    v_accvgpr_mov_b32 a140, a138
    v_accvgpr_write_b32 a138, v11
    v_accvgpr_read_b32 v11, a139
    v_accvgpr_mov_b32 a139, a141
    v_accvgpr_mov_b32 a141, a142
    v_accvgpr_write_b32 a142, v11
    s_waitcnt vmcnt(18)
    v_accvgpr_read_b32 v11, a145
    v_accvgpr_mov_b32 a145, a148
    v_accvgpr_mov_b32 a148, a146
    v_accvgpr_write_b32 a146, v11
    v_accvgpr_read_b32 v11, a147
    v_accvgpr_mov_b32 a147, a149
    v_accvgpr_mov_b32 a149, a150
    v_accvgpr_write_b32 a150, v11
    s_waitcnt vmcnt(16)
    v_accvgpr_read_b32 v11, a153
    v_accvgpr_mov_b32 a153, a156
    v_accvgpr_mov_b32 a156, a154
    v_accvgpr_write_b32 a154, v11
    v_accvgpr_read_b32 v11, a155
    v_accvgpr_mov_b32 a155, a157
    v_accvgpr_mov_b32 a157, a158
    v_accvgpr_write_b32 a158, v11
    s_waitcnt vmcnt(14)
    v_accvgpr_read_b32 v11, a161
    v_accvgpr_mov_b32 a161, a164
    v_accvgpr_mov_b32 a164, a162
    v_accvgpr_write_b32 a162, v11
    v_accvgpr_read_b32 v11, a163
    v_accvgpr_mov_b32 a163, a165
    v_accvgpr_mov_b32 a165, a166
    v_accvgpr_write_b32 a166, v11
    s_waitcnt vmcnt(12)
    v_accvgpr_read_b32 v11, a169
    v_accvgpr_mov_b32 a169, a172
    v_accvgpr_mov_b32 a172, a170
    v_accvgpr_write_b32 a170, v11
    v_accvgpr_read_b32 v11, a171
    v_accvgpr_mov_b32 a171, a173
    v_accvgpr_mov_b32 a173, a174
    v_accvgpr_write_b32 a174, v11
    s_waitcnt vmcnt(10)
    v_accvgpr_read_b32 v11, a177
    v_accvgpr_mov_b32 a177, a180
    v_accvgpr_mov_b32 a180, a178
    v_accvgpr_write_b32 a178, v11
    v_accvgpr_read_b32 v11, a179
    v_accvgpr_mov_b32 a179, a181
    v_accvgpr_mov_b32 a181, a182
    v_accvgpr_write_b32 a182, v11
    s_waitcnt vmcnt(8)
    v_accvgpr_read_b32 v11, a185
    v_accvgpr_mov_b32 a185, a188
    v_accvgpr_mov_b32 a188, a186
    v_accvgpr_write_b32 a186, v11
    v_accvgpr_read_b32 v11, a187
    v_accvgpr_mov_b32 a187, a189
    v_accvgpr_mov_b32 a189, a190
    v_accvgpr_write_b32 a190, v11
    s_waitcnt vmcnt(6)
    v_accvgpr_read_b32 v11, a193
    v_accvgpr_mov_b32 a193, a196
    v_accvgpr_mov_b32 a196, a194
    v_accvgpr_write_b32 a194, v11
    v_accvgpr_read_b32 v11, a195
    v_accvgpr_mov_b32 a195, a197
    v_accvgpr_mov_b32 a197, a198
    v_accvgpr_write_b32 a198, v11
    s_waitcnt vmcnt(4)
    v_accvgpr_read_b32 v11, a201
    v_accvgpr_mov_b32 a201, a204
    v_accvgpr_mov_b32 a204, a202
    v_accvgpr_write_b32 a202, v11
    v_accvgpr_read_b32 v11, a203
    v_accvgpr_mov_b32 a203, a205
    v_accvgpr_mov_b32 a205, a206
    v_accvgpr_write_b32 a206, v11
    s_waitcnt vmcnt(2)
    v_accvgpr_read_b32 v11, a209
    v_accvgpr_mov_b32 a209, a212
    v_accvgpr_mov_b32 a212, a210
    v_accvgpr_write_b32 a210, v11
    v_accvgpr_read_b32 v11, a211
    v_accvgpr_mov_b32 a211, a213
    v_accvgpr_mov_b32 a213, a214
    v_accvgpr_write_b32 a214, v11
    s_waitcnt vmcnt(0)
    v_accvgpr_read_b32 v11, a217
    v_accvgpr_mov_b32 a217, a220
    v_accvgpr_mov_b32 a220, a218
    v_accvgpr_write_b32 a218, v11
    v_accvgpr_read_b32 v11, a219
    v_accvgpr_mov_b32 a219, a221
    v_accvgpr_mov_b32 a221, a222
    v_accvgpr_write_b32 a222, v11
wd_18:
    v_and_b32 v11, 12, v0
    v_mul_u32_u24 v9, 36, v11
    v_and_b32 v11, 3, v0
    v_lshl_add_u32 v9, v11, 2, v9
    v_and_b32 v11, 16, v0
    v_lshl_add_u32 v9, v11, 2, v9
    s_mul_i32 s16, s3, 1152
    s_add_u32 s16, s16, 8192
    v_add_u32 v9, s16, v9
    v_lshrrev_b32 v11, 5, v0
    v_lshl_add_u32 v10, v11, 4, v9
    v_mul_u32_u24 v11, 576, v11
    v_add_u32 v9, v9, v11
    v_and_b32 v13, 1, v0
    v_lshlrev_b32 v13, 2, v13
    v_add_u32 v13, 248, v13
    v_lshlrev_b32 v12, 3, v0
    v_add_u32 v12, 74051584, v12
    s_mov_b32 s30, 400000
ww_25:
    buffer_load_dword v11, v13, s[8:11], 0 offen sc1
    buffer_load_dwordx2 v[14:15], v12, s[4:7], 0 offen sc1
    s_waitcnt vmcnt(0)
    v_min3_u32 v11, v11, v14, v15
    v_cmp_eq_u32 vcc, 0, v11
    s_cbranch_vccz wwo_26
    s_sleep 4
    s_sub_u32 s30, s30, 1
    s_cmp_lg_u32 s30, 0
    s_cbranch_scc1 ww_25
    s_branch k2_end
wwo_26:
    s_cmp_eq_u32 s14, 0
    s_cbranch_scc1 ch_score_slow
    s_cmp_eq_u32 s3, 3
    s_cbranch_scc1 sc_fin_f
    s_cmp_lg_u32 s3, 0
    s_cbranch_scc1 sc_w1_f
    s_mov_b32 s20, 0
sc_loop_f0:
    s_and_b32 s21, s20, 3
    s_lshl_b32 s24, s21, 14
    s_add_u32 s24, s24, 73760768
    s_add_u32 s25, s24, 8192
    s_lshl_b32 s26, s21, 15
    s_add_u32 s26, s26, 73826304
    s_add_u32 s45, s26, 16384
    s_xor_b32 s22, s21, 2
    s_lshl_b32 s27, s22, 15
    s_add_u32 s27, s27, 73826304
    s_add_u32 s44, s20, 1
    s_and_b32 s22, s44, 3
    s_lshl_b32 s28, s22, 14
    s_add_u32 s28, s28, 73760768
    s_xor_b32 s22, s22, 2
    s_lshl_b32 s29, s22, 14
    s_add_u32 s29, s29, 73760768
    v_mov_b64 v[12:13], 0
    v_mov_b64 v[14:15], 0
    v_mov_b64 v[16:17], 0
    v_mov_b64 v[18:19], 0
    v_mov_b64 v[20:21], 0
    v_mov_b64 v[22:23], 0
    v_mov_b64 v[24:25], 0
    v_mov_b64 v[26:27], 0
    s_mov_b32 s30, 200000
    s_mov_b64 exec, s[42:43]
    buffer_load_dword v28, v5, s[4:7], s46 offen offset:0 sc1
    s_nop 15
    s_nop 9
wf_28:
    buffer_load_dword v29, v5, s[4:7], s46 offen offset:128 sc1
    s_waitcnt vmcnt(1)
    v_cmp_gt_u32 vcc, s20, v28
    s_cbranch_vccz wfo_29
    buffer_load_dword v28, v5, s[4:7], s46 offen offset:0 sc1
    s_waitcnt vmcnt(1)
    v_cmp_gt_u32 vcc, s20, v29
    s_cbranch_vccz wfo_29
    s_sub_u32 s30, s30, 1
    s_cmp_lg_u32 s30, 0
    s_cbranch_scc1 wf_28
    s_mov_b64 exec, -1
    s_branch k2_end
wfo_29:
    s_mov_b64 exec, -1
wfb_27:
    s_mov_b32 s30, 200000
    buffer_load_dwordx4 v[28:31], v3, s[4:7], s24 offen sc1
    buffer_load_dwordx4 v[32:35], v4, s[4:7], s24 offen sc1
    s_nop 15
    s_nop 15
    s_nop 7
pm_30:
    buffer_load_dwordx4 v[36:39], v3, s[4:7], s25 offen sc1
    buffer_load_dwordx4 v[40:43], v4, s[4:7], s25 offen sc1
    s_waitcnt vmcnt(2)
    ds_write_b128 v3, v[28:31]
    ds_write_b128 v4, v[32:35]
    v_max3_u32 v0, v28, v29, v30
    v_max3_u32 v1, v31, v32, v33
    v_max3_u32 v0, v0, v34, v35
    v_max_u32 v0, v0, v1
    v_cmp_eq_u32 vcc, -1, v0
    s_cbranch_vccnz pm1_32
pmo_31:
    ds_read_b128 v[44:47], v8 offset:0
    ds_read_b128 v[48:51], v8 offset:512
    ds_read_b128 v[52:55], v8 offset:1024
    s_waitcnt lgkmcnt(3)
    s_barrier
    ds_read_b128 v[56:59], v8 offset:1536
    ds_read_b128 v[60:63], v8 offset:2048
    s_waitcnt lgkmcnt(4)
    v_smfmac_f32_16x16x64_bf16 v[12:15], v[44:47], v[64:71], v2
    v_smfmac_f32_16x16x64_bf16 v[16:19], v[44:47], v[176:183], v2
    s_waitcnt lgkmcnt(3)
    v_smfmac_f32_16x16x64_bf16 v[12:15], v[48:51], v[72:79], v2
    v_smfmac_f32_16x16x64_bf16 v[16:19], v[48:51], v[184:191], v2
    s_waitcnt vmcnt(0)
    ds_read_b128 v[28:31], v8 offset:2560
    ds_read_b128 v[32:35], v8 offset:3072
    ds_read_b128 v[36:39], v8 offset:3584
    ds_read_b128 v[40:43], v8 offset:4096
    ds_read_b128 v[44:47], v8 offset:4608
    s_waitcnt lgkmcnt(7)
    v_smfmac_f32_16x16x64_bf16 v[12:15], v[52:55], v[80:87], v2
    v_smfmac_f32_16x16x64_bf16 v[16:19], v[52:55], v[192:199], v2
    ds_read_b128 v[48:51], v8 offset:5120
    s_waitcnt lgkmcnt(7)
    v_smfmac_f32_16x16x64_bf16 v[12:15], v[56:59], v[88:95], v2
    v_smfmac_f32_16x16x64_bf16 v[16:19], v[56:59], v[200:207], v2
    ds_read_b128 v[52:55], v8 offset:5632
    s_waitcnt lgkmcnt(7)
    v_smfmac_f32_16x16x64_bf16 v[12:15], v[60:63], v[96:103], v2
    v_smfmac_f32_16x16x64_bf16 v[16:19], v[60:63], v[208:215], v2
    ds_read_b128 v[56:59], v8 offset:6144
    s_waitcnt lgkmcnt(4)
    v_smfmac_f32_16x16x64_bf16 v[12:15], v[28:31], v[104:111], v2
    v_smfmac_f32_16x16x64_bf16 v[16:19], v[28:31], v[216:223], v2
    ds_read_b128 v[60:63], v8 offset:6656
    v_smfmac_f32_16x16x64_bf16 v[12:15], v[32:35], v[112:119], v2
    v_smfmac_f32_16x16x64_bf16 v[16:19], v[32:35], v[224:231], v2
    v_smfmac_f32_16x16x64_bf16 v[12:15], v[36:39], v[120:127], v2
    v_smfmac_f32_16x16x64_bf16 v[16:19], v[36:39], v[232:239], v2
    v_smfmac_f32_16x16x64_bf16 v[12:15], v[40:43], v[128:135], v2
    v_smfmac_f32_16x16x64_bf16 v[16:19], v[40:43], v[240:247], v2
    s_waitcnt lgkmcnt(0)
    v_smfmac_f32_16x16x64_bf16 v[12:15], v[44:47], v[136:143], v2
    v_smfmac_f32_16x16x64_bf16 v[16:19], v[44:47], v[248:255], v2
    v_smfmac_f32_16x16x64_bf16 v[12:15], v[48:51], v[144:151], v2
    v_smfmac_f32_16x16x64_bf16 v[16:19], v[48:51], a[0:7], v2
    v_smfmac_f32_16x16x64_bf16 v[12:15], v[52:55], v[152:159], v2
    v_smfmac_f32_16x16x64_bf16 v[16:19], v[52:55], a[8:15], v2
    v_smfmac_f32_16x16x64_bf16 v[12:15], v[56:59], v[160:167], v2
    v_smfmac_f32_16x16x64_bf16 v[16:19], v[56:59], a[16:23], v2
    v_smfmac_f32_16x16x64_bf16 v[12:15], v[60:63], v[168:175], v2
    v_smfmac_f32_16x16x64_bf16 v[16:19], v[60:63], a[24:31], v2
    v_smfmac_f32_16x16x64_bf16 v[20:23], v[28:31], a[72:79], v2
    ds_read_b128 v[28:31], v8 offset:0
    v_smfmac_f32_16x16x64_bf16 v[20:23], v[32:35], a[80:87], v2
    ds_read_b128 v[32:35], v8 offset:512
    v_smfmac_f32_16x16x64_bf16 v[20:23], v[36:39], a[88:95], v2
    ds_read_b128 v[36:39], v8 offset:1024
    v_smfmac_f32_16x16x64_bf16 v[20:23], v[40:43], a[96:103], v2
    ds_read_b128 v[40:43], v8 offset:1536
    v_smfmac_f32_16x16x64_bf16 v[20:23], v[44:47], a[104:111], v2
    ds_read_b128 v[44:47], v8 offset:2048
    v_cvt_pk_bf16_f32 v12, v12, v16
    v_cvt_pk_bf16_f32 v13, v13, v17
    v_smfmac_f32_16x16x64_bf16 v[20:23], v[48:51], a[112:119], v2
    v_cvt_pk_bf16_f32 v14, v14, v18
    v_cvt_pk_bf16_f32 v15, v15, v19
    v_smfmac_f32_16x16x64_bf16 v[20:23], v[52:55], a[120:127], v2
    ds_write_b32 v9, v12 offset:0
    ds_write_b32 v9, v13 offset:16
    v_smfmac_f32_16x16x64_bf16 v[20:23], v[56:59], a[128:135], v2
    ds_write_b32 v9, v14 offset:32
    ds_write_b32 v9, v15 offset:48
    v_smfmac_f32_16x16x64_bf16 v[20:23], v[60:63], a[136:143], v2
    s_waitcnt lgkmcnt(4)
    v_smfmac_f32_16x16x64_bf16 v[20:23], v[28:31], a[32:39], v2
    v_smfmac_f32_16x16x64_bf16 v[20:23], v[32:35], a[40:47], v2
    v_smfmac_f32_16x16x64_bf16 v[20:23], v[36:39], a[48:55], v2
    v_smfmac_f32_16x16x64_bf16 v[20:23], v[40:43], a[56:63], v2
    s_waitcnt lgkmcnt(0)
    s_barrier
    v_smfmac_f32_16x16x64_bf16 v[20:23], v[44:47], a[64:71], v2
    v_smfmac_f32_16x16x64_bf16 v[24:27], v[48:51], a[224:231], v2
    ds_read_b128 v[48:51], v8 offset:2560
    v_smfmac_f32_16x16x64_bf16 v[24:27], v[52:55], a[232:239], v2
    ds_read_b128 v[52:55], v8 offset:3072
    v_smfmac_f32_16x16x64_bf16 v[24:27], v[56:59], a[240:247], v2
    ds_read_b128 v[56:59], v8 offset:3584
    v_smfmac_f32_16x16x64_bf16 v[24:27], v[60:63], a[248:255], v2
    ds_read_b128 v[60:63], v8 offset:4096
    v_smfmac_f32_16x16x64_bf16 v[24:27], v[28:31], a[144:151], v2
    ds_read_b128 v[28:31], v8 offset:4608
    v_permlane32_swap_b32 v20, v21
    v_permlane32_swap_b32 v22, v23
    v_smfmac_f32_16x16x64_bf16 v[24:27], v[32:35], a[152:159], v2
    v_cvt_pk_bf16_f32 v20, v20, v21
    v_cvt_pk_bf16_f32 v22, v22, v23
    v_smfmac_f32_16x16x64_bf16 v[24:27], v[36:39], a[160:167], v2
    ds_write_b32 v10, v20 offset:4608
    ds_write_b32 v10, v22 offset:4640
    v_smfmac_f32_16x16x64_bf16 v[24:27], v[40:43], a[168:175], v2
    v_smfmac_f32_16x16x64_bf16 v[24:27], v[44:47], a[176:183], v2
    s_waitcnt lgkmcnt(2)
    v_smfmac_f32_16x16x64_bf16 v[24:27], v[48:51], a[184:191], v2
    v_smfmac_f32_16x16x64_bf16 v[24:27], v[52:55], a[192:199], v2
    v_smfmac_f32_16x16x64_bf16 v[24:27], v[56:59], a[200:207], v2
    s_waitcnt lgkmcnt(0)
    s_barrier
    v_smfmac_f32_16x16x64_bf16 v[24:27], v[60:63], a[208:215], v2
    v_smfmac_f32_16x16x64_bf16 v[24:27], v[28:31], a[216:223], v2
    s_nop 7
    v_permlane32_swap_b32 v24, v25
    v_permlane32_swap_b32 v26, v27
    v_cvt_pk_bf16_f32 v24, v24, v25
    v_cvt_pk_bf16_f32 v26, v26, v27
    ds_write_b32 v10, v24 offset:5184
    ds_write_b32 v10, v26 offset:5216
    s_waitcnt lgkmcnt(0)
    s_barrier
    s_add_u32 s20, s20, 1
    s_cmp_lt_u32 s20, 63
    s_cbranch_scc1 sc_loop_f0
    s_branch k2_end
sc_w1_f:
    s_cmp_lg_u32 s3, 1
    s_cbranch_scc1 sc_w2_f
    s_mov_b32 s20, 0
sc_loop_f1:
    s_and_b32 s21, s20, 3
    s_lshl_b32 s24, s21, 14
    s_add_u32 s24, s24, 73760768
    s_add_u32 s25, s24, 8192
    s_lshl_b32 s26, s21, 15
    s_add_u32 s26, s26, 73826304
    s_add_u32 s45, s26, 16384
    s_xor_b32 s22, s21, 2
    s_lshl_b32 s27, s22, 15
    s_add_u32 s27, s27, 73826304
    s_add_u32 s44, s20, 1
    s_and_b32 s22, s44, 3
    s_lshl_b32 s28, s22, 14
    s_add_u32 s28, s28, 73760768
    s_xor_b32 s22, s22, 2
    s_lshl_b32 s29, s22, 14
    s_add_u32 s29, s29, 73760768
    v_mov_b64 v[12:13], 0
    v_mov_b64 v[14:15], 0
    v_mov_b64 v[16:17], 0
    v_mov_b64 v[18:19], 0
    v_mov_b64 v[20:21], 0
    v_mov_b64 v[22:23], 0
    v_mov_b64 v[24:25], 0
    v_mov_b64 v[26:27], 0
    s_mov_b32 s30, 200000
    s_mov_b64 exec, s[42:43]
    buffer_load_dword v28, v5, s[4:7], s46 offen offset:0 sc1
    s_nop 15
    s_nop 9
wf_34:
    buffer_load_dword v29, v5, s[4:7], s46 offen offset:128 sc1
    s_waitcnt vmcnt(1)
    v_cmp_gt_u32 vcc, s20, v28
    s_cbranch_vccz wfo_35
    buffer_load_dword v28, v5, s[4:7], s46 offen offset:0 sc1
    s_waitcnt vmcnt(1)
    v_cmp_gt_u32 vcc, s20, v29
    s_cbranch_vccz wfo_35
    s_sub_u32 s30, s30, 1
    s_cmp_lg_u32 s30, 0
    s_cbranch_scc1 wf_34
    s_mov_b64 exec, -1
    s_branch k2_end
wfo_35:
    s_mov_b64 exec, -1
wfb_33:
    s_mov_b32 s30, 200000
    buffer_load_dwordx4 v[28:31], v3, s[4:7], s24 offen sc1
    buffer_load_dwordx4 v[32:35], v4, s[4:7], s24 offen sc1
    s_nop 15
    s_nop 15
    s_nop 7
pm_36:
    buffer_load_dwordx4 v[36:39], v3, s[4:7], s25 offen sc1
    buffer_load_dwordx4 v[40:43], v4, s[4:7], s25 offen sc1
    s_waitcnt vmcnt(2)
    ds_write_b128 v3, v[28:31]
    ds_write_b128 v4, v[32:35]
    v_max3_u32 v0, v28, v29, v30
    v_max3_u32 v1, v31, v32, v33
    v_max3_u32 v0, v0, v34, v35
    v_max_u32 v0, v0, v1
    v_cmp_eq_u32 vcc, -1, v0
    s_cbranch_vccnz pm1_38
pmo_37:
    ds_read_b128 v[44:47], v8 offset:2048
    ds_read_b128 v[48:51], v8 offset:2560
    ds_read_b128 v[52:55], v8 offset:3072
    s_waitcnt lgkmcnt(3)
    s_barrier
    ds_read_b128 v[56:59], v8 offset:3584
    ds_read_b128 v[60:63], v8 offset:4096
    s_waitcnt lgkmcnt(4)
    v_smfmac_f32_16x16x64_bf16 v[12:15], v[44:47], v[96:103], v2
    v_smfmac_f32_16x16x64_bf16 v[16:19], v[44:47], v[208:215], v2
    s_waitcnt lgkmcnt(3)
    v_smfmac_f32_16x16x64_bf16 v[12:15], v[48:51], v[104:111], v2
    v_smfmac_f32_16x16x64_bf16 v[16:19], v[48:51], v[216:223], v2
    s_waitcnt vmcnt(0)
    ds_read_b128 v[28:31], v8 offset:4608
    ds_read_b128 v[32:35], v8 offset:5120
    ds_read_b128 v[36:39], v8 offset:5632
    ds_read_b128 v[40:43], v8 offset:6144
    ds_read_b128 v[44:47], v8 offset:6656
    s_waitcnt lgkmcnt(7)
    v_smfmac_f32_16x16x64_bf16 v[12:15], v[52:55], v[112:119], v2
    v_smfmac_f32_16x16x64_bf16 v[16:19], v[52:55], v[224:231], v2
    ds_read_b128 v[48:51], v8 offset:0
    s_waitcnt lgkmcnt(7)
    v_smfmac_f32_16x16x64_bf16 v[12:15], v[56:59], v[120:127], v2
    v_smfmac_f32_16x16x64_bf16 v[16:19], v[56:59], v[232:239], v2
    ds_read_b128 v[52:55], v8 offset:512
    s_waitcnt lgkmcnt(7)
    v_smfmac_f32_16x16x64_bf16 v[12:15], v[60:63], v[128:135], v2
    v_smfmac_f32_16x16x64_bf16 v[16:19], v[60:63], v[240:247], v2
    ds_read_b128 v[56:59], v8 offset:1024
    s_waitcnt lgkmcnt(4)
    v_smfmac_f32_16x16x64_bf16 v[12:15], v[28:31], v[136:143], v2
    v_smfmac_f32_16x16x64_bf16 v[16:19], v[28:31], v[248:255], v2
    ds_read_b128 v[60:63], v8 offset:1536
    v_smfmac_f32_16x16x64_bf16 v[12:15], v[32:35], v[144:151], v2
    v_smfmac_f32_16x16x64_bf16 v[16:19], v[32:35], a[0:7], v2
    v_smfmac_f32_16x16x64_bf16 v[12:15], v[36:39], v[152:159], v2
    v_smfmac_f32_16x16x64_bf16 v[16:19], v[36:39], a[8:15], v2
    v_smfmac_f32_16x16x64_bf16 v[12:15], v[40:43], v[160:167], v2
    v_smfmac_f32_16x16x64_bf16 v[16:19], v[40:43], a[16:23], v2
    s_waitcnt lgkmcnt(0)
    v_smfmac_f32_16x16x64_bf16 v[12:15], v[44:47], v[168:175], v2
    v_smfmac_f32_16x16x64_bf16 v[16:19], v[44:47], a[24:31], v2
    v_smfmac_f32_16x16x64_bf16 v[12:15], v[48:51], v[64:71], v2
    v_smfmac_f32_16x16x64_bf16 v[16:19], v[48:51], v[176:183], v2
    v_smfmac_f32_16x16x64_bf16 v[12:15], v[52:55], v[72:79], v2
    v_smfmac_f32_16x16x64_bf16 v[16:19], v[52:55], v[184:191], v2
    v_smfmac_f32_16x16x64_bf16 v[12:15], v[56:59], v[80:87], v2
    v_smfmac_f32_16x16x64_bf16 v[16:19], v[56:59], v[192:199], v2
    v_smfmac_f32_16x16x64_bf16 v[12:15], v[60:63], v[88:95], v2
    v_smfmac_f32_16x16x64_bf16 v[16:19], v[60:63], v[200:207], v2
    v_smfmac_f32_16x16x64_bf16 v[20:23], v[28:31], a[104:111], v2
    ds_read_b128 v[28:31], v8 offset:2048
    v_smfmac_f32_16x16x64_bf16 v[20:23], v[32:35], a[112:119], v2
    ds_read_b128 v[32:35], v8 offset:2560
    v_smfmac_f32_16x16x64_bf16 v[20:23], v[36:39], a[120:127], v2
    ds_read_b128 v[36:39], v8 offset:3072
    v_smfmac_f32_16x16x64_bf16 v[20:23], v[40:43], a[128:135], v2
    ds_read_b128 v[40:43], v8 offset:3584
    v_smfmac_f32_16x16x64_bf16 v[20:23], v[44:47], a[136:143], v2
    ds_read_b128 v[44:47], v8 offset:4096
    v_cvt_pk_bf16_f32 v12, v12, v16
    v_cvt_pk_bf16_f32 v13, v13, v17
    v_smfmac_f32_16x16x64_bf16 v[20:23], v[48:51], a[32:39], v2
    v_cvt_pk_bf16_f32 v14, v14, v18
    v_cvt_pk_bf16_f32 v15, v15, v19
    v_smfmac_f32_16x16x64_bf16 v[20:23], v[52:55], a[40:47], v2
    ds_write_b32 v9, v12 offset:0
    ds_write_b32 v9, v13 offset:16
    v_smfmac_f32_16x16x64_bf16 v[20:23], v[56:59], a[48:55], v2
    ds_write_b32 v9, v14 offset:32
    ds_write_b32 v9, v15 offset:48
    v_smfmac_f32_16x16x64_bf16 v[20:23], v[60:63], a[56:63], v2
    s_waitcnt lgkmcnt(4)
    v_smfmac_f32_16x16x64_bf16 v[20:23], v[28:31], a[64:71], v2
    v_smfmac_f32_16x16x64_bf16 v[20:23], v[32:35], a[72:79], v2
    v_smfmac_f32_16x16x64_bf16 v[20:23], v[36:39], a[80:87], v2
    v_smfmac_f32_16x16x64_bf16 v[20:23], v[40:43], a[88:95], v2
    s_waitcnt lgkmcnt(0)
    s_barrier
    v_smfmac_f32_16x16x64_bf16 v[20:23], v[44:47], a[96:103], v2
    v_smfmac_f32_16x16x64_bf16 v[24:27], v[48:51], a[144:151], v2
    ds_read_b128 v[48:51], v8 offset:4608
    v_smfmac_f32_16x16x64_bf16 v[24:27], v[52:55], a[152:159], v2
    ds_read_b128 v[52:55], v8 offset:5120
    v_smfmac_f32_16x16x64_bf16 v[24:27], v[56:59], a[160:167], v2
    ds_read_b128 v[56:59], v8 offset:5632
    v_smfmac_f32_16x16x64_bf16 v[24:27], v[60:63], a[168:175], v2
    ds_read_b128 v[60:63], v8 offset:6144
    v_smfmac_f32_16x16x64_bf16 v[24:27], v[28:31], a[176:183], v2
    ds_read_b128 v[28:31], v8 offset:6656
    v_permlane32_swap_b32 v20, v21
    v_permlane32_swap_b32 v22, v23
    v_smfmac_f32_16x16x64_bf16 v[24:27], v[32:35], a[184:191], v2
    v_cvt_pk_bf16_f32 v20, v20, v21
    v_cvt_pk_bf16_f32 v22, v22, v23
    v_smfmac_f32_16x16x64_bf16 v[24:27], v[36:39], a[192:199], v2
    ds_write_b32 v10, v20 offset:4608
    ds_write_b32 v10, v22 offset:4640
    v_smfmac_f32_16x16x64_bf16 v[24:27], v[40:43], a[200:207], v2
    v_smfmac_f32_16x16x64_bf16 v[24:27], v[44:47], a[208:215], v2
    s_waitcnt lgkmcnt(2)
    v_smfmac_f32_16x16x64_bf16 v[24:27], v[48:51], a[216:223], v2
    v_smfmac_f32_16x16x64_bf16 v[24:27], v[52:55], a[224:231], v2
    v_smfmac_f32_16x16x64_bf16 v[24:27], v[56:59], a[232:239], v2
    s_waitcnt lgkmcnt(0)
    s_barrier
    v_smfmac_f32_16x16x64_bf16 v[24:27], v[60:63], a[240:247], v2
    v_smfmac_f32_16x16x64_bf16 v[24:27], v[28:31], a[248:255], v2
    s_nop 7
    v_permlane32_swap_b32 v24, v25
    v_permlane32_swap_b32 v26, v27
    v_cvt_pk_bf16_f32 v24, v24, v25
    v_cvt_pk_bf16_f32 v26, v26, v27
    ds_write_b32 v10, v24 offset:5184
    ds_write_b32 v10, v26 offset:5216
    s_waitcnt lgkmcnt(0)
    s_barrier
    s_add_u32 s20, s20, 1
    s_cmp_lt_u32 s20, 63
    s_cbranch_scc1 sc_loop_f1
    s_branch k2_end
sc_w2_f:
    s_mov_b32 s20, 0
sc_loop_f2:
    s_and_b32 s21, s20, 3
    s_lshl_b32 s24, s21, 14
    s_add_u32 s24, s24, 73760768
    s_add_u32 s25, s24, 8192
    s_lshl_b32 s26, s21, 15
    s_add_u32 s26, s26, 73826304
    s_add_u32 s45, s26, 16384
    s_xor_b32 s22, s21, 2
    s_lshl_b32 s27, s22, 15
    s_add_u32 s27, s27, 73826304
    s_add_u32 s44, s20, 1
    s_and_b32 s22, s44, 3
    s_lshl_b32 s28, s22, 14
    s_add_u32 s28, s28, 73760768
    s_xor_b32 s22, s22, 2
    s_lshl_b32 s29, s22, 14
    s_add_u32 s29, s29, 73760768
    v_mov_b64 v[12:13], 0
    v_mov_b64 v[14:15], 0
    v_mov_b64 v[16:17], 0
    v_mov_b64 v[18:19], 0
    v_mov_b64 v[20:21], 0
    v_mov_b64 v[22:23], 0
    v_mov_b64 v[24:25], 0
    v_mov_b64 v[26:27], 0
    s_mov_b32 s30, 200000
    s_mov_b64 exec, s[42:43]
    buffer_load_dword v28, v5, s[4:7], s46 offen offset:0 sc1
    s_nop 15
    s_nop 9
wf_40:
    buffer_load_dword v29, v5, s[4:7], s46 offen offset:128 sc1
    s_waitcnt vmcnt(1)
    v_cmp_gt_u32 vcc, s20, v28
    s_cbranch_vccz wfo_41
    buffer_load_dword v28, v5, s[4:7], s46 offen offset:0 sc1
    s_waitcnt vmcnt(1)
    v_cmp_gt_u32 vcc, s20, v29
    s_cbranch_vccz wfo_41
    s_sub_u32 s30, s30, 1
    s_cmp_lg_u32 s30, 0
    s_cbranch_scc1 wf_40
    s_mov_b64 exec, -1
    s_branch k2_end
wfo_41:
    s_mov_b64 exec, -1
wfb_39:
    s_mov_b32 s30, 200000
    buffer_load_dwordx4 v[28:31], v3, s[4:7], s24 offen sc1
    buffer_load_dwordx4 v[32:35], v4, s[4:7], s24 offen sc1
    s_nop 15
    s_nop 15
    s_nop 7
pm_42:
    buffer_load_dwordx4 v[36:39], v3, s[4:7], s25 offen sc1
    buffer_load_dwordx4 v[40:43], v4, s[4:7], s25 offen sc1
    s_waitcnt vmcnt(2)
    ds_write_b128 v3, v[28:31]
    ds_write_b128 v4, v[32:35]
    v_max3_u32 v0, v28, v29, v30
    v_max3_u32 v1, v31, v32, v33
    v_max3_u32 v0, v0, v34, v35
    v_max_u32 v0, v0, v1
    v_cmp_eq_u32 vcc, -1, v0
    s_cbranch_vccnz pm1_44
pmo_43:
    ds_read_b128 v[44:47], v8 offset:3584
    ds_read_b128 v[48:51], v8 offset:4096
    ds_read_b128 v[52:55], v8 offset:4608
    s_waitcnt lgkmcnt(3)
    s_barrier
    ds_read_b128 v[56:59], v8 offset:5120
    ds_read_b128 v[60:63], v8 offset:5632
    s_waitcnt lgkmcnt(4)
    v_smfmac_f32_16x16x64_bf16 v[12:15], v[44:47], v[120:127], v2
    v_smfmac_f32_16x16x64_bf16 v[16:19], v[44:47], v[232:239], v2
    s_waitcnt lgkmcnt(3)
    v_smfmac_f32_16x16x64_bf16 v[12:15], v[48:51], v[128:135], v2
    v_smfmac_f32_16x16x64_bf16 v[16:19], v[48:51], v[240:247], v2
    s_waitcnt vmcnt(0)
    ds_read_b128 v[28:31], v8 offset:6144
    ds_read_b128 v[32:35], v8 offset:6656
    ds_read_b128 v[36:39], v8 offset:0
    ds_read_b128 v[40:43], v8 offset:512
    ds_read_b128 v[44:47], v8 offset:1024
    s_waitcnt lgkmcnt(7)
    v_smfmac_f32_16x16x64_bf16 v[12:15], v[52:55], v[136:143], v2
    v_smfmac_f32_16x16x64_bf16 v[16:19], v[52:55], v[248:255], v2
    ds_read_b128 v[48:51], v8 offset:1536
    s_waitcnt lgkmcnt(7)
    v_smfmac_f32_16x16x64_bf16 v[12:15], v[56:59], v[144:151], v2
    v_smfmac_f32_16x16x64_bf16 v[16:19], v[56:59], a[0:7], v2
    ds_read_b128 v[52:55], v8 offset:2048
    s_waitcnt lgkmcnt(7)
    v_smfmac_f32_16x16x64_bf16 v[12:15], v[60:63], v[152:159], v2
    v_smfmac_f32_16x16x64_bf16 v[16:19], v[60:63], a[8:15], v2
    ds_read_b128 v[56:59], v8 offset:2560
    s_waitcnt lgkmcnt(4)
    v_smfmac_f32_16x16x64_bf16 v[12:15], v[28:31], v[160:167], v2
    v_smfmac_f32_16x16x64_bf16 v[16:19], v[28:31], a[16:23], v2
    ds_read_b128 v[60:63], v8 offset:3072
    v_smfmac_f32_16x16x64_bf16 v[12:15], v[32:35], v[168:175], v2
    v_smfmac_f32_16x16x64_bf16 v[16:19], v[32:35], a[24:31], v2
    v_smfmac_f32_16x16x64_bf16 v[12:15], v[36:39], v[64:71], v2
    v_smfmac_f32_16x16x64_bf16 v[16:19], v[36:39], v[176:183], v2
    v_smfmac_f32_16x16x64_bf16 v[12:15], v[40:43], v[72:79], v2
    v_smfmac_f32_16x16x64_bf16 v[16:19], v[40:43], v[184:191], v2
    s_waitcnt lgkmcnt(0)
    v_smfmac_f32_16x16x64_bf16 v[12:15], v[44:47], v[80:87], v2
    v_smfmac_f32_16x16x64_bf16 v[16:19], v[44:47], v[192:199], v2
    v_smfmac_f32_16x16x64_bf16 v[12:15], v[48:51], v[88:95], v2
    v_smfmac_f32_16x16x64_bf16 v[16:19], v[48:51], v[200:207], v2
    v_smfmac_f32_16x16x64_bf16 v[12:15], v[52:55], v[96:103], v2
    v_smfmac_f32_16x16x64_bf16 v[16:19], v[52:55], v[208:215], v2
    v_smfmac_f32_16x16x64_bf16 v[12:15], v[56:59], v[104:111], v2
    v_smfmac_f32_16x16x64_bf16 v[16:19], v[56:59], v[216:223], v2
    v_smfmac_f32_16x16x64_bf16 v[12:15], v[60:63], v[112:119], v2
    v_smfmac_f32_16x16x64_bf16 v[16:19], v[60:63], v[224:231], v2
    v_smfmac_f32_16x16x64_bf16 v[20:23], v[28:31], a[128:135], v2
    ds_read_b128 v[28:31], v8 offset:3584
    v_smfmac_f32_16x16x64_bf16 v[20:23], v[32:35], a[136:143], v2
    ds_read_b128 v[32:35], v8 offset:4096
    v_smfmac_f32_16x16x64_bf16 v[20:23], v[36:39], a[32:39], v2
    ds_read_b128 v[36:39], v8 offset:4608
    v_smfmac_f32_16x16x64_bf16 v[20:23], v[40:43], a[40:47], v2
    ds_read_b128 v[40:43], v8 offset:5120
    v_smfmac_f32_16x16x64_bf16 v[20:23], v[44:47], a[48:55], v2
    ds_read_b128 v[44:47], v8 offset:5632
    v_cvt_pk_bf16_f32 v12, v12, v16
    v_cvt_pk_bf16_f32 v13, v13, v17
    v_smfmac_f32_16x16x64_bf16 v[20:23], v[48:51], a[56:63], v2
    v_cvt_pk_bf16_f32 v14, v14, v18
    v_cvt_pk_bf16_f32 v15, v15, v19
    v_smfmac_f32_16x16x64_bf16 v[20:23], v[52:55], a[64:71], v2
    ds_write_b32 v9, v12 offset:0
    ds_write_b32 v9, v13 offset:16
    v_smfmac_f32_16x16x64_bf16 v[20:23], v[56:59], a[72:79], v2
    ds_write_b32 v9, v14 offset:32
    ds_write_b32 v9, v15 offset:48
    v_smfmac_f32_16x16x64_bf16 v[20:23], v[60:63], a[80:87], v2
    s_waitcnt lgkmcnt(4)
    v_smfmac_f32_16x16x64_bf16 v[20:23], v[28:31], a[88:95], v2
    v_smfmac_f32_16x16x64_bf16 v[20:23], v[32:35], a[96:103], v2
    v_smfmac_f32_16x16x64_bf16 v[20:23], v[36:39], a[104:111], v2
    v_smfmac_f32_16x16x64_bf16 v[20:23], v[40:43], a[112:119], v2
    s_waitcnt lgkmcnt(0)
    s_barrier
    v_smfmac_f32_16x16x64_bf16 v[20:23], v[44:47], a[120:127], v2
    v_smfmac_f32_16x16x64_bf16 v[24:27], v[48:51], a[168:175], v2
    ds_read_b128 v[48:51], v8 offset:6144
    v_smfmac_f32_16x16x64_bf16 v[24:27], v[52:55], a[176:183], v2
    ds_read_b128 v[52:55], v8 offset:6656
    v_smfmac_f32_16x16x64_bf16 v[24:27], v[56:59], a[184:191], v2
    ds_read_b128 v[56:59], v8 offset:0
    v_smfmac_f32_16x16x64_bf16 v[24:27], v[60:63], a[192:199], v2
    ds_read_b128 v[60:63], v8 offset:512
    v_smfmac_f32_16x16x64_bf16 v[24:27], v[28:31], a[200:207], v2
    ds_read_b128 v[28:31], v8 offset:1024
    v_permlane32_swap_b32 v20, v21
    v_permlane32_swap_b32 v22, v23
    v_smfmac_f32_16x16x64_bf16 v[24:27], v[32:35], a[208:215], v2
    v_cvt_pk_bf16_f32 v20, v20, v21
    v_cvt_pk_bf16_f32 v22, v22, v23
    v_smfmac_f32_16x16x64_bf16 v[24:27], v[36:39], a[216:223], v2
    ds_write_b32 v10, v20 offset:4608
    ds_write_b32 v10, v22 offset:4640
    v_smfmac_f32_16x16x64_bf16 v[24:27], v[40:43], a[224:231], v2
    v_smfmac_f32_16x16x64_bf16 v[24:27], v[44:47], a[232:239], v2
    s_waitcnt lgkmcnt(2)
    v_smfmac_f32_16x16x64_bf16 v[24:27], v[48:51], a[240:247], v2
    v_smfmac_f32_16x16x64_bf16 v[24:27], v[52:55], a[248:255], v2
    v_smfmac_f32_16x16x64_bf16 v[24:27], v[56:59], a[144:151], v2
    s_waitcnt lgkmcnt(0)
    s_barrier
    v_smfmac_f32_16x16x64_bf16 v[24:27], v[60:63], a[152:159], v2
    v_smfmac_f32_16x16x64_bf16 v[24:27], v[28:31], a[160:167], v2
    s_nop 7
    v_permlane32_swap_b32 v24, v25
    v_permlane32_swap_b32 v26, v27
    v_cvt_pk_bf16_f32 v24, v24, v25
    v_cvt_pk_bf16_f32 v26, v26, v27
    ds_write_b32 v10, v24 offset:5184
    ds_write_b32 v10, v26 offset:5216
    s_waitcnt lgkmcnt(0)
    s_barrier
    s_add_u32 s20, s20, 1
    s_cmp_lt_u32 s20, 63
    s_cbranch_scc1 sc_loop_f2
    s_branch k2_end
sc_fin_f:
    v_lshlrev_b32 v12, 4, v0
    v_and_b32 v11, 16, v0
    v_lshlrev_b32 v1, 2, v11
    v_lshrrev_b32 v11, 5, v0
    v_lshl_add_u32 v1, v11, 4, v1
    v_and_b32 v11, 12, v0
    v_lshl_add_u32 v13, v11, 6, v1
    v_and_b32 v11, 3, v0
    v_lshl_add_u32 v13, v11, 2, v13
    s_lshr_b32 s16, s17, 1
    s_lshl_b32 s16, s16, 10
    s_and_b32 s18, s17, 1
    s_lshl_b32 s19, s18, 7
    s_add_u32 s16, s16, s19
    v_add_u32 v13, s16, v13
    v_and_b32 v11, 8, v0
    v_lshl_add_u32 v14, v11, 2, v1
    v_cmp_ne_u32 s[34:35], 0, v11
    v_and_b32 v11, 7, v0
    v_lshl_add_u32 v14, v11, 1, v14
    s_lshr_b32 s16, s17, 3
    s_lshl_b32 s16, s16, 10
    s_and_b32 s19, s17, 3
    s_lshl_b32 s19, s19, 8
    s_add_u32 s16, s16, s19
    s_and_b32 s19, s17, 4
    s_lshl_b32 s19, s19, 5
    s_add_u32 s16, s16, s19
    s_add_u32 s16, s16, 8192
    v_add_u32 v14, s16, v14
    s_lshl_b32 s16, s17, 2
    v_lshlrev_b32 v6, 7, v0
    v_add_u32 v6, s16, v6
    v_lshrrev_b32 v11, 4, v0
    v_mul_u32_u24 v15, 144, v11
    v_and_b32 v11, 7, v0
    v_lshl_add_u32 v15, v11, 4, v15
    v_add_u32 v15, 8192, v15
    s_mov_b32 s31, 0x3fb8aa3b
    s_mov_b32 s33, 0x7fff7fff
    s_mov_b32 s38, 0
    s_mov_b32 s39, -1
    v_min_u32 v7, 2, v0
    v_lshlrev_b32 v7, 8, v7
    v_add_u32 v7, 16384, v7
    s_mov_b32 s36, 0
    s_mov_b32 s32, 3670016
    s_mov_b32 s23, s32
    buffer_load_dwordx4 v[144:147], v12, s[4:7], s23 offen offset:0
    buffer_load_dwordx4 v[148:151], v12, s[4:7], s23 offen offset:1024
    buffer_load_dwordx4 v[152:155], v12, s[4:7], s23 offen offset:2048
    buffer_load_dwordx4 v[156:159], v12, s[4:7], s23 offen offset:3072
    s_add_u32 s23, s23, 4096
    buffer_load_dwordx4 v[160:163], v12, s[4:7], s23 offen offset:0
    buffer_load_dwordx4 v[164:167], v12, s[4:7], s23 offen offset:1024
    buffer_load_dwordx4 v[168:171], v12, s[4:7], s23 offen offset:2048
    buffer_load_dwordx4 v[172:175], v12, s[4:7], s23 offen offset:3072
    s_add_u32 s23, s23, 4096
    buffer_load_dwordx4 v[176:179], v12, s[4:7], s23 offen offset:0
    buffer_load_dwordx4 v[180:183], v12, s[4:7], s23 offen offset:1024
    buffer_load_dwordx4 v[184:187], v12, s[4:7], s23 offen offset:2048
    buffer_load_dwordx4 v[188:191], v12, s[4:7], s23 offen offset:3072
    s_add_u32 s23, s23, 4096
    buffer_load_dwordx4 v[192:195], v12, s[4:7], s23 offen offset:0
    buffer_load_dwordx4 v[196:199], v12, s[4:7], s23 offen offset:1024
    buffer_load_dwordx4 v[200:203], v12, s[4:7], s23 offen offset:2048
    buffer_load_dwordx4 v[204:207], v12, s[4:7], s23 offen offset:3072
    s_add_u32 s23, s23, 4096
    buffer_load_dwordx4 v[208:211], v12, s[4:7], s23 offen offset:0
    buffer_load_dwordx4 v[212:215], v12, s[4:7], s23 offen offset:1024
    buffer_load_dwordx4 v[216:219], v12, s[4:7], s23 offen offset:2048
    buffer_load_dwordx4 v[220:223], v12, s[4:7], s23 offen offset:3072
    s_add_u32 s23, s23, 4096
    buffer_load_dwordx4 v[224:227], v12, s[4:7], s23 offen offset:0
    buffer_load_dwordx4 v[228:231], v12, s[4:7], s23 offen offset:1024
    buffer_load_dwordx4 v[232:235], v12, s[4:7], s23 offen offset:2048
    buffer_load_dwordx4 v[236:239], v12, s[4:7], s23 offen offset:3072
    s_add_u32 s23, s23, 4096
    buffer_load_dwordx4 v[240:243], v12, s[4:7], s23 offen offset:0
    buffer_load_dwordx4 v[244:247], v12, s[4:7], s23 offen offset:1024
    buffer_load_dwordx4 v[248:251], v12, s[4:7], s23 offen offset:2048
    buffer_load_dwordx4 v[252:255], v12, s[4:7], s23 offen offset:3072
    s_mov_b32 s20, 0
sf_loop_f:
    s_and_b32 s21, s20, 3
    s_lshl_b32 s24, s21, 14
    s_add_u32 s24, s24, 73760768
    s_add_u32 s25, s24, 8192
    s_lshl_b32 s26, s21, 15
    s_add_u32 s26, s26, 73826304
    s_add_u32 s45, s26, 16384
    s_xor_b32 s22, s21, 2
    s_lshl_b32 s27, s22, 15
    s_add_u32 s27, s27, 73826304
    s_add_u32 s44, s20, 1
    s_and_b32 s22, s44, 3
    s_lshl_b32 s28, s22, 14
    s_add_u32 s28, s28, 73760768
    s_xor_b32 s22, s22, 2
    s_lshl_b32 s29, s22, 14
    s_add_u32 s29, s29, 73760768
    v_mov_b64 v[16:17], 0
    v_mov_b64 v[18:19], 0
    v_mov_b64 v[20:21], 0
    v_mov_b64 v[22:23], 0
    v_mov_b64 v[24:25], 0
    v_mov_b64 v[26:27], 0
    v_mov_b64 v[28:29], 0
    v_mov_b64 v[30:31], 0
    s_mov_b32 s30, 200000
    s_mov_b64 exec, s[42:43]
    buffer_load_dword v32, v5, s[4:7], s46 offen offset:0 sc1
    s_nop 15
    s_nop 9
wf_46:
    buffer_load_dword v33, v5, s[4:7], s46 offen offset:128 sc1
    s_waitcnt vmcnt(1)
    v_cmp_gt_u32 vcc, s20, v32
    s_cbranch_vccz wfo_47
    buffer_load_dword v32, v5, s[4:7], s46 offen offset:0 sc1
    s_waitcnt vmcnt(1)
    v_cmp_gt_u32 vcc, s20, v33
    s_cbranch_vccz wfo_47
    s_sub_u32 s30, s30, 1
    s_cmp_lg_u32 s30, 0
    s_cbranch_scc1 wf_46
    s_mov_b64 exec, -1
    s_branch k2_end
wfo_47:
    s_mov_b64 exec, -1
wfb_45:
    s_mov_b32 s30, 200000
    buffer_load_dwordx4 v[32:35], v3, s[4:7], s24 offen sc1
    buffer_load_dwordx4 v[36:39], v4, s[4:7], s24 offen sc1
    s_nop 15
    s_nop 15
    s_nop 7
pm_48:
    buffer_load_dwordx4 v[48:51], v3, s[4:7], s25 offen sc1
    buffer_load_dwordx4 v[52:55], v4, s[4:7], s25 offen sc1
    s_waitcnt vmcnt(2)
    ds_write_b128 v3, v[32:35]
    ds_write_b128 v4, v[36:39]
    v_max3_u32 v0, v32, v33, v34
    v_max3_u32 v1, v35, v36, v37
    v_max3_u32 v0, v0, v38, v39
    v_max_u32 v0, v0, v1
    v_cmp_eq_u32 vcc, -1, v0
    s_cbranch_vccnz pm1_50
pmo_49:
    ds_read_b128 v[108:111], v8 offset:5632
    ds_read_b128 v[112:115], v8 offset:6144
    ds_read_b128 v[116:119], v8 offset:6656
    s_waitcnt lgkmcnt(3)
    s_barrier
    ds_read_b128 v[64:67], v8 offset:0
    ds_read_b128 v[68:71], v8 offset:512
    ds_read_b128 v[72:75], v8 offset:1024
    ds_read_b128 v[76:79], v8 offset:1536
    ds_read_b128 v[80:83], v8 offset:2048
    ds_read_b128 v[84:87], v8 offset:2560
    ds_read_b128 v[88:91], v8 offset:3072
    ds_read_b128 v[92:95], v8 offset:3584
    ds_read_b128 v[96:99], v8 offset:4096
    ds_read_b128 v[100:103], v8 offset:4608
    ds_read_b128 v[104:107], v8 offset:5120
    s_waitcnt lgkmcnt(13)
    v_smfmac_f32_16x16x64_bf16 v[16:19], v[108:111], a[88:95], v2
    v_smfmac_f32_16x16x64_bf16 v[20:23], v[108:111], a[200:207], v2
    s_waitcnt lgkmcnt(12)
    v_smfmac_f32_16x16x64_bf16 v[16:19], v[112:115], a[96:103], v2
    v_smfmac_f32_16x16x64_bf16 v[20:23], v[112:115], a[208:215], v2
    s_waitcnt lgkmcnt(11)
    v_smfmac_f32_16x16x64_bf16 v[16:19], v[116:119], a[104:111], v2
    v_smfmac_f32_16x16x64_bf16 v[20:23], v[116:119], a[216:223], v2
    s_waitcnt lgkmcnt(10)
    v_smfmac_f32_16x16x64_bf16 v[16:19], v[64:67], a[0:7], v2
    v_smfmac_f32_16x16x64_bf16 v[20:23], v[64:67], a[112:119], v2
    s_waitcnt lgkmcnt(9)
    v_smfmac_f32_16x16x64_bf16 v[16:19], v[68:71], a[8:15], v2
    v_smfmac_f32_16x16x64_bf16 v[20:23], v[68:71], a[120:127], v2
    s_waitcnt lgkmcnt(8)
    v_smfmac_f32_16x16x64_bf16 v[16:19], v[72:75], a[16:23], v2
    v_smfmac_f32_16x16x64_bf16 v[20:23], v[72:75], a[128:135], v2
    s_waitcnt lgkmcnt(7)
    v_smfmac_f32_16x16x64_bf16 v[16:19], v[76:79], a[24:31], v2
    v_smfmac_f32_16x16x64_bf16 v[20:23], v[76:79], a[136:143], v2
    s_waitcnt lgkmcnt(0)
    v_smfmac_f32_16x16x64_bf16 v[16:19], v[80:83], a[32:39], v2
    v_smfmac_f32_16x16x64_bf16 v[20:23], v[80:83], a[144:151], v2
    v_smfmac_f32_16x16x64_bf16 v[16:19], v[84:87], a[40:47], v2
    v_smfmac_f32_16x16x64_bf16 v[20:23], v[84:87], a[152:159], v2
    v_smfmac_f32_16x16x64_bf16 v[16:19], v[88:91], a[48:55], v2
    v_smfmac_f32_16x16x64_bf16 v[20:23], v[88:91], a[160:167], v2
    v_smfmac_f32_16x16x64_bf16 v[16:19], v[92:95], a[56:63], v2
    v_smfmac_f32_16x16x64_bf16 v[20:23], v[92:95], a[168:175], v2
    v_smfmac_f32_16x16x64_bf16 v[16:19], v[96:99], a[64:71], v2
    v_smfmac_f32_16x16x64_bf16 v[20:23], v[96:99], a[176:183], v2
    v_smfmac_f32_16x16x64_bf16 v[16:19], v[100:103], a[72:79], v2
    v_smfmac_f32_16x16x64_bf16 v[20:23], v[100:103], a[184:191], v2
    v_smfmac_f32_16x16x64_bf16 v[16:19], v[104:107], a[80:87], v2
    v_smfmac_f32_16x16x64_bf16 v[20:23], v[104:107], a[192:199], v2
    s_nop 7
    v_cvt_pk_bf16_f32 v16, v16, v20
    v_cvt_pk_bf16_f32 v17, v17, v21
    v_cvt_pk_bf16_f32 v18, v18, v22
    v_cvt_pk_bf16_f32 v19, v19, v23
    ds_write_b32 v9, v16 offset:0
    ds_write_b32 v9, v17 offset:16
    ds_write_b32 v9, v18 offset:32
    ds_write_b32 v9, v19 offset:48
    ds_read_b128 v[120:123], v15 offset:3456
    ds_read_b128 v[124:127], v15 offset:4032
    s_waitcnt lgkmcnt(1)
    v_smfmac_f32_16x16x64_bf16 v[24:27], v[120:123], v[192:199], v2
    v_mfma_f32_16x16x32_bf16 v[28:31], v[120:123], v[88:91], v[28:31]
    s_waitcnt lgkmcnt(0)
    v_smfmac_f32_16x16x64_bf16 v[24:27], v[124:127], v[200:207], v2
    v_mfma_f32_16x16x32_bf16 v[28:31], v[124:127], v[92:95], v[28:31]
    s_barrier
    ds_read_b128 v[128:131], v15 offset:0
    ds_read_b128 v[132:135], v15 offset:576
    ds_read_b128 v[120:123], v15 offset:1152
    ds_read_b128 v[124:127], v15 offset:1728
    s_waitcnt lgkmcnt(3)
    v_smfmac_f32_16x16x64_bf16 v[24:27], v[128:131], v[144:151], v2
    v_mfma_f32_16x16x32_bf16 v[28:31], v[128:131], v[64:67], v[28:31]
    ds_read_b128 v[128:131], v15 offset:2304
    s_waitcnt lgkmcnt(3)
    v_smfmac_f32_16x16x64_bf16 v[24:27], v[132:135], v[152:159], v2
    v_mfma_f32_16x16x32_bf16 v[28:31], v[132:135], v[68:71], v[28:31]
    ds_read_b128 v[132:135], v15 offset:2880
    s_waitcnt lgkmcnt(3)
    v_smfmac_f32_16x16x64_bf16 v[24:27], v[120:123], v[160:167], v2
    v_mfma_f32_16x16x32_bf16 v[28:31], v[120:123], v[72:75], v[28:31]
    s_waitcnt lgkmcnt(2)
    v_smfmac_f32_16x16x64_bf16 v[24:27], v[124:127], v[168:175], v2
    v_mfma_f32_16x16x32_bf16 v[28:31], v[124:127], v[76:79], v[28:31]
    s_barrier
    ds_read_b128 v[120:123], v15 offset:4608
    ds_read_b128 v[124:127], v15 offset:5760
    s_waitcnt lgkmcnt(3)
    v_smfmac_f32_16x16x64_bf16 v[24:27], v[128:131], v[176:183], v2
    v_mfma_f32_16x16x32_bf16 v[28:31], v[128:131], v[80:83], v[28:31]
    ds_read_b128 v[128:131], v15 offset:6912
    s_waitcnt lgkmcnt(3)
    v_smfmac_f32_16x16x64_bf16 v[24:27], v[132:135], v[184:191], v2
    v_mfma_f32_16x16x32_bf16 v[28:31], v[132:135], v[84:87], v[28:31]
    s_waitcnt lgkmcnt(2)
    v_smfmac_f32_16x16x64_bf16 v[24:27], v[120:123], v[208:215], v2
    v_mfma_f32_16x16x32_bf16 v[28:31], v[120:123], v[96:99], v[28:31]
    s_waitcnt lgkmcnt(1)
    v_smfmac_f32_16x16x64_bf16 v[24:27], v[124:127], v[224:231], v2
    v_mfma_f32_16x16x32_bf16 v[28:31], v[124:127], v[104:107], v[28:31]
    s_waitcnt lgkmcnt(0)
    v_smfmac_f32_16x16x64_bf16 v[24:27], v[128:131], v[240:247], v2
    v_mfma_f32_16x16x32_bf16 v[28:31], v[128:131], v[112:115], v[28:31]
    s_barrier
    ds_read_b128 v[132:135], v15 offset:5184
    ds_read_b128 v[120:123], v15 offset:6336
    ds_read_b128 v[124:127], v15 offset:7488
    s_waitcnt lgkmcnt(2)
    v_smfmac_f32_16x16x64_bf16 v[24:27], v[132:135], v[216:223], v2
    v_mfma_f32_16x16x32_bf16 v[28:31], v[132:135], v[100:103], v[28:31]
    s_waitcnt lgkmcnt(1)
    v_smfmac_f32_16x16x64_bf16 v[24:27], v[120:123], v[232:239], v2
    v_mfma_f32_16x16x32_bf16 v[28:31], v[120:123], v[108:111], v[28:31]
    s_waitcnt lgkmcnt(0)
    v_smfmac_f32_16x16x64_bf16 v[24:27], v[124:127], v[248:255], v2
    v_mfma_f32_16x16x32_bf16 v[28:31], v[124:127], v[116:119], v[28:31]
    s_nop 7
    v_permlane32_swap_b32 v24, v25
    v_permlane32_swap_b32 v26, v27
    v_cndmask_b32 v28, v28, v29, s[38:39]
    v_cndmask_b32 v30, v30, v31, s[38:39]
    v_max3_f32 v140, v24, v25, v28
    v_max3_f32 v141, v26, v27, v30
    v_sub_f32 v28, v28, v140
    v_max_f32_dpp v136, v140, v140 row_ror:8 row_mask:0xf bank_mask:0xf
    v_max_f32_dpp v137, v141, v141 row_ror:8 row_mask:0xf bank_mask:0xf
    v_sub_f32 v30, v30, v141
    v_sub_f32 v24, v24, v140
    v_sub_f32 v26, v26, v141
    v_max_f32_dpp v136, v136, v136 row_ror:4 row_mask:0xf bank_mask:0xf
    v_max_f32_dpp v137, v137, v137 row_ror:4 row_mask:0xf bank_mask:0xf
    v_sub_f32 v25, v25, v140
    v_sub_f32 v27, v27, v141
    v_exp_f32 v28, v28
    v_mov_b32 v143, s44
    s_mov_b64 exec, s[72:73]
    buffer_store_dword v143, v6, s[4:7], s41 offen
    s_mov_b64 exec, -1
    v_max_f32_dpp v136, v136, v136 row_ror:2 row_mask:0xf bank_mask:0xf
    v_max_f32_dpp v137, v137, v137 row_ror:2 row_mask:0xf bank_mask:0xf
    v_exp_f32 v30, v30
    v_exp_f32 v24, v24
    v_exp_f32 v26, v26
    v_max_f32_dpp v136, v136, v136 row_ror:1 row_mask:0xf bank_mask:0xf
    v_max_f32_dpp v137, v137, v137 row_ror:1 row_mask:0xf bank_mask:0xf
    v_exp_f32 v25, v25
    v_exp_f32 v27, v27
    v_sub_f32 v140, v140, v136
    v_sub_f32 v141, v141, v137
    v_fma_f32 v138, v28, 0.5, v24
    v_fma_f32 v139, v30, 0.5, v26
    v_exp_f32 v140, v140
    v_exp_f32 v141, v141
    v_add_f32 v138, v138, v25
    v_add_f32 v139, v139, v27
    v_mul_f32 v138, v138, v140
    v_mul_f32 v139, v139, v141
    v_mul_f32 v24, v24, v140
    v_mul_f32 v26, v26, v141
    v_add_f32_dpp v138, v138, v138 row_ror:8 row_mask:0xf bank_mask:0xf
    v_add_f32_dpp v139, v139, v139 row_ror:8 row_mask:0xf bank_mask:0xf
    v_mul_f32 v25, v25, v140
    v_mul_f32 v27, v27, v141
    v_add_f32_dpp v138, v138, v138 row_ror:4 row_mask:0xf bank_mask:0xf
    v_add_f32_dpp v139, v139, v139 row_ror:4 row_mask:0xf bank_mask:0xf
    v_mul_f32 v28, v28, v140
    v_add_f32_dpp v138, v138, v138 row_ror:2 row_mask:0xf bank_mask:0xf
    v_add_f32_dpp v139, v139, v139 row_ror:2 row_mask:0xf bank_mask:0xf
    v_mul_f32 v30, v30, v141
    v_add_f32_dpp v138, v138, v138 row_ror:1 row_mask:0xf bank_mask:0xf
    v_add_f32_dpp v139, v139, v139 row_ror:1 row_mask:0xf bank_mask:0xf
    v_rcp_f32 v138, v138
    v_rcp_f32 v139, v139
    v_cndmask_b32 v142, v28, v30, s[34:35]
    v_mul_f32 v24, v24, v138
    v_mul_f32 v26, v26, v139
    v_mul_f32 v25, v25, v138
    v_mul_f32 v27, v27, v139
    v_cndmask_b32 v143, v138, v139, s[34:35]
    v_cvt_pk_bf16_f32 v140, v24, v25
    v_cvt_pk_bf16_f32 v141, v26, v27
    v_mul_f32 v142, v142, v143
    v_and_b32 v140, s33, v140
    v_and_b32 v141, s33, v141
    v_cvt_pk_bf16_f32 v142, v142, v142
    buffer_store_dword v140, v13, s[4:7], s26 offen offset:0
    buffer_store_dword v141, v13, s[4:7], s26 offen offset:32
    v_and_b32 v142, s33, v142
    buffer_store_short v142, v14, s[4:7], s26 offen
    v_mov_b32 v143, -1
    buffer_store_dword v143, v13, s[4:7], s27 offen offset:0
    buffer_store_dword v143, v13, s[4:7], s27 offen offset:32
    buffer_store_short v143, v14, s[4:7], s27 offen
    s_add_u32 s32, s32, 28672
    s_mov_b32 s23, s32
    buffer_load_dwordx4 v[144:147], v12, s[4:7], s23 offen offset:0
    buffer_load_dwordx4 v[148:151], v12, s[4:7], s23 offen offset:1024
    buffer_load_dwordx4 v[152:155], v12, s[4:7], s23 offen offset:2048
    buffer_load_dwordx4 v[156:159], v12, s[4:7], s23 offen offset:3072
    s_add_u32 s23, s23, 4096
    buffer_load_dwordx4 v[160:163], v12, s[4:7], s23 offen offset:0
    buffer_load_dwordx4 v[164:167], v12, s[4:7], s23 offen offset:1024
    buffer_load_dwordx4 v[168:171], v12, s[4:7], s23 offen offset:2048
    buffer_load_dwordx4 v[172:175], v12, s[4:7], s23 offen offset:3072
    s_add_u32 s23, s23, 4096
    buffer_load_dwordx4 v[176:179], v12, s[4:7], s23 offen offset:0
    buffer_load_dwordx4 v[180:183], v12, s[4:7], s23 offen offset:1024
    buffer_load_dwordx4 v[184:187], v12, s[4:7], s23 offen offset:2048
    buffer_load_dwordx4 v[188:191], v12, s[4:7], s23 offen offset:3072
    s_add_u32 s23, s23, 4096
    buffer_load_dwordx4 v[192:195], v12, s[4:7], s23 offen offset:0
    buffer_load_dwordx4 v[196:199], v12, s[4:7], s23 offen offset:1024
    buffer_load_dwordx4 v[200:203], v12, s[4:7], s23 offen offset:2048
    buffer_load_dwordx4 v[204:207], v12, s[4:7], s23 offen offset:3072
    s_add_u32 s23, s23, 4096
    buffer_load_dwordx4 v[208:211], v12, s[4:7], s23 offen offset:0
    buffer_load_dwordx4 v[212:215], v12, s[4:7], s23 offen offset:1024
    buffer_load_dwordx4 v[216:219], v12, s[4:7], s23 offen offset:2048
    buffer_load_dwordx4 v[220:223], v12, s[4:7], s23 offen offset:3072
    s_add_u32 s23, s23, 4096
    buffer_load_dwordx4 v[224:227], v12, s[4:7], s23 offen offset:0
    buffer_load_dwordx4 v[228:231], v12, s[4:7], s23 offen offset:1024
    buffer_load_dwordx4 v[232:235], v12, s[4:7], s23 offen offset:2048
    buffer_load_dwordx4 v[236:239], v12, s[4:7], s23 offen offset:3072
    s_add_u32 s23, s23, 4096
    buffer_load_dwordx4 v[240:243], v12, s[4:7], s23 offen offset:0
    buffer_load_dwordx4 v[244:247], v12, s[4:7], s23 offen offset:1024
    buffer_load_dwordx4 v[248:251], v12, s[4:7], s23 offen offset:2048
    buffer_load_dwordx4 v[252:255], v12, s[4:7], s23 offen offset:3072
    s_add_u32 s20, s20, 1
    s_cmp_lt_u32 s20, 63
    s_cbranch_scc1 sf_loop_f
    s_branch k2_end
pm1_32:
    buffer_load_dwordx4 v[28:31], v3, s[4:7], s24 offen sc1
    buffer_load_dwordx4 v[32:35], v4, s[4:7], s24 offen sc1
    s_waitcnt vmcnt(2)
    ds_write_b128 v3, v[36:39]
    ds_write_b128 v4, v[40:43]
    v_max3_u32 v0, v36, v37, v38
    v_max3_u32 v1, v39, v40, v41
    v_max3_u32 v0, v0, v42, v43
    v_max_u32 v0, v0, v1
    v_cmp_eq_u32 vcc, -1, v0
    s_cbranch_vccz pmo_31
    s_sub_u32 s30, s30, 1
    s_cmp_gt_u32 s30, 199996
    s_cbranch_scc1 pm_30
    s_sleep 10
    s_cmp_lg_u32 s30, 0
    s_cbranch_scc1 pm_30
    s_branch k2_end
pm1_38:
    buffer_load_dwordx4 v[28:31], v3, s[4:7], s24 offen sc1
    buffer_load_dwordx4 v[32:35], v4, s[4:7], s24 offen sc1
    s_waitcnt vmcnt(2)
    ds_write_b128 v3, v[36:39]
    ds_write_b128 v4, v[40:43]
    v_max3_u32 v0, v36, v37, v38
    v_max3_u32 v1, v39, v40, v41
    v_max3_u32 v0, v0, v42, v43
    v_max_u32 v0, v0, v1
    v_cmp_eq_u32 vcc, -1, v0
    s_cbranch_vccz pmo_37
    s_sub_u32 s30, s30, 1
    s_cmp_gt_u32 s30, 199996
    s_cbranch_scc1 pm_36
    s_sleep 10
    s_cmp_lg_u32 s30, 0
    s_cbranch_scc1 pm_36
    s_branch k2_end
pm1_44:
    buffer_load_dwordx4 v[28:31], v3, s[4:7], s24 offen sc1
    buffer_load_dwordx4 v[32:35], v4, s[4:7], s24 offen sc1
    s_waitcnt vmcnt(2)
    ds_write_b128 v3, v[36:39]
    ds_write_b128 v4, v[40:43]
    v_max3_u32 v0, v36, v37, v38
    v_max3_u32 v1, v39, v40, v41
    v_max3_u32 v0, v0, v42, v43
    v_max_u32 v0, v0, v1
    v_cmp_eq_u32 vcc, -1, v0
    s_cbranch_vccz pmo_43
    s_sub_u32 s30, s30, 1
    s_cmp_gt_u32 s30, 199996
    s_cbranch_scc1 pm_42
    s_sleep 10
    s_cmp_lg_u32 s30, 0
    s_cbranch_scc1 pm_42
    s_branch k2_end
pm1_50:
    buffer_load_dwordx4 v[32:35], v3, s[4:7], s24 offen sc1
    buffer_load_dwordx4 v[36:39], v4, s[4:7], s24 offen sc1
    s_waitcnt vmcnt(2)
    ds_write_b128 v3, v[48:51]
    ds_write_b128 v4, v[52:55]
    v_max3_u32 v0, v48, v49, v50
    v_max3_u32 v1, v51, v52, v53
    v_max3_u32 v0, v0, v54, v55
    v_max_u32 v0, v0, v1
    v_cmp_eq_u32 vcc, -1, v0
    s_cbranch_vccz pmo_49
    s_sub_u32 s30, s30, 1
    s_cmp_gt_u32 s30, 199996
    s_cbranch_scc1 pm_48
    s_sleep 10
    s_cmp_lg_u32 s30, 0
    s_cbranch_scc1 pm_48
    s_branch k2_end
ch_score_slow:
    s_cmp_eq_u32 s3, 3
    s_cbranch_scc1 sc_fin_s
    s_cmp_lg_u32 s3, 0
    s_cbranch_scc1 sc_w1_s
    s_mov_b32 s20, 0
sc_loop_s0:
    s_and_b32 s21, s20, 3
    s_lshl_b32 s24, s21, 14
    s_add_u32 s24, s24, 73760768
    s_add_u32 s25, s24, 8192
    s_lshl_b32 s26, s21, 15
    s_add_u32 s26, s26, 73826304
    s_add_u32 s45, s26, 16384
    s_xor_b32 s22, s21, 2
    s_lshl_b32 s27, s22, 15
    s_add_u32 s27, s27, 73826304
    s_add_u32 s44, s20, 1
    s_and_b32 s22, s44, 3
    s_lshl_b32 s28, s22, 14
    s_add_u32 s28, s28, 73760768
    s_xor_b32 s22, s22, 2
    s_lshl_b32 s29, s22, 14
    s_add_u32 s29, s29, 73760768
    v_mov_b64 v[12:13], 0
    v_mov_b64 v[14:15], 0
    v_mov_b64 v[16:17], 0
    v_mov_b64 v[18:19], 0
    v_mov_b64 v[20:21], 0
    v_mov_b64 v[22:23], 0
    v_mov_b64 v[24:25], 0
    v_mov_b64 v[26:27], 0
    s_mov_b32 s30, 200000
    s_mov_b64 exec, s[42:43]
    buffer_load_dword v28, v5, s[4:7], s46 offen offset:0 sc1
    s_nop 15
    s_nop 9
wf_52:
    buffer_load_dword v29, v5, s[4:7], s46 offen offset:128 sc1
    s_waitcnt vmcnt(1)
    v_cmp_gt_u32 vcc, s20, v28
    s_cbranch_vccz wfo_53
    buffer_load_dword v28, v5, s[4:7], s46 offen offset:0 sc1
    s_waitcnt vmcnt(1)
    v_cmp_gt_u32 vcc, s20, v29
    s_cbranch_vccz wfo_53
    s_sub_u32 s30, s30, 1
    s_cmp_lg_u32 s30, 0
    s_cbranch_scc1 wf_52
    s_mov_b64 exec, -1
    s_branch k2_end
wfo_53:
    s_mov_b64 exec, -1
wfb_51:
    s_mov_b32 s30, 200000
    buffer_load_dwordx4 v[28:31], v3, s[4:7], s24 offen sc1
    buffer_load_dwordx4 v[32:35], v4, s[4:7], s24 offen sc1
    s_nop 15
    s_nop 15
    s_nop 7
pm_54:
    buffer_load_dwordx4 v[36:39], v3, s[4:7], s25 offen sc1
    buffer_load_dwordx4 v[40:43], v4, s[4:7], s25 offen sc1
    s_waitcnt vmcnt(2)
    ds_write_b128 v3, v[28:31]
    ds_write_b128 v4, v[32:35]
    v_max3_u32 v0, v28, v29, v30
    v_max3_u32 v1, v31, v32, v33
    v_max3_u32 v0, v0, v34, v35
    v_max_u32 v0, v0, v1
    v_cmp_eq_u32 vcc, -1, v0
    s_cbranch_vccnz pm1_56
pmo_55:
    ds_read_b128 v[44:47], v8 offset:0
    ds_read_b128 v[48:51], v8 offset:512
    ds_read_b128 v[52:55], v8 offset:1024
    s_waitcnt lgkmcnt(3)
    s_barrier
    ds_read_b128 v[56:59], v8 offset:1536
    ds_read_b128 v[60:63], v8 offset:2048
    s_waitcnt lgkmcnt(4)
    v_smfmac_f32_16x16x64_bf16 v[12:15], v[44:47], v[64:71], v2
    v_smfmac_f32_16x16x64_bf16 v[16:19], v[44:47], v[176:183], v2
    s_waitcnt lgkmcnt(3)
    v_smfmac_f32_16x16x64_bf16 v[12:15], v[48:51], v[72:79], v2
    v_smfmac_f32_16x16x64_bf16 v[16:19], v[48:51], v[184:191], v2
    s_waitcnt vmcnt(0)
    ds_read_b128 v[28:31], v8 offset:2560
    ds_read_b128 v[32:35], v8 offset:3072
    ds_read_b128 v[36:39], v8 offset:3584
    ds_read_b128 v[40:43], v8 offset:4096
    ds_read_b128 v[44:47], v8 offset:4608
    s_waitcnt lgkmcnt(7)
    v_smfmac_f32_16x16x64_bf16 v[12:15], v[52:55], v[80:87], v2
    v_smfmac_f32_16x16x64_bf16 v[16:19], v[52:55], v[192:199], v2
    ds_read_b128 v[48:51], v8 offset:5120
    s_waitcnt lgkmcnt(7)
    v_smfmac_f32_16x16x64_bf16 v[12:15], v[56:59], v[88:95], v2
    v_smfmac_f32_16x16x64_bf16 v[16:19], v[56:59], v[200:207], v2
    ds_read_b128 v[52:55], v8 offset:5632
    s_waitcnt lgkmcnt(7)
    v_smfmac_f32_16x16x64_bf16 v[12:15], v[60:63], v[96:103], v2
    v_smfmac_f32_16x16x64_bf16 v[16:19], v[60:63], v[208:215], v2
    ds_read_b128 v[56:59], v8 offset:6144
    s_waitcnt lgkmcnt(4)
    v_smfmac_f32_16x16x64_bf16 v[12:15], v[28:31], v[104:111], v2
    v_smfmac_f32_16x16x64_bf16 v[16:19], v[28:31], v[216:223], v2
    ds_read_b128 v[60:63], v8 offset:6656
    v_smfmac_f32_16x16x64_bf16 v[12:15], v[32:35], v[112:119], v2
    v_smfmac_f32_16x16x64_bf16 v[16:19], v[32:35], v[224:231], v2
    v_smfmac_f32_16x16x64_bf16 v[12:15], v[36:39], v[120:127], v2
    v_smfmac_f32_16x16x64_bf16 v[16:19], v[36:39], v[232:239], v2
    v_smfmac_f32_16x16x64_bf16 v[12:15], v[40:43], v[128:135], v2
    v_smfmac_f32_16x16x64_bf16 v[16:19], v[40:43], v[240:247], v2
    s_waitcnt lgkmcnt(0)
    v_smfmac_f32_16x16x64_bf16 v[12:15], v[44:47], v[136:143], v2
    v_smfmac_f32_16x16x64_bf16 v[16:19], v[44:47], v[248:255], v2
    v_smfmac_f32_16x16x64_bf16 v[12:15], v[48:51], v[144:151], v2
    v_smfmac_f32_16x16x64_bf16 v[16:19], v[48:51], a[0:7], v2
    v_smfmac_f32_16x16x64_bf16 v[12:15], v[52:55], v[152:159], v2
    v_smfmac_f32_16x16x64_bf16 v[16:19], v[52:55], a[8:15], v2
    v_smfmac_f32_16x16x64_bf16 v[12:15], v[56:59], v[160:167], v2
    v_smfmac_f32_16x16x64_bf16 v[16:19], v[56:59], a[16:23], v2
    v_smfmac_f32_16x16x64_bf16 v[12:15], v[60:63], v[168:175], v2
    v_smfmac_f32_16x16x64_bf16 v[16:19], v[60:63], a[24:31], v2
    v_smfmac_f32_16x16x64_bf16 v[20:23], v[28:31], a[72:79], v2
    ds_read_b128 v[28:31], v8 offset:0
    v_smfmac_f32_16x16x64_bf16 v[20:23], v[32:35], a[80:87], v2
    ds_read_b128 v[32:35], v8 offset:512
    v_smfmac_f32_16x16x64_bf16 v[20:23], v[36:39], a[88:95], v2
    ds_read_b128 v[36:39], v8 offset:1024
    v_smfmac_f32_16x16x64_bf16 v[20:23], v[40:43], a[96:103], v2
    ds_read_b128 v[40:43], v8 offset:1536
    v_smfmac_f32_16x16x64_bf16 v[20:23], v[44:47], a[104:111], v2
    ds_read_b128 v[44:47], v8 offset:2048
    v_cvt_pk_bf16_f32 v12, v12, v16
    v_cvt_pk_bf16_f32 v13, v13, v17
    v_smfmac_f32_16x16x64_bf16 v[20:23], v[48:51], a[112:119], v2
    v_cvt_pk_bf16_f32 v14, v14, v18
    v_cvt_pk_bf16_f32 v15, v15, v19
    v_smfmac_f32_16x16x64_bf16 v[20:23], v[52:55], a[120:127], v2
    ds_write_b32 v9, v12 offset:0
    ds_write_b32 v9, v13 offset:16
    v_smfmac_f32_16x16x64_bf16 v[20:23], v[56:59], a[128:135], v2
    ds_write_b32 v9, v14 offset:32
    ds_write_b32 v9, v15 offset:48
    v_smfmac_f32_16x16x64_bf16 v[20:23], v[60:63], a[136:143], v2
    s_waitcnt lgkmcnt(4)
    v_smfmac_f32_16x16x64_bf16 v[20:23], v[28:31], a[32:39], v2
    v_smfmac_f32_16x16x64_bf16 v[20:23], v[32:35], a[40:47], v2
    v_smfmac_f32_16x16x64_bf16 v[20:23], v[36:39], a[48:55], v2
    v_smfmac_f32_16x16x64_bf16 v[20:23], v[40:43], a[56:63], v2
    s_waitcnt lgkmcnt(0)
    s_barrier
    v_smfmac_f32_16x16x64_bf16 v[20:23], v[44:47], a[64:71], v2
    v_smfmac_f32_16x16x64_bf16 v[24:27], v[48:51], a[224:231], v2
    ds_read_b128 v[48:51], v8 offset:2560
    v_smfmac_f32_16x16x64_bf16 v[24:27], v[52:55], a[232:239], v2
    ds_read_b128 v[52:55], v8 offset:3072
    v_smfmac_f32_16x16x64_bf16 v[24:27], v[56:59], a[240:247], v2
    ds_read_b128 v[56:59], v8 offset:3584
    v_smfmac_f32_16x16x64_bf16 v[24:27], v[60:63], a[248:255], v2
    ds_read_b128 v[60:63], v8 offset:4096
    v_smfmac_f32_16x16x64_bf16 v[24:27], v[28:31], a[144:151], v2
    ds_read_b128 v[28:31], v8 offset:4608
    v_permlane32_swap_b32 v20, v21
    v_permlane32_swap_b32 v22, v23
    v_smfmac_f32_16x16x64_bf16 v[24:27], v[32:35], a[152:159], v2
    v_cvt_pk_bf16_f32 v20, v20, v21
    v_cvt_pk_bf16_f32 v22, v22, v23
    v_smfmac_f32_16x16x64_bf16 v[24:27], v[36:39], a[160:167], v2
    ds_write_b32 v10, v20 offset:4608
    ds_write_b32 v10, v22 offset:4640
    v_smfmac_f32_16x16x64_bf16 v[24:27], v[40:43], a[168:175], v2
    v_smfmac_f32_16x16x64_bf16 v[24:27], v[44:47], a[176:183], v2
    s_waitcnt lgkmcnt(2)
    v_smfmac_f32_16x16x64_bf16 v[24:27], v[48:51], a[184:191], v2
    v_smfmac_f32_16x16x64_bf16 v[24:27], v[52:55], a[192:199], v2
    v_smfmac_f32_16x16x64_bf16 v[24:27], v[56:59], a[200:207], v2
    s_waitcnt lgkmcnt(0)
    s_barrier
    v_smfmac_f32_16x16x64_bf16 v[24:27], v[60:63], a[208:215], v2
    v_smfmac_f32_16x16x64_bf16 v[24:27], v[28:31], a[216:223], v2
    s_nop 7
    v_permlane32_swap_b32 v24, v25
    v_permlane32_swap_b32 v26, v27
    v_cvt_pk_bf16_f32 v24, v24, v25
    v_cvt_pk_bf16_f32 v26, v26, v27
    ds_write_b32 v10, v24 offset:5184
    ds_write_b32 v10, v26 offset:5216
    s_waitcnt lgkmcnt(0)
    s_barrier
    s_add_u32 s20, s20, 1
    s_cmp_lt_u32 s20, 63
    s_cbranch_scc1 sc_loop_s0
    s_branch k2_end
sc_w1_s:
    s_cmp_lg_u32 s3, 1
    s_cbranch_scc1 sc_w2_s
    s_mov_b32 s20, 0
sc_loop_s1:
    s_and_b32 s21, s20, 3
    s_lshl_b32 s24, s21, 14
    s_add_u32 s24, s24, 73760768
    s_add_u32 s25, s24, 8192
    s_lshl_b32 s26, s21, 15
    s_add_u32 s26, s26, 73826304
    s_add_u32 s45, s26, 16384
    s_xor_b32 s22, s21, 2
    s_lshl_b32 s27, s22, 15
    s_add_u32 s27, s27, 73826304
    s_add_u32 s44, s20, 1
    s_and_b32 s22, s44, 3
    s_lshl_b32 s28, s22, 14
    s_add_u32 s28, s28, 73760768
    s_xor_b32 s22, s22, 2
    s_lshl_b32 s29, s22, 14
    s_add_u32 s29, s29, 73760768
    v_mov_b64 v[12:13], 0
    v_mov_b64 v[14:15], 0
    v_mov_b64 v[16:17], 0
    v_mov_b64 v[18:19], 0
    v_mov_b64 v[20:21], 0
    v_mov_b64 v[22:23], 0
    v_mov_b64 v[24:25], 0
    v_mov_b64 v[26:27], 0
    s_mov_b32 s30, 200000
    s_mov_b64 exec, s[42:43]
    buffer_load_dword v28, v5, s[4:7], s46 offen offset:0 sc1
    s_nop 15
    s_nop 9
wf_58:
    buffer_load_dword v29, v5, s[4:7], s46 offen offset:128 sc1
    s_waitcnt vmcnt(1)
    v_cmp_gt_u32 vcc, s20, v28
    s_cbranch_vccz wfo_59
    buffer_load_dword v28, v5, s[4:7], s46 offen offset:0 sc1
    s_waitcnt vmcnt(1)
    v_cmp_gt_u32 vcc, s20, v29
    s_cbranch_vccz wfo_59
    s_sub_u32 s30, s30, 1
    s_cmp_lg_u32 s30, 0
    s_cbranch_scc1 wf_58
    s_mov_b64 exec, -1
    s_branch k2_end
wfo_59:
    s_mov_b64 exec, -1
wfb_57:
    s_mov_b32 s30, 200000
    buffer_load_dwordx4 v[28:31], v3, s[4:7], s24 offen sc1
    buffer_load_dwordx4 v[32:35], v4, s[4:7], s24 offen sc1
    s_nop 15
    s_nop 15
    s_nop 7
pm_60:
    buffer_load_dwordx4 v[36:39], v3, s[4:7], s25 offen sc1
    buffer_load_dwordx4 v[40:43], v4, s[4:7], s25 offen sc1
    s_waitcnt vmcnt(2)
    ds_write_b128 v3, v[28:31]
    ds_write_b128 v4, v[32:35]
    v_max3_u32 v0, v28, v29, v30
    v_max3_u32 v1, v31, v32, v33
    v_max3_u32 v0, v0, v34, v35
    v_max_u32 v0, v0, v1
    v_cmp_eq_u32 vcc, -1, v0
    s_cbranch_vccnz pm1_62
pmo_61:
    ds_read_b128 v[44:47], v8 offset:2048
    ds_read_b128 v[48:51], v8 offset:2560
    ds_read_b128 v[52:55], v8 offset:3072
    s_waitcnt lgkmcnt(3)
    s_barrier
    ds_read_b128 v[56:59], v8 offset:3584
    ds_read_b128 v[60:63], v8 offset:4096
    s_waitcnt lgkmcnt(4)
    v_smfmac_f32_16x16x64_bf16 v[12:15], v[44:47], v[96:103], v2
    v_smfmac_f32_16x16x64_bf16 v[16:19], v[44:47], v[208:215], v2
    s_waitcnt lgkmcnt(3)
    v_smfmac_f32_16x16x64_bf16 v[12:15], v[48:51], v[104:111], v2
    v_smfmac_f32_16x16x64_bf16 v[16:19], v[48:51], v[216:223], v2
    s_waitcnt vmcnt(0)
    ds_read_b128 v[28:31], v8 offset:4608
    ds_read_b128 v[32:35], v8 offset:5120
    ds_read_b128 v[36:39], v8 offset:5632
    ds_read_b128 v[40:43], v8 offset:6144
    ds_read_b128 v[44:47], v8 offset:6656
    s_waitcnt lgkmcnt(7)
    v_smfmac_f32_16x16x64_bf16 v[12:15], v[52:55], v[112:119], v2
    v_smfmac_f32_16x16x64_bf16 v[16:19], v[52:55], v[224:231], v2
    ds_read_b128 v[48:51], v8 offset:0
    s_waitcnt lgkmcnt(7)
    v_smfmac_f32_16x16x64_bf16 v[12:15], v[56:59], v[120:127], v2
    v_smfmac_f32_16x16x64_bf16 v[16:19], v[56:59], v[232:239], v2
    ds_read_b128 v[52:55], v8 offset:512
    s_waitcnt lgkmcnt(7)
    v_smfmac_f32_16x16x64_bf16 v[12:15], v[60:63], v[128:135], v2
    v_smfmac_f32_16x16x64_bf16 v[16:19], v[60:63], v[240:247], v2
    ds_read_b128 v[56:59], v8 offset:1024
    s_waitcnt lgkmcnt(4)
    v_smfmac_f32_16x16x64_bf16 v[12:15], v[28:31], v[136:143], v2
    v_smfmac_f32_16x16x64_bf16 v[16:19], v[28:31], v[248:255], v2
    ds_read_b128 v[60:63], v8 offset:1536
    v_smfmac_f32_16x16x64_bf16 v[12:15], v[32:35], v[144:151], v2
    v_smfmac_f32_16x16x64_bf16 v[16:19], v[32:35], a[0:7], v2
    v_smfmac_f32_16x16x64_bf16 v[12:15], v[36:39], v[152:159], v2
    v_smfmac_f32_16x16x64_bf16 v[16:19], v[36:39], a[8:15], v2
    v_smfmac_f32_16x16x64_bf16 v[12:15], v[40:43], v[160:167], v2
    v_smfmac_f32_16x16x64_bf16 v[16:19], v[40:43], a[16:23], v2
    s_waitcnt lgkmcnt(0)
    v_smfmac_f32_16x16x64_bf16 v[12:15], v[44:47], v[168:175], v2
    v_smfmac_f32_16x16x64_bf16 v[16:19], v[44:47], a[24:31], v2
    v_smfmac_f32_16x16x64_bf16 v[12:15], v[48:51], v[64:71], v2
    v_smfmac_f32_16x16x64_bf16 v[16:19], v[48:51], v[176:183], v2
    v_smfmac_f32_16x16x64_bf16 v[12:15], v[52:55], v[72:79], v2
    v_smfmac_f32_16x16x64_bf16 v[16:19], v[52:55], v[184:191], v2
    v_smfmac_f32_16x16x64_bf16 v[12:15], v[56:59], v[80:87], v2
    v_smfmac_f32_16x16x64_bf16 v[16:19], v[56:59], v[192:199], v2
    v_smfmac_f32_16x16x64_bf16 v[12:15], v[60:63], v[88:95], v2
    v_smfmac_f32_16x16x64_bf16 v[16:19], v[60:63], v[200:207], v2
    v_smfmac_f32_16x16x64_bf16 v[20:23], v[28:31], a[104:111], v2
    ds_read_b128 v[28:31], v8 offset:2048
    v_smfmac_f32_16x16x64_bf16 v[20:23], v[32:35], a[112:119], v2
    ds_read_b128 v[32:35], v8 offset:2560
    v_smfmac_f32_16x16x64_bf16 v[20:23], v[36:39], a[120:127], v2
    ds_read_b128 v[36:39], v8 offset:3072
    v_smfmac_f32_16x16x64_bf16 v[20:23], v[40:43], a[128:135], v2
    ds_read_b128 v[40:43], v8 offset:3584
    v_smfmac_f32_16x16x64_bf16 v[20:23], v[44:47], a[136:143], v2
    ds_read_b128 v[44:47], v8 offset:4096
    v_cvt_pk_bf16_f32 v12, v12, v16
    v_cvt_pk_bf16_f32 v13, v13, v17
    v_smfmac_f32_16x16x64_bf16 v[20:23], v[48:51], a[32:39], v2
    v_cvt_pk_bf16_f32 v14, v14, v18
    v_cvt_pk_bf16_f32 v15, v15, v19
    v_smfmac_f32_16x16x64_bf16 v[20:23], v[52:55], a[40:47], v2
    ds_write_b32 v9, v12 offset:0
    ds_write_b32 v9, v13 offset:16
    v_smfmac_f32_16x16x64_bf16 v[20:23], v[56:59], a[48:55], v2
    ds_write_b32 v9, v14 offset:32
    ds_write_b32 v9, v15 offset:48
    v_smfmac_f32_16x16x64_bf16 v[20:23], v[60:63], a[56:63], v2
    s_waitcnt lgkmcnt(4)
    v_smfmac_f32_16x16x64_bf16 v[20:23], v[28:31], a[64:71], v2
    v_smfmac_f32_16x16x64_bf16 v[20:23], v[32:35], a[72:79], v2
    v_smfmac_f32_16x16x64_bf16 v[20:23], v[36:39], a[80:87], v2
    v_smfmac_f32_16x16x64_bf16 v[20:23], v[40:43], a[88:95], v2
    s_waitcnt lgkmcnt(0)
    s_barrier
    v_smfmac_f32_16x16x64_bf16 v[20:23], v[44:47], a[96:103], v2
    v_smfmac_f32_16x16x64_bf16 v[24:27], v[48:51], a[144:151], v2
    ds_read_b128 v[48:51], v8 offset:4608
    v_smfmac_f32_16x16x64_bf16 v[24:27], v[52:55], a[152:159], v2
    ds_read_b128 v[52:55], v8 offset:5120
    v_smfmac_f32_16x16x64_bf16 v[24:27], v[56:59], a[160:167], v2
    ds_read_b128 v[56:59], v8 offset:5632
    v_smfmac_f32_16x16x64_bf16 v[24:27], v[60:63], a[168:175], v2
    ds_read_b128 v[60:63], v8 offset:6144
    v_smfmac_f32_16x16x64_bf16 v[24:27], v[28:31], a[176:183], v2
    ds_read_b128 v[28:31], v8 offset:6656
    v_permlane32_swap_b32 v20, v21
    v_permlane32_swap_b32 v22, v23
    v_smfmac_f32_16x16x64_bf16 v[24:27], v[32:35], a[184:191], v2
    v_cvt_pk_bf16_f32 v20, v20, v21
    v_cvt_pk_bf16_f32 v22, v22, v23
    v_smfmac_f32_16x16x64_bf16 v[24:27], v[36:39], a[192:199], v2
    ds_write_b32 v10, v20 offset:4608
    ds_write_b32 v10, v22 offset:4640
    v_smfmac_f32_16x16x64_bf16 v[24:27], v[40:43], a[200:207], v2
    v_smfmac_f32_16x16x64_bf16 v[24:27], v[44:47], a[208:215], v2
    s_waitcnt lgkmcnt(2)
    v_smfmac_f32_16x16x64_bf16 v[24:27], v[48:51], a[216:223], v2
    v_smfmac_f32_16x16x64_bf16 v[24:27], v[52:55], a[224:231], v2
    v_smfmac_f32_16x16x64_bf16 v[24:27], v[56:59], a[232:239], v2
    s_waitcnt lgkmcnt(0)
    s_barrier
    v_smfmac_f32_16x16x64_bf16 v[24:27], v[60:63], a[240:247], v2
    v_smfmac_f32_16x16x64_bf16 v[24:27], v[28:31], a[248:255], v2
    s_nop 7
    v_permlane32_swap_b32 v24, v25
    v_permlane32_swap_b32 v26, v27
    v_cvt_pk_bf16_f32 v24, v24, v25
    v_cvt_pk_bf16_f32 v26, v26, v27
    ds_write_b32 v10, v24 offset:5184
    ds_write_b32 v10, v26 offset:5216
    s_waitcnt lgkmcnt(0)
    s_barrier
    s_add_u32 s20, s20, 1
    s_cmp_lt_u32 s20, 63
    s_cbranch_scc1 sc_loop_s1
    s_branch k2_end
sc_w2_s:
    s_mov_b32 s20, 0
sc_loop_s2:
    s_and_b32 s21, s20, 3
    s_lshl_b32 s24, s21, 14
    s_add_u32 s24, s24, 73760768
    s_add_u32 s25, s24, 8192
    s_lshl_b32 s26, s21, 15
    s_add_u32 s26, s26, 73826304
    s_add_u32 s45, s26, 16384
    s_xor_b32 s22, s21, 2
    s_lshl_b32 s27, s22, 15
    s_add_u32 s27, s27, 73826304
    s_add_u32 s44, s20, 1
    s_and_b32 s22, s44, 3
    s_lshl_b32 s28, s22, 14
    s_add_u32 s28, s28, 73760768
    s_xor_b32 s22, s22, 2
    s_lshl_b32 s29, s22, 14
    s_add_u32 s29, s29, 73760768
    v_mov_b64 v[12:13], 0
    v_mov_b64 v[14:15], 0
    v_mov_b64 v[16:17], 0
    v_mov_b64 v[18:19], 0
    v_mov_b64 v[20:21], 0
    v_mov_b64 v[22:23], 0
    v_mov_b64 v[24:25], 0
    v_mov_b64 v[26:27], 0
    s_mov_b32 s30, 200000
    s_mov_b64 exec, s[42:43]
    buffer_load_dword v28, v5, s[4:7], s46 offen offset:0 sc1
    s_nop 15
    s_nop 9
wf_64:
    buffer_load_dword v29, v5, s[4:7], s46 offen offset:128 sc1
    s_waitcnt vmcnt(1)
    v_cmp_gt_u32 vcc, s20, v28
    s_cbranch_vccz wfo_65
    buffer_load_dword v28, v5, s[4:7], s46 offen offset:0 sc1
    s_waitcnt vmcnt(1)
    v_cmp_gt_u32 vcc, s20, v29
    s_cbranch_vccz wfo_65
    s_sub_u32 s30, s30, 1
    s_cmp_lg_u32 s30, 0
    s_cbranch_scc1 wf_64
    s_mov_b64 exec, -1
    s_branch k2_end
wfo_65:
    s_mov_b64 exec, -1
wfb_63:
    s_mov_b32 s30, 200000
    buffer_load_dwordx4 v[28:31], v3, s[4:7], s24 offen sc1
    buffer_load_dwordx4 v[32:35], v4, s[4:7], s24 offen sc1
    s_nop 15
    s_nop 15
    s_nop 7
pm_66:
    buffer_load_dwordx4 v[36:39], v3, s[4:7], s25 offen sc1
    buffer_load_dwordx4 v[40:43], v4, s[4:7], s25 offen sc1
    s_waitcnt vmcnt(2)
    ds_write_b128 v3, v[28:31]
    ds_write_b128 v4, v[32:35]
    v_max3_u32 v0, v28, v29, v30
    v_max3_u32 v1, v31, v32, v33
    v_max3_u32 v0, v0, v34, v35
    v_max_u32 v0, v0, v1
    v_cmp_eq_u32 vcc, -1, v0
    s_cbranch_vccnz pm1_68
pmo_67:
    ds_read_b128 v[44:47], v8 offset:3584
    ds_read_b128 v[48:51], v8 offset:4096
    ds_read_b128 v[52:55], v8 offset:4608
    s_waitcnt lgkmcnt(3)
    s_barrier
    ds_read_b128 v[56:59], v8 offset:5120
    ds_read_b128 v[60:63], v8 offset:5632
    s_waitcnt lgkmcnt(4)
    v_smfmac_f32_16x16x64_bf16 v[12:15], v[44:47], v[120:127], v2
    v_smfmac_f32_16x16x64_bf16 v[16:19], v[44:47], v[232:239], v2
    s_waitcnt lgkmcnt(3)
    v_smfmac_f32_16x16x64_bf16 v[12:15], v[48:51], v[128:135], v2
    v_smfmac_f32_16x16x64_bf16 v[16:19], v[48:51], v[240:247], v2
    s_waitcnt vmcnt(0)
    ds_read_b128 v[28:31], v8 offset:6144
    ds_read_b128 v[32:35], v8 offset:6656
    ds_read_b128 v[36:39], v8 offset:0
    ds_read_b128 v[40:43], v8 offset:512
    ds_read_b128 v[44:47], v8 offset:1024
    s_waitcnt lgkmcnt(7)
    v_smfmac_f32_16x16x64_bf16 v[12:15], v[52:55], v[136:143], v2
    v_smfmac_f32_16x16x64_bf16 v[16:19], v[52:55], v[248:255], v2
    ds_read_b128 v[48:51], v8 offset:1536
    s_waitcnt lgkmcnt(7)
    v_smfmac_f32_16x16x64_bf16 v[12:15], v[56:59], v[144:151], v2
    v_smfmac_f32_16x16x64_bf16 v[16:19], v[56:59], a[0:7], v2
    ds_read_b128 v[52:55], v8 offset:2048
    s_waitcnt lgkmcnt(7)
    v_smfmac_f32_16x16x64_bf16 v[12:15], v[60:63], v[152:159], v2
    v_smfmac_f32_16x16x64_bf16 v[16:19], v[60:63], a[8:15], v2
    ds_read_b128 v[56:59], v8 offset:2560
    s_waitcnt lgkmcnt(4)
    v_smfmac_f32_16x16x64_bf16 v[12:15], v[28:31], v[160:167], v2
    v_smfmac_f32_16x16x64_bf16 v[16:19], v[28:31], a[16:23], v2
    ds_read_b128 v[60:63], v8 offset:3072
    v_smfmac_f32_16x16x64_bf16 v[12:15], v[32:35], v[168:175], v2
    v_smfmac_f32_16x16x64_bf16 v[16:19], v[32:35], a[24:31], v2
    v_smfmac_f32_16x16x64_bf16 v[12:15], v[36:39], v[64:71], v2
    v_smfmac_f32_16x16x64_bf16 v[16:19], v[36:39], v[176:183], v2
    v_smfmac_f32_16x16x64_bf16 v[12:15], v[40:43], v[72:79], v2
    v_smfmac_f32_16x16x64_bf16 v[16:19], v[40:43], v[184:191], v2
    s_waitcnt lgkmcnt(0)
    v_smfmac_f32_16x16x64_bf16 v[12:15], v[44:47], v[80:87], v2
    v_smfmac_f32_16x16x64_bf16 v[16:19], v[44:47], v[192:199], v2
    v_smfmac_f32_16x16x64_bf16 v[12:15], v[48:51], v[88:95], v2
    v_smfmac_f32_16x16x64_bf16 v[16:19], v[48:51], v[200:207], v2
    v_smfmac_f32_16x16x64_bf16 v[12:15], v[52:55], v[96:103], v2
    v_smfmac_f32_16x16x64_bf16 v[16:19], v[52:55], v[208:215], v2
    v_smfmac_f32_16x16x64_bf16 v[12:15], v[56:59], v[104:111], v2
    v_smfmac_f32_16x16x64_bf16 v[16:19], v[56:59], v[216:223], v2
    v_smfmac_f32_16x16x64_bf16 v[12:15], v[60:63], v[112:119], v2
    v_smfmac_f32_16x16x64_bf16 v[16:19], v[60:63], v[224:231], v2
    v_smfmac_f32_16x16x64_bf16 v[20:23], v[28:31], a[128:135], v2
    ds_read_b128 v[28:31], v8 offset:3584
    v_smfmac_f32_16x16x64_bf16 v[20:23], v[32:35], a[136:143], v2
    ds_read_b128 v[32:35], v8 offset:4096
    v_smfmac_f32_16x16x64_bf16 v[20:23], v[36:39], a[32:39], v2
    ds_read_b128 v[36:39], v8 offset:4608
    v_smfmac_f32_16x16x64_bf16 v[20:23], v[40:43], a[40:47], v2
    ds_read_b128 v[40:43], v8 offset:5120
    v_smfmac_f32_16x16x64_bf16 v[20:23], v[44:47], a[48:55], v2
    ds_read_b128 v[44:47], v8 offset:5632
    v_cvt_pk_bf16_f32 v12, v12, v16
    v_cvt_pk_bf16_f32 v13, v13, v17
    v_smfmac_f32_16x16x64_bf16 v[20:23], v[48:51], a[56:63], v2
    v_cvt_pk_bf16_f32 v14, v14, v18
    v_cvt_pk_bf16_f32 v15, v15, v19
    v_smfmac_f32_16x16x64_bf16 v[20:23], v[52:55], a[64:71], v2
    ds_write_b32 v9, v12 offset:0
    ds_write_b32 v9, v13 offset:16
    v_smfmac_f32_16x16x64_bf16 v[20:23], v[56:59], a[72:79], v2
    ds_write_b32 v9, v14 offset:32
    ds_write_b32 v9, v15 offset:48
    v_smfmac_f32_16x16x64_bf16 v[20:23], v[60:63], a[80:87], v2
    s_waitcnt lgkmcnt(4)
    v_smfmac_f32_16x16x64_bf16 v[20:23], v[28:31], a[88:95], v2
    v_smfmac_f32_16x16x64_bf16 v[20:23], v[32:35], a[96:103], v2
    v_smfmac_f32_16x16x64_bf16 v[20:23], v[36:39], a[104:111], v2
    v_smfmac_f32_16x16x64_bf16 v[20:23], v[40:43], a[112:119], v2
    s_waitcnt lgkmcnt(0)
    s_barrier
    v_smfmac_f32_16x16x64_bf16 v[20:23], v[44:47], a[120:127], v2
    v_smfmac_f32_16x16x64_bf16 v[24:27], v[48:51], a[168:175], v2
    ds_read_b128 v[48:51], v8 offset:6144
    v_smfmac_f32_16x16x64_bf16 v[24:27], v[52:55], a[176:183], v2
    ds_read_b128 v[52:55], v8 offset:6656
    v_smfmac_f32_16x16x64_bf16 v[24:27], v[56:59], a[184:191], v2
    ds_read_b128 v[56:59], v8 offset:0
    v_smfmac_f32_16x16x64_bf16 v[24:27], v[60:63], a[192:199], v2
    ds_read_b128 v[60:63], v8 offset:512
    v_smfmac_f32_16x16x64_bf16 v[24:27], v[28:31], a[200:207], v2
    ds_read_b128 v[28:31], v8 offset:1024
    v_permlane32_swap_b32 v20, v21
    v_permlane32_swap_b32 v22, v23
    v_smfmac_f32_16x16x64_bf16 v[24:27], v[32:35], a[208:215], v2
    v_cvt_pk_bf16_f32 v20, v20, v21
    v_cvt_pk_bf16_f32 v22, v22, v23
    v_smfmac_f32_16x16x64_bf16 v[24:27], v[36:39], a[216:223], v2
    ds_write_b32 v10, v20 offset:4608
    ds_write_b32 v10, v22 offset:4640
    v_smfmac_f32_16x16x64_bf16 v[24:27], v[40:43], a[224:231], v2
    v_smfmac_f32_16x16x64_bf16 v[24:27], v[44:47], a[232:239], v2
    s_waitcnt lgkmcnt(2)
    v_smfmac_f32_16x16x64_bf16 v[24:27], v[48:51], a[240:247], v2
    v_smfmac_f32_16x16x64_bf16 v[24:27], v[52:55], a[248:255], v2
    v_smfmac_f32_16x16x64_bf16 v[24:27], v[56:59], a[144:151], v2
    s_waitcnt lgkmcnt(0)
    s_barrier
    v_smfmac_f32_16x16x64_bf16 v[24:27], v[60:63], a[152:159], v2
    v_smfmac_f32_16x16x64_bf16 v[24:27], v[28:31], a[160:167], v2
    s_nop 7
    v_permlane32_swap_b32 v24, v25
    v_permlane32_swap_b32 v26, v27
    v_cvt_pk_bf16_f32 v24, v24, v25
    v_cvt_pk_bf16_f32 v26, v26, v27
    ds_write_b32 v10, v24 offset:5184
    ds_write_b32 v10, v26 offset:5216
    s_waitcnt lgkmcnt(0)
    s_barrier
    s_add_u32 s20, s20, 1
    s_cmp_lt_u32 s20, 63
    s_cbranch_scc1 sc_loop_s2
    s_branch k2_end
sc_fin_s:
    v_lshlrev_b32 v12, 4, v0
    v_and_b32 v11, 16, v0
    v_lshlrev_b32 v1, 2, v11
    v_lshrrev_b32 v11, 5, v0
    v_lshl_add_u32 v1, v11, 4, v1
    v_and_b32 v11, 12, v0
    v_lshl_add_u32 v13, v11, 6, v1
    v_and_b32 v11, 3, v0
    v_lshl_add_u32 v13, v11, 2, v13
    s_lshr_b32 s16, s17, 1
    s_lshl_b32 s16, s16, 10
    s_and_b32 s18, s17, 1
    s_lshl_b32 s19, s18, 7
    s_add_u32 s16, s16, s19
    v_add_u32 v13, s16, v13
    v_and_b32 v11, 8, v0
    v_lshl_add_u32 v14, v11, 2, v1
    v_cmp_ne_u32 s[34:35], 0, v11
    v_and_b32 v11, 7, v0
    v_lshl_add_u32 v14, v11, 1, v14
    s_lshr_b32 s16, s17, 3
    s_lshl_b32 s16, s16, 10
    s_and_b32 s19, s17, 3
    s_lshl_b32 s19, s19, 8
    s_add_u32 s16, s16, s19
    s_and_b32 s19, s17, 4
    s_lshl_b32 s19, s19, 5
    s_add_u32 s16, s16, s19
    s_add_u32 s16, s16, 8192
    v_add_u32 v14, s16, v14
    s_lshl_b32 s16, s17, 2
    v_lshlrev_b32 v6, 7, v0
    v_add_u32 v6, s16, v6
    v_lshrrev_b32 v11, 4, v0
    v_mul_u32_u24 v15, 144, v11
    v_and_b32 v11, 7, v0
    v_lshl_add_u32 v15, v11, 4, v15
    v_add_u32 v15, 8192, v15
    s_mov_b32 s31, 0x3fb8aa3b
    s_mov_b32 s33, 0x7fff7fff
    s_mov_b32 s38, 0
    s_mov_b32 s39, -1
    v_min_u32 v7, 2, v0
    v_lshlrev_b32 v7, 8, v7
    v_add_u32 v7, 16384, v7
    s_mov_b32 s36, 0
    s_mov_b32 s32, 3670016
    s_mov_b32 s23, s32
    buffer_load_dwordx4 v[144:147], v12, s[4:7], s23 offen offset:0
    buffer_load_dwordx4 v[148:151], v12, s[4:7], s23 offen offset:1024
    buffer_load_dwordx4 v[152:155], v12, s[4:7], s23 offen offset:2048
    buffer_load_dwordx4 v[156:159], v12, s[4:7], s23 offen offset:3072
    s_add_u32 s23, s23, 4096
    buffer_load_dwordx4 v[160:163], v12, s[4:7], s23 offen offset:0
    buffer_load_dwordx4 v[164:167], v12, s[4:7], s23 offen offset:1024
    buffer_load_dwordx4 v[168:171], v12, s[4:7], s23 offen offset:2048
    buffer_load_dwordx4 v[172:175], v12, s[4:7], s23 offen offset:3072
    s_add_u32 s23, s23, 4096
    buffer_load_dwordx4 v[176:179], v12, s[4:7], s23 offen offset:0
    buffer_load_dwordx4 v[180:183], v12, s[4:7], s23 offen offset:1024
    buffer_load_dwordx4 v[184:187], v12, s[4:7], s23 offen offset:2048
    buffer_load_dwordx4 v[188:191], v12, s[4:7], s23 offen offset:3072
    s_add_u32 s23, s23, 4096
    buffer_load_dwordx4 v[192:195], v12, s[4:7], s23 offen offset:0
    buffer_load_dwordx4 v[196:199], v12, s[4:7], s23 offen offset:1024
    buffer_load_dwordx4 v[200:203], v12, s[4:7], s23 offen offset:2048
    buffer_load_dwordx4 v[204:207], v12, s[4:7], s23 offen offset:3072
    s_add_u32 s23, s23, 4096
    buffer_load_dwordx4 v[208:211], v12, s[4:7], s23 offen offset:0
    buffer_load_dwordx4 v[212:215], v12, s[4:7], s23 offen offset:1024
    buffer_load_dwordx4 v[216:219], v12, s[4:7], s23 offen offset:2048
    buffer_load_dwordx4 v[220:223], v12, s[4:7], s23 offen offset:3072
    s_add_u32 s23, s23, 4096
    buffer_load_dwordx4 v[224:227], v12, s[4:7], s23 offen offset:0
    buffer_load_dwordx4 v[228:231], v12, s[4:7], s23 offen offset:1024
    buffer_load_dwordx4 v[232:235], v12, s[4:7], s23 offen offset:2048
    buffer_load_dwordx4 v[236:239], v12, s[4:7], s23 offen offset:3072
    s_add_u32 s23, s23, 4096
    buffer_load_dwordx4 v[240:243], v12, s[4:7], s23 offen offset:0
    buffer_load_dwordx4 v[244:247], v12, s[4:7], s23 offen offset:1024
    buffer_load_dwordx4 v[248:251], v12, s[4:7], s23 offen offset:2048
    buffer_load_dwordx4 v[252:255], v12, s[4:7], s23 offen offset:3072
    s_mov_b32 s20, 0
sf_loop_s:
    s_and_b32 s21, s20, 3
    s_lshl_b32 s24, s21, 14
    s_add_u32 s24, s24, 73760768
    s_add_u32 s25, s24, 8192
    s_lshl_b32 s26, s21, 15
    s_add_u32 s26, s26, 73826304
    s_add_u32 s45, s26, 16384
    s_xor_b32 s22, s21, 2
    s_lshl_b32 s27, s22, 15
    s_add_u32 s27, s27, 73826304
    s_add_u32 s44, s20, 1
    s_and_b32 s22, s44, 3
    s_lshl_b32 s28, s22, 14
    s_add_u32 s28, s28, 73760768
    s_xor_b32 s22, s22, 2
    s_lshl_b32 s29, s22, 14
    s_add_u32 s29, s29, 73760768
    v_mov_b64 v[16:17], 0
    v_mov_b64 v[18:19], 0
    v_mov_b64 v[20:21], 0
    v_mov_b64 v[22:23], 0
    v_mov_b64 v[24:25], 0
    v_mov_b64 v[26:27], 0
    v_mov_b64 v[28:29], 0
    v_mov_b64 v[30:31], 0
    s_mov_b32 s30, 200000
    s_mov_b64 exec, s[42:43]
    buffer_load_dword v32, v5, s[4:7], s46 offen offset:0 sc1
    s_nop 15
    s_nop 9
wf_70:
    buffer_load_dword v33, v5, s[4:7], s46 offen offset:128 sc1
    s_waitcnt vmcnt(1)
    v_cmp_gt_u32 vcc, s20, v32
    s_cbranch_vccz wfo_71
    buffer_load_dword v32, v5, s[4:7], s46 offen offset:0 sc1
    s_waitcnt vmcnt(1)
    v_cmp_gt_u32 vcc, s20, v33
    s_cbranch_vccz wfo_71
    s_sub_u32 s30, s30, 1
    s_cmp_lg_u32 s30, 0
    s_cbranch_scc1 wf_70
    s_mov_b64 exec, -1
    s_branch k2_end
wfo_71:
    s_mov_b64 exec, -1
wfb_69:
    s_mov_b32 s30, 200000
    buffer_load_dwordx4 v[32:35], v3, s[4:7], s24 offen sc1
    buffer_load_dwordx4 v[36:39], v4, s[4:7], s24 offen sc1
    s_nop 15
    s_nop 15
    s_nop 7
pm_72:
    buffer_load_dwordx4 v[48:51], v3, s[4:7], s25 offen sc1
    buffer_load_dwordx4 v[52:55], v4, s[4:7], s25 offen sc1
    s_waitcnt vmcnt(2)
    ds_write_b128 v3, v[32:35]
    ds_write_b128 v4, v[36:39]
    v_max3_u32 v0, v32, v33, v34
    v_max3_u32 v1, v35, v36, v37
    v_max3_u32 v0, v0, v38, v39
    v_max_u32 v0, v0, v1
    v_cmp_eq_u32 vcc, -1, v0
    s_cbranch_vccnz pm1_74
pmo_73:
    ds_read_b128 v[108:111], v8 offset:5632
    ds_read_b128 v[112:115], v8 offset:6144
    ds_read_b128 v[116:119], v8 offset:6656
    s_waitcnt lgkmcnt(3)
    s_barrier
    ds_read_b128 v[64:67], v8 offset:0
    ds_read_b128 v[68:71], v8 offset:512
    ds_read_b128 v[72:75], v8 offset:1024
    ds_read_b128 v[76:79], v8 offset:1536
    ds_read_b128 v[80:83], v8 offset:2048
    ds_read_b128 v[84:87], v8 offset:2560
    ds_read_b128 v[88:91], v8 offset:3072
    ds_read_b128 v[92:95], v8 offset:3584
    ds_read_b128 v[96:99], v8 offset:4096
    ds_read_b128 v[100:103], v8 offset:4608
    ds_read_b128 v[104:107], v8 offset:5120
    s_waitcnt lgkmcnt(13)
    v_smfmac_f32_16x16x64_bf16 v[16:19], v[108:111], a[88:95], v2
    v_smfmac_f32_16x16x64_bf16 v[20:23], v[108:111], a[200:207], v2
    s_waitcnt lgkmcnt(12)
    v_smfmac_f32_16x16x64_bf16 v[16:19], v[112:115], a[96:103], v2
    v_smfmac_f32_16x16x64_bf16 v[20:23], v[112:115], a[208:215], v2
    s_waitcnt lgkmcnt(11)
    v_smfmac_f32_16x16x64_bf16 v[16:19], v[116:119], a[104:111], v2
    v_smfmac_f32_16x16x64_bf16 v[20:23], v[116:119], a[216:223], v2
    s_waitcnt lgkmcnt(10)
    v_smfmac_f32_16x16x64_bf16 v[16:19], v[64:67], a[0:7], v2
    v_smfmac_f32_16x16x64_bf16 v[20:23], v[64:67], a[112:119], v2
    s_waitcnt lgkmcnt(9)
    v_smfmac_f32_16x16x64_bf16 v[16:19], v[68:71], a[8:15], v2
    v_smfmac_f32_16x16x64_bf16 v[20:23], v[68:71], a[120:127], v2
    s_waitcnt lgkmcnt(8)
    v_smfmac_f32_16x16x64_bf16 v[16:19], v[72:75], a[16:23], v2
    v_smfmac_f32_16x16x64_bf16 v[20:23], v[72:75], a[128:135], v2
    s_waitcnt lgkmcnt(7)
    v_smfmac_f32_16x16x64_bf16 v[16:19], v[76:79], a[24:31], v2
    v_smfmac_f32_16x16x64_bf16 v[20:23], v[76:79], a[136:143], v2
    s_waitcnt lgkmcnt(0)
    v_smfmac_f32_16x16x64_bf16 v[16:19], v[80:83], a[32:39], v2
    v_smfmac_f32_16x16x64_bf16 v[20:23], v[80:83], a[144:151], v2
    v_smfmac_f32_16x16x64_bf16 v[16:19], v[84:87], a[40:47], v2
    v_smfmac_f32_16x16x64_bf16 v[20:23], v[84:87], a[152:159], v2
    v_smfmac_f32_16x16x64_bf16 v[16:19], v[88:91], a[48:55], v2
    v_smfmac_f32_16x16x64_bf16 v[20:23], v[88:91], a[160:167], v2
    v_smfmac_f32_16x16x64_bf16 v[16:19], v[92:95], a[56:63], v2
    v_smfmac_f32_16x16x64_bf16 v[20:23], v[92:95], a[168:175], v2
    v_smfmac_f32_16x16x64_bf16 v[16:19], v[96:99], a[64:71], v2
    v_smfmac_f32_16x16x64_bf16 v[20:23], v[96:99], a[176:183], v2
    v_smfmac_f32_16x16x64_bf16 v[16:19], v[100:103], a[72:79], v2
    v_smfmac_f32_16x16x64_bf16 v[20:23], v[100:103], a[184:191], v2
    v_smfmac_f32_16x16x64_bf16 v[16:19], v[104:107], a[80:87], v2
    v_smfmac_f32_16x16x64_bf16 v[20:23], v[104:107], a[192:199], v2
    s_nop 7
    v_cvt_pk_bf16_f32 v16, v16, v20
    v_cvt_pk_bf16_f32 v17, v17, v21
    v_cvt_pk_bf16_f32 v18, v18, v22
    v_cvt_pk_bf16_f32 v19, v19, v23
    ds_write_b32 v9, v16 offset:0
    ds_write_b32 v9, v17 offset:16
    ds_write_b32 v9, v18 offset:32
    ds_write_b32 v9, v19 offset:48
    ds_read_b128 v[120:123], v15 offset:3456
    ds_read_b128 v[124:127], v15 offset:4032
    s_waitcnt lgkmcnt(1)
    v_smfmac_f32_16x16x64_bf16 v[24:27], v[120:123], v[192:199], v2
    v_mfma_f32_16x16x32_bf16 v[28:31], v[120:123], v[88:91], v[28:31]
    s_waitcnt lgkmcnt(0)
    v_smfmac_f32_16x16x64_bf16 v[24:27], v[124:127], v[200:207], v2
    v_mfma_f32_16x16x32_bf16 v[28:31], v[124:127], v[92:95], v[28:31]
    s_barrier
    ds_read_b128 v[128:131], v15 offset:0
    ds_read_b128 v[132:135], v15 offset:576
    ds_read_b128 v[120:123], v15 offset:1152
    ds_read_b128 v[124:127], v15 offset:1728
    s_waitcnt lgkmcnt(3)
    v_smfmac_f32_16x16x64_bf16 v[24:27], v[128:131], v[144:151], v2
    v_mfma_f32_16x16x32_bf16 v[28:31], v[128:131], v[64:67], v[28:31]
    ds_read_b128 v[128:131], v15 offset:2304
    s_waitcnt lgkmcnt(3)
    v_smfmac_f32_16x16x64_bf16 v[24:27], v[132:135], v[152:159], v2
    v_mfma_f32_16x16x32_bf16 v[28:31], v[132:135], v[68:71], v[28:31]
    ds_read_b128 v[132:135], v15 offset:2880
    s_waitcnt lgkmcnt(3)
    v_smfmac_f32_16x16x64_bf16 v[24:27], v[120:123], v[160:167], v2
    v_mfma_f32_16x16x32_bf16 v[28:31], v[120:123], v[72:75], v[28:31]
    s_waitcnt lgkmcnt(2)
    v_smfmac_f32_16x16x64_bf16 v[24:27], v[124:127], v[168:175], v2
    v_mfma_f32_16x16x32_bf16 v[28:31], v[124:127], v[76:79], v[28:31]
    s_barrier
    ds_read_b128 v[120:123], v15 offset:4608
    ds_read_b128 v[124:127], v15 offset:5760
    s_waitcnt lgkmcnt(3)
    v_smfmac_f32_16x16x64_bf16 v[24:27], v[128:131], v[176:183], v2
    v_mfma_f32_16x16x32_bf16 v[28:31], v[128:131], v[80:83], v[28:31]
    ds_read_b128 v[128:131], v15 offset:6912
    s_waitcnt lgkmcnt(3)
    v_smfmac_f32_16x16x64_bf16 v[24:27], v[132:135], v[184:191], v2
    v_mfma_f32_16x16x32_bf16 v[28:31], v[132:135], v[84:87], v[28:31]
    s_waitcnt lgkmcnt(2)
    v_smfmac_f32_16x16x64_bf16 v[24:27], v[120:123], v[208:215], v2
    v_mfma_f32_16x16x32_bf16 v[28:31], v[120:123], v[96:99], v[28:31]
    s_waitcnt lgkmcnt(1)
    v_smfmac_f32_16x16x64_bf16 v[24:27], v[124:127], v[224:231], v2
    v_mfma_f32_16x16x32_bf16 v[28:31], v[124:127], v[104:107], v[28:31]
    s_waitcnt lgkmcnt(0)
    v_smfmac_f32_16x16x64_bf16 v[24:27], v[128:131], v[240:247], v2
    v_mfma_f32_16x16x32_bf16 v[28:31], v[128:131], v[112:115], v[28:31]
    s_barrier
    ds_read_b128 v[132:135], v15 offset:5184
    ds_read_b128 v[120:123], v15 offset:6336
    ds_read_b128 v[124:127], v15 offset:7488
    s_waitcnt lgkmcnt(2)
    v_smfmac_f32_16x16x64_bf16 v[24:27], v[132:135], v[216:223], v2
    v_mfma_f32_16x16x32_bf16 v[28:31], v[132:135], v[100:103], v[28:31]
    s_waitcnt lgkmcnt(1)
    v_smfmac_f32_16x16x64_bf16 v[24:27], v[120:123], v[232:239], v2
    v_mfma_f32_16x16x32_bf16 v[28:31], v[120:123], v[108:111], v[28:31]
    s_waitcnt lgkmcnt(0)
    v_smfmac_f32_16x16x64_bf16 v[24:27], v[124:127], v[248:255], v2
    v_mfma_f32_16x16x32_bf16 v[28:31], v[124:127], v[116:119], v[28:31]
    s_nop 7
    v_permlane32_swap_b32 v24, v25
    v_permlane32_swap_b32 v26, v27
    v_cndmask_b32 v28, v28, v29, s[38:39]
    v_cndmask_b32 v30, v30, v31, s[38:39]
    v_max3_f32 v140, v24, v25, v28
    v_max3_f32 v141, v26, v27, v30
    v_sub_f32 v28, v28, v140
    v_max_f32_dpp v136, v140, v140 row_ror:8 row_mask:0xf bank_mask:0xf
    v_max_f32_dpp v137, v141, v141 row_ror:8 row_mask:0xf bank_mask:0xf
    v_sub_f32 v30, v30, v141
    v_sub_f32 v24, v24, v140
    v_sub_f32 v26, v26, v141
    v_max_f32_dpp v136, v136, v136 row_ror:4 row_mask:0xf bank_mask:0xf
    v_max_f32_dpp v137, v137, v137 row_ror:4 row_mask:0xf bank_mask:0xf
    v_sub_f32 v25, v25, v140
    v_sub_f32 v27, v27, v141
    v_exp_f32 v28, v28
    v_mov_b32 v143, s44
    s_mov_b64 exec, s[72:73]
    buffer_store_dword v143, v6, s[4:7], s41 offen sc1
    s_mov_b64 exec, -1
    v_max_f32_dpp v136, v136, v136 row_ror:2 row_mask:0xf bank_mask:0xf
    v_max_f32_dpp v137, v137, v137 row_ror:2 row_mask:0xf bank_mask:0xf
    v_exp_f32 v30, v30
    v_exp_f32 v24, v24
    v_exp_f32 v26, v26
    v_max_f32_dpp v136, v136, v136 row_ror:1 row_mask:0xf bank_mask:0xf
    v_max_f32_dpp v137, v137, v137 row_ror:1 row_mask:0xf bank_mask:0xf
    v_exp_f32 v25, v25
    v_exp_f32 v27, v27
    v_sub_f32 v140, v140, v136
    v_sub_f32 v141, v141, v137
    v_fma_f32 v138, v28, 0.5, v24
    v_fma_f32 v139, v30, 0.5, v26
    v_exp_f32 v140, v140
    v_exp_f32 v141, v141
    v_add_f32 v138, v138, v25
    v_add_f32 v139, v139, v27
    v_mul_f32 v138, v138, v140
    v_mul_f32 v139, v139, v141
    v_mul_f32 v24, v24, v140
    v_mul_f32 v26, v26, v141
    v_add_f32_dpp v138, v138, v138 row_ror:8 row_mask:0xf bank_mask:0xf
    v_add_f32_dpp v139, v139, v139 row_ror:8 row_mask:0xf bank_mask:0xf
    v_mul_f32 v25, v25, v140
    v_mul_f32 v27, v27, v141
    v_add_f32_dpp v138, v138, v138 row_ror:4 row_mask:0xf bank_mask:0xf
    v_add_f32_dpp v139, v139, v139 row_ror:4 row_mask:0xf bank_mask:0xf
    v_mul_f32 v28, v28, v140
    v_add_f32_dpp v138, v138, v138 row_ror:2 row_mask:0xf bank_mask:0xf
    v_add_f32_dpp v139, v139, v139 row_ror:2 row_mask:0xf bank_mask:0xf
    v_mul_f32 v30, v30, v141
    v_add_f32_dpp v138, v138, v138 row_ror:1 row_mask:0xf bank_mask:0xf
    v_add_f32_dpp v139, v139, v139 row_ror:1 row_mask:0xf bank_mask:0xf
    v_rcp_f32 v138, v138
    v_rcp_f32 v139, v139
    v_cndmask_b32 v142, v28, v30, s[34:35]
    v_mul_f32 v24, v24, v138
    v_mul_f32 v26, v26, v139
    v_mul_f32 v25, v25, v138
    v_mul_f32 v27, v27, v139
    v_cndmask_b32 v143, v138, v139, s[34:35]
    v_cvt_pk_bf16_f32 v140, v24, v25
    v_cvt_pk_bf16_f32 v141, v26, v27
    v_mul_f32 v142, v142, v143
    v_and_b32 v140, s33, v140
    v_and_b32 v141, s33, v141
    v_cvt_pk_bf16_f32 v142, v142, v142
    buffer_store_dword v140, v13, s[4:7], s26 offen offset:0 sc1
    buffer_store_dword v141, v13, s[4:7], s26 offen offset:32 sc1
    v_and_b32 v142, s33, v142
    buffer_store_short v142, v14, s[4:7], s26 offen sc1
    v_mov_b32 v143, -1
    buffer_store_dword v143, v13, s[4:7], s27 offen offset:0 sc1
    buffer_store_dword v143, v13, s[4:7], s27 offen offset:32 sc1
    buffer_store_short v143, v14, s[4:7], s27 offen sc1
    s_add_u32 s32, s32, 28672
    s_mov_b32 s23, s32
    buffer_load_dwordx4 v[144:147], v12, s[4:7], s23 offen offset:0
    buffer_load_dwordx4 v[148:151], v12, s[4:7], s23 offen offset:1024
    buffer_load_dwordx4 v[152:155], v12, s[4:7], s23 offen offset:2048
    buffer_load_dwordx4 v[156:159], v12, s[4:7], s23 offen offset:3072
    s_add_u32 s23, s23, 4096
    buffer_load_dwordx4 v[160:163], v12, s[4:7], s23 offen offset:0
    buffer_load_dwordx4 v[164:167], v12, s[4:7], s23 offen offset:1024
    buffer_load_dwordx4 v[168:171], v12, s[4:7], s23 offen offset:2048
    buffer_load_dwordx4 v[172:175], v12, s[4:7], s23 offen offset:3072
    s_add_u32 s23, s23, 4096
    buffer_load_dwordx4 v[176:179], v12, s[4:7], s23 offen offset:0
    buffer_load_dwordx4 v[180:183], v12, s[4:7], s23 offen offset:1024
    buffer_load_dwordx4 v[184:187], v12, s[4:7], s23 offen offset:2048
    buffer_load_dwordx4 v[188:191], v12, s[4:7], s23 offen offset:3072
    s_add_u32 s23, s23, 4096
    buffer_load_dwordx4 v[192:195], v12, s[4:7], s23 offen offset:0
    buffer_load_dwordx4 v[196:199], v12, s[4:7], s23 offen offset:1024
    buffer_load_dwordx4 v[200:203], v12, s[4:7], s23 offen offset:2048
    buffer_load_dwordx4 v[204:207], v12, s[4:7], s23 offen offset:3072
    s_add_u32 s23, s23, 4096
    buffer_load_dwordx4 v[208:211], v12, s[4:7], s23 offen offset:0
    buffer_load_dwordx4 v[212:215], v12, s[4:7], s23 offen offset:1024
    buffer_load_dwordx4 v[216:219], v12, s[4:7], s23 offen offset:2048
    buffer_load_dwordx4 v[220:223], v12, s[4:7], s23 offen offset:3072
    s_add_u32 s23, s23, 4096
    buffer_load_dwordx4 v[224:227], v12, s[4:7], s23 offen offset:0
    buffer_load_dwordx4 v[228:231], v12, s[4:7], s23 offen offset:1024
    buffer_load_dwordx4 v[232:235], v12, s[4:7], s23 offen offset:2048
    buffer_load_dwordx4 v[236:239], v12, s[4:7], s23 offen offset:3072
    s_add_u32 s23, s23, 4096
    buffer_load_dwordx4 v[240:243], v12, s[4:7], s23 offen offset:0
    buffer_load_dwordx4 v[244:247], v12, s[4:7], s23 offen offset:1024
    buffer_load_dwordx4 v[248:251], v12, s[4:7], s23 offen offset:2048
    buffer_load_dwordx4 v[252:255], v12, s[4:7], s23 offen offset:3072
    s_add_u32 s20, s20, 1
    s_cmp_lt_u32 s20, 63
    s_cbranch_scc1 sf_loop_s
    s_branch k2_end
pm1_56:
    buffer_load_dwordx4 v[28:31], v3, s[4:7], s24 offen sc1
    buffer_load_dwordx4 v[32:35], v4, s[4:7], s24 offen sc1
    s_waitcnt vmcnt(2)
    ds_write_b128 v3, v[36:39]
    ds_write_b128 v4, v[40:43]
    v_max3_u32 v0, v36, v37, v38
    v_max3_u32 v1, v39, v40, v41
    v_max3_u32 v0, v0, v42, v43
    v_max_u32 v0, v0, v1
    v_cmp_eq_u32 vcc, -1, v0
    s_cbranch_vccz pmo_55
    s_sub_u32 s30, s30, 1
    s_cmp_gt_u32 s30, 199996
    s_cbranch_scc1 pm_54
    s_sleep 10
    s_cmp_lg_u32 s30, 0
    s_cbranch_scc1 pm_54
    s_branch k2_end
pm1_62:
    buffer_load_dwordx4 v[28:31], v3, s[4:7], s24 offen sc1
    buffer_load_dwordx4 v[32:35], v4, s[4:7], s24 offen sc1
    s_waitcnt vmcnt(2)
    ds_write_b128 v3, v[36:39]
    ds_write_b128 v4, v[40:43]
    v_max3_u32 v0, v36, v37, v38
    v_max3_u32 v1, v39, v40, v41
    v_max3_u32 v0, v0, v42, v43
    v_max_u32 v0, v0, v1
    v_cmp_eq_u32 vcc, -1, v0
    s_cbranch_vccz pmo_61
    s_sub_u32 s30, s30, 1
    s_cmp_gt_u32 s30, 199996
    s_cbranch_scc1 pm_60
    s_sleep 10
    s_cmp_lg_u32 s30, 0
    s_cbranch_scc1 pm_60
    s_branch k2_end
pm1_68:
    buffer_load_dwordx4 v[28:31], v3, s[4:7], s24 offen sc1
    buffer_load_dwordx4 v[32:35], v4, s[4:7], s24 offen sc1
    s_waitcnt vmcnt(2)
    ds_write_b128 v3, v[36:39]
    ds_write_b128 v4, v[40:43]
    v_max3_u32 v0, v36, v37, v38
    v_max3_u32 v1, v39, v40, v41
    v_max3_u32 v0, v0, v42, v43
    v_max_u32 v0, v0, v1
    v_cmp_eq_u32 vcc, -1, v0
    s_cbranch_vccz pmo_67
    s_sub_u32 s30, s30, 1
    s_cmp_gt_u32 s30, 199996
    s_cbranch_scc1 pm_66
    s_sleep 10
    s_cmp_lg_u32 s30, 0
    s_cbranch_scc1 pm_66
    s_branch k2_end
pm1_74:
    buffer_load_dwordx4 v[32:35], v3, s[4:7], s24 offen sc1
    buffer_load_dwordx4 v[36:39], v4, s[4:7], s24 offen sc1
    s_waitcnt vmcnt(2)
    ds_write_b128 v3, v[48:51]
    ds_write_b128 v4, v[52:55]
    v_max3_u32 v0, v48, v49, v50
    v_max3_u32 v1, v51, v52, v53
    v_max3_u32 v0, v0, v54, v55
    v_max_u32 v0, v0, v1
    v_cmp_eq_u32 vcc, -1, v0
    s_cbranch_vccz pmo_73
    s_sub_u32 s30, s30, 1
    s_cmp_gt_u32 s30, 199996
    s_cbranch_scc1 pm_72
    s_sleep 10
    s_cmp_lg_u32 s30, 0
    s_cbranch_scc1 pm_72
    s_branch k2_end
ch_value:
    s_sub_u32 s17, s15, 16
    s_mul_i32 s18, s3, 1605632
    s_mul_i32 s22, s17, 28672
    s_add_u32 s18, s18, s22
    s_add_u32 s18, s18, 11927552
    v_lshlrev_b32 v12, 4, v0
    s_mov_b32 s33, 0
    s_lshl_b32 s37, s17, 8
    s_add_u32 s37, s37, 74022912
    s_lshr_b32 s22, s17, 1
    s_add_u32 s22, s22, 7
    s_sub_u32 s22, s22, s3
    s_sub_u32 s23, s22, 7
    s_cmp_ge_u32 s22, 7
    s_cselect_b32 s21, s23, s22
    s_cmp_eq_u32 s3, 3
    s_cbranch_scc1 vw3_75
    s_cmp_ge_u32 s21, 4
    s_cbranch_scc1 vo_77
    s_lshl_b32 s19, s3, 2
    s_add_u32 s19, s19, 18
    s_lshl_b32 s19, s19, 3
    s_lshr_b32 s22, s17, 1
    s_add_u32 s19, s19, s22
    s_lshl_b32 s19, s19, 7
    v_and_b32 v13, 31, v0
    v_min_u32 v13, 27, v13
    v_lshlrev_b32 v13, 2, v13
    v_lshrrev_b32 v11, 5, v0
    v_lshl_add_u32 v13, v11, 10, v13
    s_add_u32 s19, s19, 74055680
    v_add_u32 v13, s19, v13
    s_mov_b32 s35, 400000
ww_78:
    buffer_load_dword v11, v13, s[4:7], 0 offen sc1
    s_waitcnt vmcnt(0)
    v_cmp_eq_u32 vcc, 0, v11
    s_cbranch_vccz wwo_79
    s_sleep 16
    s_sub_u32 s35, s35, 1
    s_cmp_lg_u32 s35, 0
    s_cbranch_scc1 ww_78
    s_branch k2_end
wwo_79:
    s_add_u32 s22, s18, 802816
    s_add_u32 s23, s18, 1204224
    buffer_load_dwordx4 a[32:35], v1, s[4:7], s22 offen offset:0
    buffer_load_dwordx4 a[36:39], v1, s[4:7], s23 offen offset:0
    buffer_load_dwordx4 a[40:43], v1, s[4:7], s22 offen offset:1024
    buffer_load_dwordx4 a[44:47], v1, s[4:7], s23 offen offset:1024
    buffer_load_dwordx4 a[48:51], v1, s[4:7], s22 offen offset:2048
    buffer_load_dwordx4 a[52:55], v1, s[4:7], s23 offen offset:2048
    buffer_load_dwordx4 a[56:59], v1, s[4:7], s22 offen offset:3072
    buffer_load_dwordx4 a[60:63], v1, s[4:7], s23 offen offset:3072
    s_add_u32 s22, s18, 806912
    s_add_u32 s23, s18, 1208320
    buffer_load_dwordx4 a[64:67], v1, s[4:7], s22 offen offset:0
    buffer_load_dwordx4 a[68:71], v1, s[4:7], s23 offen offset:0
    buffer_load_dwordx4 a[72:75], v1, s[4:7], s22 offen offset:1024
    buffer_load_dwordx4 a[76:79], v1, s[4:7], s23 offen offset:1024
    buffer_load_dwordx4 a[80:83], v1, s[4:7], s22 offen offset:2048
    buffer_load_dwordx4 a[84:87], v1, s[4:7], s23 offen offset:2048
    buffer_load_dwordx4 a[88:91], v1, s[4:7], s22 offen offset:3072
    buffer_load_dwordx4 a[92:95], v1, s[4:7], s23 offen offset:3072
    s_add_u32 s22, s18, 811008
    s_add_u32 s23, s18, 1212416
    buffer_load_dwordx4 a[96:99], v1, s[4:7], s22 offen offset:0
    buffer_load_dwordx4 a[100:103], v1, s[4:7], s23 offen offset:0
    buffer_load_dwordx4 a[104:107], v1, s[4:7], s22 offen offset:1024
    buffer_load_dwordx4 a[108:111], v1, s[4:7], s23 offen offset:1024
    buffer_load_dwordx4 a[112:115], v1, s[4:7], s22 offen offset:2048
    buffer_load_dwordx4 a[116:119], v1, s[4:7], s23 offen offset:2048
    buffer_load_dwordx4 a[120:123], v1, s[4:7], s22 offen offset:3072
    buffer_load_dwordx4 a[124:127], v1, s[4:7], s23 offen offset:3072
    s_add_u32 s22, s18, 815104
    s_add_u32 s23, s18, 1216512
    buffer_load_dwordx4 a[128:131], v1, s[4:7], s22 offen offset:0
    buffer_load_dwordx4 a[132:135], v1, s[4:7], s23 offen offset:0
    buffer_load_dwordx4 a[136:139], v1, s[4:7], s22 offen offset:1024
    buffer_load_dwordx4 a[140:143], v1, s[4:7], s23 offen offset:1024
    s_add_u32 s22, s18, 817152
    s_add_u32 s23, s18, 1218560
    buffer_load_dwordx4 a[144:147], v1, s[4:7], s22 offen offset:0
    buffer_load_dwordx4 a[148:151], v1, s[4:7], s23 offen offset:0
    buffer_load_dwordx4 a[152:155], v1, s[4:7], s22 offen offset:1024
    buffer_load_dwordx4 a[156:159], v1, s[4:7], s23 offen offset:1024
    buffer_load_dwordx4 a[160:163], v1, s[4:7], s22 offen offset:2048
    buffer_load_dwordx4 a[164:167], v1, s[4:7], s23 offen offset:2048
    buffer_load_dwordx4 a[168:171], v1, s[4:7], s22 offen offset:3072
    buffer_load_dwordx4 a[172:175], v1, s[4:7], s23 offen offset:3072
    s_add_u32 s22, s18, 821248
    s_add_u32 s23, s18, 1222656
    buffer_load_dwordx4 a[176:179], v1, s[4:7], s22 offen offset:0
    buffer_load_dwordx4 a[180:183], v1, s[4:7], s23 offen offset:0
    buffer_load_dwordx4 a[184:187], v1, s[4:7], s22 offen offset:1024
    buffer_load_dwordx4 a[188:191], v1, s[4:7], s23 offen offset:1024
    buffer_load_dwordx4 a[192:195], v1, s[4:7], s22 offen offset:2048
    buffer_load_dwordx4 a[196:199], v1, s[4:7], s23 offen offset:2048
    buffer_load_dwordx4 a[200:203], v1, s[4:7], s22 offen offset:3072
    buffer_load_dwordx4 a[204:207], v1, s[4:7], s23 offen offset:3072
    s_add_u32 s22, s18, 825344
    s_add_u32 s23, s18, 1226752
    buffer_load_dwordx4 a[208:211], v1, s[4:7], s22 offen offset:0
    buffer_load_dwordx4 a[212:215], v1, s[4:7], s23 offen offset:0
    buffer_load_dwordx4 a[216:219], v1, s[4:7], s22 offen offset:1024
    buffer_load_dwordx4 a[220:223], v1, s[4:7], s23 offen offset:1024
    buffer_load_dwordx4 a[224:227], v1, s[4:7], s22 offen offset:2048
    buffer_load_dwordx4 a[228:231], v1, s[4:7], s23 offen offset:2048
    buffer_load_dwordx4 a[232:235], v1, s[4:7], s22 offen offset:3072
    buffer_load_dwordx4 a[236:239], v1, s[4:7], s23 offen offset:3072
    s_add_u32 s22, s18, 829440
    s_add_u32 s23, s18, 1230848
    buffer_load_dwordx4 a[240:243], v1, s[4:7], s22 offen offset:0
    buffer_load_dwordx4 a[244:247], v1, s[4:7], s23 offen offset:0
    buffer_load_dwordx4 a[248:251], v1, s[4:7], s22 offen offset:1024
    buffer_load_dwordx4 a[252:255], v1, s[4:7], s23 offen offset:1024
    s_lshl_b32 s19, s3, 2
    s_add_u32 s19, s19, 16
    s_lshl_b32 s19, s19, 3
    s_lshr_b32 s22, s17, 1
    s_add_u32 s19, s19, s22
    s_lshl_b32 s19, s19, 7
    v_and_b32 v13, 31, v0
    v_min_u32 v13, 27, v13
    v_lshlrev_b32 v13, 2, v13
    v_lshrrev_b32 v11, 5, v0
    v_lshl_add_u32 v13, v11, 10, v13
    s_add_u32 s19, s19, 74055680
    v_add_u32 v13, s19, v13
    s_mov_b32 s35, 400000
ww_80:
    buffer_load_dword v11, v13, s[4:7], 0 offen sc1
    s_waitcnt vmcnt(0)
    v_cmp_eq_u32 vcc, 0, v11
    s_cbranch_vccz wwo_81
    s_sleep 16
    s_sub_u32 s35, s35, 1
    s_cmp_lg_u32 s35, 0
    s_cbranch_scc1 ww_80
    s_branch k2_end
wwo_81:
    s_add_u32 s22, s18, 0
    s_add_u32 s23, s18, 401408
    buffer_load_dwordx4 v[64:67], v1, s[4:7], s22 offen offset:0
    buffer_load_dwordx4 v[68:71], v1, s[4:7], s23 offen offset:0
    buffer_load_dwordx4 v[72:75], v1, s[4:7], s22 offen offset:1024
    buffer_load_dwordx4 v[76:79], v1, s[4:7], s23 offen offset:1024
    buffer_load_dwordx4 v[80:83], v1, s[4:7], s22 offen offset:2048
    buffer_load_dwordx4 v[84:87], v1, s[4:7], s23 offen offset:2048
    s_waitcnt vmcnt(60)
    v_accvgpr_read_b32 v11, a33
    v_accvgpr_mov_b32 a33, a36
    v_accvgpr_mov_b32 a36, a34
    v_accvgpr_write_b32 a34, v11
    v_accvgpr_read_b32 v11, a35
    v_accvgpr_mov_b32 a35, a37
    v_accvgpr_mov_b32 a37, a38
    v_accvgpr_write_b32 a38, v11
    buffer_load_dwordx4 v[88:91], v1, s[4:7], s22 offen offset:3072
    buffer_load_dwordx4 v[92:95], v1, s[4:7], s23 offen offset:3072
    s_waitcnt vmcnt(60)
    v_accvgpr_read_b32 v11, a41
    v_accvgpr_mov_b32 a41, a44
    v_accvgpr_mov_b32 a44, a42
    v_accvgpr_write_b32 a42, v11
    v_accvgpr_read_b32 v11, a43
    v_accvgpr_mov_b32 a43, a45
    v_accvgpr_mov_b32 a45, a46
    v_accvgpr_write_b32 a46, v11
    s_add_u32 s22, s18, 4096
    s_add_u32 s23, s18, 405504
    buffer_load_dwordx4 v[96:99], v1, s[4:7], s22 offen offset:0
    buffer_load_dwordx4 v[100:103], v1, s[4:7], s23 offen offset:0
    s_waitcnt vmcnt(60)
    v_accvgpr_read_b32 v11, a49
    v_accvgpr_mov_b32 a49, a52
    v_accvgpr_mov_b32 a52, a50
    v_accvgpr_write_b32 a50, v11
    v_accvgpr_read_b32 v11, a51
    v_accvgpr_mov_b32 a51, a53
    v_accvgpr_mov_b32 a53, a54
    v_accvgpr_write_b32 a54, v11
    buffer_load_dwordx4 v[104:107], v1, s[4:7], s22 offen offset:1024
    buffer_load_dwordx4 v[108:111], v1, s[4:7], s23 offen offset:1024
    s_waitcnt vmcnt(60)
    v_accvgpr_read_b32 v11, a57
    v_accvgpr_mov_b32 a57, a60
    v_accvgpr_mov_b32 a60, a58
    v_accvgpr_write_b32 a58, v11
    v_accvgpr_read_b32 v11, a59
    v_accvgpr_mov_b32 a59, a61
    v_accvgpr_mov_b32 a61, a62
    v_accvgpr_write_b32 a62, v11
    buffer_load_dwordx4 v[112:115], v1, s[4:7], s22 offen offset:2048
    buffer_load_dwordx4 v[116:119], v1, s[4:7], s23 offen offset:2048
    s_waitcnt vmcnt(60)
    v_accvgpr_read_b32 v11, a65
    v_accvgpr_mov_b32 a65, a68
    v_accvgpr_mov_b32 a68, a66
    v_accvgpr_write_b32 a66, v11
    v_accvgpr_read_b32 v11, a67
    v_accvgpr_mov_b32 a67, a69
    v_accvgpr_mov_b32 a69, a70
    v_accvgpr_write_b32 a70, v11
    buffer_load_dwordx4 v[120:123], v1, s[4:7], s22 offen offset:3072
    buffer_load_dwordx4 v[124:127], v1, s[4:7], s23 offen offset:3072
    s_waitcnt vmcnt(60)
    v_accvgpr_read_b32 v11, a73
    v_accvgpr_mov_b32 a73, a76
    v_accvgpr_mov_b32 a76, a74
    v_accvgpr_write_b32 a74, v11
    v_accvgpr_read_b32 v11, a75
    v_accvgpr_mov_b32 a75, a77
    v_accvgpr_mov_b32 a77, a78
    v_accvgpr_write_b32 a78, v11
    s_add_u32 s22, s18, 8192
    s_add_u32 s23, s18, 409600
    buffer_load_dwordx4 v[128:131], v1, s[4:7], s22 offen offset:0
    buffer_load_dwordx4 v[132:135], v1, s[4:7], s23 offen offset:0
    s_waitcnt vmcnt(60)
    v_accvgpr_read_b32 v11, a81
    v_accvgpr_mov_b32 a81, a84
    v_accvgpr_mov_b32 a84, a82
    v_accvgpr_write_b32 a82, v11
    v_accvgpr_read_b32 v11, a83
    v_accvgpr_mov_b32 a83, a85
    v_accvgpr_mov_b32 a85, a86
    v_accvgpr_write_b32 a86, v11
    buffer_load_dwordx4 v[136:139], v1, s[4:7], s22 offen offset:1024
    buffer_load_dwordx4 v[140:143], v1, s[4:7], s23 offen offset:1024
    s_waitcnt vmcnt(60)
    v_accvgpr_read_b32 v11, a89
    v_accvgpr_mov_b32 a89, a92
    v_accvgpr_mov_b32 a92, a90
    v_accvgpr_write_b32 a90, v11
    v_accvgpr_read_b32 v11, a91
    v_accvgpr_mov_b32 a91, a93
    v_accvgpr_mov_b32 a93, a94
    v_accvgpr_write_b32 a94, v11
    buffer_load_dwordx4 v[144:147], v1, s[4:7], s22 offen offset:2048
    buffer_load_dwordx4 v[148:151], v1, s[4:7], s23 offen offset:2048
    s_waitcnt vmcnt(60)
    v_accvgpr_read_b32 v11, a97
    v_accvgpr_mov_b32 a97, a100
    v_accvgpr_mov_b32 a100, a98
    v_accvgpr_write_b32 a98, v11
    v_accvgpr_read_b32 v11, a99
    v_accvgpr_mov_b32 a99, a101
    v_accvgpr_mov_b32 a101, a102
    v_accvgpr_write_b32 a102, v11
    buffer_load_dwordx4 v[152:155], v1, s[4:7], s22 offen offset:3072
    buffer_load_dwordx4 v[156:159], v1, s[4:7], s23 offen offset:3072
    s_waitcnt vmcnt(60)
    v_accvgpr_read_b32 v11, a105
    v_accvgpr_mov_b32 a105, a108
    v_accvgpr_mov_b32 a108, a106
    v_accvgpr_write_b32 a106, v11
    v_accvgpr_read_b32 v11, a107
    v_accvgpr_mov_b32 a107, a109
    v_accvgpr_mov_b32 a109, a110
    v_accvgpr_write_b32 a110, v11
    s_add_u32 s22, s18, 12288
    s_add_u32 s23, s18, 413696
    buffer_load_dwordx4 v[160:163], v1, s[4:7], s22 offen offset:0
    buffer_load_dwordx4 v[164:167], v1, s[4:7], s23 offen offset:0
    s_waitcnt vmcnt(60)
    v_accvgpr_read_b32 v11, a113
    v_accvgpr_mov_b32 a113, a116
    v_accvgpr_mov_b32 a116, a114
    v_accvgpr_write_b32 a114, v11
    v_accvgpr_read_b32 v11, a115
    v_accvgpr_mov_b32 a115, a117
    v_accvgpr_mov_b32 a117, a118
    v_accvgpr_write_b32 a118, v11
    buffer_load_dwordx4 v[168:171], v1, s[4:7], s22 offen offset:1024
    buffer_load_dwordx4 v[172:175], v1, s[4:7], s23 offen offset:1024
    s_waitcnt vmcnt(60)
    v_accvgpr_read_b32 v11, a121
    v_accvgpr_mov_b32 a121, a124
    v_accvgpr_mov_b32 a124, a122
    v_accvgpr_write_b32 a122, v11
    v_accvgpr_read_b32 v11, a123
    v_accvgpr_mov_b32 a123, a125
    v_accvgpr_mov_b32 a125, a126
    v_accvgpr_write_b32 a126, v11
    s_add_u32 s22, s18, 14336
    s_add_u32 s23, s18, 415744
    buffer_load_dwordx4 v[176:179], v1, s[4:7], s22 offen offset:0
    buffer_load_dwordx4 v[180:183], v1, s[4:7], s23 offen offset:0
    s_waitcnt vmcnt(60)
    v_accvgpr_read_b32 v11, a129
    v_accvgpr_mov_b32 a129, a132
    v_accvgpr_mov_b32 a132, a130
    v_accvgpr_write_b32 a130, v11
    v_accvgpr_read_b32 v11, a131
    v_accvgpr_mov_b32 a131, a133
    v_accvgpr_mov_b32 a133, a134
    v_accvgpr_write_b32 a134, v11
    buffer_load_dwordx4 v[184:187], v1, s[4:7], s22 offen offset:1024
    buffer_load_dwordx4 v[188:191], v1, s[4:7], s23 offen offset:1024
    s_waitcnt vmcnt(60)
    v_accvgpr_read_b32 v11, a137
    v_accvgpr_mov_b32 a137, a140
    v_accvgpr_mov_b32 a140, a138
    v_accvgpr_write_b32 a138, v11
    v_accvgpr_read_b32 v11, a139
    v_accvgpr_mov_b32 a139, a141
    v_accvgpr_mov_b32 a141, a142
    v_accvgpr_write_b32 a142, v11
    buffer_load_dwordx4 v[192:195], v1, s[4:7], s22 offen offset:2048
    buffer_load_dwordx4 v[196:199], v1, s[4:7], s23 offen offset:2048
    s_waitcnt vmcnt(60)
    v_accvgpr_read_b32 v11, a145
    v_accvgpr_mov_b32 a145, a148
    v_accvgpr_mov_b32 a148, a146
    v_accvgpr_write_b32 a146, v11
    v_accvgpr_read_b32 v11, a147
    v_accvgpr_mov_b32 a147, a149
    v_accvgpr_mov_b32 a149, a150
    v_accvgpr_write_b32 a150, v11
    buffer_load_dwordx4 v[200:203], v1, s[4:7], s22 offen offset:3072
    buffer_load_dwordx4 v[204:207], v1, s[4:7], s23 offen offset:3072
    s_waitcnt vmcnt(60)
    v_accvgpr_read_b32 v11, a153
    v_accvgpr_mov_b32 a153, a156
    v_accvgpr_mov_b32 a156, a154
    v_accvgpr_write_b32 a154, v11
    v_accvgpr_read_b32 v11, a155
    v_accvgpr_mov_b32 a155, a157
    v_accvgpr_mov_b32 a157, a158
    v_accvgpr_write_b32 a158, v11
    s_add_u32 s22, s18, 18432
    s_add_u32 s23, s18, 419840
    buffer_load_dwordx4 v[208:211], v1, s[4:7], s22 offen offset:0
    buffer_load_dwordx4 v[212:215], v1, s[4:7], s23 offen offset:0
    s_waitcnt vmcnt(60)
    v_accvgpr_read_b32 v11, a161
    v_accvgpr_mov_b32 a161, a164
    v_accvgpr_mov_b32 a164, a162
    v_accvgpr_write_b32 a162, v11
    v_accvgpr_read_b32 v11, a163
    v_accvgpr_mov_b32 a163, a165
    v_accvgpr_mov_b32 a165, a166
    v_accvgpr_write_b32 a166, v11
    buffer_load_dwordx4 v[216:219], v1, s[4:7], s22 offen offset:1024
    buffer_load_dwordx4 v[220:223], v1, s[4:7], s23 offen offset:1024
    s_waitcnt vmcnt(60)
    v_accvgpr_read_b32 v11, a169
    v_accvgpr_mov_b32 a169, a172
    v_accvgpr_mov_b32 a172, a170
    v_accvgpr_write_b32 a170, v11
    v_accvgpr_read_b32 v11, a171
    v_accvgpr_mov_b32 a171, a173
    v_accvgpr_mov_b32 a173, a174
    v_accvgpr_write_b32 a174, v11
    buffer_load_dwordx4 v[224:227], v1, s[4:7], s22 offen offset:2048
    buffer_load_dwordx4 v[228:231], v1, s[4:7], s23 offen offset:2048
    s_waitcnt vmcnt(60)
    v_accvgpr_read_b32 v11, a177
    v_accvgpr_mov_b32 a177, a180
    v_accvgpr_mov_b32 a180, a178
    v_accvgpr_write_b32 a178, v11
    v_accvgpr_read_b32 v11, a179
    v_accvgpr_mov_b32 a179, a181
    v_accvgpr_mov_b32 a181, a182
    v_accvgpr_write_b32 a182, v11
    buffer_load_dwordx4 v[232:235], v1, s[4:7], s22 offen offset:3072
    buffer_load_dwordx4 v[236:239], v1, s[4:7], s23 offen offset:3072
    s_waitcnt vmcnt(60)
    v_accvgpr_read_b32 v11, a185
    v_accvgpr_mov_b32 a185, a188
    v_accvgpr_mov_b32 a188, a186
    v_accvgpr_write_b32 a186, v11
    v_accvgpr_read_b32 v11, a187
    v_accvgpr_mov_b32 a187, a189
    v_accvgpr_mov_b32 a189, a190
    v_accvgpr_write_b32 a190, v11
    s_add_u32 s22, s18, 22528
    s_add_u32 s23, s18, 423936
    buffer_load_dwordx4 v[240:243], v1, s[4:7], s22 offen offset:0
    buffer_load_dwordx4 v[244:247], v1, s[4:7], s23 offen offset:0
    s_waitcnt vmcnt(60)
    v_accvgpr_read_b32 v11, a193
    v_accvgpr_mov_b32 a193, a196
    v_accvgpr_mov_b32 a196, a194
    v_accvgpr_write_b32 a194, v11
    v_accvgpr_read_b32 v11, a195
    v_accvgpr_mov_b32 a195, a197
    v_accvgpr_mov_b32 a197, a198
    v_accvgpr_write_b32 a198, v11
    buffer_load_dwordx4 v[248:251], v1, s[4:7], s22 offen offset:1024
    buffer_load_dwordx4 v[252:255], v1, s[4:7], s23 offen offset:1024
    s_waitcnt vmcnt(60)
    v_accvgpr_read_b32 v11, a201
    v_accvgpr_mov_b32 a201, a204
    v_accvgpr_mov_b32 a204, a202
    v_accvgpr_write_b32 a202, v11
    v_accvgpr_read_b32 v11, a203
    v_accvgpr_mov_b32 a203, a205
    v_accvgpr_mov_b32 a205, a206
    v_accvgpr_write_b32 a206, v11
    buffer_load_dwordx4 a[0:3], v1, s[4:7], s22 offen offset:2048
    buffer_load_dwordx4 a[4:7], v1, s[4:7], s23 offen offset:2048
    s_waitcnt vmcnt(60)
    v_accvgpr_read_b32 v11, a209
    v_accvgpr_mov_b32 a209, a212
    v_accvgpr_mov_b32 a212, a210
    v_accvgpr_write_b32 a210, v11
    v_accvgpr_read_b32 v11, a211
    v_accvgpr_mov_b32 a211, a213
    v_accvgpr_mov_b32 a213, a214
    v_accvgpr_write_b32 a214, v11
    buffer_load_dwordx4 a[8:11], v1, s[4:7], s22 offen offset:3072
    buffer_load_dwordx4 a[12:15], v1, s[4:7], s23 offen offset:3072
    s_waitcnt vmcnt(60)
    v_accvgpr_read_b32 v11, a217
    v_accvgpr_mov_b32 a217, a220
    v_accvgpr_mov_b32 a220, a218
    v_accvgpr_write_b32 a218, v11
    v_accvgpr_read_b32 v11, a219
    v_accvgpr_mov_b32 a219, a221
    v_accvgpr_mov_b32 a221, a222
    v_accvgpr_write_b32 a222, v11
    s_add_u32 s22, s18, 26624
    s_add_u32 s23, s18, 428032
    buffer_load_dwordx4 a[16:19], v1, s[4:7], s22 offen offset:0
    buffer_load_dwordx4 a[20:23], v1, s[4:7], s23 offen offset:0
    s_waitcnt vmcnt(60)
    v_accvgpr_read_b32 v11, a225
    v_accvgpr_mov_b32 a225, a228
    v_accvgpr_mov_b32 a228, a226
    v_accvgpr_write_b32 a226, v11
    v_accvgpr_read_b32 v11, a227
    v_accvgpr_mov_b32 a227, a229
    v_accvgpr_mov_b32 a229, a230
    v_accvgpr_write_b32 a230, v11
    buffer_load_dwordx4 a[24:27], v1, s[4:7], s22 offen offset:1024
    buffer_load_dwordx4 a[28:31], v1, s[4:7], s23 offen offset:1024
    s_waitcnt vmcnt(60)
    v_accvgpr_read_b32 v11, a233
    v_accvgpr_mov_b32 a233, a236
    v_accvgpr_mov_b32 a236, a234
    v_accvgpr_write_b32 a234, v11
    v_accvgpr_read_b32 v11, a235
    v_accvgpr_mov_b32 a235, a237
    v_accvgpr_mov_b32 a237, a238
    v_accvgpr_write_b32 a238, v11
    s_waitcnt vmcnt(58)
    v_accvgpr_read_b32 v11, a241
    v_accvgpr_mov_b32 a241, a244
    v_accvgpr_mov_b32 a244, a242
    v_accvgpr_write_b32 a242, v11
    v_accvgpr_read_b32 v11, a243
    v_accvgpr_mov_b32 a243, a245
    v_accvgpr_mov_b32 a245, a246
    v_accvgpr_write_b32 a246, v11
    s_waitcnt vmcnt(56)
    v_accvgpr_read_b32 v11, a249
    v_accvgpr_mov_b32 a249, a252
    v_accvgpr_mov_b32 a252, a250
    v_accvgpr_write_b32 a250, v11
    v_accvgpr_read_b32 v11, a251
    v_accvgpr_mov_b32 a251, a253
    v_accvgpr_mov_b32 a253, a254
    v_accvgpr_write_b32 a254, v11
    s_waitcnt vmcnt(54)
    v_swap_b32 v65, v68
    v_swap_b32 v66, v68
    v_swap_b32 v67, v69
    v_swap_b32 v69, v70
    s_waitcnt vmcnt(52)
    v_swap_b32 v73, v76
    v_swap_b32 v74, v76
    v_swap_b32 v75, v77
    v_swap_b32 v77, v78
    s_waitcnt vmcnt(50)
    v_swap_b32 v81, v84
    v_swap_b32 v82, v84
    v_swap_b32 v83, v85
    v_swap_b32 v85, v86
    s_waitcnt vmcnt(48)
    v_swap_b32 v89, v92
    v_swap_b32 v90, v92
    v_swap_b32 v91, v93
    v_swap_b32 v93, v94
    s_waitcnt vmcnt(46)
    v_swap_b32 v97, v100
    v_swap_b32 v98, v100
    v_swap_b32 v99, v101
    v_swap_b32 v101, v102
    s_waitcnt vmcnt(44)
    v_swap_b32 v105, v108
    v_swap_b32 v106, v108
    v_swap_b32 v107, v109
    v_swap_b32 v109, v110
    s_waitcnt vmcnt(42)
    v_swap_b32 v113, v116
    v_swap_b32 v114, v116
    v_swap_b32 v115, v117
    v_swap_b32 v117, v118
    s_waitcnt vmcnt(40)
    v_swap_b32 v121, v124
    v_swap_b32 v122, v124
    v_swap_b32 v123, v125
    v_swap_b32 v125, v126
    s_waitcnt vmcnt(38)
    v_swap_b32 v129, v132
    v_swap_b32 v130, v132
    v_swap_b32 v131, v133
    v_swap_b32 v133, v134
    s_waitcnt vmcnt(36)
    v_swap_b32 v137, v140
    v_swap_b32 v138, v140
    v_swap_b32 v139, v141
    v_swap_b32 v141, v142
    s_waitcnt vmcnt(34)
    v_swap_b32 v145, v148
    v_swap_b32 v146, v148
    v_swap_b32 v147, v149
    v_swap_b32 v149, v150
    s_waitcnt vmcnt(32)
    v_swap_b32 v153, v156
    v_swap_b32 v154, v156
    v_swap_b32 v155, v157
    v_swap_b32 v157, v158
    s_waitcnt vmcnt(30)
    v_swap_b32 v161, v164
    v_swap_b32 v162, v164
    v_swap_b32 v163, v165
    v_swap_b32 v165, v166
    s_waitcnt vmcnt(28)
    v_swap_b32 v169, v172
    v_swap_b32 v170, v172
    v_swap_b32 v171, v173
    v_swap_b32 v173, v174
    s_waitcnt vmcnt(26)
    v_swap_b32 v177, v180
    v_swap_b32 v178, v180
    v_swap_b32 v179, v181
    v_swap_b32 v181, v182
    s_waitcnt vmcnt(24)
    v_swap_b32 v185, v188
    v_swap_b32 v186, v188
    v_swap_b32 v187, v189
    v_swap_b32 v189, v190
    s_waitcnt vmcnt(22)
    v_swap_b32 v193, v196
    v_swap_b32 v194, v196
    v_swap_b32 v195, v197
    v_swap_b32 v197, v198
    s_waitcnt vmcnt(20)
    v_swap_b32 v201, v204
    v_swap_b32 v202, v204
    v_swap_b32 v203, v205
    v_swap_b32 v205, v206
    s_waitcnt vmcnt(18)
    v_swap_b32 v209, v212
    v_swap_b32 v210, v212
    v_swap_b32 v211, v213
    v_swap_b32 v213, v214
    s_waitcnt vmcnt(16)
    v_swap_b32 v217, v220
    v_swap_b32 v218, v220
    v_swap_b32 v219, v221
    v_swap_b32 v221, v222
    s_waitcnt vmcnt(14)
    v_swap_b32 v225, v228
    v_swap_b32 v226, v228
    v_swap_b32 v227, v229
    v_swap_b32 v229, v230
    s_waitcnt vmcnt(12)
    v_swap_b32 v233, v236
    v_swap_b32 v234, v236
    v_swap_b32 v235, v237
    v_swap_b32 v237, v238
    s_waitcnt vmcnt(10)
    v_swap_b32 v241, v244
    v_swap_b32 v242, v244
    v_swap_b32 v243, v245
    v_swap_b32 v245, v246
    s_waitcnt vmcnt(8)
    v_swap_b32 v249, v252
    v_swap_b32 v250, v252
    v_swap_b32 v251, v253
    v_swap_b32 v253, v254
    s_waitcnt vmcnt(6)
    v_accvgpr_read_b32 v11, a1
    v_accvgpr_mov_b32 a1, a4
    v_accvgpr_mov_b32 a4, a2
    v_accvgpr_write_b32 a2, v11
    v_accvgpr_read_b32 v11, a3
    v_accvgpr_mov_b32 a3, a5
    v_accvgpr_mov_b32 a5, a6
    v_accvgpr_write_b32 a6, v11
    s_waitcnt vmcnt(4)
    v_accvgpr_read_b32 v11, a9
    v_accvgpr_mov_b32 a9, a12
    v_accvgpr_mov_b32 a12, a10
    v_accvgpr_write_b32 a10, v11
    v_accvgpr_read_b32 v11, a11
    v_accvgpr_mov_b32 a11, a13
    v_accvgpr_mov_b32 a13, a14
    v_accvgpr_write_b32 a14, v11
    s_waitcnt vmcnt(2)
    v_accvgpr_read_b32 v11, a17
    v_accvgpr_mov_b32 a17, a20
    v_accvgpr_mov_b32 a20, a18
    v_accvgpr_write_b32 a18, v11
    v_accvgpr_read_b32 v11, a19
    v_accvgpr_mov_b32 a19, a21
    v_accvgpr_mov_b32 a21, a22
    v_accvgpr_write_b32 a22, v11
    s_waitcnt vmcnt(0)
    v_accvgpr_read_b32 v11, a25
    v_accvgpr_mov_b32 a25, a28
    v_accvgpr_mov_b32 a28, a26
    v_accvgpr_write_b32 a26, v11
    v_accvgpr_read_b32 v11, a27
    v_accvgpr_mov_b32 a27, a29
    v_accvgpr_mov_b32 a29, a30
    v_accvgpr_write_b32 a30, v11
    s_branch vwd_76
vo_77:
    s_lshl_b32 s19, s3, 2
    s_add_u32 s19, s19, 16
    s_lshl_b32 s19, s19, 3
    s_lshr_b32 s22, s17, 1
    s_add_u32 s19, s19, s22
    s_lshl_b32 s19, s19, 7
    v_and_b32 v13, 31, v0
    v_min_u32 v13, 27, v13
    v_lshlrev_b32 v13, 2, v13
    v_lshrrev_b32 v11, 5, v0
    v_lshl_add_u32 v13, v11, 10, v13
    s_add_u32 s19, s19, 74055680
    v_add_u32 v13, s19, v13
    s_mov_b32 s35, 400000
ww_82:
    buffer_load_dword v11, v13, s[4:7], 0 offen sc1
    s_waitcnt vmcnt(0)
    v_cmp_eq_u32 vcc, 0, v11
    s_cbranch_vccz wwo_83
    s_sleep 16
    s_sub_u32 s35, s35, 1
    s_cmp_lg_u32 s35, 0
    s_cbranch_scc1 ww_82
    s_branch k2_end
wwo_83:
    s_add_u32 s22, s18, 0
    s_add_u32 s23, s18, 401408
    buffer_load_dwordx4 v[64:67], v1, s[4:7], s22 offen offset:0
    buffer_load_dwordx4 v[68:71], v1, s[4:7], s23 offen offset:0
    buffer_load_dwordx4 v[72:75], v1, s[4:7], s22 offen offset:1024
    buffer_load_dwordx4 v[76:79], v1, s[4:7], s23 offen offset:1024
    buffer_load_dwordx4 v[80:83], v1, s[4:7], s22 offen offset:2048
    buffer_load_dwordx4 v[84:87], v1, s[4:7], s23 offen offset:2048
    buffer_load_dwordx4 v[88:91], v1, s[4:7], s22 offen offset:3072
    buffer_load_dwordx4 v[92:95], v1, s[4:7], s23 offen offset:3072
    s_add_u32 s22, s18, 4096
    s_add_u32 s23, s18, 405504
    buffer_load_dwordx4 v[96:99], v1, s[4:7], s22 offen offset:0
    buffer_load_dwordx4 v[100:103], v1, s[4:7], s23 offen offset:0
    buffer_load_dwordx4 v[104:107], v1, s[4:7], s22 offen offset:1024
    buffer_load_dwordx4 v[108:111], v1, s[4:7], s23 offen offset:1024
    buffer_load_dwordx4 v[112:115], v1, s[4:7], s22 offen offset:2048
    buffer_load_dwordx4 v[116:119], v1, s[4:7], s23 offen offset:2048
    buffer_load_dwordx4 v[120:123], v1, s[4:7], s22 offen offset:3072
    buffer_load_dwordx4 v[124:127], v1, s[4:7], s23 offen offset:3072
    s_add_u32 s22, s18, 8192
    s_add_u32 s23, s18, 409600
    buffer_load_dwordx4 v[128:131], v1, s[4:7], s22 offen offset:0
    buffer_load_dwordx4 v[132:135], v1, s[4:7], s23 offen offset:0
    buffer_load_dwordx4 v[136:139], v1, s[4:7], s22 offen offset:1024
    buffer_load_dwordx4 v[140:143], v1, s[4:7], s23 offen offset:1024
    buffer_load_dwordx4 v[144:147], v1, s[4:7], s22 offen offset:2048
    buffer_load_dwordx4 v[148:151], v1, s[4:7], s23 offen offset:2048
    buffer_load_dwordx4 v[152:155], v1, s[4:7], s22 offen offset:3072
    buffer_load_dwordx4 v[156:159], v1, s[4:7], s23 offen offset:3072
    s_add_u32 s22, s18, 12288
    s_add_u32 s23, s18, 413696
    buffer_load_dwordx4 v[160:163], v1, s[4:7], s22 offen offset:0
    buffer_load_dwordx4 v[164:167], v1, s[4:7], s23 offen offset:0
    buffer_load_dwordx4 v[168:171], v1, s[4:7], s22 offen offset:1024
    buffer_load_dwordx4 v[172:175], v1, s[4:7], s23 offen offset:1024
    s_add_u32 s22, s18, 14336
    s_add_u32 s23, s18, 415744
    buffer_load_dwordx4 v[176:179], v1, s[4:7], s22 offen offset:0
    buffer_load_dwordx4 v[180:183], v1, s[4:7], s23 offen offset:0
    buffer_load_dwordx4 v[184:187], v1, s[4:7], s22 offen offset:1024
    buffer_load_dwordx4 v[188:191], v1, s[4:7], s23 offen offset:1024
    buffer_load_dwordx4 v[192:195], v1, s[4:7], s22 offen offset:2048
    buffer_load_dwordx4 v[196:199], v1, s[4:7], s23 offen offset:2048
    buffer_load_dwordx4 v[200:203], v1, s[4:7], s22 offen offset:3072
    buffer_load_dwordx4 v[204:207], v1, s[4:7], s23 offen offset:3072
    s_add_u32 s22, s18, 18432
    s_add_u32 s23, s18, 419840
    buffer_load_dwordx4 v[208:211], v1, s[4:7], s22 offen offset:0
    buffer_load_dwordx4 v[212:215], v1, s[4:7], s23 offen offset:0
    buffer_load_dwordx4 v[216:219], v1, s[4:7], s22 offen offset:1024
    buffer_load_dwordx4 v[220:223], v1, s[4:7], s23 offen offset:1024
    buffer_load_dwordx4 v[224:227], v1, s[4:7], s22 offen offset:2048
    buffer_load_dwordx4 v[228:231], v1, s[4:7], s23 offen offset:2048
    buffer_load_dwordx4 v[232:235], v1, s[4:7], s22 offen offset:3072
    buffer_load_dwordx4 v[236:239], v1, s[4:7], s23 offen offset:3072
    s_add_u32 s22, s18, 22528
    s_add_u32 s23, s18, 423936
    buffer_load_dwordx4 v[240:243], v1, s[4:7], s22 offen offset:0
    buffer_load_dwordx4 v[244:247], v1, s[4:7], s23 offen offset:0
    buffer_load_dwordx4 v[248:251], v1, s[4:7], s22 offen offset:1024
    buffer_load_dwordx4 v[252:255], v1, s[4:7], s23 offen offset:1024
    buffer_load_dwordx4 a[0:3], v1, s[4:7], s22 offen offset:2048
    buffer_load_dwordx4 a[4:7], v1, s[4:7], s23 offen offset:2048
    buffer_load_dwordx4 a[8:11], v1, s[4:7], s22 offen offset:3072
    buffer_load_dwordx4 a[12:15], v1, s[4:7], s23 offen offset:3072
    s_add_u32 s22, s18, 26624
    s_add_u32 s23, s18, 428032
    buffer_load_dwordx4 a[16:19], v1, s[4:7], s22 offen offset:0
    buffer_load_dwordx4 a[20:23], v1, s[4:7], s23 offen offset:0
    buffer_load_dwordx4 a[24:27], v1, s[4:7], s22 offen offset:1024
    buffer_load_dwordx4 a[28:31], v1, s[4:7], s23 offen offset:1024
    s_lshl_b32 s19, s3, 2
    s_add_u32 s19, s19, 18
    s_lshl_b32 s19, s19, 3
    s_lshr_b32 s22, s17, 1
    s_add_u32 s19, s19, s22
    s_lshl_b32 s19, s19, 7
    v_and_b32 v13, 31, v0
    v_min_u32 v13, 27, v13
    v_lshlrev_b32 v13, 2, v13
    v_lshrrev_b32 v11, 5, v0
    v_lshl_add_u32 v13, v11, 10, v13
    s_add_u32 s19, s19, 74055680
    v_add_u32 v13, s19, v13
    s_mov_b32 s35, 400000
ww_84:
    buffer_load_dword v11, v13, s[4:7], 0 offen sc1
    s_waitcnt vmcnt(0)
    v_cmp_eq_u32 vcc, 0, v11
    s_cbranch_vccz wwo_85
    s_sleep 16
    s_sub_u32 s35, s35, 1
    s_cmp_lg_u32 s35, 0
    s_cbranch_scc1 ww_84
    s_branch k2_end
wwo_85:
    s_add_u32 s22, s18, 802816
    s_add_u32 s23, s18, 1204224
    buffer_load_dwordx4 a[32:35], v1, s[4:7], s22 offen offset:0
    buffer_load_dwordx4 a[36:39], v1, s[4:7], s23 offen offset:0
    buffer_load_dwordx4 a[40:43], v1, s[4:7], s22 offen offset:1024
    buffer_load_dwordx4 a[44:47], v1, s[4:7], s23 offen offset:1024
    buffer_load_dwordx4 a[48:51], v1, s[4:7], s22 offen offset:2048
    buffer_load_dwordx4 a[52:55], v1, s[4:7], s23 offen offset:2048
    s_waitcnt vmcnt(60)
    v_swap_b32 v65, v68
    v_swap_b32 v66, v68
    v_swap_b32 v67, v69
    v_swap_b32 v69, v70
    buffer_load_dwordx4 a[56:59], v1, s[4:7], s22 offen offset:3072
    buffer_load_dwordx4 a[60:63], v1, s[4:7], s23 offen offset:3072
    s_waitcnt vmcnt(60)
    v_swap_b32 v73, v76
    v_swap_b32 v74, v76
    v_swap_b32 v75, v77
    v_swap_b32 v77, v78
    s_add_u32 s22, s18, 806912
    s_add_u32 s23, s18, 1208320
    buffer_load_dwordx4 a[64:67], v1, s[4:7], s22 offen offset:0
    buffer_load_dwordx4 a[68:71], v1, s[4:7], s23 offen offset:0
    s_waitcnt vmcnt(60)
    v_swap_b32 v81, v84
    v_swap_b32 v82, v84
    v_swap_b32 v83, v85
    v_swap_b32 v85, v86
    buffer_load_dwordx4 a[72:75], v1, s[4:7], s22 offen offset:1024
    buffer_load_dwordx4 a[76:79], v1, s[4:7], s23 offen offset:1024
    s_waitcnt vmcnt(60)
    v_swap_b32 v89, v92
    v_swap_b32 v90, v92
    v_swap_b32 v91, v93
    v_swap_b32 v93, v94
    buffer_load_dwordx4 a[80:83], v1, s[4:7], s22 offen offset:2048
    buffer_load_dwordx4 a[84:87], v1, s[4:7], s23 offen offset:2048
    s_waitcnt vmcnt(60)
    v_swap_b32 v97, v100
    v_swap_b32 v98, v100
    v_swap_b32 v99, v101
    v_swap_b32 v101, v102
    buffer_load_dwordx4 a[88:91], v1, s[4:7], s22 offen offset:3072
    buffer_load_dwordx4 a[92:95], v1, s[4:7], s23 offen offset:3072
    s_waitcnt vmcnt(60)
    v_swap_b32 v105, v108
    v_swap_b32 v106, v108
    v_swap_b32 v107, v109
    v_swap_b32 v109, v110
    s_add_u32 s22, s18, 811008
    s_add_u32 s23, s18, 1212416
    buffer_load_dwordx4 a[96:99], v1, s[4:7], s22 offen offset:0
    buffer_load_dwordx4 a[100:103], v1, s[4:7], s23 offen offset:0
    s_waitcnt vmcnt(60)
    v_swap_b32 v113, v116
    v_swap_b32 v114, v116
    v_swap_b32 v115, v117
    v_swap_b32 v117, v118
    buffer_load_dwordx4 a[104:107], v1, s[4:7], s22 offen offset:1024
    buffer_load_dwordx4 a[108:111], v1, s[4:7], s23 offen offset:1024
    s_waitcnt vmcnt(60)
    v_swap_b32 v121, v124
    v_swap_b32 v122, v124
    v_swap_b32 v123, v125
    v_swap_b32 v125, v126
    buffer_load_dwordx4 a[112:115], v1, s[4:7], s22 offen offset:2048
    buffer_load_dwordx4 a[116:119], v1, s[4:7], s23 offen offset:2048
    s_waitcnt vmcnt(60)
    v_swap_b32 v129, v132
    v_swap_b32 v130, v132
    v_swap_b32 v131, v133
    v_swap_b32 v133, v134
    buffer_load_dwordx4 a[120:123], v1, s[4:7], s22 offen offset:3072
    buffer_load_dwordx4 a[124:127], v1, s[4:7], s23 offen offset:3072
    s_waitcnt vmcnt(60)
    v_swap_b32 v137, v140
    v_swap_b32 v138, v140
    v_swap_b32 v139, v141
    v_swap_b32 v141, v142
    s_add_u32 s22, s18, 815104
    s_add_u32 s23, s18, 1216512
    buffer_load_dwordx4 a[128:131], v1, s[4:7], s22 offen offset:0
    buffer_load_dwordx4 a[132:135], v1, s[4:7], s23 offen offset:0
    s_waitcnt vmcnt(60)
    v_swap_b32 v145, v148
    v_swap_b32 v146, v148
    v_swap_b32 v147, v149
    v_swap_b32 v149, v150
    buffer_load_dwordx4 a[136:139], v1, s[4:7], s22 offen offset:1024
    buffer_load_dwordx4 a[140:143], v1, s[4:7], s23 offen offset:1024
    s_waitcnt vmcnt(60)
    v_swap_b32 v153, v156
    v_swap_b32 v154, v156
    v_swap_b32 v155, v157
    v_swap_b32 v157, v158
    s_add_u32 s22, s18, 817152
    s_add_u32 s23, s18, 1218560
    buffer_load_dwordx4 a[144:147], v1, s[4:7], s22 offen offset:0
    buffer_load_dwordx4 a[148:151], v1, s[4:7], s23 offen offset:0
    s_waitcnt vmcnt(60)
    v_swap_b32 v161, v164
    v_swap_b32 v162, v164
    v_swap_b32 v163, v165
    v_swap_b32 v165, v166
    buffer_load_dwordx4 a[152:155], v1, s[4:7], s22 offen offset:1024
    buffer_load_dwordx4 a[156:159], v1, s[4:7], s23 offen offset:1024
    s_waitcnt vmcnt(60)
    v_swap_b32 v169, v172
    v_swap_b32 v170, v172
    v_swap_b32 v171, v173
    v_swap_b32 v173, v174
    buffer_load_dwordx4 a[160:163], v1, s[4:7], s22 offen offset:2048
    buffer_load_dwordx4 a[164:167], v1, s[4:7], s23 offen offset:2048
    s_waitcnt vmcnt(60)
    v_swap_b32 v177, v180
    v_swap_b32 v178, v180
    v_swap_b32 v179, v181
    v_swap_b32 v181, v182
    buffer_load_dwordx4 a[168:171], v1, s[4:7], s22 offen offset:3072
    buffer_load_dwordx4 a[172:175], v1, s[4:7], s23 offen offset:3072
    s_waitcnt vmcnt(60)
    v_swap_b32 v185, v188
    v_swap_b32 v186, v188
    v_swap_b32 v187, v189
    v_swap_b32 v189, v190
    s_add_u32 s22, s18, 821248
    s_add_u32 s23, s18, 1222656
    buffer_load_dwordx4 a[176:179], v1, s[4:7], s22 offen offset:0
    buffer_load_dwordx4 a[180:183], v1, s[4:7], s23 offen offset:0
    s_waitcnt vmcnt(60)
    v_swap_b32 v193, v196
    v_swap_b32 v194, v196
    v_swap_b32 v195, v197
    v_swap_b32 v197, v198
    buffer_load_dwordx4 a[184:187], v1, s[4:7], s22 offen offset:1024
    buffer_load_dwordx4 a[188:191], v1, s[4:7], s23 offen offset:1024
    s_waitcnt vmcnt(60)
    v_swap_b32 v201, v204
    v_swap_b32 v202, v204
    v_swap_b32 v203, v205
    v_swap_b32 v205, v206
    buffer_load_dwordx4 a[192:195], v1, s[4:7], s22 offen offset:2048
    buffer_load_dwordx4 a[196:199], v1, s[4:7], s23 offen offset:2048
    s_waitcnt vmcnt(60)
    v_swap_b32 v209, v212
    v_swap_b32 v210, v212
    v_swap_b32 v211, v213
    v_swap_b32 v213, v214
    buffer_load_dwordx4 a[200:203], v1, s[4:7], s22 offen offset:3072
    buffer_load_dwordx4 a[204:207], v1, s[4:7], s23 offen offset:3072
    s_waitcnt vmcnt(60)
    v_swap_b32 v217, v220
    v_swap_b32 v218, v220
    v_swap_b32 v219, v221
    v_swap_b32 v221, v222
    s_add_u32 s22, s18, 825344
    s_add_u32 s23, s18, 1226752
    buffer_load_dwordx4 a[208:211], v1, s[4:7], s22 offen offset:0
    buffer_load_dwordx4 a[212:215], v1, s[4:7], s23 offen offset:0
    s_waitcnt vmcnt(60)
    v_swap_b32 v225, v228
    v_swap_b32 v226, v228
    v_swap_b32 v227, v229
    v_swap_b32 v229, v230
    buffer_load_dwordx4 a[216:219], v1, s[4:7], s22 offen offset:1024
    buffer_load_dwordx4 a[220:223], v1, s[4:7], s23 offen offset:1024
    s_waitcnt vmcnt(60)
    v_swap_b32 v233, v236
    v_swap_b32 v234, v236
    v_swap_b32 v235, v237
    v_swap_b32 v237, v238
    buffer_load_dwordx4 a[224:227], v1, s[4:7], s22 offen offset:2048
    buffer_load_dwordx4 a[228:231], v1, s[4:7], s23 offen offset:2048
    s_waitcnt vmcnt(60)
    v_swap_b32 v241, v244
    v_swap_b32 v242, v244
    v_swap_b32 v243, v245
    v_swap_b32 v245, v246
    buffer_load_dwordx4 a[232:235], v1, s[4:7], s22 offen offset:3072
    buffer_load_dwordx4 a[236:239], v1, s[4:7], s23 offen offset:3072
    s_waitcnt vmcnt(60)
    v_swap_b32 v249, v252
    v_swap_b32 v250, v252
    v_swap_b32 v251, v253
    v_swap_b32 v253, v254
    s_add_u32 s22, s18, 829440
    s_add_u32 s23, s18, 1230848
    buffer_load_dwordx4 a[240:243], v1, s[4:7], s22 offen offset:0
    buffer_load_dwordx4 a[244:247], v1, s[4:7], s23 offen offset:0
    s_waitcnt vmcnt(60)
    v_accvgpr_read_b32 v11, a1
    v_accvgpr_mov_b32 a1, a4
    v_accvgpr_mov_b32 a4, a2
    v_accvgpr_write_b32 a2, v11
    v_accvgpr_read_b32 v11, a3
    v_accvgpr_mov_b32 a3, a5
    v_accvgpr_mov_b32 a5, a6
    v_accvgpr_write_b32 a6, v11
    buffer_load_dwordx4 a[248:251], v1, s[4:7], s22 offen offset:1024
    buffer_load_dwordx4 a[252:255], v1, s[4:7], s23 offen offset:1024
    s_waitcnt vmcnt(60)
    v_accvgpr_read_b32 v11, a9
    v_accvgpr_mov_b32 a9, a12
    v_accvgpr_mov_b32 a12, a10
    v_accvgpr_write_b32 a10, v11
    v_accvgpr_read_b32 v11, a11
    v_accvgpr_mov_b32 a11, a13
    v_accvgpr_mov_b32 a13, a14
    v_accvgpr_write_b32 a14, v11
    s_waitcnt vmcnt(58)
    v_accvgpr_read_b32 v11, a17
    v_accvgpr_mov_b32 a17, a20
    v_accvgpr_mov_b32 a20, a18
    v_accvgpr_write_b32 a18, v11
    v_accvgpr_read_b32 v11, a19
    v_accvgpr_mov_b32 a19, a21
    v_accvgpr_mov_b32 a21, a22
    v_accvgpr_write_b32 a22, v11
    s_waitcnt vmcnt(56)
    v_accvgpr_read_b32 v11, a25
    v_accvgpr_mov_b32 a25, a28
    v_accvgpr_mov_b32 a28, a26
    v_accvgpr_write_b32 a26, v11
    v_accvgpr_read_b32 v11, a27
    v_accvgpr_mov_b32 a27, a29
    v_accvgpr_mov_b32 a29, a30
    v_accvgpr_write_b32 a30, v11
    s_waitcnt vmcnt(54)
    v_accvgpr_read_b32 v11, a33
    v_accvgpr_mov_b32 a33, a36
    v_accvgpr_mov_b32 a36, a34
    v_accvgpr_write_b32 a34, v11
    v_accvgpr_read_b32 v11, a35
    v_accvgpr_mov_b32 a35, a37
    v_accvgpr_mov_b32 a37, a38
    v_accvgpr_write_b32 a38, v11
    s_waitcnt vmcnt(52)
    v_accvgpr_read_b32 v11, a41
    v_accvgpr_mov_b32 a41, a44
    v_accvgpr_mov_b32 a44, a42
    v_accvgpr_write_b32 a42, v11
    v_accvgpr_read_b32 v11, a43
    v_accvgpr_mov_b32 a43, a45
    v_accvgpr_mov_b32 a45, a46
    v_accvgpr_write_b32 a46, v11
    s_waitcnt vmcnt(50)
    v_accvgpr_read_b32 v11, a49
    v_accvgpr_mov_b32 a49, a52
    v_accvgpr_mov_b32 a52, a50
    v_accvgpr_write_b32 a50, v11
    v_accvgpr_read_b32 v11, a51
    v_accvgpr_mov_b32 a51, a53
    v_accvgpr_mov_b32 a53, a54
    v_accvgpr_write_b32 a54, v11
    s_waitcnt vmcnt(48)
    v_accvgpr_read_b32 v11, a57
    v_accvgpr_mov_b32 a57, a60
    v_accvgpr_mov_b32 a60, a58
    v_accvgpr_write_b32 a58, v11
    v_accvgpr_read_b32 v11, a59
    v_accvgpr_mov_b32 a59, a61
    v_accvgpr_mov_b32 a61, a62
    v_accvgpr_write_b32 a62, v11
    s_waitcnt vmcnt(46)
    v_accvgpr_read_b32 v11, a65
    v_accvgpr_mov_b32 a65, a68
    v_accvgpr_mov_b32 a68, a66
    v_accvgpr_write_b32 a66, v11
    v_accvgpr_read_b32 v11, a67
    v_accvgpr_mov_b32 a67, a69
    v_accvgpr_mov_b32 a69, a70
    v_accvgpr_write_b32 a70, v11
    s_waitcnt vmcnt(44)
    v_accvgpr_read_b32 v11, a73
    v_accvgpr_mov_b32 a73, a76
    v_accvgpr_mov_b32 a76, a74
    v_accvgpr_write_b32 a74, v11
    v_accvgpr_read_b32 v11, a75
    v_accvgpr_mov_b32 a75, a77
    v_accvgpr_mov_b32 a77, a78
    v_accvgpr_write_b32 a78, v11
    s_waitcnt vmcnt(42)
    v_accvgpr_read_b32 v11, a81
    v_accvgpr_mov_b32 a81, a84
    v_accvgpr_mov_b32 a84, a82
    v_accvgpr_write_b32 a82, v11
    v_accvgpr_read_b32 v11, a83
    v_accvgpr_mov_b32 a83, a85
    v_accvgpr_mov_b32 a85, a86
    v_accvgpr_write_b32 a86, v11
    s_waitcnt vmcnt(40)
    v_accvgpr_read_b32 v11, a89
    v_accvgpr_mov_b32 a89, a92
    v_accvgpr_mov_b32 a92, a90
    v_accvgpr_write_b32 a90, v11
    v_accvgpr_read_b32 v11, a91
    v_accvgpr_mov_b32 a91, a93
    v_accvgpr_mov_b32 a93, a94
    v_accvgpr_write_b32 a94, v11
    s_waitcnt vmcnt(38)
    v_accvgpr_read_b32 v11, a97
    v_accvgpr_mov_b32 a97, a100
    v_accvgpr_mov_b32 a100, a98
    v_accvgpr_write_b32 a98, v11
    v_accvgpr_read_b32 v11, a99
    v_accvgpr_mov_b32 a99, a101
    v_accvgpr_mov_b32 a101, a102
    v_accvgpr_write_b32 a102, v11
    s_waitcnt vmcnt(36)
    v_accvgpr_read_b32 v11, a105
    v_accvgpr_mov_b32 a105, a108
    v_accvgpr_mov_b32 a108, a106
    v_accvgpr_write_b32 a106, v11
    v_accvgpr_read_b32 v11, a107
    v_accvgpr_mov_b32 a107, a109
    v_accvgpr_mov_b32 a109, a110
    v_accvgpr_write_b32 a110, v11
    s_waitcnt vmcnt(34)
    v_accvgpr_read_b32 v11, a113
    v_accvgpr_mov_b32 a113, a116
    v_accvgpr_mov_b32 a116, a114
    v_accvgpr_write_b32 a114, v11
    v_accvgpr_read_b32 v11, a115
    v_accvgpr_mov_b32 a115, a117
    v_accvgpr_mov_b32 a117, a118
    v_accvgpr_write_b32 a118, v11
    s_waitcnt vmcnt(32)
    v_accvgpr_read_b32 v11, a121
    v_accvgpr_mov_b32 a121, a124
    v_accvgpr_mov_b32 a124, a122
    v_accvgpr_write_b32 a122, v11
    v_accvgpr_read_b32 v11, a123
    v_accvgpr_mov_b32 a123, a125
    v_accvgpr_mov_b32 a125, a126
    v_accvgpr_write_b32 a126, v11
    s_waitcnt vmcnt(30)
    v_accvgpr_read_b32 v11, a129
    v_accvgpr_mov_b32 a129, a132
    v_accvgpr_mov_b32 a132, a130
    v_accvgpr_write_b32 a130, v11
    v_accvgpr_read_b32 v11, a131
    v_accvgpr_mov_b32 a131, a133
    v_accvgpr_mov_b32 a133, a134
    v_accvgpr_write_b32 a134, v11
    s_waitcnt vmcnt(28)
    v_accvgpr_read_b32 v11, a137
    v_accvgpr_mov_b32 a137, a140
    v_accvgpr_mov_b32 a140, a138
    v_accvgpr_write_b32 a138, v11
    v_accvgpr_read_b32 v11, a139
    v_accvgpr_mov_b32 a139, a141
    v_accvgpr_mov_b32 a141, a142
    v_accvgpr_write_b32 a142, v11
    s_waitcnt vmcnt(26)
    v_accvgpr_read_b32 v11, a145
    v_accvgpr_mov_b32 a145, a148
    v_accvgpr_mov_b32 a148, a146
    v_accvgpr_write_b32 a146, v11
    v_accvgpr_read_b32 v11, a147
    v_accvgpr_mov_b32 a147, a149
    v_accvgpr_mov_b32 a149, a150
    v_accvgpr_write_b32 a150, v11
    s_waitcnt vmcnt(24)
    v_accvgpr_read_b32 v11, a153
    v_accvgpr_mov_b32 a153, a156
    v_accvgpr_mov_b32 a156, a154
    v_accvgpr_write_b32 a154, v11
    v_accvgpr_read_b32 v11, a155
    v_accvgpr_mov_b32 a155, a157
    v_accvgpr_mov_b32 a157, a158
    v_accvgpr_write_b32 a158, v11
    s_waitcnt vmcnt(22)
    v_accvgpr_read_b32 v11, a161
    v_accvgpr_mov_b32 a161, a164
    v_accvgpr_mov_b32 a164, a162
    v_accvgpr_write_b32 a162, v11
    v_accvgpr_read_b32 v11, a163
    v_accvgpr_mov_b32 a163, a165
    v_accvgpr_mov_b32 a165, a166
    v_accvgpr_write_b32 a166, v11
    s_waitcnt vmcnt(20)
    v_accvgpr_read_b32 v11, a169
    v_accvgpr_mov_b32 a169, a172
    v_accvgpr_mov_b32 a172, a170
    v_accvgpr_write_b32 a170, v11
    v_accvgpr_read_b32 v11, a171
    v_accvgpr_mov_b32 a171, a173
    v_accvgpr_mov_b32 a173, a174
    v_accvgpr_write_b32 a174, v11
    s_waitcnt vmcnt(18)
    v_accvgpr_read_b32 v11, a177
    v_accvgpr_mov_b32 a177, a180
    v_accvgpr_mov_b32 a180, a178
    v_accvgpr_write_b32 a178, v11
    v_accvgpr_read_b32 v11, a179
    v_accvgpr_mov_b32 a179, a181
    v_accvgpr_mov_b32 a181, a182
    v_accvgpr_write_b32 a182, v11
    s_waitcnt vmcnt(16)
    v_accvgpr_read_b32 v11, a185
    v_accvgpr_mov_b32 a185, a188
    v_accvgpr_mov_b32 a188, a186
    v_accvgpr_write_b32 a186, v11
    v_accvgpr_read_b32 v11, a187
    v_accvgpr_mov_b32 a187, a189
    v_accvgpr_mov_b32 a189, a190
    v_accvgpr_write_b32 a190, v11
    s_waitcnt vmcnt(14)
    v_accvgpr_read_b32 v11, a193
    v_accvgpr_mov_b32 a193, a196
    v_accvgpr_mov_b32 a196, a194
    v_accvgpr_write_b32 a194, v11
    v_accvgpr_read_b32 v11, a195
    v_accvgpr_mov_b32 a195, a197
    v_accvgpr_mov_b32 a197, a198
    v_accvgpr_write_b32 a198, v11
    s_waitcnt vmcnt(12)
    v_accvgpr_read_b32 v11, a201
    v_accvgpr_mov_b32 a201, a204
    v_accvgpr_mov_b32 a204, a202
    v_accvgpr_write_b32 a202, v11
    v_accvgpr_read_b32 v11, a203
    v_accvgpr_mov_b32 a203, a205
    v_accvgpr_mov_b32 a205, a206
    v_accvgpr_write_b32 a206, v11
    s_waitcnt vmcnt(10)
    v_accvgpr_read_b32 v11, a209
    v_accvgpr_mov_b32 a209, a212
    v_accvgpr_mov_b32 a212, a210
    v_accvgpr_write_b32 a210, v11
    v_accvgpr_read_b32 v11, a211
    v_accvgpr_mov_b32 a211, a213
    v_accvgpr_mov_b32 a213, a214
    v_accvgpr_write_b32 a214, v11
    s_waitcnt vmcnt(8)
    v_accvgpr_read_b32 v11, a217
    v_accvgpr_mov_b32 a217, a220
    v_accvgpr_mov_b32 a220, a218
    v_accvgpr_write_b32 a218, v11
    v_accvgpr_read_b32 v11, a219
    v_accvgpr_mov_b32 a219, a221
    v_accvgpr_mov_b32 a221, a222
    v_accvgpr_write_b32 a222, v11
    s_waitcnt vmcnt(6)
    v_accvgpr_read_b32 v11, a225
    v_accvgpr_mov_b32 a225, a228
    v_accvgpr_mov_b32 a228, a226
    v_accvgpr_write_b32 a226, v11
    v_accvgpr_read_b32 v11, a227
    v_accvgpr_mov_b32 a227, a229
    v_accvgpr_mov_b32 a229, a230
    v_accvgpr_write_b32 a230, v11
    s_waitcnt vmcnt(4)
    v_accvgpr_read_b32 v11, a233
    v_accvgpr_mov_b32 a233, a236
    v_accvgpr_mov_b32 a236, a234
    v_accvgpr_write_b32 a234, v11
    v_accvgpr_read_b32 v11, a235
    v_accvgpr_mov_b32 a235, a237
    v_accvgpr_mov_b32 a237, a238
    v_accvgpr_write_b32 a238, v11
    s_waitcnt vmcnt(2)
    v_accvgpr_read_b32 v11, a241
    v_accvgpr_mov_b32 a241, a244
    v_accvgpr_mov_b32 a244, a242
    v_accvgpr_write_b32 a242, v11
    v_accvgpr_read_b32 v11, a243
    v_accvgpr_mov_b32 a243, a245
    v_accvgpr_mov_b32 a245, a246
    v_accvgpr_write_b32 a246, v11
    s_waitcnt vmcnt(0)
    v_accvgpr_read_b32 v11, a249
    v_accvgpr_mov_b32 a249, a252
    v_accvgpr_mov_b32 a252, a250
    v_accvgpr_write_b32 a250, v11
    v_accvgpr_read_b32 v11, a251
    v_accvgpr_mov_b32 a251, a253
    v_accvgpr_mov_b32 a253, a254
    v_accvgpr_write_b32 a254, v11
    s_branch vwd_76
vw3_75:
    v_add_u32 v14, 16384, v12
    s_cmp_ge_u32 s21, 4
    s_cbranch_scc1 vo_86
    s_lshl_b32 s19, s3, 2
    s_add_u32 s19, s19, 18
    s_lshl_b32 s19, s19, 3
    s_lshr_b32 s22, s17, 1
    s_add_u32 s19, s19, s22
    s_lshl_b32 s19, s19, 7
    v_and_b32 v13, 31, v0
    v_min_u32 v13, 27, v13
    v_lshlrev_b32 v13, 2, v13
    v_lshrrev_b32 v11, 5, v0
    v_lshl_add_u32 v13, v11, 10, v13
    s_add_u32 s19, s19, 74055680
    v_add_u32 v13, s19, v13
    s_mov_b32 s35, 400000
ww_87:
    buffer_load_dword v11, v13, s[4:7], 0 offen sc1
    s_waitcnt vmcnt(0)
    v_cmp_eq_u32 vcc, 0, v11
    s_cbranch_vccz wwo_88
    s_sleep 16
    s_sub_u32 s35, s35, 1
    s_cmp_lg_u32 s35, 0
    s_cbranch_scc1 ww_87
    s_branch k2_end
wwo_88:
    s_add_u32 s22, s18, 802816
    s_add_u32 s23, s18, 1204224
    buffer_load_dwordx4 v[32:35], v1, s[4:7], s22 offen offset:0
    buffer_load_dwordx4 v[36:39], v1, s[4:7], s23 offen offset:0
    buffer_load_dwordx4 v[40:43], v1, s[4:7], s22 offen offset:1024
    buffer_load_dwordx4 v[44:47], v1, s[4:7], s23 offen offset:1024
    buffer_load_dwordx4 v[48:51], v1, s[4:7], s22 offen offset:2048
    buffer_load_dwordx4 v[52:55], v1, s[4:7], s23 offen offset:2048
    buffer_load_dwordx4 v[56:59], v1, s[4:7], s22 offen offset:3072
    buffer_load_dwordx4 v[60:63], v1, s[4:7], s23 offen offset:3072
    s_add_u32 s22, s18, 806912
    s_add_u32 s23, s18, 1208320
    buffer_load_dwordx4 v[64:67], v1, s[4:7], s22 offen offset:0
    buffer_load_dwordx4 v[68:71], v1, s[4:7], s23 offen offset:0
    buffer_load_dwordx4 v[72:75], v1, s[4:7], s22 offen offset:1024
    buffer_load_dwordx4 v[76:79], v1, s[4:7], s23 offen offset:1024
    buffer_load_dwordx4 v[80:83], v1, s[4:7], s22 offen offset:2048
    buffer_load_dwordx4 v[84:87], v1, s[4:7], s23 offen offset:2048
    buffer_load_dwordx4 v[88:91], v1, s[4:7], s22 offen offset:3072
    buffer_load_dwordx4 v[92:95], v1, s[4:7], s23 offen offset:3072
    s_add_u32 s22, s18, 811008
    s_add_u32 s23, s18, 1212416
    buffer_load_dwordx4 v[96:99], v1, s[4:7], s22 offen offset:0
    buffer_load_dwordx4 v[100:103], v1, s[4:7], s23 offen offset:0
    buffer_load_dwordx4 v[104:107], v1, s[4:7], s22 offen offset:1024
    buffer_load_dwordx4 v[108:111], v1, s[4:7], s23 offen offset:1024
    buffer_load_dwordx4 v[112:115], v1, s[4:7], s22 offen offset:2048
    buffer_load_dwordx4 v[116:119], v1, s[4:7], s23 offen offset:2048
    buffer_load_dwordx4 v[120:123], v1, s[4:7], s22 offen offset:3072
    buffer_load_dwordx4 v[124:127], v1, s[4:7], s23 offen offset:3072
    s_add_u32 s22, s18, 815104
    s_add_u32 s23, s18, 1216512
    buffer_load_dwordx4 v[128:131], v1, s[4:7], s22 offen offset:0
    buffer_load_dwordx4 v[132:135], v1, s[4:7], s23 offen offset:0
    buffer_load_dwordx4 v[136:139], v1, s[4:7], s22 offen offset:1024
    buffer_load_dwordx4 v[140:143], v1, s[4:7], s23 offen offset:1024
    s_add_u32 s22, s18, 817152
    s_add_u32 s23, s18, 1218560
    buffer_load_dwordx4 v[144:147], v1, s[4:7], s22 offen offset:0
    buffer_load_dwordx4 v[148:151], v1, s[4:7], s23 offen offset:0
    buffer_load_dwordx4 v[152:155], v1, s[4:7], s22 offen offset:1024
    buffer_load_dwordx4 v[156:159], v1, s[4:7], s23 offen offset:1024
    buffer_load_dwordx4 v[160:163], v1, s[4:7], s22 offen offset:2048
    buffer_load_dwordx4 v[164:167], v1, s[4:7], s23 offen offset:2048
    buffer_load_dwordx4 v[168:171], v1, s[4:7], s22 offen offset:3072
    buffer_load_dwordx4 v[172:175], v1, s[4:7], s23 offen offset:3072
    s_add_u32 s22, s18, 821248
    s_add_u32 s23, s18, 1222656
    buffer_load_dwordx4 v[176:179], v1, s[4:7], s22 offen offset:0
    buffer_load_dwordx4 v[180:183], v1, s[4:7], s23 offen offset:0
    buffer_load_dwordx4 v[184:187], v1, s[4:7], s22 offen offset:1024
    buffer_load_dwordx4 v[188:191], v1, s[4:7], s23 offen offset:1024
    buffer_load_dwordx4 v[192:195], v1, s[4:7], s22 offen offset:2048
    buffer_load_dwordx4 v[196:199], v1, s[4:7], s23 offen offset:2048
    buffer_load_dwordx4 v[200:203], v1, s[4:7], s22 offen offset:3072
    buffer_load_dwordx4 v[204:207], v1, s[4:7], s23 offen offset:3072
    s_add_u32 s22, s18, 825344
    s_add_u32 s23, s18, 1226752
    buffer_load_dwordx4 v[208:211], v1, s[4:7], s22 offen offset:0
    buffer_load_dwordx4 v[212:215], v1, s[4:7], s23 offen offset:0
    buffer_load_dwordx4 v[216:219], v1, s[4:7], s22 offen offset:1024
    buffer_load_dwordx4 v[220:223], v1, s[4:7], s23 offen offset:1024
    buffer_load_dwordx4 v[224:227], v1, s[4:7], s22 offen offset:2048
    buffer_load_dwordx4 v[228:231], v1, s[4:7], s23 offen offset:2048
    buffer_load_dwordx4 v[232:235], v1, s[4:7], s22 offen offset:3072
    buffer_load_dwordx4 v[236:239], v1, s[4:7], s23 offen offset:3072
    s_add_u32 s22, s18, 829440
    s_add_u32 s23, s18, 1230848
    buffer_load_dwordx4 v[240:243], v1, s[4:7], s22 offen offset:0
    buffer_load_dwordx4 v[244:247], v1, s[4:7], s23 offen offset:0
    buffer_load_dwordx4 v[248:251], v1, s[4:7], s22 offen offset:1024
    buffer_load_dwordx4 v[252:255], v1, s[4:7], s23 offen offset:1024
    s_lshl_b32 s19, s3, 2
    s_add_u32 s19, s19, 16
    s_lshl_b32 s19, s19, 3
    s_lshr_b32 s22, s17, 1
    s_add_u32 s19, s19, s22
    s_lshl_b32 s19, s19, 7
    v_and_b32 v13, 31, v0
    v_min_u32 v13, 27, v13
    v_lshlrev_b32 v13, 2, v13
    v_lshrrev_b32 v11, 5, v0
    v_lshl_add_u32 v13, v11, 10, v13
    s_add_u32 s19, s19, 74055680
    v_add_u32 v13, s19, v13
    s_mov_b32 s35, 400000
ww_89:
    buffer_load_dword v11, v13, s[4:7], 0 offen sc1
    s_waitcnt vmcnt(0)
    v_cmp_eq_u32 vcc, 0, v11
    s_cbranch_vccz wwo_90
    s_sleep 16
    s_sub_u32 s35, s35, 1
    s_cmp_lg_u32 s35, 0
    s_cbranch_scc1 ww_89
    s_branch k2_end
wwo_90:
    s_add_u32 s22, s18, 0
    s_add_u32 s23, s18, 401408
    buffer_load_dwordx4 a[0:3], v1, s[4:7], s22 offen offset:0
    buffer_load_dwordx4 a[4:7], v1, s[4:7], s23 offen offset:0
    buffer_load_dwordx4 a[8:11], v1, s[4:7], s22 offen offset:1024
    buffer_load_dwordx4 a[12:15], v1, s[4:7], s23 offen offset:1024
    buffer_load_dwordx4 a[16:19], v1, s[4:7], s22 offen offset:2048
    buffer_load_dwordx4 a[20:23], v1, s[4:7], s23 offen offset:2048
    s_waitcnt vmcnt(60)
    v_swap_b32 v33, v36
    v_swap_b32 v34, v36
    v_swap_b32 v35, v37
    v_swap_b32 v37, v38
    ds_write_b128 v14, v[32:35] offset:0
    ds_write_b128 v14, v[36:39] offset:1024
    buffer_load_dwordx4 a[24:27], v1, s[4:7], s22 offen offset:3072
    buffer_load_dwordx4 a[28:31], v1, s[4:7], s23 offen offset:3072
    s_waitcnt vmcnt(60)
    v_swap_b32 v41, v44
    v_swap_b32 v42, v44
    v_swap_b32 v43, v45
    v_swap_b32 v45, v46
    ds_write_b128 v14, v[40:43] offset:4096
    ds_write_b128 v14, v[44:47] offset:5120
    s_add_u32 s22, s18, 4096
    s_add_u32 s23, s18, 405504
    buffer_load_dwordx4 a[32:35], v1, s[4:7], s22 offen offset:0
    buffer_load_dwordx4 a[36:39], v1, s[4:7], s23 offen offset:0
    s_waitcnt vmcnt(60)
    v_swap_b32 v49, v52
    v_swap_b32 v50, v52
    v_swap_b32 v51, v53
    v_swap_b32 v53, v54
    ds_write_b128 v14, v[48:51] offset:8192
    ds_write_b128 v14, v[52:55] offset:9216
    buffer_load_dwordx4 a[40:43], v1, s[4:7], s22 offen offset:1024
    buffer_load_dwordx4 a[44:47], v1, s[4:7], s23 offen offset:1024
    s_waitcnt vmcnt(60)
    v_swap_b32 v57, v60
    v_swap_b32 v58, v60
    v_swap_b32 v59, v61
    v_swap_b32 v61, v62
    ds_write_b128 v14, v[56:59] offset:12288
    ds_write_b128 v14, v[60:63] offset:13312
    buffer_load_dwordx4 a[48:51], v1, s[4:7], s22 offen offset:2048
    buffer_load_dwordx4 a[52:55], v1, s[4:7], s23 offen offset:2048
    s_waitcnt vmcnt(60)
    v_swap_b32 v65, v68
    v_swap_b32 v66, v68
    v_swap_b32 v67, v69
    v_swap_b32 v69, v70
    ds_write_b128 v14, v[64:67] offset:16384
    ds_write_b128 v14, v[68:71] offset:17408
    buffer_load_dwordx4 a[56:59], v1, s[4:7], s22 offen offset:3072
    buffer_load_dwordx4 a[60:63], v1, s[4:7], s23 offen offset:3072
    s_waitcnt vmcnt(60)
    v_swap_b32 v73, v76
    v_swap_b32 v74, v76
    v_swap_b32 v75, v77
    v_swap_b32 v77, v78
    ds_write_b128 v14, v[72:75] offset:20480
    ds_write_b128 v14, v[76:79] offset:21504
    s_add_u32 s22, s18, 8192
    s_add_u32 s23, s18, 409600
    buffer_load_dwordx4 a[64:67], v1, s[4:7], s22 offen offset:0
    buffer_load_dwordx4 a[68:71], v1, s[4:7], s23 offen offset:0
    s_waitcnt vmcnt(60)
    v_swap_b32 v81, v84
    v_swap_b32 v82, v84
    v_swap_b32 v83, v85
    v_swap_b32 v85, v86
    ds_write_b128 v14, v[80:83] offset:24576
    ds_write_b128 v14, v[84:87] offset:25600
    buffer_load_dwordx4 a[72:75], v1, s[4:7], s22 offen offset:1024
    buffer_load_dwordx4 a[76:79], v1, s[4:7], s23 offen offset:1024
    s_waitcnt vmcnt(60)
    v_swap_b32 v89, v92
    v_swap_b32 v90, v92
    v_swap_b32 v91, v93
    v_swap_b32 v93, v94
    ds_write_b128 v14, v[88:91] offset:28672
    ds_write_b128 v14, v[92:95] offset:29696
    buffer_load_dwordx4 a[80:83], v1, s[4:7], s22 offen offset:2048
    buffer_load_dwordx4 a[84:87], v1, s[4:7], s23 offen offset:2048
    s_waitcnt vmcnt(60)
    v_swap_b32 v97, v100
    v_swap_b32 v98, v100
    v_swap_b32 v99, v101
    v_swap_b32 v101, v102
    ds_write_b128 v14, v[96:99] offset:32768
    ds_write_b128 v14, v[100:103] offset:33792
    buffer_load_dwordx4 a[88:91], v1, s[4:7], s22 offen offset:3072
    buffer_load_dwordx4 a[92:95], v1, s[4:7], s23 offen offset:3072
    s_waitcnt vmcnt(60)
    v_swap_b32 v105, v108
    v_swap_b32 v106, v108
    v_swap_b32 v107, v109
    v_swap_b32 v109, v110
    ds_write_b128 v14, v[104:107] offset:36864
    ds_write_b128 v14, v[108:111] offset:37888
    s_add_u32 s22, s18, 12288
    s_add_u32 s23, s18, 413696
    buffer_load_dwordx4 a[96:99], v1, s[4:7], s22 offen offset:0
    buffer_load_dwordx4 a[100:103], v1, s[4:7], s23 offen offset:0
    s_waitcnt vmcnt(60)
    v_swap_b32 v113, v116
    v_swap_b32 v114, v116
    v_swap_b32 v115, v117
    v_swap_b32 v117, v118
    ds_write_b128 v14, v[112:115] offset:40960
    ds_write_b128 v14, v[116:119] offset:41984
    buffer_load_dwordx4 a[104:107], v1, s[4:7], s22 offen offset:1024
    buffer_load_dwordx4 a[108:111], v1, s[4:7], s23 offen offset:1024
    s_waitcnt vmcnt(60)
    v_swap_b32 v121, v124
    v_swap_b32 v122, v124
    v_swap_b32 v123, v125
    v_swap_b32 v125, v126
    ds_write_b128 v14, v[120:123] offset:45056
    ds_write_b128 v14, v[124:127] offset:46080
    s_add_u32 s22, s18, 14336
    s_add_u32 s23, s18, 415744
    buffer_load_dwordx4 a[112:115], v1, s[4:7], s22 offen offset:0
    buffer_load_dwordx4 a[116:119], v1, s[4:7], s23 offen offset:0
    s_waitcnt vmcnt(60)
    v_swap_b32 v129, v132
    v_swap_b32 v130, v132
    v_swap_b32 v131, v133
    v_swap_b32 v133, v134
    ds_write_b128 v14, v[128:131] offset:49152
    ds_write_b128 v14, v[132:135] offset:50176
    buffer_load_dwordx4 a[120:123], v1, s[4:7], s22 offen offset:1024
    buffer_load_dwordx4 a[124:127], v1, s[4:7], s23 offen offset:1024
    s_waitcnt vmcnt(60)
    v_swap_b32 v137, v140
    v_swap_b32 v138, v140
    v_swap_b32 v139, v141
    v_swap_b32 v141, v142
    ds_write_b128 v14, v[136:139] offset:53248
    ds_write_b128 v14, v[140:143] offset:54272
    buffer_load_dwordx4 a[128:131], v1, s[4:7], s22 offen offset:2048
    buffer_load_dwordx4 a[132:135], v1, s[4:7], s23 offen offset:2048
    s_waitcnt vmcnt(60)
    v_swap_b32 v145, v148
    v_swap_b32 v146, v148
    v_swap_b32 v147, v149
    v_swap_b32 v149, v150
    ds_write_b128 v14, v[144:147] offset:2048
    ds_write_b128 v14, v[148:151] offset:3072
    buffer_load_dwordx4 a[136:139], v1, s[4:7], s22 offen offset:3072
    buffer_load_dwordx4 a[140:143], v1, s[4:7], s23 offen offset:3072
    s_waitcnt vmcnt(60)
    v_swap_b32 v153, v156
    v_swap_b32 v154, v156
    v_swap_b32 v155, v157
    v_swap_b32 v157, v158
    ds_write_b128 v14, v[152:155] offset:6144
    ds_write_b128 v14, v[156:159] offset:7168
    s_add_u32 s22, s18, 18432
    s_add_u32 s23, s18, 419840
    buffer_load_dwordx4 a[144:147], v1, s[4:7], s22 offen offset:0
    buffer_load_dwordx4 a[148:151], v1, s[4:7], s23 offen offset:0
    s_waitcnt vmcnt(60)
    v_swap_b32 v161, v164
    v_swap_b32 v162, v164
    v_swap_b32 v163, v165
    v_swap_b32 v165, v166
    ds_write_b128 v14, v[160:163] offset:10240
    ds_write_b128 v14, v[164:167] offset:11264
    buffer_load_dwordx4 a[152:155], v1, s[4:7], s22 offen offset:1024
    buffer_load_dwordx4 a[156:159], v1, s[4:7], s23 offen offset:1024
    s_waitcnt vmcnt(60)
    v_swap_b32 v169, v172
    v_swap_b32 v170, v172
    v_swap_b32 v171, v173
    v_swap_b32 v173, v174
    ds_write_b128 v14, v[168:171] offset:14336
    ds_write_b128 v14, v[172:175] offset:15360
    buffer_load_dwordx4 a[160:163], v1, s[4:7], s22 offen offset:2048
    buffer_load_dwordx4 a[164:167], v1, s[4:7], s23 offen offset:2048
    s_waitcnt vmcnt(60)
    v_swap_b32 v177, v180
    v_swap_b32 v178, v180
    v_swap_b32 v179, v181
    v_swap_b32 v181, v182
    ds_write_b128 v14, v[176:179] offset:18432
    ds_write_b128 v14, v[180:183] offset:19456
    buffer_load_dwordx4 a[168:171], v1, s[4:7], s22 offen offset:3072
    buffer_load_dwordx4 a[172:175], v1, s[4:7], s23 offen offset:3072
    s_waitcnt vmcnt(60)
    v_swap_b32 v185, v188
    v_swap_b32 v186, v188
    v_swap_b32 v187, v189
    v_swap_b32 v189, v190
    ds_write_b128 v14, v[184:187] offset:22528
    ds_write_b128 v14, v[188:191] offset:23552
    s_add_u32 s22, s18, 22528
    s_add_u32 s23, s18, 423936
    buffer_load_dwordx4 a[176:179], v1, s[4:7], s22 offen offset:0
    buffer_load_dwordx4 a[180:183], v1, s[4:7], s23 offen offset:0
    s_waitcnt vmcnt(60)
    v_swap_b32 v193, v196
    v_swap_b32 v194, v196
    v_swap_b32 v195, v197
    v_swap_b32 v197, v198
    ds_write_b128 v14, v[192:195] offset:26624
    ds_write_b128 v14, v[196:199] offset:27648
    buffer_load_dwordx4 a[184:187], v1, s[4:7], s22 offen offset:1024
    buffer_load_dwordx4 a[188:191], v1, s[4:7], s23 offen offset:1024
    s_waitcnt vmcnt(60)
    v_swap_b32 v201, v204
    v_swap_b32 v202, v204
    v_swap_b32 v203, v205
    v_swap_b32 v205, v206
    ds_write_b128 v14, v[200:203] offset:30720
    ds_write_b128 v14, v[204:207] offset:31744
    buffer_load_dwordx4 a[192:195], v1, s[4:7], s22 offen offset:2048
    buffer_load_dwordx4 a[196:199], v1, s[4:7], s23 offen offset:2048
    s_waitcnt vmcnt(60)
    v_swap_b32 v209, v212
    v_swap_b32 v210, v212
    v_swap_b32 v211, v213
    v_swap_b32 v213, v214
    ds_write_b128 v14, v[208:211] offset:34816
    ds_write_b128 v14, v[212:215] offset:35840
    buffer_load_dwordx4 a[200:203], v1, s[4:7], s22 offen offset:3072
    buffer_load_dwordx4 a[204:207], v1, s[4:7], s23 offen offset:3072
    s_waitcnt vmcnt(60)
    v_swap_b32 v217, v220
    v_swap_b32 v218, v220
    v_swap_b32 v219, v221
    v_swap_b32 v221, v222
    ds_write_b128 v14, v[216:219] offset:38912
    ds_write_b128 v14, v[220:223] offset:39936
    s_add_u32 s22, s18, 26624
    s_add_u32 s23, s18, 428032
    buffer_load_dwordx4 a[208:211], v1, s[4:7], s22 offen offset:0
    buffer_load_dwordx4 a[212:215], v1, s[4:7], s23 offen offset:0
    s_waitcnt vmcnt(60)
    v_swap_b32 v225, v228
    v_swap_b32 v226, v228
    v_swap_b32 v227, v229
    v_swap_b32 v229, v230
    ds_write_b128 v14, v[224:227] offset:43008
    ds_write_b128 v14, v[228:231] offset:44032
    buffer_load_dwordx4 a[216:219], v1, s[4:7], s22 offen offset:1024
    buffer_load_dwordx4 a[220:223], v1, s[4:7], s23 offen offset:1024
    s_waitcnt vmcnt(60)
    v_swap_b32 v233, v236
    v_swap_b32 v234, v236
    v_swap_b32 v235, v237
    v_swap_b32 v237, v238
    ds_write_b128 v14, v[232:235] offset:47104
    ds_write_b128 v14, v[236:239] offset:48128
    v_mov_b32 v15, v0
    s_mov_b32 s20, 0
    s_cmp_lt_u32 s20, s33
    s_cbranch_scc1 uro_92
    v_lshrrev_b32 v1, 2, v12
    s_lshr_b32 s21, s20, 3
    s_mul_i32 s19, s21, 3584
    s_add_u32 s19, s19, s37
    s_mov_b32 s30, 200000
urp_93:
    buffer_load_dword v16, v1, s[4:7], s19 offen sc1
    s_sub_u32 s30, s30, 1
    s_cmp_eq_u32 s30, 0
    s_cbranch_scc1 k2_end
    s_waitcnt vmcnt(0)
    v_cmp_eq_u32 vcc, 0, v16
    s_or_b32 s22, vcc_lo, vcc_hi
    s_lshr_b32 s23, s22, 16
    s_or_b32 s22, s22, s23
    s_lshr_b32 s23, s22, 8
    s_or_b32 s22, s22, s23
    s_and_b32 s22, s22, 0xff
    s_or_b32 s22, s22, 0x100
    s_ff1_i32_b32 s22, s22
    s_lshl_b32 s33, s21, 3
    s_add_u32 s33, s33, s22
uro_92:
    v_mov_b32 v0, v15
    v_lshlrev_b32 v1, 4, v0
    s_waitcnt vmcnt(58)
    v_swap_b32 v241, v244
    v_swap_b32 v242, v244
    v_swap_b32 v243, v245
    v_swap_b32 v245, v246
    ds_write_b128 v14, v[240:243] offset:51200
    ds_write_b128 v14, v[244:247] offset:52224
    s_waitcnt vmcnt(56)
    v_swap_b32 v249, v252
    v_swap_b32 v250, v252
    v_swap_b32 v251, v253
    v_swap_b32 v253, v254
    ds_write_b128 v14, v[248:251] offset:55296
    ds_write_b128 v14, v[252:255] offset:56320
    s_waitcnt vmcnt(54)
    v_accvgpr_read_b32 v11, a1
    v_accvgpr_mov_b32 a1, a4
    v_accvgpr_mov_b32 a4, a2
    v_accvgpr_write_b32 a2, v11
    v_accvgpr_read_b32 v11, a3
    v_accvgpr_mov_b32 a3, a5
    v_accvgpr_mov_b32 a5, a6
    v_accvgpr_write_b32 a6, v11
    s_waitcnt vmcnt(52)
    v_accvgpr_read_b32 v11, a9
    v_accvgpr_mov_b32 a9, a12
    v_accvgpr_mov_b32 a12, a10
    v_accvgpr_write_b32 a10, v11
    v_accvgpr_read_b32 v11, a11
    v_accvgpr_mov_b32 a11, a13
    v_accvgpr_mov_b32 a13, a14
    v_accvgpr_write_b32 a14, v11
    s_waitcnt vmcnt(50)
    v_accvgpr_read_b32 v11, a17
    v_accvgpr_mov_b32 a17, a20
    v_accvgpr_mov_b32 a20, a18
    v_accvgpr_write_b32 a18, v11
    v_accvgpr_read_b32 v11, a19
    v_accvgpr_mov_b32 a19, a21
    v_accvgpr_mov_b32 a21, a22
    v_accvgpr_write_b32 a22, v11
    s_waitcnt vmcnt(48)
    v_accvgpr_read_b32 v11, a25
    v_accvgpr_mov_b32 a25, a28
    v_accvgpr_mov_b32 a28, a26
    v_accvgpr_write_b32 a26, v11
    v_accvgpr_read_b32 v11, a27
    v_accvgpr_mov_b32 a27, a29
    v_accvgpr_mov_b32 a29, a30
    v_accvgpr_write_b32 a30, v11
    s_waitcnt vmcnt(46)
    v_accvgpr_read_b32 v11, a33
    v_accvgpr_mov_b32 a33, a36
    v_accvgpr_mov_b32 a36, a34
    v_accvgpr_write_b32 a34, v11
    v_accvgpr_read_b32 v11, a35
    v_accvgpr_mov_b32 a35, a37
    v_accvgpr_mov_b32 a37, a38
    v_accvgpr_write_b32 a38, v11
    s_waitcnt vmcnt(44)
    v_accvgpr_read_b32 v11, a41
    v_accvgpr_mov_b32 a41, a44
    v_accvgpr_mov_b32 a44, a42
    v_accvgpr_write_b32 a42, v11
    v_accvgpr_read_b32 v11, a43
    v_accvgpr_mov_b32 a43, a45
    v_accvgpr_mov_b32 a45, a46
    v_accvgpr_write_b32 a46, v11
    s_waitcnt vmcnt(42)
    v_accvgpr_read_b32 v11, a49
    v_accvgpr_mov_b32 a49, a52
    v_accvgpr_mov_b32 a52, a50
    v_accvgpr_write_b32 a50, v11
    v_accvgpr_read_b32 v11, a51
    v_accvgpr_mov_b32 a51, a53
    v_accvgpr_mov_b32 a53, a54
    v_accvgpr_write_b32 a54, v11
    s_waitcnt vmcnt(40)
    v_accvgpr_read_b32 v11, a57
    v_accvgpr_mov_b32 a57, a60
    v_accvgpr_mov_b32 a60, a58
    v_accvgpr_write_b32 a58, v11
    v_accvgpr_read_b32 v11, a59
    v_accvgpr_mov_b32 a59, a61
    v_accvgpr_mov_b32 a61, a62
    v_accvgpr_write_b32 a62, v11
    s_waitcnt vmcnt(38)
    v_accvgpr_read_b32 v11, a65
    v_accvgpr_mov_b32 a65, a68
    v_accvgpr_mov_b32 a68, a66
    v_accvgpr_write_b32 a66, v11
    v_accvgpr_read_b32 v11, a67
    v_accvgpr_mov_b32 a67, a69
    v_accvgpr_mov_b32 a69, a70
    v_accvgpr_write_b32 a70, v11
    s_waitcnt vmcnt(36)
    v_accvgpr_read_b32 v11, a73
    v_accvgpr_mov_b32 a73, a76
    v_accvgpr_mov_b32 a76, a74
    v_accvgpr_write_b32 a74, v11
    v_accvgpr_read_b32 v11, a75
    v_accvgpr_mov_b32 a75, a77
    v_accvgpr_mov_b32 a77, a78
    v_accvgpr_write_b32 a78, v11
    s_waitcnt vmcnt(34)
    v_accvgpr_read_b32 v11, a81
    v_accvgpr_mov_b32 a81, a84
    v_accvgpr_mov_b32 a84, a82
    v_accvgpr_write_b32 a82, v11
    v_accvgpr_read_b32 v11, a83
    v_accvgpr_mov_b32 a83, a85
    v_accvgpr_mov_b32 a85, a86
    v_accvgpr_write_b32 a86, v11
    s_waitcnt vmcnt(32)
    v_accvgpr_read_b32 v11, a89
    v_accvgpr_mov_b32 a89, a92
    v_accvgpr_mov_b32 a92, a90
    v_accvgpr_write_b32 a90, v11
    v_accvgpr_read_b32 v11, a91
    v_accvgpr_mov_b32 a91, a93
    v_accvgpr_mov_b32 a93, a94
    v_accvgpr_write_b32 a94, v11
    s_waitcnt vmcnt(30)
    v_accvgpr_read_b32 v11, a97
    v_accvgpr_mov_b32 a97, a100
    v_accvgpr_mov_b32 a100, a98
    v_accvgpr_write_b32 a98, v11
    v_accvgpr_read_b32 v11, a99
    v_accvgpr_mov_b32 a99, a101
    v_accvgpr_mov_b32 a101, a102
    v_accvgpr_write_b32 a102, v11
    s_waitcnt vmcnt(28)
    v_accvgpr_read_b32 v11, a105
    v_accvgpr_mov_b32 a105, a108
    v_accvgpr_mov_b32 a108, a106
    v_accvgpr_write_b32 a106, v11
    v_accvgpr_read_b32 v11, a107
    v_accvgpr_mov_b32 a107, a109
    v_accvgpr_mov_b32 a109, a110
    v_accvgpr_write_b32 a110, v11
    s_waitcnt vmcnt(26)
    v_accvgpr_read_b32 v11, a113
    v_accvgpr_mov_b32 a113, a116
    v_accvgpr_mov_b32 a116, a114
    v_accvgpr_write_b32 a114, v11
    v_accvgpr_read_b32 v11, a115
    v_accvgpr_mov_b32 a115, a117
    v_accvgpr_mov_b32 a117, a118
    v_accvgpr_write_b32 a118, v11
    s_waitcnt vmcnt(24)
    v_accvgpr_read_b32 v11, a121
    v_accvgpr_mov_b32 a121, a124
    v_accvgpr_mov_b32 a124, a122
    v_accvgpr_write_b32 a122, v11
    v_accvgpr_read_b32 v11, a123
    v_accvgpr_mov_b32 a123, a125
    v_accvgpr_mov_b32 a125, a126
    v_accvgpr_write_b32 a126, v11
    s_waitcnt vmcnt(22)
    v_accvgpr_read_b32 v11, a129
    v_accvgpr_mov_b32 a129, a132
    v_accvgpr_mov_b32 a132, a130
    v_accvgpr_write_b32 a130, v11
    v_accvgpr_read_b32 v11, a131
    v_accvgpr_mov_b32 a131, a133
    v_accvgpr_mov_b32 a133, a134
    v_accvgpr_write_b32 a134, v11
    s_waitcnt vmcnt(20)
    v_accvgpr_read_b32 v11, a137
    v_accvgpr_mov_b32 a137, a140
    v_accvgpr_mov_b32 a140, a138
    v_accvgpr_write_b32 a138, v11
    v_accvgpr_read_b32 v11, a139
    v_accvgpr_mov_b32 a139, a141
    v_accvgpr_mov_b32 a141, a142
    v_accvgpr_write_b32 a142, v11
    s_waitcnt vmcnt(18)
    v_accvgpr_read_b32 v11, a145
    v_accvgpr_mov_b32 a145, a148
    v_accvgpr_mov_b32 a148, a146
    v_accvgpr_write_b32 a146, v11
    v_accvgpr_read_b32 v11, a147
    v_accvgpr_mov_b32 a147, a149
    v_accvgpr_mov_b32 a149, a150
    v_accvgpr_write_b32 a150, v11
    s_waitcnt vmcnt(16)
    v_accvgpr_read_b32 v11, a153
    v_accvgpr_mov_b32 a153, a156
    v_accvgpr_mov_b32 a156, a154
    v_accvgpr_write_b32 a154, v11
    v_accvgpr_read_b32 v11, a155
    v_accvgpr_mov_b32 a155, a157
    v_accvgpr_mov_b32 a157, a158
    v_accvgpr_write_b32 a158, v11
    s_waitcnt vmcnt(14)
    v_accvgpr_read_b32 v11, a161
    v_accvgpr_mov_b32 a161, a164
    v_accvgpr_mov_b32 a164, a162
    v_accvgpr_write_b32 a162, v11
    v_accvgpr_read_b32 v11, a163
    v_accvgpr_mov_b32 a163, a165
    v_accvgpr_mov_b32 a165, a166
    v_accvgpr_write_b32 a166, v11
    s_waitcnt vmcnt(12)
    v_accvgpr_read_b32 v11, a169
    v_accvgpr_mov_b32 a169, a172
    v_accvgpr_mov_b32 a172, a170
    v_accvgpr_write_b32 a170, v11
    v_accvgpr_read_b32 v11, a171
    v_accvgpr_mov_b32 a171, a173
    v_accvgpr_mov_b32 a173, a174
    v_accvgpr_write_b32 a174, v11
    s_waitcnt vmcnt(10)
    v_accvgpr_read_b32 v11, a177
    v_accvgpr_mov_b32 a177, a180
    v_accvgpr_mov_b32 a180, a178
    v_accvgpr_write_b32 a178, v11
    v_accvgpr_read_b32 v11, a179
    v_accvgpr_mov_b32 a179, a181
    v_accvgpr_mov_b32 a181, a182
    v_accvgpr_write_b32 a182, v11
    s_waitcnt vmcnt(8)
    v_accvgpr_read_b32 v11, a185
    v_accvgpr_mov_b32 a185, a188
    v_accvgpr_mov_b32 a188, a186
    v_accvgpr_write_b32 a186, v11
    v_accvgpr_read_b32 v11, a187
    v_accvgpr_mov_b32 a187, a189
    v_accvgpr_mov_b32 a189, a190
    v_accvgpr_write_b32 a190, v11
    s_waitcnt vmcnt(6)
    v_accvgpr_read_b32 v11, a193
    v_accvgpr_mov_b32 a193, a196
    v_accvgpr_mov_b32 a196, a194
    v_accvgpr_write_b32 a194, v11
    v_accvgpr_read_b32 v11, a195
    v_accvgpr_mov_b32 a195, a197
    v_accvgpr_mov_b32 a197, a198
    v_accvgpr_write_b32 a198, v11
    s_waitcnt vmcnt(4)
    v_accvgpr_read_b32 v11, a201
    v_accvgpr_mov_b32 a201, a204
    v_accvgpr_mov_b32 a204, a202
    v_accvgpr_write_b32 a202, v11
    v_accvgpr_read_b32 v11, a203
    v_accvgpr_mov_b32 a203, a205
    v_accvgpr_mov_b32 a205, a206
    v_accvgpr_write_b32 a206, v11
    s_waitcnt vmcnt(2)
    v_accvgpr_read_b32 v11, a209
    v_accvgpr_mov_b32 a209, a212
    v_accvgpr_mov_b32 a212, a210
    v_accvgpr_write_b32 a210, v11
    v_accvgpr_read_b32 v11, a211
    v_accvgpr_mov_b32 a211, a213
    v_accvgpr_mov_b32 a213, a214
    v_accvgpr_write_b32 a214, v11
    s_waitcnt vmcnt(0)
    v_accvgpr_read_b32 v11, a217
    v_accvgpr_mov_b32 a217, a220
    v_accvgpr_mov_b32 a220, a218
    v_accvgpr_write_b32 a218, v11
    v_accvgpr_read_b32 v11, a219
    v_accvgpr_mov_b32 a219, a221
    v_accvgpr_mov_b32 a221, a222
    v_accvgpr_write_b32 a222, v11
    s_waitcnt lgkmcnt(0)
    s_branch vwd_76
vo_86:
    s_lshl_b32 s19, s3, 2
    s_add_u32 s19, s19, 16
    s_lshl_b32 s19, s19, 3
    s_lshr_b32 s22, s17, 1
    s_add_u32 s19, s19, s22
    s_lshl_b32 s19, s19, 7
    v_and_b32 v13, 31, v0
    v_min_u32 v13, 27, v13
    v_lshlrev_b32 v13, 2, v13
    v_lshrrev_b32 v11, 5, v0
    v_lshl_add_u32 v13, v11, 10, v13
    s_add_u32 s19, s19, 74055680
    v_add_u32 v13, s19, v13
    s_mov_b32 s35, 400000
ww_94:
    buffer_load_dword v11, v13, s[4:7], 0 offen sc1
    s_waitcnt vmcnt(0)
    v_cmp_eq_u32 vcc, 0, v11
    s_cbranch_vccz wwo_95
    s_sleep 16
    s_sub_u32 s35, s35, 1
    s_cmp_lg_u32 s35, 0
    s_cbranch_scc1 ww_94
    s_branch k2_end
wwo_95:
    s_add_u32 s22, s18, 0
    s_add_u32 s23, s18, 401408
    buffer_load_dwordx4 a[0:3], v1, s[4:7], s22 offen offset:0
    buffer_load_dwordx4 a[4:7], v1, s[4:7], s23 offen offset:0
    buffer_load_dwordx4 a[8:11], v1, s[4:7], s22 offen offset:1024
    buffer_load_dwordx4 a[12:15], v1, s[4:7], s23 offen offset:1024
    buffer_load_dwordx4 a[16:19], v1, s[4:7], s22 offen offset:2048
    buffer_load_dwordx4 a[20:23], v1, s[4:7], s23 offen offset:2048
    buffer_load_dwordx4 a[24:27], v1, s[4:7], s22 offen offset:3072
    buffer_load_dwordx4 a[28:31], v1, s[4:7], s23 offen offset:3072
    s_add_u32 s22, s18, 4096
    s_add_u32 s23, s18, 405504
    buffer_load_dwordx4 a[32:35], v1, s[4:7], s22 offen offset:0
    buffer_load_dwordx4 a[36:39], v1, s[4:7], s23 offen offset:0
    buffer_load_dwordx4 a[40:43], v1, s[4:7], s22 offen offset:1024
    buffer_load_dwordx4 a[44:47], v1, s[4:7], s23 offen offset:1024
    buffer_load_dwordx4 a[48:51], v1, s[4:7], s22 offen offset:2048
    buffer_load_dwordx4 a[52:55], v1, s[4:7], s23 offen offset:2048
    buffer_load_dwordx4 a[56:59], v1, s[4:7], s22 offen offset:3072
    buffer_load_dwordx4 a[60:63], v1, s[4:7], s23 offen offset:3072
    s_add_u32 s22, s18, 8192
    s_add_u32 s23, s18, 409600
    buffer_load_dwordx4 a[64:67], v1, s[4:7], s22 offen offset:0
    buffer_load_dwordx4 a[68:71], v1, s[4:7], s23 offen offset:0
    buffer_load_dwordx4 a[72:75], v1, s[4:7], s22 offen offset:1024
    buffer_load_dwordx4 a[76:79], v1, s[4:7], s23 offen offset:1024
    buffer_load_dwordx4 a[80:83], v1, s[4:7], s22 offen offset:2048
    buffer_load_dwordx4 a[84:87], v1, s[4:7], s23 offen offset:2048
    buffer_load_dwordx4 a[88:91], v1, s[4:7], s22 offen offset:3072
    buffer_load_dwordx4 a[92:95], v1, s[4:7], s23 offen offset:3072
    s_add_u32 s22, s18, 12288
    s_add_u32 s23, s18, 413696
    buffer_load_dwordx4 a[96:99], v1, s[4:7], s22 offen offset:0
    buffer_load_dwordx4 a[100:103], v1, s[4:7], s23 offen offset:0
    buffer_load_dwordx4 a[104:107], v1, s[4:7], s22 offen offset:1024
    buffer_load_dwordx4 a[108:111], v1, s[4:7], s23 offen offset:1024
    s_add_u32 s22, s18, 14336
    s_add_u32 s23, s18, 415744
    buffer_load_dwordx4 a[112:115], v1, s[4:7], s22 offen offset:0
    buffer_load_dwordx4 a[116:119], v1, s[4:7], s23 offen offset:0
    buffer_load_dwordx4 a[120:123], v1, s[4:7], s22 offen offset:1024
    buffer_load_dwordx4 a[124:127], v1, s[4:7], s23 offen offset:1024
    buffer_load_dwordx4 a[128:131], v1, s[4:7], s22 offen offset:2048
    buffer_load_dwordx4 a[132:135], v1, s[4:7], s23 offen offset:2048
    buffer_load_dwordx4 a[136:139], v1, s[4:7], s22 offen offset:3072
    buffer_load_dwordx4 a[140:143], v1, s[4:7], s23 offen offset:3072
    s_add_u32 s22, s18, 18432
    s_add_u32 s23, s18, 419840
    buffer_load_dwordx4 a[144:147], v1, s[4:7], s22 offen offset:0
    buffer_load_dwordx4 a[148:151], v1, s[4:7], s23 offen offset:0
    buffer_load_dwordx4 a[152:155], v1, s[4:7], s22 offen offset:1024
    buffer_load_dwordx4 a[156:159], v1, s[4:7], s23 offen offset:1024
    buffer_load_dwordx4 a[160:163], v1, s[4:7], s22 offen offset:2048
    buffer_load_dwordx4 a[164:167], v1, s[4:7], s23 offen offset:2048
    buffer_load_dwordx4 a[168:171], v1, s[4:7], s22 offen offset:3072
    buffer_load_dwordx4 a[172:175], v1, s[4:7], s23 offen offset:3072
    s_add_u32 s22, s18, 22528
    s_add_u32 s23, s18, 423936
    buffer_load_dwordx4 a[176:179], v1, s[4:7], s22 offen offset:0
    buffer_load_dwordx4 a[180:183], v1, s[4:7], s23 offen offset:0
    buffer_load_dwordx4 a[184:187], v1, s[4:7], s22 offen offset:1024
    buffer_load_dwordx4 a[188:191], v1, s[4:7], s23 offen offset:1024
    buffer_load_dwordx4 a[192:195], v1, s[4:7], s22 offen offset:2048
    buffer_load_dwordx4 a[196:199], v1, s[4:7], s23 offen offset:2048
    buffer_load_dwordx4 a[200:203], v1, s[4:7], s22 offen offset:3072
    buffer_load_dwordx4 a[204:207], v1, s[4:7], s23 offen offset:3072
    s_add_u32 s22, s18, 26624
    s_add_u32 s23, s18, 428032
    buffer_load_dwordx4 a[208:211], v1, s[4:7], s22 offen offset:0
    buffer_load_dwordx4 a[212:215], v1, s[4:7], s23 offen offset:0
    buffer_load_dwordx4 a[216:219], v1, s[4:7], s22 offen offset:1024
    buffer_load_dwordx4 a[220:223], v1, s[4:7], s23 offen offset:1024
    s_lshl_b32 s19, s3, 2
    s_add_u32 s19, s19, 18
    s_lshl_b32 s19, s19, 3
    s_lshr_b32 s22, s17, 1
    s_add_u32 s19, s19, s22
    s_lshl_b32 s19, s19, 7
    v_and_b32 v13, 31, v0
    v_min_u32 v13, 27, v13
    v_lshlrev_b32 v13, 2, v13
    v_lshrrev_b32 v11, 5, v0
    v_lshl_add_u32 v13, v11, 10, v13
    s_add_u32 s19, s19, 74055680
    v_add_u32 v13, s19, v13
    s_mov_b32 s35, 400000
ww_96:
    buffer_load_dword v11, v13, s[4:7], 0 offen sc1
    s_waitcnt vmcnt(0)
    v_cmp_eq_u32 vcc, 0, v11
    s_cbranch_vccz wwo_97
    s_sleep 16
    s_sub_u32 s35, s35, 1
    s_cmp_lg_u32 s35, 0
    s_cbranch_scc1 ww_96
    s_branch k2_end
wwo_97:
    s_add_u32 s22, s18, 802816
    s_add_u32 s23, s18, 1204224
    buffer_load_dwordx4 v[32:35], v1, s[4:7], s22 offen offset:0
    buffer_load_dwordx4 v[36:39], v1, s[4:7], s23 offen offset:0
    buffer_load_dwordx4 v[40:43], v1, s[4:7], s22 offen offset:1024
    buffer_load_dwordx4 v[44:47], v1, s[4:7], s23 offen offset:1024
    buffer_load_dwordx4 v[48:51], v1, s[4:7], s22 offen offset:2048
    buffer_load_dwordx4 v[52:55], v1, s[4:7], s23 offen offset:2048
    s_waitcnt vmcnt(60)
    v_accvgpr_read_b32 v11, a1
    v_accvgpr_mov_b32 a1, a4
    v_accvgpr_mov_b32 a4, a2
    v_accvgpr_write_b32 a2, v11
    v_accvgpr_read_b32 v11, a3
    v_accvgpr_mov_b32 a3, a5
    v_accvgpr_mov_b32 a5, a6
    v_accvgpr_write_b32 a6, v11
    buffer_load_dwordx4 v[56:59], v1, s[4:7], s22 offen offset:3072
    buffer_load_dwordx4 v[60:63], v1, s[4:7], s23 offen offset:3072
    s_waitcnt vmcnt(60)
    v_accvgpr_read_b32 v11, a9
    v_accvgpr_mov_b32 a9, a12
    v_accvgpr_mov_b32 a12, a10
    v_accvgpr_write_b32 a10, v11
    v_accvgpr_read_b32 v11, a11
    v_accvgpr_mov_b32 a11, a13
    v_accvgpr_mov_b32 a13, a14
    v_accvgpr_write_b32 a14, v11
    s_add_u32 s22, s18, 806912
    s_add_u32 s23, s18, 1208320
    buffer_load_dwordx4 v[64:67], v1, s[4:7], s22 offen offset:0
    buffer_load_dwordx4 v[68:71], v1, s[4:7], s23 offen offset:0
    s_waitcnt vmcnt(60)
    v_accvgpr_read_b32 v11, a17
    v_accvgpr_mov_b32 a17, a20
    v_accvgpr_mov_b32 a20, a18
    v_accvgpr_write_b32 a18, v11
    v_accvgpr_read_b32 v11, a19
    v_accvgpr_mov_b32 a19, a21
    v_accvgpr_mov_b32 a21, a22
    v_accvgpr_write_b32 a22, v11
    buffer_load_dwordx4 v[72:75], v1, s[4:7], s22 offen offset:1024
    buffer_load_dwordx4 v[76:79], v1, s[4:7], s23 offen offset:1024
    s_waitcnt vmcnt(60)
    v_accvgpr_read_b32 v11, a25
    v_accvgpr_mov_b32 a25, a28
    v_accvgpr_mov_b32 a28, a26
    v_accvgpr_write_b32 a26, v11
    v_accvgpr_read_b32 v11, a27
    v_accvgpr_mov_b32 a27, a29
    v_accvgpr_mov_b32 a29, a30
    v_accvgpr_write_b32 a30, v11
    buffer_load_dwordx4 v[80:83], v1, s[4:7], s22 offen offset:2048
    buffer_load_dwordx4 v[84:87], v1, s[4:7], s23 offen offset:2048
    s_waitcnt vmcnt(60)
    v_accvgpr_read_b32 v11, a33
    v_accvgpr_mov_b32 a33, a36
    v_accvgpr_mov_b32 a36, a34
    v_accvgpr_write_b32 a34, v11
    v_accvgpr_read_b32 v11, a35
    v_accvgpr_mov_b32 a35, a37
    v_accvgpr_mov_b32 a37, a38
    v_accvgpr_write_b32 a38, v11
    buffer_load_dwordx4 v[88:91], v1, s[4:7], s22 offen offset:3072
    buffer_load_dwordx4 v[92:95], v1, s[4:7], s23 offen offset:3072
    s_waitcnt vmcnt(60)
    v_accvgpr_read_b32 v11, a41
    v_accvgpr_mov_b32 a41, a44
    v_accvgpr_mov_b32 a44, a42
    v_accvgpr_write_b32 a42, v11
    v_accvgpr_read_b32 v11, a43
    v_accvgpr_mov_b32 a43, a45
    v_accvgpr_mov_b32 a45, a46
    v_accvgpr_write_b32 a46, v11
    s_add_u32 s22, s18, 811008
    s_add_u32 s23, s18, 1212416
    buffer_load_dwordx4 v[96:99], v1, s[4:7], s22 offen offset:0
    buffer_load_dwordx4 v[100:103], v1, s[4:7], s23 offen offset:0
    s_waitcnt vmcnt(60)
    v_accvgpr_read_b32 v11, a49
    v_accvgpr_mov_b32 a49, a52
    v_accvgpr_mov_b32 a52, a50
    v_accvgpr_write_b32 a50, v11
    v_accvgpr_read_b32 v11, a51
    v_accvgpr_mov_b32 a51, a53
    v_accvgpr_mov_b32 a53, a54
    v_accvgpr_write_b32 a54, v11
    buffer_load_dwordx4 v[104:107], v1, s[4:7], s22 offen offset:1024
    buffer_load_dwordx4 v[108:111], v1, s[4:7], s23 offen offset:1024
    s_waitcnt vmcnt(60)
    v_accvgpr_read_b32 v11, a57
    v_accvgpr_mov_b32 a57, a60
    v_accvgpr_mov_b32 a60, a58
    v_accvgpr_write_b32 a58, v11
    v_accvgpr_read_b32 v11, a59
    v_accvgpr_mov_b32 a59, a61
    v_accvgpr_mov_b32 a61, a62
    v_accvgpr_write_b32 a62, v11
    buffer_load_dwordx4 v[112:115], v1, s[4:7], s22 offen offset:2048
    buffer_load_dwordx4 v[116:119], v1, s[4:7], s23 offen offset:2048
    s_waitcnt vmcnt(60)
    v_accvgpr_read_b32 v11, a65
    v_accvgpr_mov_b32 a65, a68
    v_accvgpr_mov_b32 a68, a66
    v_accvgpr_write_b32 a66, v11
    v_accvgpr_read_b32 v11, a67
    v_accvgpr_mov_b32 a67, a69
    v_accvgpr_mov_b32 a69, a70
    v_accvgpr_write_b32 a70, v11
    buffer_load_dwordx4 v[120:123], v1, s[4:7], s22 offen offset:3072
    buffer_load_dwordx4 v[124:127], v1, s[4:7], s23 offen offset:3072
    s_waitcnt vmcnt(60)
    v_accvgpr_read_b32 v11, a73
    v_accvgpr_mov_b32 a73, a76
    v_accvgpr_mov_b32 a76, a74
    v_accvgpr_write_b32 a74, v11
    v_accvgpr_read_b32 v11, a75
    v_accvgpr_mov_b32 a75, a77
    v_accvgpr_mov_b32 a77, a78
    v_accvgpr_write_b32 a78, v11
    s_add_u32 s22, s18, 815104
    s_add_u32 s23, s18, 1216512
    buffer_load_dwordx4 v[128:131], v1, s[4:7], s22 offen offset:0
    buffer_load_dwordx4 v[132:135], v1, s[4:7], s23 offen offset:0
    s_waitcnt vmcnt(60)
    v_accvgpr_read_b32 v11, a81
    v_accvgpr_mov_b32 a81, a84
    v_accvgpr_mov_b32 a84, a82
    v_accvgpr_write_b32 a82, v11
    v_accvgpr_read_b32 v11, a83
    v_accvgpr_mov_b32 a83, a85
    v_accvgpr_mov_b32 a85, a86
    v_accvgpr_write_b32 a86, v11
    buffer_load_dwordx4 v[136:139], v1, s[4:7], s22 offen offset:1024
    buffer_load_dwordx4 v[140:143], v1, s[4:7], s23 offen offset:1024
    s_waitcnt vmcnt(60)
    v_accvgpr_read_b32 v11, a89
    v_accvgpr_mov_b32 a89, a92
    v_accvgpr_mov_b32 a92, a90
    v_accvgpr_write_b32 a90, v11
    v_accvgpr_read_b32 v11, a91
    v_accvgpr_mov_b32 a91, a93
    v_accvgpr_mov_b32 a93, a94
    v_accvgpr_write_b32 a94, v11
    s_add_u32 s22, s18, 817152
    s_add_u32 s23, s18, 1218560
    buffer_load_dwordx4 v[144:147], v1, s[4:7], s22 offen offset:0
    buffer_load_dwordx4 v[148:151], v1, s[4:7], s23 offen offset:0
    s_waitcnt vmcnt(60)
    v_accvgpr_read_b32 v11, a97
    v_accvgpr_mov_b32 a97, a100
    v_accvgpr_mov_b32 a100, a98
    v_accvgpr_write_b32 a98, v11
    v_accvgpr_read_b32 v11, a99
    v_accvgpr_mov_b32 a99, a101
    v_accvgpr_mov_b32 a101, a102
    v_accvgpr_write_b32 a102, v11
    buffer_load_dwordx4 v[152:155], v1, s[4:7], s22 offen offset:1024
    buffer_load_dwordx4 v[156:159], v1, s[4:7], s23 offen offset:1024
    s_waitcnt vmcnt(60)
    v_accvgpr_read_b32 v11, a105
    v_accvgpr_mov_b32 a105, a108
    v_accvgpr_mov_b32 a108, a106
    v_accvgpr_write_b32 a106, v11
    v_accvgpr_read_b32 v11, a107
    v_accvgpr_mov_b32 a107, a109
    v_accvgpr_mov_b32 a109, a110
    v_accvgpr_write_b32 a110, v11
    buffer_load_dwordx4 v[160:163], v1, s[4:7], s22 offen offset:2048
    buffer_load_dwordx4 v[164:167], v1, s[4:7], s23 offen offset:2048
    s_waitcnt vmcnt(60)
    v_accvgpr_read_b32 v11, a113
    v_accvgpr_mov_b32 a113, a116
    v_accvgpr_mov_b32 a116, a114
    v_accvgpr_write_b32 a114, v11
    v_accvgpr_read_b32 v11, a115
    v_accvgpr_mov_b32 a115, a117
    v_accvgpr_mov_b32 a117, a118
    v_accvgpr_write_b32 a118, v11
    buffer_load_dwordx4 v[168:171], v1, s[4:7], s22 offen offset:3072
    buffer_load_dwordx4 v[172:175], v1, s[4:7], s23 offen offset:3072
    s_waitcnt vmcnt(60)
    v_accvgpr_read_b32 v11, a121
    v_accvgpr_mov_b32 a121, a124
    v_accvgpr_mov_b32 a124, a122
    v_accvgpr_write_b32 a122, v11
    v_accvgpr_read_b32 v11, a123
    v_accvgpr_mov_b32 a123, a125
    v_accvgpr_mov_b32 a125, a126
    v_accvgpr_write_b32 a126, v11
    s_add_u32 s22, s18, 821248
    s_add_u32 s23, s18, 1222656
    buffer_load_dwordx4 v[176:179], v1, s[4:7], s22 offen offset:0
    buffer_load_dwordx4 v[180:183], v1, s[4:7], s23 offen offset:0
    s_waitcnt vmcnt(60)
    v_accvgpr_read_b32 v11, a129
    v_accvgpr_mov_b32 a129, a132
    v_accvgpr_mov_b32 a132, a130
    v_accvgpr_write_b32 a130, v11
    v_accvgpr_read_b32 v11, a131
    v_accvgpr_mov_b32 a131, a133
    v_accvgpr_mov_b32 a133, a134
    v_accvgpr_write_b32 a134, v11
    buffer_load_dwordx4 v[184:187], v1, s[4:7], s22 offen offset:1024
    buffer_load_dwordx4 v[188:191], v1, s[4:7], s23 offen offset:1024
    s_waitcnt vmcnt(60)
    v_accvgpr_read_b32 v11, a137
    v_accvgpr_mov_b32 a137, a140
    v_accvgpr_mov_b32 a140, a138
    v_accvgpr_write_b32 a138, v11
    v_accvgpr_read_b32 v11, a139
    v_accvgpr_mov_b32 a139, a141
    v_accvgpr_mov_b32 a141, a142
    v_accvgpr_write_b32 a142, v11
    buffer_load_dwordx4 v[192:195], v1, s[4:7], s22 offen offset:2048
    buffer_load_dwordx4 v[196:199], v1, s[4:7], s23 offen offset:2048
    s_waitcnt vmcnt(60)
    v_accvgpr_read_b32 v11, a145
    v_accvgpr_mov_b32 a145, a148
    v_accvgpr_mov_b32 a148, a146
    v_accvgpr_write_b32 a146, v11
    v_accvgpr_read_b32 v11, a147
    v_accvgpr_mov_b32 a147, a149
    v_accvgpr_mov_b32 a149, a150
    v_accvgpr_write_b32 a150, v11
    buffer_load_dwordx4 v[200:203], v1, s[4:7], s22 offen offset:3072
    buffer_load_dwordx4 v[204:207], v1, s[4:7], s23 offen offset:3072
    s_waitcnt vmcnt(60)
    v_accvgpr_read_b32 v11, a153
    v_accvgpr_mov_b32 a153, a156
    v_accvgpr_mov_b32 a156, a154
    v_accvgpr_write_b32 a154, v11
    v_accvgpr_read_b32 v11, a155
    v_accvgpr_mov_b32 a155, a157
    v_accvgpr_mov_b32 a157, a158
    v_accvgpr_write_b32 a158, v11
    s_add_u32 s22, s18, 825344
    s_add_u32 s23, s18, 1226752
    buffer_load_dwordx4 v[208:211], v1, s[4:7], s22 offen offset:0
    buffer_load_dwordx4 v[212:215], v1, s[4:7], s23 offen offset:0
    s_waitcnt vmcnt(60)
    v_accvgpr_read_b32 v11, a161
    v_accvgpr_mov_b32 a161, a164
    v_accvgpr_mov_b32 a164, a162
    v_accvgpr_write_b32 a162, v11
    v_accvgpr_read_b32 v11, a163
    v_accvgpr_mov_b32 a163, a165
    v_accvgpr_mov_b32 a165, a166
    v_accvgpr_write_b32 a166, v11
    buffer_load_dwordx4 v[216:219], v1, s[4:7], s22 offen offset:1024
    buffer_load_dwordx4 v[220:223], v1, s[4:7], s23 offen offset:1024
    s_waitcnt vmcnt(60)
    v_accvgpr_read_b32 v11, a169
    v_accvgpr_mov_b32 a169, a172
    v_accvgpr_mov_b32 a172, a170
    v_accvgpr_write_b32 a170, v11
    v_accvgpr_read_b32 v11, a171
    v_accvgpr_mov_b32 a171, a173
    v_accvgpr_mov_b32 a173, a174
    v_accvgpr_write_b32 a174, v11
    buffer_load_dwordx4 v[224:227], v1, s[4:7], s22 offen offset:2048
    buffer_load_dwordx4 v[228:231], v1, s[4:7], s23 offen offset:2048
    s_waitcnt vmcnt(60)
    v_accvgpr_read_b32 v11, a177
    v_accvgpr_mov_b32 a177, a180
    v_accvgpr_mov_b32 a180, a178
    v_accvgpr_write_b32 a178, v11
    v_accvgpr_read_b32 v11, a179
    v_accvgpr_mov_b32 a179, a181
    v_accvgpr_mov_b32 a181, a182
    v_accvgpr_write_b32 a182, v11
    buffer_load_dwordx4 v[232:235], v1, s[4:7], s22 offen offset:3072
    buffer_load_dwordx4 v[236:239], v1, s[4:7], s23 offen offset:3072
    s_waitcnt vmcnt(60)
    v_accvgpr_read_b32 v11, a185
    v_accvgpr_mov_b32 a185, a188
    v_accvgpr_mov_b32 a188, a186
    v_accvgpr_write_b32 a186, v11
    v_accvgpr_read_b32 v11, a187
    v_accvgpr_mov_b32 a187, a189
    v_accvgpr_mov_b32 a189, a190
    v_accvgpr_write_b32 a190, v11
    s_add_u32 s22, s18, 829440
    s_add_u32 s23, s18, 1230848
    buffer_load_dwordx4 v[240:243], v1, s[4:7], s22 offen offset:0
    buffer_load_dwordx4 v[244:247], v1, s[4:7], s23 offen offset:0
    s_waitcnt vmcnt(60)
    v_accvgpr_read_b32 v11, a193
    v_accvgpr_mov_b32 a193, a196
    v_accvgpr_mov_b32 a196, a194
    v_accvgpr_write_b32 a194, v11
    v_accvgpr_read_b32 v11, a195
    v_accvgpr_mov_b32 a195, a197
    v_accvgpr_mov_b32 a197, a198
    v_accvgpr_write_b32 a198, v11
    buffer_load_dwordx4 v[248:251], v1, s[4:7], s22 offen offset:1024
    buffer_load_dwordx4 v[252:255], v1, s[4:7], s23 offen offset:1024
    s_waitcnt vmcnt(60)
    v_accvgpr_read_b32 v11, a201
    v_accvgpr_mov_b32 a201, a204
    v_accvgpr_mov_b32 a204, a202
    v_accvgpr_write_b32 a202, v11
    v_accvgpr_read_b32 v11, a203
    v_accvgpr_mov_b32 a203, a205
    v_accvgpr_mov_b32 a205, a206
    v_accvgpr_write_b32 a206, v11
    v_mov_b32 v15, v0
    s_mov_b32 s20, 0
    s_cmp_lt_u32 s20, s33
    s_cbranch_scc1 uro_99
    v_lshrrev_b32 v1, 2, v12
    s_lshr_b32 s21, s20, 3
    s_mul_i32 s19, s21, 3584
    s_add_u32 s19, s19, s37
    s_mov_b32 s30, 200000
urp_100:
    buffer_load_dword v16, v1, s[4:7], s19 offen sc1
    s_sub_u32 s30, s30, 1
    s_cmp_eq_u32 s30, 0
    s_cbranch_scc1 k2_end
    s_waitcnt vmcnt(0)
    v_cmp_eq_u32 vcc, 0, v16
    s_or_b32 s22, vcc_lo, vcc_hi
    s_lshr_b32 s23, s22, 16
    s_or_b32 s22, s22, s23
    s_lshr_b32 s23, s22, 8
    s_or_b32 s22, s22, s23
    s_and_b32 s22, s22, 0xff
    s_or_b32 s22, s22, 0x100
    s_ff1_i32_b32 s22, s22
    s_lshl_b32 s33, s21, 3
    s_add_u32 s33, s33, s22
uro_99:
    v_mov_b32 v0, v15
    v_lshlrev_b32 v1, 4, v0
    s_waitcnt vmcnt(58)
    v_accvgpr_read_b32 v11, a209
    v_accvgpr_mov_b32 a209, a212
    v_accvgpr_mov_b32 a212, a210
    v_accvgpr_write_b32 a210, v11
    v_accvgpr_read_b32 v11, a211
    v_accvgpr_mov_b32 a211, a213
    v_accvgpr_mov_b32 a213, a214
    v_accvgpr_write_b32 a214, v11
    s_waitcnt vmcnt(56)
    v_accvgpr_read_b32 v11, a217
    v_accvgpr_mov_b32 a217, a220
    v_accvgpr_mov_b32 a220, a218
    v_accvgpr_write_b32 a218, v11
    v_accvgpr_read_b32 v11, a219
    v_accvgpr_mov_b32 a219, a221
    v_accvgpr_mov_b32 a221, a222
    v_accvgpr_write_b32 a222, v11
    s_waitcnt vmcnt(54)
    v_swap_b32 v33, v36
    v_swap_b32 v34, v36
    v_swap_b32 v35, v37
    v_swap_b32 v37, v38
    ds_write_b128 v14, v[32:35] offset:0
    ds_write_b128 v14, v[36:39] offset:1024
    s_waitcnt vmcnt(52)
    v_swap_b32 v41, v44
    v_swap_b32 v42, v44
    v_swap_b32 v43, v45
    v_swap_b32 v45, v46
    ds_write_b128 v14, v[40:43] offset:4096
    ds_write_b128 v14, v[44:47] offset:5120
    s_waitcnt vmcnt(50)
    v_swap_b32 v49, v52
    v_swap_b32 v50, v52
    v_swap_b32 v51, v53
    v_swap_b32 v53, v54
    ds_write_b128 v14, v[48:51] offset:8192
    ds_write_b128 v14, v[52:55] offset:9216
    s_waitcnt vmcnt(48)
    v_swap_b32 v57, v60
    v_swap_b32 v58, v60
    v_swap_b32 v59, v61
    v_swap_b32 v61, v62
    ds_write_b128 v14, v[56:59] offset:12288
    ds_write_b128 v14, v[60:63] offset:13312
    s_waitcnt vmcnt(46)
    v_swap_b32 v65, v68
    v_swap_b32 v66, v68
    v_swap_b32 v67, v69
    v_swap_b32 v69, v70
    ds_write_b128 v14, v[64:67] offset:16384
    ds_write_b128 v14, v[68:71] offset:17408
    s_waitcnt vmcnt(44)
    v_swap_b32 v73, v76
    v_swap_b32 v74, v76
    v_swap_b32 v75, v77
    v_swap_b32 v77, v78
    ds_write_b128 v14, v[72:75] offset:20480
    ds_write_b128 v14, v[76:79] offset:21504
    s_waitcnt vmcnt(42)
    v_swap_b32 v81, v84
    v_swap_b32 v82, v84
    v_swap_b32 v83, v85
    v_swap_b32 v85, v86
    ds_write_b128 v14, v[80:83] offset:24576
    ds_write_b128 v14, v[84:87] offset:25600
    s_waitcnt vmcnt(40)
    v_swap_b32 v89, v92
    v_swap_b32 v90, v92
    v_swap_b32 v91, v93
    v_swap_b32 v93, v94
    ds_write_b128 v14, v[88:91] offset:28672
    ds_write_b128 v14, v[92:95] offset:29696
    s_waitcnt vmcnt(38)
    v_swap_b32 v97, v100
    v_swap_b32 v98, v100
    v_swap_b32 v99, v101
    v_swap_b32 v101, v102
    ds_write_b128 v14, v[96:99] offset:32768
    ds_write_b128 v14, v[100:103] offset:33792
    s_waitcnt vmcnt(36)
    v_swap_b32 v105, v108
    v_swap_b32 v106, v108
    v_swap_b32 v107, v109
    v_swap_b32 v109, v110
    ds_write_b128 v14, v[104:107] offset:36864
    ds_write_b128 v14, v[108:111] offset:37888
    s_waitcnt vmcnt(34)
    v_swap_b32 v113, v116
    v_swap_b32 v114, v116
    v_swap_b32 v115, v117
    v_swap_b32 v117, v118
    ds_write_b128 v14, v[112:115] offset:40960
    ds_write_b128 v14, v[116:119] offset:41984
    s_waitcnt vmcnt(32)
    v_swap_b32 v121, v124
    v_swap_b32 v122, v124
    v_swap_b32 v123, v125
    v_swap_b32 v125, v126
    ds_write_b128 v14, v[120:123] offset:45056
    ds_write_b128 v14, v[124:127] offset:46080
    s_waitcnt vmcnt(30)
    v_swap_b32 v129, v132
    v_swap_b32 v130, v132
    v_swap_b32 v131, v133
    v_swap_b32 v133, v134
    ds_write_b128 v14, v[128:131] offset:49152
    ds_write_b128 v14, v[132:135] offset:50176
    s_waitcnt vmcnt(28)
    v_swap_b32 v137, v140
    v_swap_b32 v138, v140
    v_swap_b32 v139, v141
    v_swap_b32 v141, v142
    ds_write_b128 v14, v[136:139] offset:53248
    ds_write_b128 v14, v[140:143] offset:54272
    s_waitcnt vmcnt(26)
    v_swap_b32 v145, v148
    v_swap_b32 v146, v148
    v_swap_b32 v147, v149
    v_swap_b32 v149, v150
    ds_write_b128 v14, v[144:147] offset:2048
    ds_write_b128 v14, v[148:151] offset:3072
    s_waitcnt vmcnt(24)
    v_swap_b32 v153, v156
    v_swap_b32 v154, v156
    v_swap_b32 v155, v157
    v_swap_b32 v157, v158
    ds_write_b128 v14, v[152:155] offset:6144
    ds_write_b128 v14, v[156:159] offset:7168
    s_waitcnt vmcnt(22)
    v_swap_b32 v161, v164
    v_swap_b32 v162, v164
    v_swap_b32 v163, v165
    v_swap_b32 v165, v166
    ds_write_b128 v14, v[160:163] offset:10240
    ds_write_b128 v14, v[164:167] offset:11264
    s_waitcnt vmcnt(20)
    v_swap_b32 v169, v172
    v_swap_b32 v170, v172
    v_swap_b32 v171, v173
    v_swap_b32 v173, v174
    ds_write_b128 v14, v[168:171] offset:14336
    ds_write_b128 v14, v[172:175] offset:15360
    s_waitcnt vmcnt(18)
    v_swap_b32 v177, v180
    v_swap_b32 v178, v180
    v_swap_b32 v179, v181
    v_swap_b32 v181, v182
    ds_write_b128 v14, v[176:179] offset:18432
    ds_write_b128 v14, v[180:183] offset:19456
    s_waitcnt vmcnt(16)
    v_swap_b32 v185, v188
    v_swap_b32 v186, v188
    v_swap_b32 v187, v189
    v_swap_b32 v189, v190
    ds_write_b128 v14, v[184:187] offset:22528
    ds_write_b128 v14, v[188:191] offset:23552
    s_waitcnt vmcnt(14)
    v_swap_b32 v193, v196
    v_swap_b32 v194, v196
    v_swap_b32 v195, v197
    v_swap_b32 v197, v198
    ds_write_b128 v14, v[192:195] offset:26624
    ds_write_b128 v14, v[196:199] offset:27648
    s_waitcnt vmcnt(12)
    v_swap_b32 v201, v204
    v_swap_b32 v202, v204
    v_swap_b32 v203, v205
    v_swap_b32 v205, v206
    ds_write_b128 v14, v[200:203] offset:30720
    ds_write_b128 v14, v[204:207] offset:31744
    s_waitcnt vmcnt(10)
    v_swap_b32 v209, v212
    v_swap_b32 v210, v212
    v_swap_b32 v211, v213
    v_swap_b32 v213, v214
    ds_write_b128 v14, v[208:211] offset:34816
    ds_write_b128 v14, v[212:215] offset:35840
    s_waitcnt vmcnt(8)
    v_swap_b32 v217, v220
    v_swap_b32 v218, v220
    v_swap_b32 v219, v221
    v_swap_b32 v221, v222
    ds_write_b128 v14, v[216:219] offset:38912
    ds_write_b128 v14, v[220:223] offset:39936
    s_waitcnt vmcnt(6)
    v_swap_b32 v225, v228
    v_swap_b32 v226, v228
    v_swap_b32 v227, v229
    v_swap_b32 v229, v230
    ds_write_b128 v14, v[224:227] offset:43008
    ds_write_b128 v14, v[228:231] offset:44032
    s_waitcnt vmcnt(4)
    v_swap_b32 v233, v236
    v_swap_b32 v234, v236
    v_swap_b32 v235, v237
    v_swap_b32 v237, v238
    ds_write_b128 v14, v[232:235] offset:47104
    ds_write_b128 v14, v[236:239] offset:48128
    s_waitcnt vmcnt(2)
    v_swap_b32 v241, v244
    v_swap_b32 v242, v244
    v_swap_b32 v243, v245
    v_swap_b32 v245, v246
    ds_write_b128 v14, v[240:243] offset:51200
    ds_write_b128 v14, v[244:247] offset:52224
    s_waitcnt vmcnt(0)
    v_swap_b32 v249, v252
    v_swap_b32 v250, v252
    v_swap_b32 v251, v253
    v_swap_b32 v253, v254
    ds_write_b128 v14, v[248:251] offset:55296
    ds_write_b128 v14, v[252:255] offset:56320
    s_waitcnt lgkmcnt(0)
    s_branch vwd_76
vwd_76:
    s_lshr_b32 s22, s3, 1
    s_lshl_b32 s22, s22, 12
    s_and_b32 s23, s3, 1
    s_lshl_b32 s23, s23, 2
    s_add_u32 s22, s22, s23
    s_add_u32 s22, s22, 8192
    v_add_u32 v13, s22, v12
    v_and_b32 v11, 15, v0
    v_lshlrev_b32 v7, 2, v11
    v_and_b32 v11, 12, v0
    v_lshlrev_b32 v15, 5, v11
    v_and_b32 v11, 3, v0
    v_lshl_add_u32 v15, v11, 2, v15
    v_and_b32 v11, 16, v0
    v_lshl_add_u32 v15, v11, 2, v15
    v_lshrrev_b32 v11, 5, v0
    v_lshl_add_u32 v15, v11, 4, v15
    s_lshl_b32 s23, s17, 9
    v_add_u32 v15, s23, v15
    s_lshl_b32 s23, s17, 2
    v_lshlrev_b32 v6, 7, v0
    v_add_u32 v6, s23, v6
    s_lshl_b32 s36, s17, 12
    s_add_u32 s36, s36, 23166976
    s_mov_b32 s39, 62234624
    v_and_b32 v16, 1, v0
    v_lshlrev_b32 v16, 2, v16
    v_add_u32 v16, 248, v16
    s_mov_b32 s30, 400000
ww_101:
    buffer_load_dword v17, v16, s[8:11], 0 offen sc1
    s_waitcnt vmcnt(0)
    v_cmp_eq_u32 vcc, 0, v17
    s_cbranch_vccz wwo_102
    s_sleep 4
    s_sub_u32 s30, s30, 1
    s_cmp_lg_u32 s30, 0
    s_cbranch_scc1 ww_101
    s_branch k2_end
wwo_102:
    v_add_u32 v11, 16384, v12
    s_cmp_eq_u32 s14, 0
    s_cbranch_scc1 ch_value_slow
    s_cmp_eq_u32 s3, 3
    s_cbranch_scc1 va3_f
    s_mov_b32 s20, 0
va_loop_f:
    s_and_b32 s21, s20, 3
    s_lshl_b32 s24, s21, 14
    s_add_u32 s24, s24, 73760768
    s_add_u32 s25, s24, 8192
    s_lshl_b32 s26, s21, 15
    s_add_u32 s26, s26, 73826304
    s_add_u32 s45, s26, 16384
    s_xor_b32 s22, s21, 2
    s_lshl_b32 s27, s22, 15
    s_add_u32 s27, s27, 73826304
    s_add_u32 s44, s20, 1
    s_and_b32 s22, s44, 3
    s_lshl_b32 s28, s22, 14
    s_add_u32 s28, s28, 73760768
    s_xor_b32 s22, s22, 2
    s_lshl_b32 s29, s22, 14
    s_add_u32 s29, s29, 73760768
    v_mov_b64 v[16:17], 0
    v_mov_b64 v[18:19], 0
    v_mov_b64 v[20:21], 0
    v_mov_b64 v[22:23], 0
    v_mov_b64 v[24:25], 0
    v_mov_b64 v[26:27], 0
    v_mov_b64 v[28:29], 0
    v_mov_b64 v[30:31], 0
    s_mov_b32 s30, 200000
    buffer_load_dwordx4 v[48:51], v3, s[4:7], s24 offen sc1
    buffer_load_dwordx4 v[52:55], v4, s[4:7], s24 offen sc1
    s_nop 15
    s_nop 15
    s_nop 7
pm_103:
    buffer_load_dwordx4 v[56:59], v3, s[4:7], s25 offen sc1
    buffer_load_dwordx4 v[60:63], v4, s[4:7], s25 offen sc1
    s_waitcnt vmcnt(2)
    ds_write_b128 v3, v[48:51]
    ds_write_b128 v4, v[52:55]
    v_max3_u32 v0, v48, v49, v50
    v_max3_u32 v1, v51, v52, v53
    v_max3_u32 v0, v0, v54, v55
    v_max_u32 v0, v0, v1
    v_cmp_eq_u32 vcc, -1, v0
    s_cbranch_vccnz pm1_105
pmo_104:
    s_waitcnt lgkmcnt(0)
    s_barrier
    ds_read_b128 v[32:35], v8 offset:0
    ds_read_b128 v[36:39], v8 offset:512
    ds_read_b128 v[40:43], v8 offset:1024
    ds_read_b128 v[44:47], v8 offset:1536
    s_waitcnt lgkmcnt(3)
    v_smfmac_f32_16x16x64_bf16 v[16:19], v[32:35], v[64:71], v2
    v_smfmac_f32_16x16x64_bf16 v[20:23], v[32:35], v[176:183], v2
    v_smfmac_f32_16x16x64_bf16 v[24:27], v[32:35], a[32:39], v2
    v_smfmac_f32_16x16x64_bf16 v[28:31], v[32:35], a[144:151], v2
    ds_read_b128 v[32:35], v8 offset:2048
    s_waitcnt lgkmcnt(3)
    v_smfmac_f32_16x16x64_bf16 v[16:19], v[36:39], v[72:79], v2
    v_smfmac_f32_16x16x64_bf16 v[20:23], v[36:39], v[184:191], v2
    v_smfmac_f32_16x16x64_bf16 v[24:27], v[36:39], a[40:47], v2
    v_smfmac_f32_16x16x64_bf16 v[28:31], v[36:39], a[152:159], v2
    ds_read_b128 v[36:39], v8 offset:2560
    s_waitcnt lgkmcnt(3)
    v_smfmac_f32_16x16x64_bf16 v[16:19], v[40:43], v[80:87], v2
    v_smfmac_f32_16x16x64_bf16 v[20:23], v[40:43], v[192:199], v2
    v_smfmac_f32_16x16x64_bf16 v[24:27], v[40:43], a[48:55], v2
    v_smfmac_f32_16x16x64_bf16 v[28:31], v[40:43], a[160:167], v2
    ds_read_b128 v[40:43], v8 offset:3072
    s_waitcnt lgkmcnt(3)
    v_smfmac_f32_16x16x64_bf16 v[16:19], v[44:47], v[88:95], v2
    v_smfmac_f32_16x16x64_bf16 v[20:23], v[44:47], v[200:207], v2
    v_smfmac_f32_16x16x64_bf16 v[24:27], v[44:47], a[56:63], v2
    v_smfmac_f32_16x16x64_bf16 v[28:31], v[44:47], a[168:175], v2
    ds_read_b128 v[44:47], v8 offset:3584
    s_waitcnt lgkmcnt(3)
    v_smfmac_f32_16x16x64_bf16 v[16:19], v[32:35], v[96:103], v2
    v_smfmac_f32_16x16x64_bf16 v[20:23], v[32:35], v[208:215], v2
    v_smfmac_f32_16x16x64_bf16 v[24:27], v[32:35], a[64:71], v2
    v_smfmac_f32_16x16x64_bf16 v[28:31], v[32:35], a[176:183], v2
    ds_read_b128 v[32:35], v8 offset:4096
    s_waitcnt lgkmcnt(3)
    v_smfmac_f32_16x16x64_bf16 v[16:19], v[36:39], v[104:111], v2
    v_smfmac_f32_16x16x64_bf16 v[20:23], v[36:39], v[216:223], v2
    v_smfmac_f32_16x16x64_bf16 v[24:27], v[36:39], a[72:79], v2
    v_smfmac_f32_16x16x64_bf16 v[28:31], v[36:39], a[184:191], v2
    ds_read_b128 v[36:39], v8 offset:4608
    s_waitcnt lgkmcnt(3)
    v_smfmac_f32_16x16x64_bf16 v[16:19], v[40:43], v[112:119], v2
    v_smfmac_f32_16x16x64_bf16 v[20:23], v[40:43], v[224:231], v2
    v_smfmac_f32_16x16x64_bf16 v[24:27], v[40:43], a[80:87], v2
    v_smfmac_f32_16x16x64_bf16 v[28:31], v[40:43], a[192:199], v2
    ds_read_b128 v[40:43], v8 offset:5120
    s_waitcnt lgkmcnt(3)
    v_smfmac_f32_16x16x64_bf16 v[16:19], v[44:47], v[120:127], v2
    v_smfmac_f32_16x16x64_bf16 v[20:23], v[44:47], v[232:239], v2
    v_smfmac_f32_16x16x64_bf16 v[24:27], v[44:47], a[88:95], v2
    v_smfmac_f32_16x16x64_bf16 v[28:31], v[44:47], a[200:207], v2
    ds_read_b128 v[44:47], v8 offset:5632
    s_waitcnt lgkmcnt(3)
    v_smfmac_f32_16x16x64_bf16 v[16:19], v[32:35], v[128:135], v2
    v_smfmac_f32_16x16x64_bf16 v[20:23], v[32:35], v[240:247], v2
    v_smfmac_f32_16x16x64_bf16 v[24:27], v[32:35], a[96:103], v2
    v_smfmac_f32_16x16x64_bf16 v[28:31], v[32:35], a[208:215], v2
    ds_read_b128 v[32:35], v8 offset:6144
    s_waitcnt lgkmcnt(3)
    v_smfmac_f32_16x16x64_bf16 v[16:19], v[36:39], v[136:143], v2
    v_smfmac_f32_16x16x64_bf16 v[20:23], v[36:39], v[248:255], v2
    v_smfmac_f32_16x16x64_bf16 v[24:27], v[36:39], a[104:111], v2
    v_smfmac_f32_16x16x64_bf16 v[28:31], v[36:39], a[216:223], v2
    ds_read_b128 v[36:39], v8 offset:6656
    s_waitcnt lgkmcnt(3)
    v_smfmac_f32_16x16x64_bf16 v[16:19], v[40:43], v[144:151], v2
    v_smfmac_f32_16x16x64_bf16 v[20:23], v[40:43], a[0:7], v2
    v_smfmac_f32_16x16x64_bf16 v[24:27], v[40:43], a[112:119], v2
    v_smfmac_f32_16x16x64_bf16 v[28:31], v[40:43], a[224:231], v2
    s_waitcnt lgkmcnt(2)
    v_smfmac_f32_16x16x64_bf16 v[16:19], v[44:47], v[152:159], v2
    v_smfmac_f32_16x16x64_bf16 v[20:23], v[44:47], a[8:15], v2
    v_smfmac_f32_16x16x64_bf16 v[24:27], v[44:47], a[120:127], v2
    v_smfmac_f32_16x16x64_bf16 v[28:31], v[44:47], a[232:239], v2
    s_waitcnt lgkmcnt(1)
    v_smfmac_f32_16x16x64_bf16 v[16:19], v[32:35], v[160:167], v2
    v_smfmac_f32_16x16x64_bf16 v[20:23], v[32:35], a[16:23], v2
    v_smfmac_f32_16x16x64_bf16 v[24:27], v[32:35], a[128:135], v2
    v_smfmac_f32_16x16x64_bf16 v[28:31], v[32:35], a[240:247], v2
    s_waitcnt lgkmcnt(0)
    v_smfmac_f32_16x16x64_bf16 v[16:19], v[36:39], v[168:175], v2
    v_smfmac_f32_16x16x64_bf16 v[20:23], v[36:39], a[24:31], v2
    v_smfmac_f32_16x16x64_bf16 v[24:27], v[36:39], a[136:143], v2
    v_smfmac_f32_16x16x64_bf16 v[28:31], v[36:39], a[248:255], v2
    s_nop 7
    v_cvt_pk_bf16_f32 v32, v16, v17
    v_cvt_pk_bf16_f32 v33, v18, v19
    ds_write_b32 v13, v32 offset:0
    ds_write_b32 v13, v33 offset:8
    v_cvt_pk_bf16_f32 v36, v24, v25
    v_cvt_pk_bf16_f32 v37, v26, v27
    ds_write_b32 v13, v36 offset:1024
    ds_write_b32 v13, v37 offset:1032
    v_cvt_pk_bf16_f32 v34, v20, v21
    v_cvt_pk_bf16_f32 v35, v22, v23
    ds_write_b32 v13, v34 offset:2048
    ds_write_b32 v13, v35 offset:2056
    v_cvt_pk_bf16_f32 v38, v28, v29
    v_cvt_pk_bf16_f32 v39, v30, v31
    ds_write_b32 v13, v38 offset:3072
    ds_write_b32 v13, v39 offset:3080
    s_waitcnt lgkmcnt(0)
    s_barrier
    s_barrier
    s_add_u32 s20, s20, 1
    s_cmp_lt_u32 s20, 63
    s_cbranch_scc1 va_loop_f
    s_branch k2_end
va3_f:
    s_mov_b32 s20, 0
va3_loop_f:
    s_cmp_lt_u32 s20, s33
    s_cbranch_scc1 uro_107
    v_lshrrev_b32 v1, 2, v12
    s_cmp_lt_u32 s20, 8
    s_cbranch_scc1 ur_106
    s_add_u32 s22, s37, 0
    buffer_load_dword v80, v1, s[4:7], s22 offen sc1
    s_add_u32 s22, s37, 3584
    buffer_load_dword v81, v1, s[4:7], s22 offen sc1
    s_add_u32 s22, s37, 7168
    buffer_load_dword v82, v1, s[4:7], s22 offen sc1
    s_add_u32 s22, s37, 10752
    buffer_load_dword v83, v1, s[4:7], s22 offen sc1
    s_add_u32 s22, s37, 14336
    buffer_load_dword v84, v1, s[4:7], s22 offen sc1
    s_add_u32 s22, s37, 17920
    buffer_load_dword v85, v1, s[4:7], s22 offen sc1
    s_add_u32 s22, s37, 21504
    buffer_load_dword v86, v1, s[4:7], s22 offen sc1
    s_add_u32 s22, s37, 25088
    buffer_load_dword v87, v1, s[4:7], s22 offen sc1
    s_waitcnt vmcnt(0)
    s_mov_b32 s33, 64
    v_cmp_eq_u32 vcc, 0, v87
    s_cmp_lg_u64 vcc, 0
    s_cselect_b32 s33, 56, s33
    v_cmp_eq_u32 vcc, 0, v86
    s_cmp_lg_u64 vcc, 0
    s_cselect_b32 s33, 48, s33
    v_cmp_eq_u32 vcc, 0, v85
    s_cmp_lg_u64 vcc, 0
    s_cselect_b32 s33, 40, s33
    v_cmp_eq_u32 vcc, 0, v84
    s_cmp_lg_u64 vcc, 0
    s_cselect_b32 s33, 32, s33
    v_cmp_eq_u32 vcc, 0, v83
    s_cmp_lg_u64 vcc, 0
    s_cselect_b32 s33, 24, s33
    v_cmp_eq_u32 vcc, 0, v82
    s_cmp_lg_u64 vcc, 0
    s_cselect_b32 s33, 16, s33
    v_cmp_eq_u32 vcc, 0, v81
    s_cmp_lg_u64 vcc, 0
    s_cselect_b32 s33, 8, s33
    v_cmp_eq_u32 vcc, 0, v80
    s_cmp_lg_u64 vcc, 0
    s_cselect_b32 s33, 0, s33
    s_cmp_lt_u32 s20, s33
    s_cbranch_scc1 uro_107
ur_106:
    s_lshr_b32 s21, s20, 3
    s_mul_i32 s19, s21, 3584
    s_add_u32 s19, s19, s37
    s_mov_b32 s30, 200000
urp_108:
    buffer_load_dword v80, v1, s[4:7], s19 offen sc1
    s_sub_u32 s30, s30, 1
    s_cmp_eq_u32 s30, 0
    s_cbranch_scc1 k2_end
    s_waitcnt vmcnt(0)
    v_cmp_eq_u32 vcc, 0, v80
    s_or_b32 s22, vcc_lo, vcc_hi
    s_lshr_b32 s23, s22, 16
    s_or_b32 s22, s22, s23
    s_lshr_b32 s23, s22, 8
    s_or_b32 s22, s22, s23
    s_and_b32 s22, s22, 0xff
    s_or_b32 s22, s22, 0x100
    s_ff1_i32_b32 s22, s22
    s_lshl_b32 s33, s21, 3
    s_add_u32 s33, s33, s22
    s_cmp_lt_u32 s20, s33
    s_cbranch_scc1 uro_107
    s_sleep 12
    s_branch urp_108
uro_107:
    s_and_b32 s21, s20, 3
    s_lshl_b32 s24, s21, 14
    s_add_u32 s24, s24, 73760768
    s_add_u32 s25, s24, 8192
    s_lshl_b32 s26, s21, 15
    s_add_u32 s26, s26, 73826304
    s_add_u32 s45, s26, 16384
    s_xor_b32 s22, s21, 2
    s_lshl_b32 s27, s22, 15
    s_add_u32 s27, s27, 73826304
    s_add_u32 s44, s20, 1
    s_and_b32 s22, s44, 3
    s_lshl_b32 s28, s22, 14
    s_add_u32 s28, s28, 73760768
    s_xor_b32 s22, s22, 2
    s_lshl_b32 s29, s22, 14
    s_add_u32 s29, s29, 73760768
    v_mov_b64 v[16:17], 0
    v_mov_b64 v[18:19], 0
    v_mov_b64 v[20:21], 0
    v_mov_b64 v[22:23], 0
    v_mov_b64 v[24:25], 0
    v_mov_b64 v[26:27], 0
    v_mov_b64 v[28:29], 0
    v_mov_b64 v[30:31], 0
    s_mov_b32 s30, 200000
    buffer_load_dwordx4 v[80:83], v3, s[4:7], s24 offen sc1
    buffer_load_dwordx4 v[84:87], v4, s[4:7], s24 offen sc1
    s_nop 15
    s_nop 15
    s_nop 7
pm_109:
    buffer_load_dwordx4 v[88:91], v3, s[4:7], s25 offen sc1
    buffer_load_dwordx4 v[92:95], v4, s[4:7], s25 offen sc1
    s_waitcnt vmcnt(2)
    ds_write_b128 v3, v[80:83]
    ds_write_b128 v4, v[84:87]
    v_max3_u32 v0, v80, v81, v82
    v_max3_u32 v1, v83, v84, v85
    v_max3_u32 v0, v0, v86, v87
    v_max_u32 v0, v0, v1
    v_cmp_eq_u32 vcc, -1, v0
    s_cbranch_vccnz pm1_111
pmo_110:
    s_waitcnt lgkmcnt(0)
    s_barrier
    ds_read_b128 v[32:35], v8 offset:0
    ds_read_b128 v[36:39], v8 offset:512
    ds_read_b128 v[40:43], v8 offset:1024
    ds_read_b128 v[48:51], v11 offset:0
    ds_read_b128 v[52:55], v11 offset:1024
    ds_read_b128 v[56:59], v11 offset:2048
    ds_read_b128 v[60:63], v11 offset:3072
    ds_read_b128 v[64:67], v11 offset:4096
    ds_read_b128 v[68:71], v11 offset:5120
    ds_read_b128 v[72:75], v11 offset:6144
    ds_read_b128 v[76:79], v11 offset:7168
    ds_read_b128 v[44:47], v8 offset:1536
    s_waitcnt lgkmcnt(11)
    v_smfmac_f32_16x16x64_bf16 v[16:19], v[32:35], a[0:7], v2
    s_add_u32 s23, s36, 0
    buffer_load_dwordx4 v[128:131], v12, s[4:7], s23 offen offset:0
    v_smfmac_f32_16x16x64_bf16 v[20:23], v[32:35], a[112:119], v2
    buffer_load_dwordx4 v[132:135], v12, s[4:7], s23 offen offset:1024
    buffer_load_dwordx4 v[136:139], v12, s[4:7], s23 offen offset:2048
    s_waitcnt lgkmcnt(7)
    v_smfmac_f32_16x16x64_bf16 v[24:27], v[32:35], v[48:55], v2
    ds_read_b128 v[48:51], v11 offset:8192
    ds_read_b128 v[52:55], v11 offset:9216
    s_waitcnt lgkmcnt(7)
    v_smfmac_f32_16x16x64_bf16 v[28:31], v[32:35], v[56:63], v2
    ds_read_b128 v[56:59], v11 offset:10240
    ds_read_b128 v[60:63], v11 offset:11264
    ds_read_b128 v[32:35], v8 offset:2048
    v_smfmac_f32_16x16x64_bf16 v[16:19], v[36:39], a[8:15], v2
    buffer_load_dwordx4 v[140:143], v12, s[4:7], s23 offen offset:3072
    s_add_u32 s23, s36, 57344
    v_smfmac_f32_16x16x64_bf16 v[20:23], v[36:39], a[120:127], v2
    buffer_load_dwordx4 v[144:147], v12, s[4:7], s23 offen offset:0
    buffer_load_dwordx4 v[148:151], v12, s[4:7], s23 offen offset:1024
    s_waitcnt lgkmcnt(8)
    v_smfmac_f32_16x16x64_bf16 v[24:27], v[36:39], v[64:71], v2
    ds_read_b128 v[64:67], v11 offset:12288
    ds_read_b128 v[68:71], v11 offset:13312
    s_waitcnt lgkmcnt(8)
    v_smfmac_f32_16x16x64_bf16 v[28:31], v[36:39], v[72:79], v2
    ds_read_b128 v[72:75], v11 offset:14336
    ds_read_b128 v[76:79], v11 offset:15360
    ds_read_b128 v[36:39], v8 offset:2560
    v_smfmac_f32_16x16x64_bf16 v[16:19], v[40:43], a[16:23], v2
    buffer_load_dwordx4 v[152:155], v12, s[4:7], s23 offen offset:2048
    buffer_load_dwordx4 v[156:159], v12, s[4:7], s23 offen offset:3072
    v_smfmac_f32_16x16x64_bf16 v[20:23], v[40:43], a[128:135], v2
    s_add_u32 s23, s36, 114688
    buffer_load_dwordx4 v[160:163], v12, s[4:7], s23 offen offset:0
    s_waitcnt lgkmcnt(8)
    v_smfmac_f32_16x16x64_bf16 v[24:27], v[40:43], v[48:55], v2
    ds_read_b128 v[48:51], v11 offset:16384
    ds_read_b128 v[52:55], v11 offset:17408
    s_waitcnt lgkmcnt(8)
    v_smfmac_f32_16x16x64_bf16 v[28:31], v[40:43], v[56:63], v2
    ds_read_b128 v[56:59], v11 offset:18432
    ds_read_b128 v[60:63], v11 offset:19456
    ds_read_b128 v[40:43], v8 offset:3072
    v_smfmac_f32_16x16x64_bf16 v[16:19], v[44:47], a[24:31], v2
    buffer_load_dwordx4 v[164:167], v12, s[4:7], s23 offen offset:1024
    buffer_load_dwordx4 v[168:171], v12, s[4:7], s23 offen offset:2048
    v_smfmac_f32_16x16x64_bf16 v[20:23], v[44:47], a[136:143], v2
    buffer_load_dwordx4 v[172:175], v12, s[4:7], s23 offen offset:3072
    s_add_u32 s23, s36, 172032
    s_waitcnt lgkmcnt(8)
    v_smfmac_f32_16x16x64_bf16 v[24:27], v[44:47], v[64:71], v2
    ds_read_b128 v[64:67], v11 offset:20480
    ds_read_b128 v[68:71], v11 offset:21504
    s_waitcnt lgkmcnt(8)
    v_smfmac_f32_16x16x64_bf16 v[28:31], v[44:47], v[72:79], v2
    ds_read_b128 v[72:75], v11 offset:22528
    ds_read_b128 v[76:79], v11 offset:23552
    ds_read_b128 v[44:47], v8 offset:3584
    v_smfmac_f32_16x16x64_bf16 v[16:19], v[32:35], a[32:39], v2
    buffer_load_dwordx4 v[176:179], v12, s[4:7], s23 offen offset:0
    buffer_load_dwordx4 v[180:183], v12, s[4:7], s23 offen offset:1024
    v_smfmac_f32_16x16x64_bf16 v[20:23], v[32:35], a[144:151], v2
    buffer_load_dwordx4 v[184:187], v12, s[4:7], s23 offen offset:2048
    buffer_load_dwordx4 v[188:191], v12, s[4:7], s23 offen offset:3072
    s_waitcnt lgkmcnt(8)
    v_smfmac_f32_16x16x64_bf16 v[24:27], v[32:35], v[48:55], v2
    ds_read_b128 v[48:51], v11 offset:24576
    ds_read_b128 v[52:55], v11 offset:25600
    s_waitcnt lgkmcnt(8)
    v_smfmac_f32_16x16x64_bf16 v[28:31], v[32:35], v[56:63], v2
    ds_read_b128 v[56:59], v11 offset:26624
    ds_read_b128 v[60:63], v11 offset:27648
    ds_read_b128 v[32:35], v8 offset:4096
    v_smfmac_f32_16x16x64_bf16 v[16:19], v[36:39], a[40:47], v2
    s_add_u32 s23, s36, 229376
    buffer_load_dwordx4 v[192:195], v12, s[4:7], s23 offen offset:0
    v_smfmac_f32_16x16x64_bf16 v[20:23], v[36:39], a[152:159], v2
    buffer_load_dwordx4 v[196:199], v12, s[4:7], s23 offen offset:1024
    buffer_load_dwordx4 v[200:203], v12, s[4:7], s23 offen offset:2048
    s_waitcnt lgkmcnt(8)
    v_smfmac_f32_16x16x64_bf16 v[24:27], v[36:39], v[64:71], v2
    ds_read_b128 v[64:67], v11 offset:28672
    ds_read_b128 v[68:71], v11 offset:29696
    s_waitcnt lgkmcnt(8)
    v_smfmac_f32_16x16x64_bf16 v[28:31], v[36:39], v[72:79], v2
    ds_read_b128 v[72:75], v11 offset:30720
    ds_read_b128 v[76:79], v11 offset:31744
    ds_read_b128 v[36:39], v8 offset:4608
    v_smfmac_f32_16x16x64_bf16 v[16:19], v[40:43], a[48:55], v2
    buffer_load_dwordx4 v[204:207], v12, s[4:7], s23 offen offset:3072
    s_add_u32 s23, s36, 286720
    v_smfmac_f32_16x16x64_bf16 v[20:23], v[40:43], a[160:167], v2
    buffer_load_dwordx4 v[208:211], v12, s[4:7], s23 offen offset:0
    buffer_load_dwordx4 v[212:215], v12, s[4:7], s23 offen offset:1024
    s_waitcnt lgkmcnt(8)
    v_smfmac_f32_16x16x64_bf16 v[24:27], v[40:43], v[48:55], v2
    ds_read_b128 v[48:51], v11 offset:32768
    ds_read_b128 v[52:55], v11 offset:33792
    s_waitcnt lgkmcnt(8)
    v_smfmac_f32_16x16x64_bf16 v[28:31], v[40:43], v[56:63], v2
    ds_read_b128 v[56:59], v11 offset:34816
    ds_read_b128 v[60:63], v11 offset:35840
    ds_read_b128 v[40:43], v8 offset:5120
    v_smfmac_f32_16x16x64_bf16 v[16:19], v[44:47], a[56:63], v2
    buffer_load_dwordx4 v[216:219], v12, s[4:7], s23 offen offset:2048
    buffer_load_dwordx4 v[220:223], v12, s[4:7], s23 offen offset:3072
    v_smfmac_f32_16x16x64_bf16 v[20:23], v[44:47], a[168:175], v2
    s_add_u32 s23, s36, 344064
    buffer_load_dwordx4 v[224:227], v12, s[4:7], s23 offen offset:0
    s_waitcnt lgkmcnt(8)
    v_smfmac_f32_16x16x64_bf16 v[24:27], v[44:47], v[64:71], v2
    ds_read_b128 v[64:67], v11 offset:36864
    ds_read_b128 v[68:71], v11 offset:37888
    s_waitcnt lgkmcnt(8)
    v_smfmac_f32_16x16x64_bf16 v[28:31], v[44:47], v[72:79], v2
    ds_read_b128 v[72:75], v11 offset:38912
    ds_read_b128 v[76:79], v11 offset:39936
    ds_read_b128 v[44:47], v8 offset:5632
    v_smfmac_f32_16x16x64_bf16 v[16:19], v[32:35], a[64:71], v2
    buffer_load_dwordx4 v[228:231], v12, s[4:7], s23 offen offset:1024
    buffer_load_dwordx4 v[232:235], v12, s[4:7], s23 offen offset:2048
    v_smfmac_f32_16x16x64_bf16 v[20:23], v[32:35], a[176:183], v2
    buffer_load_dwordx4 v[236:239], v12, s[4:7], s23 offen offset:3072
    s_add_u32 s23, s36, 401408
    s_waitcnt lgkmcnt(8)
    v_smfmac_f32_16x16x64_bf16 v[24:27], v[32:35], v[48:55], v2
    ds_read_b128 v[48:51], v11 offset:40960
    ds_read_b128 v[52:55], v11 offset:41984
    s_waitcnt lgkmcnt(8)
    v_smfmac_f32_16x16x64_bf16 v[28:31], v[32:35], v[56:63], v2
    ds_read_b128 v[56:59], v11 offset:43008
    ds_read_b128 v[60:63], v11 offset:44032
    ds_read_b128 v[32:35], v8 offset:6144
    v_smfmac_f32_16x16x64_bf16 v[16:19], v[36:39], a[72:79], v2
    buffer_load_dwordx4 v[240:243], v12, s[4:7], s23 offen offset:0
    buffer_load_dwordx4 v[244:247], v12, s[4:7], s23 offen offset:1024
    v_smfmac_f32_16x16x64_bf16 v[20:23], v[36:39], a[184:191], v2
    buffer_load_dwordx4 v[248:251], v12, s[4:7], s23 offen offset:2048
    buffer_load_dwordx4 v[252:255], v12, s[4:7], s23 offen offset:3072
    s_waitcnt lgkmcnt(8)
    v_smfmac_f32_16x16x64_bf16 v[24:27], v[36:39], v[64:71], v2
    ds_read_b128 v[64:67], v11 offset:45056
    ds_read_b128 v[68:71], v11 offset:46080
    s_waitcnt lgkmcnt(8)
    v_smfmac_f32_16x16x64_bf16 v[28:31], v[36:39], v[72:79], v2
    ds_read_b128 v[72:75], v11 offset:47104
    ds_read_b128 v[76:79], v11 offset:48128
    ds_read_b128 v[36:39], v8 offset:6656
    v_smfmac_f32_16x16x64_bf16 v[16:19], v[40:43], a[80:87], v2
    v_smfmac_f32_16x16x64_bf16 v[20:23], v[40:43], a[192:199], v2
    s_waitcnt lgkmcnt(8)
    v_smfmac_f32_16x16x64_bf16 v[24:27], v[40:43], v[48:55], v2
    ds_read_b128 v[48:51], v11 offset:49152
    ds_read_b128 v[52:55], v11 offset:50176
    s_waitcnt lgkmcnt(8)
    v_smfmac_f32_16x16x64_bf16 v[28:31], v[40:43], v[56:63], v2
    ds_read_b128 v[56:59], v11 offset:51200
    ds_read_b128 v[60:63], v11 offset:52224
    v_smfmac_f32_16x16x64_bf16 v[16:19], v[44:47], a[88:95], v2
    v_smfmac_f32_16x16x64_bf16 v[20:23], v[44:47], a[200:207], v2
    s_waitcnt lgkmcnt(7)
    v_smfmac_f32_16x16x64_bf16 v[24:27], v[44:47], v[64:71], v2
    ds_read_b128 v[64:67], v11 offset:53248
    ds_read_b128 v[68:71], v11 offset:54272
    s_waitcnt lgkmcnt(7)
    v_smfmac_f32_16x16x64_bf16 v[28:31], v[44:47], v[72:79], v2
    ds_read_b128 v[72:75], v11 offset:55296
    ds_read_b128 v[76:79], v11 offset:56320
    v_smfmac_f32_16x16x64_bf16 v[16:19], v[32:35], a[96:103], v2
    v_smfmac_f32_16x16x64_bf16 v[20:23], v[32:35], a[208:215], v2
    s_waitcnt lgkmcnt(6)
    v_smfmac_f32_16x16x64_bf16 v[24:27], v[32:35], v[48:55], v2
    s_waitcnt lgkmcnt(4)
    v_smfmac_f32_16x16x64_bf16 v[28:31], v[32:35], v[56:63], v2
    v_smfmac_f32_16x16x64_bf16 v[16:19], v[36:39], a[104:111], v2
    v_smfmac_f32_16x16x64_bf16 v[20:23], v[36:39], a[216:223], v2
    s_waitcnt lgkmcnt(2)
    v_smfmac_f32_16x16x64_bf16 v[24:27], v[36:39], v[64:71], v2
    s_waitcnt lgkmcnt(0)
    v_smfmac_f32_16x16x64_bf16 v[28:31], v[36:39], v[72:79], v2
    s_add_u32 s36, s36, 462848
    s_nop 7
    v_cvt_pk_bf16_f32 v32, v16, v17
    v_cvt_pk_bf16_f32 v33, v18, v19
    ds_write_b32 v13, v32 offset:0
    ds_write_b32 v13, v33 offset:8
    v_cvt_pk_bf16_f32 v36, v24, v25
    v_cvt_pk_bf16_f32 v37, v26, v27
    ds_write_b32 v13, v36 offset:1024
    ds_write_b32 v13, v37 offset:1032
    v_cvt_pk_bf16_f32 v34, v20, v21
    v_cvt_pk_bf16_f32 v35, v22, v23
    ds_write_b32 v13, v34 offset:2048
    ds_write_b32 v13, v35 offset:2056
    v_cvt_pk_bf16_f32 v38, v28, v29
    v_cvt_pk_bf16_f32 v39, v30, v31
    ds_write_b32 v13, v38 offset:3072
    ds_write_b32 v13, v39 offset:3080
    s_waitcnt lgkmcnt(0)
    s_barrier
    ds_read_b128 a[224:227], v12 offset:8192
    ds_read_b128 a[228:231], v12 offset:9216
    ds_read_b128 a[232:235], v12 offset:10240
    ds_read_b128 a[236:239], v12 offset:11264
    ds_read_b128 a[240:243], v12 offset:12288
    ds_read_b128 a[244:247], v12 offset:13312
    ds_read_b128 a[248:251], v12 offset:14336
    ds_read_b128 a[252:255], v12 offset:15360
    v_mov_b64 v[16:17], 0
    v_mov_b64 v[18:19], 0
    v_mov_b64 v[20:21], 0
    v_mov_b64 v[22:23], 0
    s_mov_b32 s30, 200000
    s_mov_b64 exec, s[42:43]
    buffer_load_dword v32, v7, s[4:7], s47 offen offset:0 sc1
    s_nop 15
    s_nop 9
wf_113:
    buffer_load_dword v33, v7, s[4:7], s47 offen offset:128 sc1
    s_waitcnt vmcnt(1)
    v_cmp_gt_u32 vcc, s44, v32
    s_cbranch_vccz wfo_114
    buffer_load_dword v32, v7, s[4:7], s47 offen offset:0 sc1
    s_waitcnt vmcnt(1)
    v_cmp_gt_u32 vcc, s44, v33
    s_cbranch_vccz wfo_114
    s_sub_u32 s30, s30, 1
    s_cmp_lg_u32 s30, 0
    s_cbranch_scc1 wf_113
    s_mov_b64 exec, -1
    s_branch k2_end
wfo_114:
    s_mov_b64 exec, -1
wfb_112:
    s_waitcnt lgkmcnt(0)
    s_add_u32 s22, s26, 4096
    s_add_u32 s23, s26, 8192
    s_add_u32 s18, s45, 4096
    s_add_u32 s19, s45, 8192
    s_mov_b32 s30, 200000
pp_115:
    buffer_load_dwordx4 v[32:35], v12, s[4:7], s26 offen offset:0 sc1
    buffer_load_dwordx4 v[36:39], v12, s[4:7], s26 offen offset:1024 sc1
    buffer_load_dwordx4 v[40:43], v12, s[4:7], s26 offen offset:2048 sc1
    buffer_load_dwordx4 v[44:47], v12, s[4:7], s26 offen offset:3072 sc1
    buffer_load_dwordx4 v[48:51], v12, s[4:7], s22 offen offset:0 sc1
    buffer_load_dwordx4 v[52:55], v12, s[4:7], s22 offen offset:1024 sc1
    buffer_load_dwordx4 v[56:59], v12, s[4:7], s22 offen offset:2048 sc1
    buffer_load_dwordx4 v[60:63], v12, s[4:7], s22 offen offset:3072 sc1
    buffer_load_dwordx4 v[64:67], v12, s[4:7], s23 offen offset:0 sc1
    buffer_load_dwordx4 v[68:71], v12, s[4:7], s23 offen offset:1024 sc1
    v_mov_b32 v1, s44
    s_mov_b32 exec_hi, 0x40000000
    buffer_store_dword v1, v6, s[4:7], s40 offen
    s_mov_b64 exec, -1
    s_waitcnt vmcnt(10)
    v_smfmac_f32_16x16x64_bf16 v[16:19], v[32:35], v[128:135], v2
    v_smfmac_f32_16x16x64_bf16 v[20:23], v[32:35], v[136:143], v2
    s_waitcnt vmcnt(9)
    v_smfmac_f32_16x16x64_bf16 v[16:19], v[36:39], v[144:151], v2
    v_smfmac_f32_16x16x64_bf16 v[20:23], v[36:39], v[152:159], v2
    s_waitcnt vmcnt(8)
    v_smfmac_f32_16x16x64_bf16 v[16:19], v[40:43], v[160:167], v2
    v_smfmac_f32_16x16x64_bf16 v[20:23], v[40:43], v[168:175], v2
    s_waitcnt vmcnt(7)
    v_smfmac_f32_16x16x64_bf16 v[16:19], v[44:47], v[176:183], v2
    v_smfmac_f32_16x16x64_bf16 v[20:23], v[44:47], v[184:191], v2
    s_waitcnt vmcnt(6)
    v_smfmac_f32_16x16x64_bf16 v[16:19], v[48:51], v[192:199], v2
    v_smfmac_f32_16x16x64_bf16 v[20:23], v[48:51], v[200:207], v2
    s_waitcnt vmcnt(5)
    v_smfmac_f32_16x16x64_bf16 v[16:19], v[52:55], v[208:215], v2
    v_smfmac_f32_16x16x64_bf16 v[20:23], v[52:55], v[216:223], v2
    s_waitcnt vmcnt(4)
    v_smfmac_f32_16x16x64_bf16 v[16:19], v[56:59], v[224:231], v2
    v_smfmac_f32_16x16x64_bf16 v[20:23], v[56:59], v[232:239], v2
    s_waitcnt vmcnt(3)
    v_smfmac_f32_16x16x64_bf16 v[16:19], v[60:63], v[240:247], v2
    v_smfmac_f32_16x16x64_bf16 v[20:23], v[60:63], v[248:255], v2
    s_waitcnt vmcnt(2)
    v_smfmac_f32_16x16x64_bf16 v[16:19], v[64:67], a[224:231], v2
    v_smfmac_f32_16x16x64_bf16 v[20:23], v[64:67], a[232:239], v2
    s_waitcnt vmcnt(1)
    v_smfmac_f32_16x16x64_bf16 v[16:19], v[68:71], a[240:247], v2
    v_smfmac_f32_16x16x64_bf16 v[20:23], v[68:71], a[248:255], v2
    s_nop 2
ppf_116:
    s_nop 4
    v_permlane32_swap_b32 v16, v17
    v_permlane32_swap_b32 v18, v19
    v_permlane32_swap_b32 v20, v21
    v_permlane32_swap_b32 v22, v23
    v_add_f32 v16, v16, v17
    v_add_f32 v20, v20, v21
    v_add_f32 v18, v18, v19
    v_add_f32 v22, v22, v23
    v_cmp_u_f32 vcc, v16, v18
    v_cvt_pk_bf16_f32 v24, v16, v20
    v_cvt_pk_bf16_f32 v25, v18, v22
    v_min_u32 v24, 0xfffffffe, v24
    v_min_u32 v25, 0xfffffffe, v25
    s_cbranch_vccnz pl_117
pa_118:
    buffer_store_dword v24, v15, s[4:7], s28 offen offset:0
    buffer_store_dword v25, v15, s[4:7], s28 offen offset:32
    s_add_u32 s28, s28, 8192
    buffer_store_dword v24, v15, s[4:7], s28 offen offset:0
    buffer_store_dword v25, v15, s[4:7], s28 offen offset:32
    s_barrier
    v_mov_b32 v26, -1
    buffer_store_dword v26, v15, s[4:7], s29 offen offset:0
    buffer_store_dword v26, v15, s[4:7], s29 offen offset:32
    s_add_u32 s29, s29, 8192
    buffer_store_dword v26, v15, s[4:7], s29 offen offset:0
    buffer_store_dword v26, v15, s[4:7], s29 offen offset:32
    buffer_store_dword v24, v15, s[4:7], s39 offen offset:0
    buffer_store_dword v25, v15, s[4:7], s39 offen offset:32
    s_cmp_lg_u32 s20, 62
    s_cbranch_scc1 vnx_119
    s_mov_b32 s22, 63266816
    buffer_store_dword v24, v15, s[4:7], s22 offen offset:0 sc1
    buffer_store_dword v25, v15, s[4:7], s22 offen offset:32 sc1
vnx_119:
    s_add_u32 s39, s39, 8192
    s_add_u32 s20, s20, 1
    s_cmp_lt_u32 s20, 63
    s_cbranch_scc1 va3_loop_f
    s_branch k2_end
pm1_105:
    buffer_load_dwordx4 v[48:51], v3, s[4:7], s24 offen sc1
    buffer_load_dwordx4 v[52:55], v4, s[4:7], s24 offen sc1
    s_waitcnt vmcnt(2)
    ds_write_b128 v3, v[56:59]
    ds_write_b128 v4, v[60:63]
    v_max3_u32 v0, v56, v57, v58
    v_max3_u32 v1, v59, v60, v61
    v_max3_u32 v0, v0, v62, v63
    v_max_u32 v0, v0, v1
    v_cmp_eq_u32 vcc, -1, v0
    s_cbranch_vccz pmo_104
    s_sub_u32 s30, s30, 1
    s_cmp_gt_u32 s30, 199996
    s_cbranch_scc1 pm_103
    s_sleep 10
    s_cmp_lg_u32 s30, 0
    s_cbranch_scc1 pm_103
    s_branch k2_end
pm1_111:
    buffer_load_dwordx4 v[80:83], v3, s[4:7], s24 offen sc1
    buffer_load_dwordx4 v[84:87], v4, s[4:7], s24 offen sc1
    s_waitcnt vmcnt(2)
    ds_write_b128 v3, v[88:91]
    ds_write_b128 v4, v[92:95]
    v_max3_u32 v0, v88, v89, v90
    v_max3_u32 v1, v91, v92, v93
    v_max3_u32 v0, v0, v94, v95
    v_max_u32 v0, v0, v1
    v_cmp_eq_u32 vcc, -1, v0
    s_cbranch_vccz pmo_110
    s_sub_u32 s30, s30, 1
    s_cmp_gt_u32 s30, 199996
    s_cbranch_scc1 pm_109
    s_sleep 10
    s_cmp_lg_u32 s30, 0
    s_cbranch_scc1 pm_109
    s_branch k2_end
pl_117:
    v_or3_b32 v0, v32, v33, v34
    v_or3_b32 v0, v0, v35, v36
    v_or3_b32 v0, v0, v37, v38
    v_or3_b32 v0, v0, v39, v40
    v_or3_b32 v0, v0, v41, v42
    v_or3_b32 v0, v0, v43, v44
    v_or3_b32 v0, v0, v45, v46
    v_or3_b32 v0, v0, v47, v48
    v_or3_b32 v0, v0, v49, v50
    v_or3_b32 v0, v0, v51, v52
    v_or3_b32 v0, v0, v53, v54
    v_or3_b32 v0, v0, v55, v56
    v_or3_b32 v0, v0, v57, v58
    v_or3_b32 v0, v0, v59, v60
    v_or3_b32 v0, v0, v61, v62
    v_or3_b32 v0, v0, v63, v64
    v_or3_b32 v0, v0, v65, v66
    v_or3_b32 v0, v0, v67, v68
    v_or3_b32 v0, v0, v69, v70
    v_or_b32 v0, v0, v71
    v_and_b32 v0, 0x80008000, v0
    v_cmp_ne_u32 vcc, 0, v0
    s_cbranch_vccz pa_118
    v_mov_b64 v[16:17], 0
    v_mov_b64 v[18:19], 0
    v_mov_b64 v[20:21], 0
    v_mov_b64 v[22:23], 0
    s_waitcnt vmcnt(0)
    s_sub_u32 s30, s30, 1
    s_cmp_lg_u32 s30, 0
    s_cbranch_scc1 pp_115
    s_branch k2_end
ch_value_slow:
    s_cmp_eq_u32 s3, 3
    s_cbranch_scc1 va3_s
    s_mov_b32 s20, 0
va_loop_s:
    s_and_b32 s21, s20, 3
    s_lshl_b32 s24, s21, 14
    s_add_u32 s24, s24, 73760768
    s_add_u32 s25, s24, 8192
    s_lshl_b32 s26, s21, 15
    s_add_u32 s26, s26, 73826304
    s_add_u32 s45, s26, 16384
    s_xor_b32 s22, s21, 2
    s_lshl_b32 s27, s22, 15
    s_add_u32 s27, s27, 73826304
    s_add_u32 s44, s20, 1
    s_and_b32 s22, s44, 3
    s_lshl_b32 s28, s22, 14
    s_add_u32 s28, s28, 73760768
    s_xor_b32 s22, s22, 2
    s_lshl_b32 s29, s22, 14
    s_add_u32 s29, s29, 73760768
    v_mov_b64 v[16:17], 0
    v_mov_b64 v[18:19], 0
    v_mov_b64 v[20:21], 0
    v_mov_b64 v[22:23], 0
    v_mov_b64 v[24:25], 0
    v_mov_b64 v[26:27], 0
    v_mov_b64 v[28:29], 0
    v_mov_b64 v[30:31], 0
    s_mov_b32 s30, 200000
    buffer_load_dwordx4 v[48:51], v3, s[4:7], s24 offen sc1
    buffer_load_dwordx4 v[52:55], v4, s[4:7], s24 offen sc1
    s_nop 15
    s_nop 15
    s_nop 7
pm_120:
    buffer_load_dwordx4 v[56:59], v3, s[4:7], s25 offen sc1
    buffer_load_dwordx4 v[60:63], v4, s[4:7], s25 offen sc1
    s_waitcnt vmcnt(2)
    ds_write_b128 v3, v[48:51]
    ds_write_b128 v4, v[52:55]
    v_max3_u32 v0, v48, v49, v50
    v_max3_u32 v1, v51, v52, v53
    v_max3_u32 v0, v0, v54, v55
    v_max_u32 v0, v0, v1
    v_cmp_eq_u32 vcc, -1, v0
    s_cbranch_vccnz pm1_122
pmo_121:
    s_waitcnt lgkmcnt(0)
    s_barrier
    ds_read_b128 v[32:35], v8 offset:0
    ds_read_b128 v[36:39], v8 offset:512
    ds_read_b128 v[40:43], v8 offset:1024
    ds_read_b128 v[44:47], v8 offset:1536
    s_waitcnt lgkmcnt(3)
    v_smfmac_f32_16x16x64_bf16 v[16:19], v[32:35], v[64:71], v2
    v_smfmac_f32_16x16x64_bf16 v[20:23], v[32:35], v[176:183], v2
    v_smfmac_f32_16x16x64_bf16 v[24:27], v[32:35], a[32:39], v2
    v_smfmac_f32_16x16x64_bf16 v[28:31], v[32:35], a[144:151], v2
    ds_read_b128 v[32:35], v8 offset:2048
    s_waitcnt lgkmcnt(3)
    v_smfmac_f32_16x16x64_bf16 v[16:19], v[36:39], v[72:79], v2
    v_smfmac_f32_16x16x64_bf16 v[20:23], v[36:39], v[184:191], v2
    v_smfmac_f32_16x16x64_bf16 v[24:27], v[36:39], a[40:47], v2
    v_smfmac_f32_16x16x64_bf16 v[28:31], v[36:39], a[152:159], v2
    ds_read_b128 v[36:39], v8 offset:2560
    s_waitcnt lgkmcnt(3)
    v_smfmac_f32_16x16x64_bf16 v[16:19], v[40:43], v[80:87], v2
    v_smfmac_f32_16x16x64_bf16 v[20:23], v[40:43], v[192:199], v2
    v_smfmac_f32_16x16x64_bf16 v[24:27], v[40:43], a[48:55], v2
    v_smfmac_f32_16x16x64_bf16 v[28:31], v[40:43], a[160:167], v2
    ds_read_b128 v[40:43], v8 offset:3072
    s_waitcnt lgkmcnt(3)
    v_smfmac_f32_16x16x64_bf16 v[16:19], v[44:47], v[88:95], v2
    v_smfmac_f32_16x16x64_bf16 v[20:23], v[44:47], v[200:207], v2
    v_smfmac_f32_16x16x64_bf16 v[24:27], v[44:47], a[56:63], v2
    v_smfmac_f32_16x16x64_bf16 v[28:31], v[44:47], a[168:175], v2
    ds_read_b128 v[44:47], v8 offset:3584
    s_waitcnt lgkmcnt(3)
    v_smfmac_f32_16x16x64_bf16 v[16:19], v[32:35], v[96:103], v2
    v_smfmac_f32_16x16x64_bf16 v[20:23], v[32:35], v[208:215], v2
    v_smfmac_f32_16x16x64_bf16 v[24:27], v[32:35], a[64:71], v2
    v_smfmac_f32_16x16x64_bf16 v[28:31], v[32:35], a[176:183], v2
    ds_read_b128 v[32:35], v8 offset:4096
    s_waitcnt lgkmcnt(3)
    v_smfmac_f32_16x16x64_bf16 v[16:19], v[36:39], v[104:111], v2
    v_smfmac_f32_16x16x64_bf16 v[20:23], v[36:39], v[216:223], v2
    v_smfmac_f32_16x16x64_bf16 v[24:27], v[36:39], a[72:79], v2
    v_smfmac_f32_16x16x64_bf16 v[28:31], v[36:39], a[184:191], v2
    ds_read_b128 v[36:39], v8 offset:4608
    s_waitcnt lgkmcnt(3)
    v_smfmac_f32_16x16x64_bf16 v[16:19], v[40:43], v[112:119], v2
    v_smfmac_f32_16x16x64_bf16 v[20:23], v[40:43], v[224:231], v2
    v_smfmac_f32_16x16x64_bf16 v[24:27], v[40:43], a[80:87], v2
    v_smfmac_f32_16x16x64_bf16 v[28:31], v[40:43], a[192:199], v2
    ds_read_b128 v[40:43], v8 offset:5120
    s_waitcnt lgkmcnt(3)
    v_smfmac_f32_16x16x64_bf16 v[16:19], v[44:47], v[120:127], v2
    v_smfmac_f32_16x16x64_bf16 v[20:23], v[44:47], v[232:239], v2
    v_smfmac_f32_16x16x64_bf16 v[24:27], v[44:47], a[88:95], v2
    v_smfmac_f32_16x16x64_bf16 v[28:31], v[44:47], a[200:207], v2
    ds_read_b128 v[44:47], v8 offset:5632
    s_waitcnt lgkmcnt(3)
    v_smfmac_f32_16x16x64_bf16 v[16:19], v[32:35], v[128:135], v2
    v_smfmac_f32_16x16x64_bf16 v[20:23], v[32:35], v[240:247], v2
    v_smfmac_f32_16x16x64_bf16 v[24:27], v[32:35], a[96:103], v2
    v_smfmac_f32_16x16x64_bf16 v[28:31], v[32:35], a[208:215], v2
    ds_read_b128 v[32:35], v8 offset:6144
    s_waitcnt lgkmcnt(3)
    v_smfmac_f32_16x16x64_bf16 v[16:19], v[36:39], v[136:143], v2
    v_smfmac_f32_16x16x64_bf16 v[20:23], v[36:39], v[248:255], v2
    v_smfmac_f32_16x16x64_bf16 v[24:27], v[36:39], a[104:111], v2
    v_smfmac_f32_16x16x64_bf16 v[28:31], v[36:39], a[216:223], v2
    ds_read_b128 v[36:39], v8 offset:6656
    s_waitcnt lgkmcnt(3)
    v_smfmac_f32_16x16x64_bf16 v[16:19], v[40:43], v[144:151], v2
    v_smfmac_f32_16x16x64_bf16 v[20:23], v[40:43], a[0:7], v2
    v_smfmac_f32_16x16x64_bf16 v[24:27], v[40:43], a[112:119], v2
    v_smfmac_f32_16x16x64_bf16 v[28:31], v[40:43], a[224:231], v2
    s_waitcnt lgkmcnt(2)
    v_smfmac_f32_16x16x64_bf16 v[16:19], v[44:47], v[152:159], v2
    v_smfmac_f32_16x16x64_bf16 v[20:23], v[44:47], a[8:15], v2
    v_smfmac_f32_16x16x64_bf16 v[24:27], v[44:47], a[120:127], v2
    v_smfmac_f32_16x16x64_bf16 v[28:31], v[44:47], a[232:239], v2
    s_waitcnt lgkmcnt(1)
    v_smfmac_f32_16x16x64_bf16 v[16:19], v[32:35], v[160:167], v2
    v_smfmac_f32_16x16x64_bf16 v[20:23], v[32:35], a[16:23], v2
    v_smfmac_f32_16x16x64_bf16 v[24:27], v[32:35], a[128:135], v2
    v_smfmac_f32_16x16x64_bf16 v[28:31], v[32:35], a[240:247], v2
    s_waitcnt lgkmcnt(0)
    v_smfmac_f32_16x16x64_bf16 v[16:19], v[36:39], v[168:175], v2
    v_smfmac_f32_16x16x64_bf16 v[20:23], v[36:39], a[24:31], v2
    v_smfmac_f32_16x16x64_bf16 v[24:27], v[36:39], a[136:143], v2
    v_smfmac_f32_16x16x64_bf16 v[28:31], v[36:39], a[248:255], v2
    s_nop 7
    v_cvt_pk_bf16_f32 v32, v16, v17
    v_cvt_pk_bf16_f32 v33, v18, v19
    ds_write_b32 v13, v32 offset:0
    ds_write_b32 v13, v33 offset:8
    v_cvt_pk_bf16_f32 v36, v24, v25
    v_cvt_pk_bf16_f32 v37, v26, v27
    ds_write_b32 v13, v36 offset:1024
    ds_write_b32 v13, v37 offset:1032
    v_cvt_pk_bf16_f32 v34, v20, v21
    v_cvt_pk_bf16_f32 v35, v22, v23
    ds_write_b32 v13, v34 offset:2048
    ds_write_b32 v13, v35 offset:2056
    v_cvt_pk_bf16_f32 v38, v28, v29
    v_cvt_pk_bf16_f32 v39, v30, v31
    ds_write_b32 v13, v38 offset:3072
    ds_write_b32 v13, v39 offset:3080
    s_waitcnt lgkmcnt(0)
    s_barrier
    s_barrier
    s_add_u32 s20, s20, 1
    s_cmp_lt_u32 s20, 63
    s_cbranch_scc1 va_loop_s
    s_branch k2_end
va3_s:
    s_mov_b32 s20, 0
va3_loop_s:
    s_cmp_lt_u32 s20, s33
    s_cbranch_scc1 uro_124
    v_lshrrev_b32 v1, 2, v12
    s_cmp_lt_u32 s20, 8
    s_cbranch_scc1 ur_123
    s_add_u32 s22, s37, 0
    buffer_load_dword v80, v1, s[4:7], s22 offen sc1
    s_add_u32 s22, s37, 3584
    buffer_load_dword v81, v1, s[4:7], s22 offen sc1
    s_add_u32 s22, s37, 7168
    buffer_load_dword v82, v1, s[4:7], s22 offen sc1
    s_add_u32 s22, s37, 10752
    buffer_load_dword v83, v1, s[4:7], s22 offen sc1
    s_add_u32 s22, s37, 14336
    buffer_load_dword v84, v1, s[4:7], s22 offen sc1
    s_add_u32 s22, s37, 17920
    buffer_load_dword v85, v1, s[4:7], s22 offen sc1
    s_add_u32 s22, s37, 21504
    buffer_load_dword v86, v1, s[4:7], s22 offen sc1
    s_add_u32 s22, s37, 25088
    buffer_load_dword v87, v1, s[4:7], s22 offen sc1
    s_waitcnt vmcnt(0)
    s_mov_b32 s33, 64
    v_cmp_eq_u32 vcc, 0, v87
    s_cmp_lg_u64 vcc, 0
    s_cselect_b32 s33, 56, s33
    v_cmp_eq_u32 vcc, 0, v86
    s_cmp_lg_u64 vcc, 0
    s_cselect_b32 s33, 48, s33
    v_cmp_eq_u32 vcc, 0, v85
    s_cmp_lg_u64 vcc, 0
    s_cselect_b32 s33, 40, s33
    v_cmp_eq_u32 vcc, 0, v84
    s_cmp_lg_u64 vcc, 0
    s_cselect_b32 s33, 32, s33
    v_cmp_eq_u32 vcc, 0, v83
    s_cmp_lg_u64 vcc, 0
    s_cselect_b32 s33, 24, s33
    v_cmp_eq_u32 vcc, 0, v82
    s_cmp_lg_u64 vcc, 0
    s_cselect_b32 s33, 16, s33
    v_cmp_eq_u32 vcc, 0, v81
    s_cmp_lg_u64 vcc, 0
    s_cselect_b32 s33, 8, s33
    v_cmp_eq_u32 vcc, 0, v80
    s_cmp_lg_u64 vcc, 0
    s_cselect_b32 s33, 0, s33
    s_cmp_lt_u32 s20, s33
    s_cbranch_scc1 uro_124
ur_123:
    s_lshr_b32 s21, s20, 3
    s_mul_i32 s19, s21, 3584
    s_add_u32 s19, s19, s37
    s_mov_b32 s30, 200000
urp_125:
    buffer_load_dword v80, v1, s[4:7], s19 offen sc1
    s_sub_u32 s30, s30, 1
    s_cmp_eq_u32 s30, 0
    s_cbranch_scc1 k2_end
    s_waitcnt vmcnt(0)
    v_cmp_eq_u32 vcc, 0, v80
    s_or_b32 s22, vcc_lo, vcc_hi
    s_lshr_b32 s23, s22, 16
    s_or_b32 s22, s22, s23
    s_lshr_b32 s23, s22, 8
    s_or_b32 s22, s22, s23
    s_and_b32 s22, s22, 0xff
    s_or_b32 s22, s22, 0x100
    s_ff1_i32_b32 s22, s22
    s_lshl_b32 s33, s21, 3
    s_add_u32 s33, s33, s22
    s_cmp_lt_u32 s20, s33
    s_cbranch_scc1 uro_124
    s_sleep 12
    s_branch urp_125
uro_124:
    s_and_b32 s21, s20, 3
    s_lshl_b32 s24, s21, 14
    s_add_u32 s24, s24, 73760768
    s_add_u32 s25, s24, 8192
    s_lshl_b32 s26, s21, 15
    s_add_u32 s26, s26, 73826304
    s_add_u32 s45, s26, 16384
    s_xor_b32 s22, s21, 2
    s_lshl_b32 s27, s22, 15
    s_add_u32 s27, s27, 73826304
    s_add_u32 s44, s20, 1
    s_and_b32 s22, s44, 3
    s_lshl_b32 s28, s22, 14
    s_add_u32 s28, s28, 73760768
    s_xor_b32 s22, s22, 2
    s_lshl_b32 s29, s22, 14
    s_add_u32 s29, s29, 73760768
    v_mov_b64 v[16:17], 0
    v_mov_b64 v[18:19], 0
    v_mov_b64 v[20:21], 0
    v_mov_b64 v[22:23], 0
    v_mov_b64 v[24:25], 0
    v_mov_b64 v[26:27], 0
    v_mov_b64 v[28:29], 0
    v_mov_b64 v[30:31], 0
    s_mov_b32 s30, 200000
    buffer_load_dwordx4 v[80:83], v3, s[4:7], s24 offen sc1
    buffer_load_dwordx4 v[84:87], v4, s[4:7], s24 offen sc1
    s_nop 15
    s_nop 15
    s_nop 7
pm_126:
    buffer_load_dwordx4 v[88:91], v3, s[4:7], s25 offen sc1
    buffer_load_dwordx4 v[92:95], v4, s[4:7], s25 offen sc1
    s_waitcnt vmcnt(2)
    ds_write_b128 v3, v[80:83]
    ds_write_b128 v4, v[84:87]
    v_max3_u32 v0, v80, v81, v82
    v_max3_u32 v1, v83, v84, v85
    v_max3_u32 v0, v0, v86, v87
    v_max_u32 v0, v0, v1
    v_cmp_eq_u32 vcc, -1, v0
    s_cbranch_vccnz pm1_128
pmo_127:
    s_waitcnt lgkmcnt(0)
    s_barrier
    ds_read_b128 v[32:35], v8 offset:0
    ds_read_b128 v[36:39], v8 offset:512
    ds_read_b128 v[40:43], v8 offset:1024
    ds_read_b128 v[48:51], v11 offset:0
    ds_read_b128 v[52:55], v11 offset:1024
    ds_read_b128 v[56:59], v11 offset:2048
    ds_read_b128 v[60:63], v11 offset:3072
    ds_read_b128 v[64:67], v11 offset:4096
    ds_read_b128 v[68:71], v11 offset:5120
    ds_read_b128 v[72:75], v11 offset:6144
    ds_read_b128 v[76:79], v11 offset:7168
    ds_read_b128 v[44:47], v8 offset:1536
    s_waitcnt lgkmcnt(11)
    v_smfmac_f32_16x16x64_bf16 v[16:19], v[32:35], a[0:7], v2
    s_add_u32 s23, s36, 0
    buffer_load_dwordx4 v[128:131], v12, s[4:7], s23 offen offset:0
    v_smfmac_f32_16x16x64_bf16 v[20:23], v[32:35], a[112:119], v2
    buffer_load_dwordx4 v[132:135], v12, s[4:7], s23 offen offset:1024
    buffer_load_dwordx4 v[136:139], v12, s[4:7], s23 offen offset:2048
    s_waitcnt lgkmcnt(7)
    v_smfmac_f32_16x16x64_bf16 v[24:27], v[32:35], v[48:55], v2
    ds_read_b128 v[48:51], v11 offset:8192
    ds_read_b128 v[52:55], v11 offset:9216
    s_waitcnt lgkmcnt(7)
    v_smfmac_f32_16x16x64_bf16 v[28:31], v[32:35], v[56:63], v2
    ds_read_b128 v[56:59], v11 offset:10240
    ds_read_b128 v[60:63], v11 offset:11264
    ds_read_b128 v[32:35], v8 offset:2048
    v_smfmac_f32_16x16x64_bf16 v[16:19], v[36:39], a[8:15], v2
    buffer_load_dwordx4 v[140:143], v12, s[4:7], s23 offen offset:3072
    s_add_u32 s23, s36, 57344
    v_smfmac_f32_16x16x64_bf16 v[20:23], v[36:39], a[120:127], v2
    buffer_load_dwordx4 v[144:147], v12, s[4:7], s23 offen offset:0
    buffer_load_dwordx4 v[148:151], v12, s[4:7], s23 offen offset:1024
    s_waitcnt lgkmcnt(8)
    v_smfmac_f32_16x16x64_bf16 v[24:27], v[36:39], v[64:71], v2
    ds_read_b128 v[64:67], v11 offset:12288
    ds_read_b128 v[68:71], v11 offset:13312
    s_waitcnt lgkmcnt(8)
    v_smfmac_f32_16x16x64_bf16 v[28:31], v[36:39], v[72:79], v2
    ds_read_b128 v[72:75], v11 offset:14336
    ds_read_b128 v[76:79], v11 offset:15360
    ds_read_b128 v[36:39], v8 offset:2560
    v_smfmac_f32_16x16x64_bf16 v[16:19], v[40:43], a[16:23], v2
    buffer_load_dwordx4 v[152:155], v12, s[4:7], s23 offen offset:2048
    buffer_load_dwordx4 v[156:159], v12, s[4:7], s23 offen offset:3072
    v_smfmac_f32_16x16x64_bf16 v[20:23], v[40:43], a[128:135], v2
    s_add_u32 s23, s36, 114688
    buffer_load_dwordx4 v[160:163], v12, s[4:7], s23 offen offset:0
    s_waitcnt lgkmcnt(8)
    v_smfmac_f32_16x16x64_bf16 v[24:27], v[40:43], v[48:55], v2
    ds_read_b128 v[48:51], v11 offset:16384
    ds_read_b128 v[52:55], v11 offset:17408
    s_waitcnt lgkmcnt(8)
    v_smfmac_f32_16x16x64_bf16 v[28:31], v[40:43], v[56:63], v2
    ds_read_b128 v[56:59], v11 offset:18432
    ds_read_b128 v[60:63], v11 offset:19456
    ds_read_b128 v[40:43], v8 offset:3072
    v_smfmac_f32_16x16x64_bf16 v[16:19], v[44:47], a[24:31], v2
    buffer_load_dwordx4 v[164:167], v12, s[4:7], s23 offen offset:1024
    buffer_load_dwordx4 v[168:171], v12, s[4:7], s23 offen offset:2048
    v_smfmac_f32_16x16x64_bf16 v[20:23], v[44:47], a[136:143], v2
    buffer_load_dwordx4 v[172:175], v12, s[4:7], s23 offen offset:3072
    s_add_u32 s23, s36, 172032
    s_waitcnt lgkmcnt(8)
    v_smfmac_f32_16x16x64_bf16 v[24:27], v[44:47], v[64:71], v2
    ds_read_b128 v[64:67], v11 offset:20480
    ds_read_b128 v[68:71], v11 offset:21504
    s_waitcnt lgkmcnt(8)
    v_smfmac_f32_16x16x64_bf16 v[28:31], v[44:47], v[72:79], v2
    ds_read_b128 v[72:75], v11 offset:22528
    ds_read_b128 v[76:79], v11 offset:23552
    ds_read_b128 v[44:47], v8 offset:3584
    v_smfmac_f32_16x16x64_bf16 v[16:19], v[32:35], a[32:39], v2
    buffer_load_dwordx4 v[176:179], v12, s[4:7], s23 offen offset:0
    buffer_load_dwordx4 v[180:183], v12, s[4:7], s23 offen offset:1024
    v_smfmac_f32_16x16x64_bf16 v[20:23], v[32:35], a[144:151], v2
    buffer_load_dwordx4 v[184:187], v12, s[4:7], s23 offen offset:2048
    buffer_load_dwordx4 v[188:191], v12, s[4:7], s23 offen offset:3072
    s_waitcnt lgkmcnt(8)
    v_smfmac_f32_16x16x64_bf16 v[24:27], v[32:35], v[48:55], v2
    ds_read_b128 v[48:51], v11 offset:24576
    ds_read_b128 v[52:55], v11 offset:25600
    s_waitcnt lgkmcnt(8)
    v_smfmac_f32_16x16x64_bf16 v[28:31], v[32:35], v[56:63], v2
    ds_read_b128 v[56:59], v11 offset:26624
    ds_read_b128 v[60:63], v11 offset:27648
    ds_read_b128 v[32:35], v8 offset:4096
    v_smfmac_f32_16x16x64_bf16 v[16:19], v[36:39], a[40:47], v2
    s_add_u32 s23, s36, 229376
    buffer_load_dwordx4 v[192:195], v12, s[4:7], s23 offen offset:0
    v_smfmac_f32_16x16x64_bf16 v[20:23], v[36:39], a[152:159], v2
    buffer_load_dwordx4 v[196:199], v12, s[4:7], s23 offen offset:1024
    buffer_load_dwordx4 v[200:203], v12, s[4:7], s23 offen offset:2048
    s_waitcnt lgkmcnt(8)
    v_smfmac_f32_16x16x64_bf16 v[24:27], v[36:39], v[64:71], v2
    ds_read_b128 v[64:67], v11 offset:28672
    ds_read_b128 v[68:71], v11 offset:29696
    s_waitcnt lgkmcnt(8)
    v_smfmac_f32_16x16x64_bf16 v[28:31], v[36:39], v[72:79], v2
    ds_read_b128 v[72:75], v11 offset:30720
    ds_read_b128 v[76:79], v11 offset:31744
    ds_read_b128 v[36:39], v8 offset:4608
    v_smfmac_f32_16x16x64_bf16 v[16:19], v[40:43], a[48:55], v2
    buffer_load_dwordx4 v[204:207], v12, s[4:7], s23 offen offset:3072
    s_add_u32 s23, s36, 286720
    v_smfmac_f32_16x16x64_bf16 v[20:23], v[40:43], a[160:167], v2
    buffer_load_dwordx4 v[208:211], v12, s[4:7], s23 offen offset:0
    buffer_load_dwordx4 v[212:215], v12, s[4:7], s23 offen offset:1024
    s_waitcnt lgkmcnt(8)
    v_smfmac_f32_16x16x64_bf16 v[24:27], v[40:43], v[48:55], v2
    ds_read_b128 v[48:51], v11 offset:32768
    ds_read_b128 v[52:55], v11 offset:33792
    s_waitcnt lgkmcnt(8)
    v_smfmac_f32_16x16x64_bf16 v[28:31], v[40:43], v[56:63], v2
    ds_read_b128 v[56:59], v11 offset:34816
    ds_read_b128 v[60:63], v11 offset:35840
    ds_read_b128 v[40:43], v8 offset:5120
    v_smfmac_f32_16x16x64_bf16 v[16:19], v[44:47], a[56:63], v2
    buffer_load_dwordx4 v[216:219], v12, s[4:7], s23 offen offset:2048
    buffer_load_dwordx4 v[220:223], v12, s[4:7], s23 offen offset:3072
    v_smfmac_f32_16x16x64_bf16 v[20:23], v[44:47], a[168:175], v2
    s_add_u32 s23, s36, 344064
    buffer_load_dwordx4 v[224:227], v12, s[4:7], s23 offen offset:0
    s_waitcnt lgkmcnt(8)
    v_smfmac_f32_16x16x64_bf16 v[24:27], v[44:47], v[64:71], v2
    ds_read_b128 v[64:67], v11 offset:36864
    ds_read_b128 v[68:71], v11 offset:37888
    s_waitcnt lgkmcnt(8)
    v_smfmac_f32_16x16x64_bf16 v[28:31], v[44:47], v[72:79], v2
    ds_read_b128 v[72:75], v11 offset:38912
    ds_read_b128 v[76:79], v11 offset:39936
    ds_read_b128 v[44:47], v8 offset:5632
    v_smfmac_f32_16x16x64_bf16 v[16:19], v[32:35], a[64:71], v2
    buffer_load_dwordx4 v[228:231], v12, s[4:7], s23 offen offset:1024
    buffer_load_dwordx4 v[232:235], v12, s[4:7], s23 offen offset:2048
    v_smfmac_f32_16x16x64_bf16 v[20:23], v[32:35], a[176:183], v2
    buffer_load_dwordx4 v[236:239], v12, s[4:7], s23 offen offset:3072
    s_add_u32 s23, s36, 401408
    s_waitcnt lgkmcnt(8)
    v_smfmac_f32_16x16x64_bf16 v[24:27], v[32:35], v[48:55], v2
    ds_read_b128 v[48:51], v11 offset:40960
    ds_read_b128 v[52:55], v11 offset:41984
    s_waitcnt lgkmcnt(8)
    v_smfmac_f32_16x16x64_bf16 v[28:31], v[32:35], v[56:63], v2
    ds_read_b128 v[56:59], v11 offset:43008
    ds_read_b128 v[60:63], v11 offset:44032
    ds_read_b128 v[32:35], v8 offset:6144
    v_smfmac_f32_16x16x64_bf16 v[16:19], v[36:39], a[72:79], v2
    buffer_load_dwordx4 v[240:243], v12, s[4:7], s23 offen offset:0
    buffer_load_dwordx4 v[244:247], v12, s[4:7], s23 offen offset:1024
    v_smfmac_f32_16x16x64_bf16 v[20:23], v[36:39], a[184:191], v2
    buffer_load_dwordx4 v[248:251], v12, s[4:7], s23 offen offset:2048
    buffer_load_dwordx4 v[252:255], v12, s[4:7], s23 offen offset:3072
    s_waitcnt lgkmcnt(8)
    v_smfmac_f32_16x16x64_bf16 v[24:27], v[36:39], v[64:71], v2
    ds_read_b128 v[64:67], v11 offset:45056
    ds_read_b128 v[68:71], v11 offset:46080
    s_waitcnt lgkmcnt(8)
    v_smfmac_f32_16x16x64_bf16 v[28:31], v[36:39], v[72:79], v2
    ds_read_b128 v[72:75], v11 offset:47104
    ds_read_b128 v[76:79], v11 offset:48128
    ds_read_b128 v[36:39], v8 offset:6656
    v_smfmac_f32_16x16x64_bf16 v[16:19], v[40:43], a[80:87], v2
    v_smfmac_f32_16x16x64_bf16 v[20:23], v[40:43], a[192:199], v2
    s_waitcnt lgkmcnt(8)
    v_smfmac_f32_16x16x64_bf16 v[24:27], v[40:43], v[48:55], v2
    ds_read_b128 v[48:51], v11 offset:49152
    ds_read_b128 v[52:55], v11 offset:50176
    s_waitcnt lgkmcnt(8)
    v_smfmac_f32_16x16x64_bf16 v[28:31], v[40:43], v[56:63], v2
    ds_read_b128 v[56:59], v11 offset:51200
    ds_read_b128 v[60:63], v11 offset:52224
    v_smfmac_f32_16x16x64_bf16 v[16:19], v[44:47], a[88:95], v2
    v_smfmac_f32_16x16x64_bf16 v[20:23], v[44:47], a[200:207], v2
    s_waitcnt lgkmcnt(7)
    v_smfmac_f32_16x16x64_bf16 v[24:27], v[44:47], v[64:71], v2
    ds_read_b128 v[64:67], v11 offset:53248
    ds_read_b128 v[68:71], v11 offset:54272
    s_waitcnt lgkmcnt(7)
    v_smfmac_f32_16x16x64_bf16 v[28:31], v[44:47], v[72:79], v2
    ds_read_b128 v[72:75], v11 offset:55296
    ds_read_b128 v[76:79], v11 offset:56320
    v_smfmac_f32_16x16x64_bf16 v[16:19], v[32:35], a[96:103], v2
    v_smfmac_f32_16x16x64_bf16 v[20:23], v[32:35], a[208:215], v2
    s_waitcnt lgkmcnt(6)
    v_smfmac_f32_16x16x64_bf16 v[24:27], v[32:35], v[48:55], v2
    s_waitcnt lgkmcnt(4)
    v_smfmac_f32_16x16x64_bf16 v[28:31], v[32:35], v[56:63], v2
    v_smfmac_f32_16x16x64_bf16 v[16:19], v[36:39], a[104:111], v2
    v_smfmac_f32_16x16x64_bf16 v[20:23], v[36:39], a[216:223], v2
    s_waitcnt lgkmcnt(2)
    v_smfmac_f32_16x16x64_bf16 v[24:27], v[36:39], v[64:71], v2
    s_waitcnt lgkmcnt(0)
    v_smfmac_f32_16x16x64_bf16 v[28:31], v[36:39], v[72:79], v2
    s_add_u32 s36, s36, 462848
    s_nop 7
    v_cvt_pk_bf16_f32 v32, v16, v17
    v_cvt_pk_bf16_f32 v33, v18, v19
    ds_write_b32 v13, v32 offset:0
    ds_write_b32 v13, v33 offset:8
    v_cvt_pk_bf16_f32 v36, v24, v25
    v_cvt_pk_bf16_f32 v37, v26, v27
    ds_write_b32 v13, v36 offset:1024
    ds_write_b32 v13, v37 offset:1032
    v_cvt_pk_bf16_f32 v34, v20, v21
    v_cvt_pk_bf16_f32 v35, v22, v23
    ds_write_b32 v13, v34 offset:2048
    ds_write_b32 v13, v35 offset:2056
    v_cvt_pk_bf16_f32 v38, v28, v29
    v_cvt_pk_bf16_f32 v39, v30, v31
    ds_write_b32 v13, v38 offset:3072
    ds_write_b32 v13, v39 offset:3080
    s_waitcnt lgkmcnt(0)
    s_barrier
    ds_read_b128 a[224:227], v12 offset:8192
    ds_read_b128 a[228:231], v12 offset:9216
    ds_read_b128 a[232:235], v12 offset:10240
    ds_read_b128 a[236:239], v12 offset:11264
    ds_read_b128 a[240:243], v12 offset:12288
    ds_read_b128 a[244:247], v12 offset:13312
    ds_read_b128 a[248:251], v12 offset:14336
    ds_read_b128 a[252:255], v12 offset:15360
    v_mov_b64 v[16:17], 0
    v_mov_b64 v[18:19], 0
    v_mov_b64 v[20:21], 0
    v_mov_b64 v[22:23], 0
    s_mov_b32 s30, 200000
    s_mov_b64 exec, s[42:43]
    buffer_load_dword v32, v7, s[4:7], s47 offen offset:0 sc1
    s_nop 15
    s_nop 9
wf_130:
    buffer_load_dword v33, v7, s[4:7], s47 offen offset:128 sc1
    s_waitcnt vmcnt(1)
    v_cmp_gt_u32 vcc, s44, v32
    s_cbranch_vccz wfo_131
    buffer_load_dword v32, v7, s[4:7], s47 offen offset:0 sc1
    s_waitcnt vmcnt(1)
    v_cmp_gt_u32 vcc, s44, v33
    s_cbranch_vccz wfo_131
    s_sub_u32 s30, s30, 1
    s_cmp_lg_u32 s30, 0
    s_cbranch_scc1 wf_130
    s_mov_b64 exec, -1
    s_branch k2_end
wfo_131:
    s_mov_b64 exec, -1
wfb_129:
    s_waitcnt lgkmcnt(0)
    s_add_u32 s22, s26, 4096
    s_add_u32 s23, s26, 8192
    s_add_u32 s18, s45, 4096
    s_add_u32 s19, s45, 8192
    s_mov_b32 s30, 200000
pp_132:
    buffer_load_dwordx4 v[32:35], v12, s[4:7], s26 offen offset:0 sc1
    buffer_load_dwordx4 v[36:39], v12, s[4:7], s26 offen offset:1024 sc1
    buffer_load_dwordx4 v[40:43], v12, s[4:7], s26 offen offset:2048 sc1
    buffer_load_dwordx4 v[44:47], v12, s[4:7], s26 offen offset:3072 sc1
    buffer_load_dwordx4 v[48:51], v12, s[4:7], s22 offen offset:0 sc1
    buffer_load_dwordx4 v[52:55], v12, s[4:7], s22 offen offset:1024 sc1
    buffer_load_dwordx4 v[56:59], v12, s[4:7], s22 offen offset:2048 sc1
    buffer_load_dwordx4 v[60:63], v12, s[4:7], s22 offen offset:3072 sc1
    buffer_load_dwordx4 v[64:67], v12, s[4:7], s23 offen offset:0 sc1
    buffer_load_dwordx4 v[68:71], v12, s[4:7], s23 offen offset:1024 sc1
    v_mov_b32 v1, s44
    s_mov_b32 exec_hi, 0x40000000
    buffer_store_dword v1, v6, s[4:7], s40 offen sc1
    s_mov_b64 exec, -1
    s_waitcnt vmcnt(10)
    v_smfmac_f32_16x16x64_bf16 v[16:19], v[32:35], v[128:135], v2
    v_smfmac_f32_16x16x64_bf16 v[20:23], v[32:35], v[136:143], v2
    s_waitcnt vmcnt(9)
    v_smfmac_f32_16x16x64_bf16 v[16:19], v[36:39], v[144:151], v2
    v_smfmac_f32_16x16x64_bf16 v[20:23], v[36:39], v[152:159], v2
    s_waitcnt vmcnt(8)
    v_smfmac_f32_16x16x64_bf16 v[16:19], v[40:43], v[160:167], v2
    v_smfmac_f32_16x16x64_bf16 v[20:23], v[40:43], v[168:175], v2
    s_waitcnt vmcnt(7)
    v_smfmac_f32_16x16x64_bf16 v[16:19], v[44:47], v[176:183], v2
    v_smfmac_f32_16x16x64_bf16 v[20:23], v[44:47], v[184:191], v2
    s_waitcnt vmcnt(6)
    v_smfmac_f32_16x16x64_bf16 v[16:19], v[48:51], v[192:199], v2
    v_smfmac_f32_16x16x64_bf16 v[20:23], v[48:51], v[200:207], v2
    s_waitcnt vmcnt(5)
    v_smfmac_f32_16x16x64_bf16 v[16:19], v[52:55], v[208:215], v2
    v_smfmac_f32_16x16x64_bf16 v[20:23], v[52:55], v[216:223], v2
    s_waitcnt vmcnt(4)
    v_smfmac_f32_16x16x64_bf16 v[16:19], v[56:59], v[224:231], v2
    v_smfmac_f32_16x16x64_bf16 v[20:23], v[56:59], v[232:239], v2
    s_waitcnt vmcnt(3)
    v_smfmac_f32_16x16x64_bf16 v[16:19], v[60:63], v[240:247], v2
    v_smfmac_f32_16x16x64_bf16 v[20:23], v[60:63], v[248:255], v2
    s_waitcnt vmcnt(2)
    v_smfmac_f32_16x16x64_bf16 v[16:19], v[64:67], a[224:231], v2
    v_smfmac_f32_16x16x64_bf16 v[20:23], v[64:67], a[232:239], v2
    s_waitcnt vmcnt(1)
    v_smfmac_f32_16x16x64_bf16 v[16:19], v[68:71], a[240:247], v2
    v_smfmac_f32_16x16x64_bf16 v[20:23], v[68:71], a[248:255], v2
    s_nop 2
ppf_133:
    s_nop 4
    v_permlane32_swap_b32 v16, v17
    v_permlane32_swap_b32 v18, v19
    v_permlane32_swap_b32 v20, v21
    v_permlane32_swap_b32 v22, v23
    v_add_f32 v16, v16, v17
    v_add_f32 v20, v20, v21
    v_add_f32 v18, v18, v19
    v_add_f32 v22, v22, v23
    v_cmp_u_f32 vcc, v16, v18
    v_cvt_pk_bf16_f32 v24, v16, v20
    v_cvt_pk_bf16_f32 v25, v18, v22
    v_min_u32 v24, 0xfffffffe, v24
    v_min_u32 v25, 0xfffffffe, v25
    s_cbranch_vccnz pl_134
pa_135:
    buffer_store_dword v24, v15, s[4:7], s28 offen offset:0 sc1
    buffer_store_dword v25, v15, s[4:7], s28 offen offset:32 sc1
    s_add_u32 s28, s28, 8192
    buffer_store_dword v24, v15, s[4:7], s28 offen offset:0 sc1
    buffer_store_dword v25, v15, s[4:7], s28 offen offset:32 sc1
    s_barrier
    v_mov_b32 v26, -1
    buffer_store_dword v26, v15, s[4:7], s29 offen offset:0 sc1
    buffer_store_dword v26, v15, s[4:7], s29 offen offset:32 sc1
    s_add_u32 s29, s29, 8192
    buffer_store_dword v26, v15, s[4:7], s29 offen offset:0 sc1
    buffer_store_dword v26, v15, s[4:7], s29 offen offset:32 sc1
    buffer_store_dword v24, v15, s[4:7], s39 offen offset:0 sc1
    buffer_store_dword v25, v15, s[4:7], s39 offen offset:32 sc1
    s_cmp_lg_u32 s20, 62
    s_cbranch_scc1 vnx_136
    s_mov_b32 s22, 63266816
    buffer_store_dword v24, v15, s[4:7], s22 offen offset:0 sc1
    buffer_store_dword v25, v15, s[4:7], s22 offen offset:32 sc1
vnx_136:
    s_add_u32 s39, s39, 8192
    s_add_u32 s20, s20, 1
    s_cmp_lt_u32 s20, 63
    s_cbranch_scc1 va3_loop_s
    s_branch k2_end
pm1_122:
    buffer_load_dwordx4 v[48:51], v3, s[4:7], s24 offen sc1
    buffer_load_dwordx4 v[52:55], v4, s[4:7], s24 offen sc1
    s_waitcnt vmcnt(2)
    ds_write_b128 v3, v[56:59]
    ds_write_b128 v4, v[60:63]
    v_max3_u32 v0, v56, v57, v58
    v_max3_u32 v1, v59, v60, v61
    v_max3_u32 v0, v0, v62, v63
    v_max_u32 v0, v0, v1
    v_cmp_eq_u32 vcc, -1, v0
    s_cbranch_vccz pmo_121
    s_sub_u32 s30, s30, 1
    s_cmp_gt_u32 s30, 199996
    s_cbranch_scc1 pm_120
    s_sleep 10
    s_cmp_lg_u32 s30, 0
    s_cbranch_scc1 pm_120
    s_branch k2_end
pm1_128:
    buffer_load_dwordx4 v[80:83], v3, s[4:7], s24 offen sc1
    buffer_load_dwordx4 v[84:87], v4, s[4:7], s24 offen sc1
    s_waitcnt vmcnt(2)
    ds_write_b128 v3, v[88:91]
    ds_write_b128 v4, v[92:95]
    v_max3_u32 v0, v88, v89, v90
    v_max3_u32 v1, v91, v92, v93
    v_max3_u32 v0, v0, v94, v95
    v_max_u32 v0, v0, v1
    v_cmp_eq_u32 vcc, -1, v0
    s_cbranch_vccz pmo_127
    s_sub_u32 s30, s30, 1
    s_cmp_gt_u32 s30, 199996
    s_cbranch_scc1 pm_126
    s_sleep 10
    s_cmp_lg_u32 s30, 0
    s_cbranch_scc1 pm_126
    s_branch k2_end
pl_134:
    v_or3_b32 v0, v32, v33, v34
    v_or3_b32 v0, v0, v35, v36
    v_or3_b32 v0, v0, v37, v38
    v_or3_b32 v0, v0, v39, v40
    v_or3_b32 v0, v0, v41, v42
    v_or3_b32 v0, v0, v43, v44
    v_or3_b32 v0, v0, v45, v46
    v_or3_b32 v0, v0, v47, v48
    v_or3_b32 v0, v0, v49, v50
    v_or3_b32 v0, v0, v51, v52
    v_or3_b32 v0, v0, v53, v54
    v_or3_b32 v0, v0, v55, v56
    v_or3_b32 v0, v0, v57, v58
    v_or3_b32 v0, v0, v59, v60
    v_or3_b32 v0, v0, v61, v62
    v_or3_b32 v0, v0, v63, v64
    v_or3_b32 v0, v0, v65, v66
    v_or3_b32 v0, v0, v67, v68
    v_or3_b32 v0, v0, v69, v70
    v_or_b32 v0, v0, v71
    v_and_b32 v0, 0x80008000, v0
    v_cmp_ne_u32 vcc, 0, v0
    s_cbranch_vccz pa_135
    v_mov_b64 v[16:17], 0
    v_mov_b64 v[18:19], 0
    v_mov_b64 v[20:21], 0
    v_mov_b64 v[22:23], 0
    s_waitcnt vmcnt(0)
    s_sub_u32 s30, s30, 1
    s_cmp_lg_u32 s30, 0
    s_cbranch_scc1 pp_132
    s_branch k2_end
k2_worker:
    s_mul_i32 s96, s15, 7
    s_add_u32 s96, s96, s16
    s_sub_u32 s96, s96, 1
    s_sub_u32 s91, s16, 1
    s_mov_b32 s92, s15
    s_load_dwordx2 s[8:9], s[0:1], 0
    s_mov_b32 s10, 1835008
    s_mov_b32 s11, 0x00020000
    s_load_dwordx2 s[12:13], s[0:1], 88
    s_mov_b32 s14, 1835008
    s_mov_b32 s15, 0x00020000
    s_load_dwordx2 s[44:45], s[0:1], 96
    s_mov_b32 s46, 256
    s_mov_b32 s47, 0x00020000
    v_lshrrev_b32 v2, 4, v0
    v_and_b32 v3, 15, v0
    v_lshlrev_b32 v4, 4, v0
    s_mov_b32 s20, 0x05040100
    s_mov_b32 s21, 0x07060302
    s_lshl_b32 s16, s91, 5
    s_add_u32 s16, s16, s92
    s_mul_i32 s32, s16, 293
    s_lshr_b32 s32, s32, 11
    s_mul_i32 s19, s32, 7
    s_sub_u32 s19, s16, s19
    s_lshr_b32 s17, s32, 3
    s_lshl_b32 s17, s17, 2
    s_and_b32 s16, s32, 3
    s_add_u32 s17, s17, s16
    s_bfe_u32 s33, s32, 0x10002
    s_lshl_b32 s16, s33, 4
    s_add_u32 s16, s16, 16
    s_load_dwordx2 s[36:37], s[0:1], s16
    s_add_u32 s16, s16, 8
    s_load_dwordx2 s[40:41], s[0:1], s16
    s_mov_b32 s38, 3670016
    s_mov_b32 s39, 0x00020000
    s_mov_b32 s42, 3670016
    s_mov_b32 s43, 0x00020000
    s_lshl_b32 s23, s17, 9
    v_lshrrev_b32 v7, 5, v0
    v_and_b32 v6, 31, v0
    v_xor_b32 v5, v6, v7
    v_lshlrev_b32 v5, 4, v5
    v_lshl_add_u32 v5, v7, 13, v5
    v_lshlrev_b32 v6, 4, v6
    v_lshl_add_u32 v6, v7, 13, v6
    v_xor_b32 v7, v2, v3
    v_lshlrev_b32 v7, 4, v7
    s_lshr_b32 s24, s3, 1
    s_lshl_b32 s24, s24, 14
    s_and_b32 s25, s3, 1
    s_lshl_b32 s25, s25, 9
    s_add_u32 s24, s24, s25
    v_xor_b32 v8, 0, v7
    v_lshl_add_u32 v12, v3, 10, v8
    v_add_u32 v12, s24, v12
    v_lshl_add_u32 v8, v3, 9, v8
    v_xor_b32 v9, 64, v7
    v_lshl_add_u32 v13, v3, 10, v9
    v_add_u32 v13, s24, v13
    v_lshl_add_u32 v9, v3, 9, v9
    v_xor_b32 v10, 128, v7
    v_lshl_add_u32 v14, v3, 10, v10
    v_add_u32 v14, s24, v14
    v_lshl_add_u32 v10, v3, 9, v10
    v_xor_b32 v11, 192, v7
    v_lshl_add_u32 v15, v3, 10, v11
    v_add_u32 v15, s24, v15
    v_lshl_add_u32 v11, v3, 9, v11
    s_lshl_b32 s24, s3, 13
    s_lshl_b32 s34, s33, 4
    s_add_u32 s34, s34, s17
    s_lshl_b32 s34, s34, 10
    s_lshl_b32 s16, s19, 2
    s_add_u32 s16, s16, s3
    s_lshl_b32 s16, s16, 2
    s_add_u32 s34, s34, s16
    s_add_u32 s34, s34, 74055680
    s_mul_i32 s32, s17, 401408
    s_lshl_b32 s16, s19, 11
    s_add_u32 s32, s32, s16
    s_waitcnt lgkmcnt(0)
    s_lshl_b32 s25, s19, 19
    s_lshl_b32 s26, s3, 17
    s_add_u32 s25, s25, s26
    s_add_u32 s25, s25, s23
    s_mov_b32 m0, s24
    v_xor_b32 v1, 0, v5
    buffer_load_dwordx4 v1, s[36:39], s25 offen lds
    s_add_u32 s25, s25, 16384
    s_add_u32 m0, m0, 1024
    v_xor_b32 v1, 32, v5
    buffer_load_dwordx4 v1, s[36:39], s25 offen lds
    s_add_u32 s25, s25, 16384
    s_add_u32 m0, m0, 1024
    v_xor_b32 v1, 64, v5
    buffer_load_dwordx4 v1, s[36:39], s25 offen lds
    s_add_u32 s25, s25, 16384
    s_add_u32 m0, m0, 1024
    v_xor_b32 v1, 96, v5
    buffer_load_dwordx4 v1, s[36:39], s25 offen lds
    s_add_u32 s25, s25, 16384
    s_add_u32 m0, m0, 1024
    v_xor_b32 v1, 128, v5
    buffer_load_dwordx4 v1, s[36:39], s25 offen lds
    s_add_u32 s25, s25, 16384
    s_add_u32 m0, m0, 1024
    v_xor_b32 v1, 160, v5
    buffer_load_dwordx4 v1, s[36:39], s25 offen lds
    s_add_u32 s25, s25, 16384
    s_add_u32 m0, m0, 1024
    v_xor_b32 v1, 192, v5
    buffer_load_dwordx4 v1, s[36:39], s25 offen lds
    s_add_u32 s25, s25, 16384
    s_add_u32 m0, m0, 1024
    v_xor_b32 v1, 224, v5
    buffer_load_dwordx4 v1, s[36:39], s25 offen lds
    s_add_u32 s25, s25, 16384
    s_add_u32 m0, m0, 1024
    s_cmp_lg_u32 s33, 0
    s_cbranch_scc1 k1_N
    s_mov_b32 s48, 0
    s_mov_b32 s49, 1
    s_mov_b32 s50, 2
    s_mov_b32 s51, 3
    s_mov_b32 s52, 4
    s_mov_b32 s53, 5
    s_mov_b32 s54, 6
    s_mov_b32 s30, 0x3db8aa3b
    s_mov_b32 s31, 0x3db8aa3b
    s_add_u32 s32, s32, 5505024
    s_mul_i32 s16, s3, 14336
    s_add_u32 s32, s32, s16
    s_lshl_b32 s27, s3, 17
    s_add_u32 s27, s27, s23
    s_lshl_b32 s28, s3, 7
    s_and_b32 s28, s28, 0xff
    v_xor_b32 v6, s28, v6
    s_add_u32 s26, s24, 32768
    s_mov_b32 m0, s26
    s_lshl_b32 s25, s48, 19
    s_add_u32 s25, s25, s27
    v_xor_b32 v1, 0, v6
    buffer_load_dwordx4 v1, s[40:43], s25 offen lds
    s_add_u32 s25, s25, 16384
    s_add_u32 m0, m0, 1024
    v_xor_b32 v1, 16, v6
    buffer_load_dwordx4 v1, s[40:43], s25 offen lds
    s_add_u32 s25, s25, 16384
    s_add_u32 m0, m0, 1024
    v_xor_b32 v1, 32, v6
    buffer_load_dwordx4 v1, s[40:43], s25 offen lds
    s_add_u32 s25, s25, 16384
    s_add_u32 m0, m0, 1024
    v_xor_b32 v1, 48, v6
    buffer_load_dwordx4 v1, s[40:43], s25 offen lds
    s_add_u32 s25, s25, 16384
    s_add_u32 m0, m0, 1024
    v_xor_b32 v1, 64, v6
    buffer_load_dwordx4 v1, s[40:43], s25 offen lds
    s_add_u32 s25, s25, 16384
    s_add_u32 m0, m0, 1024
    v_xor_b32 v1, 80, v6
    buffer_load_dwordx4 v1, s[40:43], s25 offen lds
    s_add_u32 s25, s25, 16384
    s_add_u32 m0, m0, 1024
    v_xor_b32 v1, 96, v6
    buffer_load_dwordx4 v1, s[40:43], s25 offen lds
    s_add_u32 s25, s25, 16384
    s_add_u32 m0, m0, 1024
    v_xor_b32 v1, 112, v6
    buffer_load_dwordx4 v1, s[40:43], s25 offen lds
    s_add_u32 s25, s25, 16384
    s_add_u32 m0, m0, 1024
    s_add_u32 s26, s24, 65536
    s_mov_b32 m0, s26
    s_lshl_b32 s25, s49, 19
    s_add_u32 s25, s25, s27
    v_xor_b32 v1, 0, v6
    buffer_load_dwordx4 v1, s[40:43], s25 offen lds
    s_add_u32 s25, s25, 16384
    s_add_u32 m0, m0, 1024
    v_xor_b32 v1, 16, v6
    buffer_load_dwordx4 v1, s[40:43], s25 offen lds
    s_add_u32 s25, s25, 16384
    s_add_u32 m0, m0, 1024
    v_xor_b32 v1, 32, v6
    buffer_load_dwordx4 v1, s[40:43], s25 offen lds
    s_add_u32 s25, s25, 16384
    s_add_u32 m0, m0, 1024
    v_xor_b32 v1, 48, v6
    buffer_load_dwordx4 v1, s[40:43], s25 offen lds
    s_add_u32 s25, s25, 16384
    s_add_u32 m0, m0, 1024
    v_xor_b32 v1, 64, v6
    buffer_load_dwordx4 v1, s[40:43], s25 offen lds
    s_add_u32 s25, s25, 16384
    s_add_u32 m0, m0, 1024
    v_xor_b32 v1, 80, v6
    buffer_load_dwordx4 v1, s[40:43], s25 offen lds
    s_add_u32 s25, s25, 16384
    s_add_u32 m0, m0, 1024
    v_xor_b32 v1, 96, v6
    buffer_load_dwordx4 v1, s[40:43], s25 offen lds
    s_add_u32 s25, s25, 16384
    s_add_u32 m0, m0, 1024
    v_xor_b32 v1, 112, v6
    buffer_load_dwordx4 v1, s[40:43], s25 offen lds
    s_add_u32 s25, s25, 16384
    s_add_u32 m0, m0, 1024
    v_mov_b32 v128, 1
    v_mov_b32 v129, 0
    v_mov_b32 v136, -1
    v_mov_b32 v137, -1
    v_mov_b32 v138, -1
    v_mov_b32 v139, -1
    s_lshl_b32 s16, s3, 10
    v_lshlrev_b32 v140, 4, v0
    v_add_u32 v140, s16, v140
    s_mov_b32 s29, s17
    s_lshl_b32 s17, s96, 12
    s_add_u32 s17, s17, 73777152
k1_fillam:
    s_cmp_ge_u32 s17, 73957376
    s_cbranch_scc1 k1_filleam
    buffer_store_dwordx4 v[136:139], v140, s[4:7], s17 offen sc1
    s_add_u32 s17, s17, 917504
    s_branch k1_fillam
k1_filleam:
    s_lshl_b32 s17, s96, 12
    s_add_u32 s17, s17, 62234624
k1_fillbm:
    s_cmp_ge_u32 s17, 62750720
    s_cbranch_scc1 k1_fillebm
    buffer_store_dwordx4 v[136:139], v140, s[4:7], s17 offen sc1
    s_add_u32 s17, s17, 917504
    s_branch k1_fillbm
k1_fillebm:
    s_lshl_b32 s17, s96, 12
    s_add_u32 s17, s17, 62758912
k1_filldm:
    s_cmp_ge_u32 s17, 63275008
    s_cbranch_scc1 k1_filledm
    buffer_store_dwordx4 v[136:139], v140, s[4:7], s17 offen sc1
    s_add_u32 s17, s17, 917504
    s_branch k1_filldm
k1_filledm:
    s_mov_b32 s17, s29
    s_waitcnt vmcnt(16)
    s_barrier
    ds_read_b128 a[0:3], v8 offset:0
    ds_read_b128 a[4:7], v9 offset:0
    ds_read_b128 a[8:11], v10 offset:0
    ds_read_b128 a[12:15], v11 offset:0
    ds_read_b128 a[16:19], v8 offset:256
    ds_read_b128 a[20:23], v9 offset:256
    ds_read_b128 a[24:27], v10 offset:256
    ds_read_b128 a[28:31], v11 offset:256
    ds_read_b128 a[32:35], v8 offset:8192
    ds_read_b128 a[36:39], v9 offset:8192
    ds_read_b128 a[40:43], v10 offset:8192
    ds_read_b128 a[44:47], v11 offset:8192
    ds_read_b128 a[48:51], v8 offset:8448
    ds_read_b128 a[52:55], v9 offset:8448
    ds_read_b128 a[56:59], v10 offset:8448
    ds_read_b128 a[60:63], v11 offset:8448
    ds_read_b128 a[64:67], v8 offset:16384
    ds_read_b128 a[68:71], v9 offset:16384
    ds_read_b128 a[72:75], v10 offset:16384
    ds_read_b128 a[76:79], v11 offset:16384
    ds_read_b128 a[80:83], v8 offset:16640
    ds_read_b128 a[84:87], v9 offset:16640
    ds_read_b128 a[88:91], v10 offset:16640
    ds_read_b128 a[92:95], v11 offset:16640
    ds_read_b128 a[96:99], v8 offset:24576
    ds_read_b128 a[100:103], v9 offset:24576
    ds_read_b128 a[104:107], v10 offset:24576
    ds_read_b128 a[108:111], v11 offset:24576
    ds_read_b128 a[112:115], v8 offset:24832
    ds_read_b128 a[116:119], v9 offset:24832
    ds_read_b128 a[120:123], v10 offset:24832
    ds_read_b128 a[124:127], v11 offset:24832
    s_waitcnt vmcnt(8)
    s_barrier
    v_add_u32 v130, 32768, v12
    v_add_u32 v131, 32768, v13
    v_add_u32 v132, 32768, v14
    v_add_u32 v133, 32768, v15
    ds_read_b128 v[48:51], v130 offset:0
    ds_read_b128 v[52:55], v131 offset:0
    ds_read_b128 v[56:59], v132 offset:0
    ds_read_b128 v[60:63], v133 offset:0
    ds_read_b128 v[64:67], v130 offset:256
    ds_read_b128 v[68:71], v131 offset:256
    ds_read_b128 v[72:75], v132 offset:256
    ds_read_b128 v[76:79], v133 offset:256
    s_add_u32 s26, s24, 98304
    s_mov_b32 m0, s26
    s_lshl_b32 s25, s50, 19
    s_add_u32 s25, s25, s27
    v_xor_b32 v1, 0, v6
    buffer_load_dwordx4 v1, s[40:43], s25 offen lds
    s_add_u32 s25, s25, 16384
    s_add_u32 m0, m0, 1024
    v_xor_b32 v1, 16, v6
    buffer_load_dwordx4 v1, s[40:43], s25 offen lds
    s_add_u32 s25, s25, 16384
    s_add_u32 m0, m0, 1024
    v_xor_b32 v1, 32, v6
    buffer_load_dwordx4 v1, s[40:43], s25 offen lds
    s_add_u32 s25, s25, 16384
    s_add_u32 m0, m0, 1024
    v_xor_b32 v1, 48, v6
    buffer_load_dwordx4 v1, s[40:43], s25 offen lds
    s_add_u32 s25, s25, 16384
    s_add_u32 m0, m0, 1024
    v_xor_b32 v1, 64, v6
    buffer_load_dwordx4 v1, s[40:43], s25 offen lds
    s_add_u32 s25, s25, 16384
    s_add_u32 m0, m0, 1024
    v_xor_b32 v1, 80, v6
    buffer_load_dwordx4 v1, s[40:43], s25 offen lds
    s_add_u32 s25, s25, 16384
    s_add_u32 m0, m0, 1024
    v_xor_b32 v1, 96, v6
    buffer_load_dwordx4 v1, s[40:43], s25 offen lds
    s_add_u32 s25, s25, 16384
    s_add_u32 m0, m0, 1024
    v_xor_b32 v1, 112, v6
    buffer_load_dwordx4 v1, s[40:43], s25 offen lds
    s_add_u32 s25, s25, 16384
    s_add_u32 m0, m0, 1024
    s_waitcnt lgkmcnt(7)
    v_mfma_f32_16x16x32_bf16 v[16:19], a[0:3], v[48:51], 0
    v_mfma_f32_16x16x32_bf16 v[20:23], a[32:35], v[48:51], 0
    v_mfma_f32_16x16x32_bf16 v[24:27], a[64:67], v[48:51], 0
    v_mfma_f32_16x16x32_bf16 v[28:31], a[96:99], v[48:51], 0
    s_waitcnt lgkmcnt(6)
    v_mfma_f32_16x16x32_bf16 v[16:19], a[4:7], v[52:55], v[16:19]
    v_mfma_f32_16x16x32_bf16 v[20:23], a[36:39], v[52:55], v[20:23]
    v_mfma_f32_16x16x32_bf16 v[24:27], a[68:71], v[52:55], v[24:27]
    v_mfma_f32_16x16x32_bf16 v[28:31], a[100:103], v[52:55], v[28:31]
    s_waitcnt lgkmcnt(5)
    v_mfma_f32_16x16x32_bf16 v[16:19], a[8:11], v[56:59], v[16:19]
    v_mfma_f32_16x16x32_bf16 v[20:23], a[40:43], v[56:59], v[20:23]
    v_mfma_f32_16x16x32_bf16 v[24:27], a[72:75], v[56:59], v[24:27]
    v_mfma_f32_16x16x32_bf16 v[28:31], a[104:107], v[56:59], v[28:31]
    s_waitcnt lgkmcnt(4)
    v_mfma_f32_16x16x32_bf16 v[16:19], a[12:15], v[60:63], v[16:19]
    v_mfma_f32_16x16x32_bf16 v[20:23], a[44:47], v[60:63], v[20:23]
    v_mfma_f32_16x16x32_bf16 v[24:27], a[76:79], v[60:63], v[24:27]
    v_mfma_f32_16x16x32_bf16 v[28:31], a[108:111], v[60:63], v[28:31]
    s_waitcnt lgkmcnt(3)
    v_mfma_f32_16x16x32_bf16 v[16:19], a[16:19], v[64:67], v[16:19]
    v_mfma_f32_16x16x32_bf16 v[20:23], a[48:51], v[64:67], v[20:23]
    v_mfma_f32_16x16x32_bf16 v[24:27], a[80:83], v[64:67], v[24:27]
    v_mfma_f32_16x16x32_bf16 v[28:31], a[112:115], v[64:67], v[28:31]
    s_waitcnt lgkmcnt(2)
    v_mfma_f32_16x16x32_bf16 v[16:19], a[20:23], v[68:71], v[16:19]
    v_mfma_f32_16x16x32_bf16 v[20:23], a[52:55], v[68:71], v[20:23]
    v_mfma_f32_16x16x32_bf16 v[24:27], a[84:87], v[68:71], v[24:27]
    v_mfma_f32_16x16x32_bf16 v[28:31], a[116:119], v[68:71], v[28:31]
    s_waitcnt lgkmcnt(1)
    v_mfma_f32_16x16x32_bf16 v[16:19], a[24:27], v[72:75], v[16:19]
    v_mfma_f32_16x16x32_bf16 v[20:23], a[56:59], v[72:75], v[20:23]
    v_mfma_f32_16x16x32_bf16 v[24:27], a[88:91], v[72:75], v[24:27]
    v_mfma_f32_16x16x32_bf16 v[28:31], a[120:123], v[72:75], v[28:31]
    s_waitcnt lgkmcnt(0)
    v_mfma_f32_16x16x32_bf16 v[16:19], a[28:31], v[76:79], v[16:19]
    v_mfma_f32_16x16x32_bf16 v[20:23], a[60:63], v[76:79], v[20:23]
    v_mfma_f32_16x16x32_bf16 v[24:27], a[92:95], v[76:79], v[24:27]
    v_mfma_f32_16x16x32_bf16 v[28:31], a[124:127], v[76:79], v[28:31]
    s_mul_i32 s28, s48, 57344
    s_add_u32 s28, s28, s32
    s_nop 6
    v_pk_mul_f32 v[16:17], v[16:17], s[30:31]
    v_pk_mul_f32 v[18:19], v[18:19], s[30:31]
    v_cvt_pk_bf16_f32 v112, v16, v17
    v_cvt_pk_bf16_f32 v113, v18, v19
    v_pk_mul_f32 v[20:21], v[20:21], s[30:31]
    v_pk_mul_f32 v[22:23], v[22:23], s[30:31]
    v_cvt_pk_bf16_f32 v114, v20, v21
    v_cvt_pk_bf16_f32 v115, v22, v23
    buffer_store_dwordx4 v[112:115], v4, s[4:7], s28 offen offset:0 sc1
    v_pk_mul_f32 v[24:25], v[24:25], s[30:31]
    v_pk_mul_f32 v[26:27], v[26:27], s[30:31]
    v_cvt_pk_bf16_f32 v116, v24, v25
    v_cvt_pk_bf16_f32 v117, v26, v27
    v_pk_mul_f32 v[28:29], v[28:29], s[30:31]
    v_pk_mul_f32 v[30:31], v[30:31], s[30:31]
    v_cvt_pk_bf16_f32 v118, v28, v29
    v_cvt_pk_bf16_f32 v119, v30, v31
    buffer_store_dwordx4 v[116:119], v4, s[4:7], s28 offen offset:1024 sc1
    s_waitcnt vmcnt(10)
    s_barrier
    v_add_u32 v130, 65536, v12
    v_add_u32 v131, 65536, v13
    v_add_u32 v132, 65536, v14
    v_add_u32 v133, 65536, v15
    ds_read_b128 v[80:83], v130 offset:0
    ds_read_b128 v[84:87], v131 offset:0
    ds_read_b128 v[88:91], v132 offset:0
    ds_read_b128 v[92:95], v133 offset:0
    ds_read_b128 v[96:99], v130 offset:256
    ds_read_b128 v[100:103], v131 offset:256
    ds_read_b128 v[104:107], v132 offset:256
    ds_read_b128 v[108:111], v133 offset:256
    s_add_u32 s26, s24, 131072
    s_mov_b32 m0, s26
    s_lshl_b32 s25, s51, 19
    s_add_u32 s25, s25, s27
    v_xor_b32 v1, 0, v6
    buffer_load_dwordx4 v1, s[40:43], s25 offen lds
    s_add_u32 s25, s25, 16384
    s_add_u32 m0, m0, 1024
    v_xor_b32 v1, 16, v6
    buffer_load_dwordx4 v1, s[40:43], s25 offen lds
    s_add_u32 s25, s25, 16384
    s_add_u32 m0, m0, 1024
    v_xor_b32 v1, 32, v6
    buffer_load_dwordx4 v1, s[40:43], s25 offen lds
    s_add_u32 s25, s25, 16384
    s_add_u32 m0, m0, 1024
    v_xor_b32 v1, 48, v6
    buffer_load_dwordx4 v1, s[40:43], s25 offen lds
    s_add_u32 s25, s25, 16384
    s_add_u32 m0, m0, 1024
    v_xor_b32 v1, 64, v6
    buffer_load_dwordx4 v1, s[40:43], s25 offen lds
    s_add_u32 s25, s25, 16384
    s_add_u32 m0, m0, 1024
    v_xor_b32 v1, 80, v6
    buffer_load_dwordx4 v1, s[40:43], s25 offen lds
    s_add_u32 s25, s25, 16384
    s_add_u32 m0, m0, 1024
    v_xor_b32 v1, 96, v6
    buffer_load_dwordx4 v1, s[40:43], s25 offen lds
    s_add_u32 s25, s25, 16384
    s_add_u32 m0, m0, 1024
    v_xor_b32 v1, 112, v6
    buffer_load_dwordx4 v1, s[40:43], s25 offen lds
    s_add_u32 s25, s25, 16384
    s_add_u32 m0, m0, 1024
    s_waitcnt lgkmcnt(7)
    v_mfma_f32_16x16x32_bf16 v[32:35], a[0:3], v[80:83], 0
    v_mfma_f32_16x16x32_bf16 v[36:39], a[32:35], v[80:83], 0
    v_mfma_f32_16x16x32_bf16 v[40:43], a[64:67], v[80:83], 0
    v_mfma_f32_16x16x32_bf16 v[44:47], a[96:99], v[80:83], 0
    s_waitcnt lgkmcnt(6)
    v_mfma_f32_16x16x32_bf16 v[32:35], a[4:7], v[84:87], v[32:35]
    v_mfma_f32_16x16x32_bf16 v[36:39], a[36:39], v[84:87], v[36:39]
    v_mfma_f32_16x16x32_bf16 v[40:43], a[68:71], v[84:87], v[40:43]
    v_mfma_f32_16x16x32_bf16 v[44:47], a[100:103], v[84:87], v[44:47]
    s_waitcnt lgkmcnt(5)
    v_mfma_f32_16x16x32_bf16 v[32:35], a[8:11], v[88:91], v[32:35]
    v_mfma_f32_16x16x32_bf16 v[36:39], a[40:43], v[88:91], v[36:39]
    v_mfma_f32_16x16x32_bf16 v[40:43], a[72:75], v[88:91], v[40:43]
    v_mfma_f32_16x16x32_bf16 v[44:47], a[104:107], v[88:91], v[44:47]
    s_waitcnt lgkmcnt(4)
    v_mfma_f32_16x16x32_bf16 v[32:35], a[12:15], v[92:95], v[32:35]
    v_mfma_f32_16x16x32_bf16 v[36:39], a[44:47], v[92:95], v[36:39]
    v_mfma_f32_16x16x32_bf16 v[40:43], a[76:79], v[92:95], v[40:43]
    v_mfma_f32_16x16x32_bf16 v[44:47], a[108:111], v[92:95], v[44:47]
    s_waitcnt lgkmcnt(3)
    v_mfma_f32_16x16x32_bf16 v[32:35], a[16:19], v[96:99], v[32:35]
    v_mfma_f32_16x16x32_bf16 v[36:39], a[48:51], v[96:99], v[36:39]
    v_mfma_f32_16x16x32_bf16 v[40:43], a[80:83], v[96:99], v[40:43]
    v_mfma_f32_16x16x32_bf16 v[44:47], a[112:115], v[96:99], v[44:47]
    s_waitcnt lgkmcnt(2)
    v_mfma_f32_16x16x32_bf16 v[32:35], a[20:23], v[100:103], v[32:35]
    v_mfma_f32_16x16x32_bf16 v[36:39], a[52:55], v[100:103], v[36:39]
    v_mfma_f32_16x16x32_bf16 v[40:43], a[84:87], v[100:103], v[40:43]
    v_mfma_f32_16x16x32_bf16 v[44:47], a[116:119], v[100:103], v[44:47]
    s_waitcnt lgkmcnt(1)
    v_mfma_f32_16x16x32_bf16 v[32:35], a[24:27], v[104:107], v[32:35]
    v_mfma_f32_16x16x32_bf16 v[36:39], a[56:59], v[104:107], v[36:39]
    v_mfma_f32_16x16x32_bf16 v[40:43], a[88:91], v[104:107], v[40:43]
    v_mfma_f32_16x16x32_bf16 v[44:47], a[120:123], v[104:107], v[44:47]
    s_waitcnt lgkmcnt(0)
    v_mfma_f32_16x16x32_bf16 v[32:35], a[28:31], v[108:111], v[32:35]
    v_mfma_f32_16x16x32_bf16 v[36:39], a[60:63], v[108:111], v[36:39]
    v_mfma_f32_16x16x32_bf16 v[40:43], a[92:95], v[108:111], v[40:43]
    v_mfma_f32_16x16x32_bf16 v[44:47], a[124:127], v[108:111], v[44:47]
    s_mul_i32 s28, s49, 57344
    s_add_u32 s28, s28, s32
    s_nop 6
    v_pk_mul_f32 v[32:33], v[32:33], s[30:31]
    v_pk_mul_f32 v[34:35], v[34:35], s[30:31]
    v_cvt_pk_bf16_f32 v120, v32, v33
    v_cvt_pk_bf16_f32 v121, v34, v35
    v_pk_mul_f32 v[36:37], v[36:37], s[30:31]
    v_pk_mul_f32 v[38:39], v[38:39], s[30:31]
    v_cvt_pk_bf16_f32 v122, v36, v37
    v_cvt_pk_bf16_f32 v123, v38, v39
    buffer_store_dwordx4 v[120:123], v4, s[4:7], s28 offen offset:0 sc1
    v_pk_mul_f32 v[40:41], v[40:41], s[30:31]
    v_pk_mul_f32 v[42:43], v[42:43], s[30:31]
    v_cvt_pk_bf16_f32 v124, v40, v41
    v_cvt_pk_bf16_f32 v125, v42, v43
    v_pk_mul_f32 v[44:45], v[44:45], s[30:31]
    v_pk_mul_f32 v[46:47], v[46:47], s[30:31]
    v_cvt_pk_bf16_f32 v126, v44, v45
    v_cvt_pk_bf16_f32 v127, v46, v47
    buffer_store_dwordx4 v[124:127], v4, s[4:7], s28 offen offset:1024 sc1
    s_waitcnt vmcnt(12)
    s_waitcnt vmcnt(10)
    v_and_b32 v5, 31, v0
    v_lshlrev_b32 v5, 2, v5
    s_mov_b32 s35, 400000
ww_137:
    buffer_load_dword v1, v5, s[44:47], 0 offen sc1
    s_waitcnt vmcnt(0)
    v_cmp_eq_u32 vcc, 0, v1
    s_cbranch_vccz wwo_138
    s_sleep 4
    s_sub_u32 s35, s35, 1
    s_cmp_lg_u32 s35, 0
    s_cbranch_scc1 ww_137
    s_branch k2_end
wwo_138:
    s_lshl_b32 s16, s96, 2
    s_add_u32 s16, s16, s3
    s_lshl_b32 s16, s16, 2
    s_add_u32 s16, s16, 73977856
    s_mov_b64 exec, 1
    buffer_store_dword v128, v129, s[4:7], s16 offen sc1
    s_mov_b64 exec, -1
    s_lshl_b32 s16, s48, 7
    s_add_u32 s16, s16, s34
    s_mov_b64 exec, 1
    buffer_store_dword v128, v129, s[4:7], s16 offen sc1
    s_mov_b64 exec, -1
    s_barrier
    v_add_u32 v130, 98304, v12
    v_add_u32 v131, 98304, v13
    v_add_u32 v132, 98304, v14
    v_add_u32 v133, 98304, v15
    ds_read_b128 v[48:51], v130 offset:0
    ds_read_b128 v[52:55], v131 offset:0
    ds_read_b128 v[56:59], v132 offset:0
    ds_read_b128 v[60:63], v133 offset:0
    ds_read_b128 v[64:67], v130 offset:256
    ds_read_b128 v[68:71], v131 offset:256
    ds_read_b128 v[72:75], v132 offset:256
    ds_read_b128 v[76:79], v133 offset:256
    s_add_u32 s26, s24, 32768
    s_mov_b32 m0, s26
    s_lshl_b32 s25, s52, 19
    s_add_u32 s25, s25, s27
    v_xor_b32 v1, 0, v6
    buffer_load_dwordx4 v1, s[40:43], s25 offen lds
    s_add_u32 s25, s25, 16384
    s_add_u32 m0, m0, 1024
    v_xor_b32 v1, 16, v6
    buffer_load_dwordx4 v1, s[40:43], s25 offen lds
    s_add_u32 s25, s25, 16384
    s_add_u32 m0, m0, 1024
    v_xor_b32 v1, 32, v6
    buffer_load_dwordx4 v1, s[40:43], s25 offen lds
    s_add_u32 s25, s25, 16384
    s_add_u32 m0, m0, 1024
    v_xor_b32 v1, 48, v6
    buffer_load_dwordx4 v1, s[40:43], s25 offen lds
    s_add_u32 s25, s25, 16384
    s_add_u32 m0, m0, 1024
    v_xor_b32 v1, 64, v6
    buffer_load_dwordx4 v1, s[40:43], s25 offen lds
    s_add_u32 s25, s25, 16384
    s_add_u32 m0, m0, 1024
    v_xor_b32 v1, 80, v6
    buffer_load_dwordx4 v1, s[40:43], s25 offen lds
    s_add_u32 s25, s25, 16384
    s_add_u32 m0, m0, 1024
    v_xor_b32 v1, 96, v6
    buffer_load_dwordx4 v1, s[40:43], s25 offen lds
    s_add_u32 s25, s25, 16384
    s_add_u32 m0, m0, 1024
    v_xor_b32 v1, 112, v6
    buffer_load_dwordx4 v1, s[40:43], s25 offen lds
    s_add_u32 s25, s25, 16384
    s_add_u32 m0, m0, 1024
    s_waitcnt lgkmcnt(7)
    v_mfma_f32_16x16x32_bf16 v[16:19], a[0:3], v[48:51], 0
    v_mfma_f32_16x16x32_bf16 v[20:23], a[32:35], v[48:51], 0
    v_mfma_f32_16x16x32_bf16 v[24:27], a[64:67], v[48:51], 0
    v_mfma_f32_16x16x32_bf16 v[28:31], a[96:99], v[48:51], 0
    s_waitcnt lgkmcnt(6)
    v_mfma_f32_16x16x32_bf16 v[16:19], a[4:7], v[52:55], v[16:19]
    v_mfma_f32_16x16x32_bf16 v[20:23], a[36:39], v[52:55], v[20:23]
    v_mfma_f32_16x16x32_bf16 v[24:27], a[68:71], v[52:55], v[24:27]
    v_mfma_f32_16x16x32_bf16 v[28:31], a[100:103], v[52:55], v[28:31]
    s_waitcnt lgkmcnt(5)
    v_mfma_f32_16x16x32_bf16 v[16:19], a[8:11], v[56:59], v[16:19]
    v_mfma_f32_16x16x32_bf16 v[20:23], a[40:43], v[56:59], v[20:23]
    v_mfma_f32_16x16x32_bf16 v[24:27], a[72:75], v[56:59], v[24:27]
    v_mfma_f32_16x16x32_bf16 v[28:31], a[104:107], v[56:59], v[28:31]
    s_waitcnt lgkmcnt(4)
    v_mfma_f32_16x16x32_bf16 v[16:19], a[12:15], v[60:63], v[16:19]
    v_mfma_f32_16x16x32_bf16 v[20:23], a[44:47], v[60:63], v[20:23]
    v_mfma_f32_16x16x32_bf16 v[24:27], a[76:79], v[60:63], v[24:27]
    v_mfma_f32_16x16x32_bf16 v[28:31], a[108:111], v[60:63], v[28:31]
    s_waitcnt lgkmcnt(3)
    v_mfma_f32_16x16x32_bf16 v[16:19], a[16:19], v[64:67], v[16:19]
    v_mfma_f32_16x16x32_bf16 v[20:23], a[48:51], v[64:67], v[20:23]
    v_mfma_f32_16x16x32_bf16 v[24:27], a[80:83], v[64:67], v[24:27]
    v_mfma_f32_16x16x32_bf16 v[28:31], a[112:115], v[64:67], v[28:31]
    s_waitcnt lgkmcnt(2)
    v_mfma_f32_16x16x32_bf16 v[16:19], a[20:23], v[68:71], v[16:19]
    v_mfma_f32_16x16x32_bf16 v[20:23], a[52:55], v[68:71], v[20:23]
    v_mfma_f32_16x16x32_bf16 v[24:27], a[84:87], v[68:71], v[24:27]
    v_mfma_f32_16x16x32_bf16 v[28:31], a[116:119], v[68:71], v[28:31]
    s_waitcnt lgkmcnt(1)
    v_mfma_f32_16x16x32_bf16 v[16:19], a[24:27], v[72:75], v[16:19]
    v_mfma_f32_16x16x32_bf16 v[20:23], a[56:59], v[72:75], v[20:23]
    v_mfma_f32_16x16x32_bf16 v[24:27], a[88:91], v[72:75], v[24:27]
    v_mfma_f32_16x16x32_bf16 v[28:31], a[120:123], v[72:75], v[28:31]
    s_waitcnt lgkmcnt(0)
    v_mfma_f32_16x16x32_bf16 v[16:19], a[28:31], v[76:79], v[16:19]
    v_mfma_f32_16x16x32_bf16 v[20:23], a[60:63], v[76:79], v[20:23]
    v_mfma_f32_16x16x32_bf16 v[24:27], a[92:95], v[76:79], v[24:27]
    v_mfma_f32_16x16x32_bf16 v[28:31], a[124:127], v[76:79], v[28:31]
    s_mul_i32 s28, s50, 57344
    s_add_u32 s28, s28, s32
    s_nop 6
    v_pk_mul_f32 v[16:17], v[16:17], s[30:31]
    v_pk_mul_f32 v[18:19], v[18:19], s[30:31]
    v_cvt_pk_bf16_f32 v112, v16, v17
    v_cvt_pk_bf16_f32 v113, v18, v19
    v_pk_mul_f32 v[20:21], v[20:21], s[30:31]
    v_pk_mul_f32 v[22:23], v[22:23], s[30:31]
    v_cvt_pk_bf16_f32 v114, v20, v21
    v_cvt_pk_bf16_f32 v115, v22, v23
    buffer_store_dwordx4 v[112:115], v4, s[4:7], s28 offen offset:0 sc1
    v_pk_mul_f32 v[24:25], v[24:25], s[30:31]
    v_pk_mul_f32 v[26:27], v[26:27], s[30:31]
    v_cvt_pk_bf16_f32 v116, v24, v25
    v_cvt_pk_bf16_f32 v117, v26, v27
    v_pk_mul_f32 v[28:29], v[28:29], s[30:31]
    v_pk_mul_f32 v[30:31], v[30:31], s[30:31]
    v_cvt_pk_bf16_f32 v118, v28, v29
    v_cvt_pk_bf16_f32 v119, v30, v31
    buffer_store_dwordx4 v[116:119], v4, s[4:7], s28 offen offset:1024 sc1
    s_lshl_b32 s16, s49, 7
    s_add_u32 s16, s16, s34
    s_mov_b64 exec, 1
    buffer_store_dword v128, v129, s[4:7], s16 offen sc1
    s_mov_b64 exec, -1
    s_barrier
    v_add_u32 v130, 131072, v12
    v_add_u32 v131, 131072, v13
    v_add_u32 v132, 131072, v14
    v_add_u32 v133, 131072, v15
    ds_read_b128 v[80:83], v130 offset:0
    ds_read_b128 v[84:87], v131 offset:0
    ds_read_b128 v[88:91], v132 offset:0
    ds_read_b128 v[92:95], v133 offset:0
    ds_read_b128 v[96:99], v130 offset:256
    ds_read_b128 v[100:103], v131 offset:256
    ds_read_b128 v[104:107], v132 offset:256
    ds_read_b128 v[108:111], v133 offset:256
    s_add_u32 s26, s24, 65536
    s_mov_b32 m0, s26
    s_lshl_b32 s25, s53, 19
    s_add_u32 s25, s25, s27
    v_xor_b32 v1, 0, v6
    buffer_load_dwordx4 v1, s[40:43], s25 offen lds
    s_add_u32 s25, s25, 16384
    s_add_u32 m0, m0, 1024
    v_xor_b32 v1, 16, v6
    buffer_load_dwordx4 v1, s[40:43], s25 offen lds
    s_add_u32 s25, s25, 16384
    s_add_u32 m0, m0, 1024
    v_xor_b32 v1, 32, v6
    buffer_load_dwordx4 v1, s[40:43], s25 offen lds
    s_add_u32 s25, s25, 16384
    s_add_u32 m0, m0, 1024
    v_xor_b32 v1, 48, v6
    buffer_load_dwordx4 v1, s[40:43], s25 offen lds
    s_add_u32 s25, s25, 16384
    s_add_u32 m0, m0, 1024
    v_xor_b32 v1, 64, v6
    buffer_load_dwordx4 v1, s[40:43], s25 offen lds
    s_add_u32 s25, s25, 16384
    s_add_u32 m0, m0, 1024
    v_xor_b32 v1, 80, v6
    buffer_load_dwordx4 v1, s[40:43], s25 offen lds
    s_add_u32 s25, s25, 16384
    s_add_u32 m0, m0, 1024
    v_xor_b32 v1, 96, v6
    buffer_load_dwordx4 v1, s[40:43], s25 offen lds
    s_add_u32 s25, s25, 16384
    s_add_u32 m0, m0, 1024
    v_xor_b32 v1, 112, v6
    buffer_load_dwordx4 v1, s[40:43], s25 offen lds
    s_add_u32 s25, s25, 16384
    s_add_u32 m0, m0, 1024
    s_waitcnt lgkmcnt(7)
    v_mfma_f32_16x16x32_bf16 v[32:35], a[0:3], v[80:83], 0
    v_mfma_f32_16x16x32_bf16 v[36:39], a[32:35], v[80:83], 0
    v_mfma_f32_16x16x32_bf16 v[40:43], a[64:67], v[80:83], 0
    v_mfma_f32_16x16x32_bf16 v[44:47], a[96:99], v[80:83], 0
    s_waitcnt lgkmcnt(6)
    v_mfma_f32_16x16x32_bf16 v[32:35], a[4:7], v[84:87], v[32:35]
    v_mfma_f32_16x16x32_bf16 v[36:39], a[36:39], v[84:87], v[36:39]
    v_mfma_f32_16x16x32_bf16 v[40:43], a[68:71], v[84:87], v[40:43]
    v_mfma_f32_16x16x32_bf16 v[44:47], a[100:103], v[84:87], v[44:47]
    s_waitcnt lgkmcnt(5)
    v_mfma_f32_16x16x32_bf16 v[32:35], a[8:11], v[88:91], v[32:35]
    v_mfma_f32_16x16x32_bf16 v[36:39], a[40:43], v[88:91], v[36:39]
    v_mfma_f32_16x16x32_bf16 v[40:43], a[72:75], v[88:91], v[40:43]
    v_mfma_f32_16x16x32_bf16 v[44:47], a[104:107], v[88:91], v[44:47]
    s_waitcnt lgkmcnt(4)
    v_mfma_f32_16x16x32_bf16 v[32:35], a[12:15], v[92:95], v[32:35]
    v_mfma_f32_16x16x32_bf16 v[36:39], a[44:47], v[92:95], v[36:39]
    v_mfma_f32_16x16x32_bf16 v[40:43], a[76:79], v[92:95], v[40:43]
    v_mfma_f32_16x16x32_bf16 v[44:47], a[108:111], v[92:95], v[44:47]
    s_waitcnt lgkmcnt(3)
    v_mfma_f32_16x16x32_bf16 v[32:35], a[16:19], v[96:99], v[32:35]
    v_mfma_f32_16x16x32_bf16 v[36:39], a[48:51], v[96:99], v[36:39]
    v_mfma_f32_16x16x32_bf16 v[40:43], a[80:83], v[96:99], v[40:43]
    v_mfma_f32_16x16x32_bf16 v[44:47], a[112:115], v[96:99], v[44:47]
    s_waitcnt lgkmcnt(2)
    v_mfma_f32_16x16x32_bf16 v[32:35], a[20:23], v[100:103], v[32:35]
    v_mfma_f32_16x16x32_bf16 v[36:39], a[52:55], v[100:103], v[36:39]
    v_mfma_f32_16x16x32_bf16 v[40:43], a[84:87], v[100:103], v[40:43]
    v_mfma_f32_16x16x32_bf16 v[44:47], a[116:119], v[100:103], v[44:47]
    s_waitcnt lgkmcnt(1)
    v_mfma_f32_16x16x32_bf16 v[32:35], a[24:27], v[104:107], v[32:35]
    v_mfma_f32_16x16x32_bf16 v[36:39], a[56:59], v[104:107], v[36:39]
    v_mfma_f32_16x16x32_bf16 v[40:43], a[88:91], v[104:107], v[40:43]
    v_mfma_f32_16x16x32_bf16 v[44:47], a[120:123], v[104:107], v[44:47]
    s_waitcnt lgkmcnt(0)
    v_mfma_f32_16x16x32_bf16 v[32:35], a[28:31], v[108:111], v[32:35]
    v_mfma_f32_16x16x32_bf16 v[36:39], a[60:63], v[108:111], v[36:39]
    v_mfma_f32_16x16x32_bf16 v[40:43], a[92:95], v[108:111], v[40:43]
    v_mfma_f32_16x16x32_bf16 v[44:47], a[124:127], v[108:111], v[44:47]
    s_mul_i32 s28, s51, 57344
    s_add_u32 s28, s28, s32
    s_nop 6
    v_pk_mul_f32 v[32:33], v[32:33], s[30:31]
    v_pk_mul_f32 v[34:35], v[34:35], s[30:31]
    v_cvt_pk_bf16_f32 v120, v32, v33
    v_cvt_pk_bf16_f32 v121, v34, v35
    v_pk_mul_f32 v[36:37], v[36:37], s[30:31]
    v_pk_mul_f32 v[38:39], v[38:39], s[30:31]
    v_cvt_pk_bf16_f32 v122, v36, v37
    v_cvt_pk_bf16_f32 v123, v38, v39
    buffer_store_dwordx4 v[120:123], v4, s[4:7], s28 offen offset:0 sc1
    v_pk_mul_f32 v[40:41], v[40:41], s[30:31]
    v_pk_mul_f32 v[42:43], v[42:43], s[30:31]
    v_cvt_pk_bf16_f32 v124, v40, v41
    v_cvt_pk_bf16_f32 v125, v42, v43
    v_pk_mul_f32 v[44:45], v[44:45], s[30:31]
    v_pk_mul_f32 v[46:47], v[46:47], s[30:31]
    v_cvt_pk_bf16_f32 v126, v44, v45
    v_cvt_pk_bf16_f32 v127, v46, v47
    buffer_store_dwordx4 v[124:127], v4, s[4:7], s28 offen offset:1024 sc1
    s_waitcnt vmcnt(13)
    s_waitcnt vmcnt(11)
    s_lshl_b32 s16, s50, 7
    s_add_u32 s16, s16, s34
    s_mov_b64 exec, 1
    buffer_store_dword v128, v129, s[4:7], s16 offen sc1
    s_mov_b64 exec, -1
    s_barrier
    v_add_u32 v130, 32768, v12
    v_add_u32 v131, 32768, v13
    v_add_u32 v132, 32768, v14
    v_add_u32 v133, 32768, v15
    ds_read_b128 v[48:51], v130 offset:0
    ds_read_b128 v[52:55], v131 offset:0
    ds_read_b128 v[56:59], v132 offset:0
    ds_read_b128 v[60:63], v133 offset:0
    ds_read_b128 v[64:67], v130 offset:256
    ds_read_b128 v[68:71], v131 offset:256
    ds_read_b128 v[72:75], v132 offset:256
    ds_read_b128 v[76:79], v133 offset:256
    s_add_u32 s26, s24, 98304
    s_mov_b32 m0, s26
    s_lshl_b32 s25, s54, 19
    s_add_u32 s25, s25, s27
    v_xor_b32 v1, 0, v6
    buffer_load_dwordx4 v1, s[40:43], s25 offen lds
    s_add_u32 s25, s25, 16384
    s_add_u32 m0, m0, 1024
    v_xor_b32 v1, 16, v6
    buffer_load_dwordx4 v1, s[40:43], s25 offen lds
    s_add_u32 s25, s25, 16384
    s_add_u32 m0, m0, 1024
    v_xor_b32 v1, 32, v6
    buffer_load_dwordx4 v1, s[40:43], s25 offen lds
    s_add_u32 s25, s25, 16384
    s_add_u32 m0, m0, 1024
    v_xor_b32 v1, 48, v6
    buffer_load_dwordx4 v1, s[40:43], s25 offen lds
    s_add_u32 s25, s25, 16384
    s_add_u32 m0, m0, 1024
    v_xor_b32 v1, 64, v6
    buffer_load_dwordx4 v1, s[40:43], s25 offen lds
    s_add_u32 s25, s25, 16384
    s_add_u32 m0, m0, 1024
    v_xor_b32 v1, 80, v6
    buffer_load_dwordx4 v1, s[40:43], s25 offen lds
    s_add_u32 s25, s25, 16384
    s_add_u32 m0, m0, 1024
    v_xor_b32 v1, 96, v6
    buffer_load_dwordx4 v1, s[40:43], s25 offen lds
    s_add_u32 s25, s25, 16384
    s_add_u32 m0, m0, 1024
    v_xor_b32 v1, 112, v6
    buffer_load_dwordx4 v1, s[40:43], s25 offen lds
    s_add_u32 s25, s25, 16384
    s_add_u32 m0, m0, 1024
    s_waitcnt lgkmcnt(7)
    v_mfma_f32_16x16x32_bf16 v[16:19], a[0:3], v[48:51], 0
    v_mfma_f32_16x16x32_bf16 v[20:23], a[32:35], v[48:51], 0
    v_mfma_f32_16x16x32_bf16 v[24:27], a[64:67], v[48:51], 0
    v_mfma_f32_16x16x32_bf16 v[28:31], a[96:99], v[48:51], 0
    s_waitcnt lgkmcnt(6)
    v_mfma_f32_16x16x32_bf16 v[16:19], a[4:7], v[52:55], v[16:19]
    v_mfma_f32_16x16x32_bf16 v[20:23], a[36:39], v[52:55], v[20:23]
    v_mfma_f32_16x16x32_bf16 v[24:27], a[68:71], v[52:55], v[24:27]
    v_mfma_f32_16x16x32_bf16 v[28:31], a[100:103], v[52:55], v[28:31]
    s_waitcnt lgkmcnt(5)
    v_mfma_f32_16x16x32_bf16 v[16:19], a[8:11], v[56:59], v[16:19]
    v_mfma_f32_16x16x32_bf16 v[20:23], a[40:43], v[56:59], v[20:23]
    v_mfma_f32_16x16x32_bf16 v[24:27], a[72:75], v[56:59], v[24:27]
    v_mfma_f32_16x16x32_bf16 v[28:31], a[104:107], v[56:59], v[28:31]
    s_waitcnt lgkmcnt(4)
    v_mfma_f32_16x16x32_bf16 v[16:19], a[12:15], v[60:63], v[16:19]
    v_mfma_f32_16x16x32_bf16 v[20:23], a[44:47], v[60:63], v[20:23]
    v_mfma_f32_16x16x32_bf16 v[24:27], a[76:79], v[60:63], v[24:27]
    v_mfma_f32_16x16x32_bf16 v[28:31], a[108:111], v[60:63], v[28:31]
    s_waitcnt lgkmcnt(3)
    v_mfma_f32_16x16x32_bf16 v[16:19], a[16:19], v[64:67], v[16:19]
    v_mfma_f32_16x16x32_bf16 v[20:23], a[48:51], v[64:67], v[20:23]
    v_mfma_f32_16x16x32_bf16 v[24:27], a[80:83], v[64:67], v[24:27]
    v_mfma_f32_16x16x32_bf16 v[28:31], a[112:115], v[64:67], v[28:31]
    s_waitcnt lgkmcnt(2)
    v_mfma_f32_16x16x32_bf16 v[16:19], a[20:23], v[68:71], v[16:19]
    v_mfma_f32_16x16x32_bf16 v[20:23], a[52:55], v[68:71], v[20:23]
    v_mfma_f32_16x16x32_bf16 v[24:27], a[84:87], v[68:71], v[24:27]
    v_mfma_f32_16x16x32_bf16 v[28:31], a[116:119], v[68:71], v[28:31]
    s_waitcnt lgkmcnt(1)
    v_mfma_f32_16x16x32_bf16 v[16:19], a[24:27], v[72:75], v[16:19]
    v_mfma_f32_16x16x32_bf16 v[20:23], a[56:59], v[72:75], v[20:23]
    v_mfma_f32_16x16x32_bf16 v[24:27], a[88:91], v[72:75], v[24:27]
    v_mfma_f32_16x16x32_bf16 v[28:31], a[120:123], v[72:75], v[28:31]
    s_waitcnt lgkmcnt(0)
    v_mfma_f32_16x16x32_bf16 v[16:19], a[28:31], v[76:79], v[16:19]
    v_mfma_f32_16x16x32_bf16 v[20:23], a[60:63], v[76:79], v[20:23]
    v_mfma_f32_16x16x32_bf16 v[24:27], a[92:95], v[76:79], v[24:27]
    v_mfma_f32_16x16x32_bf16 v[28:31], a[124:127], v[76:79], v[28:31]
    s_mul_i32 s28, s52, 57344
    s_add_u32 s28, s28, s32
    s_nop 6
    v_pk_mul_f32 v[16:17], v[16:17], s[30:31]
    v_pk_mul_f32 v[18:19], v[18:19], s[30:31]
    v_cvt_pk_bf16_f32 v112, v16, v17
    v_cvt_pk_bf16_f32 v113, v18, v19
    v_pk_mul_f32 v[20:21], v[20:21], s[30:31]
    v_pk_mul_f32 v[22:23], v[22:23], s[30:31]
    v_cvt_pk_bf16_f32 v114, v20, v21
    v_cvt_pk_bf16_f32 v115, v22, v23
    buffer_store_dwordx4 v[112:115], v4, s[4:7], s28 offen offset:0 sc1
    v_pk_mul_f32 v[24:25], v[24:25], s[30:31]
    v_pk_mul_f32 v[26:27], v[26:27], s[30:31]
    v_cvt_pk_bf16_f32 v116, v24, v25
    v_cvt_pk_bf16_f32 v117, v26, v27
    v_pk_mul_f32 v[28:29], v[28:29], s[30:31]
    v_pk_mul_f32 v[30:31], v[30:31], s[30:31]
    v_cvt_pk_bf16_f32 v118, v28, v29
    v_cvt_pk_bf16_f32 v119, v30, v31
    buffer_store_dwordx4 v[116:119], v4, s[4:7], s28 offen offset:1024 sc1
    s_waitcnt vmcnt(13)
    s_waitcnt vmcnt(11)
    s_lshl_b32 s16, s51, 7
    s_add_u32 s16, s16, s34
    s_mov_b64 exec, 1
    buffer_store_dword v128, v129, s[4:7], s16 offen sc1
    s_mov_b64 exec, -1
    s_barrier
    v_add_u32 v130, 65536, v12
    v_add_u32 v131, 65536, v13
    v_add_u32 v132, 65536, v14
    v_add_u32 v133, 65536, v15
    ds_read_b128 v[80:83], v130 offset:0
    ds_read_b128 v[84:87], v131 offset:0
    ds_read_b128 v[88:91], v132 offset:0
    ds_read_b128 v[92:95], v133 offset:0
    ds_read_b128 v[96:99], v130 offset:256
    ds_read_b128 v[100:103], v131 offset:256
    ds_read_b128 v[104:107], v132 offset:256
    ds_read_b128 v[108:111], v133 offset:256
    s_waitcnt lgkmcnt(7)
    v_mfma_f32_16x16x32_bf16 v[32:35], a[0:3], v[80:83], 0
    v_mfma_f32_16x16x32_bf16 v[36:39], a[32:35], v[80:83], 0
    v_mfma_f32_16x16x32_bf16 v[40:43], a[64:67], v[80:83], 0
    v_mfma_f32_16x16x32_bf16 v[44:47], a[96:99], v[80:83], 0
    s_waitcnt lgkmcnt(6)
    v_mfma_f32_16x16x32_bf16 v[32:35], a[4:7], v[84:87], v[32:35]
    v_mfma_f32_16x16x32_bf16 v[36:39], a[36:39], v[84:87], v[36:39]
    v_mfma_f32_16x16x32_bf16 v[40:43], a[68:71], v[84:87], v[40:43]
    v_mfma_f32_16x16x32_bf16 v[44:47], a[100:103], v[84:87], v[44:47]
    s_waitcnt lgkmcnt(5)
    v_mfma_f32_16x16x32_bf16 v[32:35], a[8:11], v[88:91], v[32:35]
    v_mfma_f32_16x16x32_bf16 v[36:39], a[40:43], v[88:91], v[36:39]
    v_mfma_f32_16x16x32_bf16 v[40:43], a[72:75], v[88:91], v[40:43]
    v_mfma_f32_16x16x32_bf16 v[44:47], a[104:107], v[88:91], v[44:47]
    s_waitcnt lgkmcnt(4)
    v_mfma_f32_16x16x32_bf16 v[32:35], a[12:15], v[92:95], v[32:35]
    v_mfma_f32_16x16x32_bf16 v[36:39], a[44:47], v[92:95], v[36:39]
    v_mfma_f32_16x16x32_bf16 v[40:43], a[76:79], v[92:95], v[40:43]
    v_mfma_f32_16x16x32_bf16 v[44:47], a[108:111], v[92:95], v[44:47]
    s_waitcnt lgkmcnt(3)
    v_mfma_f32_16x16x32_bf16 v[32:35], a[16:19], v[96:99], v[32:35]
    v_mfma_f32_16x16x32_bf16 v[36:39], a[48:51], v[96:99], v[36:39]
    v_mfma_f32_16x16x32_bf16 v[40:43], a[80:83], v[96:99], v[40:43]
    v_mfma_f32_16x16x32_bf16 v[44:47], a[112:115], v[96:99], v[44:47]
    s_waitcnt lgkmcnt(2)
    v_mfma_f32_16x16x32_bf16 v[32:35], a[20:23], v[100:103], v[32:35]
    v_mfma_f32_16x16x32_bf16 v[36:39], a[52:55], v[100:103], v[36:39]
    v_mfma_f32_16x16x32_bf16 v[40:43], a[84:87], v[100:103], v[40:43]
    v_mfma_f32_16x16x32_bf16 v[44:47], a[116:119], v[100:103], v[44:47]
    s_waitcnt lgkmcnt(1)
    v_mfma_f32_16x16x32_bf16 v[32:35], a[24:27], v[104:107], v[32:35]
    v_mfma_f32_16x16x32_bf16 v[36:39], a[56:59], v[104:107], v[36:39]
    v_mfma_f32_16x16x32_bf16 v[40:43], a[88:91], v[104:107], v[40:43]
    v_mfma_f32_16x16x32_bf16 v[44:47], a[120:123], v[104:107], v[44:47]
    s_waitcnt lgkmcnt(0)
    v_mfma_f32_16x16x32_bf16 v[32:35], a[28:31], v[108:111], v[32:35]
    v_mfma_f32_16x16x32_bf16 v[36:39], a[60:63], v[108:111], v[36:39]
    v_mfma_f32_16x16x32_bf16 v[40:43], a[92:95], v[108:111], v[40:43]
    v_mfma_f32_16x16x32_bf16 v[44:47], a[124:127], v[108:111], v[44:47]
    s_mul_i32 s28, s53, 57344
    s_add_u32 s28, s28, s32
    s_nop 6
    v_pk_mul_f32 v[32:33], v[32:33], s[30:31]
    v_pk_mul_f32 v[34:35], v[34:35], s[30:31]
    v_cvt_pk_bf16_f32 v120, v32, v33
    v_cvt_pk_bf16_f32 v121, v34, v35
    v_pk_mul_f32 v[36:37], v[36:37], s[30:31]
    v_pk_mul_f32 v[38:39], v[38:39], s[30:31]
    v_cvt_pk_bf16_f32 v122, v36, v37
    v_cvt_pk_bf16_f32 v123, v38, v39
    buffer_store_dwordx4 v[120:123], v4, s[4:7], s28 offen offset:0 sc1
    v_pk_mul_f32 v[40:41], v[40:41], s[30:31]
    v_pk_mul_f32 v[42:43], v[42:43], s[30:31]
    v_cvt_pk_bf16_f32 v124, v40, v41
    v_cvt_pk_bf16_f32 v125, v42, v43
    v_pk_mul_f32 v[44:45], v[44:45], s[30:31]
    v_pk_mul_f32 v[46:47], v[46:47], s[30:31]
    v_cvt_pk_bf16_f32 v126, v44, v45
    v_cvt_pk_bf16_f32 v127, v46, v47
    buffer_store_dwordx4 v[124:127], v4, s[4:7], s28 offen offset:1024 sc1
    s_waitcnt vmcnt(5)
    s_waitcnt vmcnt(3)
    s_lshl_b32 s16, s52, 7
    s_add_u32 s16, s16, s34
    s_mov_b64 exec, 1
    buffer_store_dword v128, v129, s[4:7], s16 offen sc1
    s_mov_b64 exec, -1
    s_barrier
    v_add_u32 v130, 98304, v12
    v_add_u32 v131, 98304, v13
    v_add_u32 v132, 98304, v14
    v_add_u32 v133, 98304, v15
    ds_read_b128 v[48:51], v130 offset:0
    ds_read_b128 v[52:55], v131 offset:0
    ds_read_b128 v[56:59], v132 offset:0
    ds_read_b128 v[60:63], v133 offset:0
    ds_read_b128 v[64:67], v130 offset:256
    ds_read_b128 v[68:71], v131 offset:256
    ds_read_b128 v[72:75], v132 offset:256
    ds_read_b128 v[76:79], v133 offset:256
    s_waitcnt lgkmcnt(7)
    v_mfma_f32_16x16x32_bf16 v[16:19], a[0:3], v[48:51], 0
    v_mfma_f32_16x16x32_bf16 v[20:23], a[32:35], v[48:51], 0
    v_mfma_f32_16x16x32_bf16 v[24:27], a[64:67], v[48:51], 0
    v_mfma_f32_16x16x32_bf16 v[28:31], a[96:99], v[48:51], 0
    s_waitcnt lgkmcnt(6)
    v_mfma_f32_16x16x32_bf16 v[16:19], a[4:7], v[52:55], v[16:19]
    v_mfma_f32_16x16x32_bf16 v[20:23], a[36:39], v[52:55], v[20:23]
    v_mfma_f32_16x16x32_bf16 v[24:27], a[68:71], v[52:55], v[24:27]
    v_mfma_f32_16x16x32_bf16 v[28:31], a[100:103], v[52:55], v[28:31]
    s_waitcnt lgkmcnt(5)
    v_mfma_f32_16x16x32_bf16 v[16:19], a[8:11], v[56:59], v[16:19]
    v_mfma_f32_16x16x32_bf16 v[20:23], a[40:43], v[56:59], v[20:23]
    v_mfma_f32_16x16x32_bf16 v[24:27], a[72:75], v[56:59], v[24:27]
    v_mfma_f32_16x16x32_bf16 v[28:31], a[104:107], v[56:59], v[28:31]
    s_waitcnt lgkmcnt(4)
    v_mfma_f32_16x16x32_bf16 v[16:19], a[12:15], v[60:63], v[16:19]
    v_mfma_f32_16x16x32_bf16 v[20:23], a[44:47], v[60:63], v[20:23]
    v_mfma_f32_16x16x32_bf16 v[24:27], a[76:79], v[60:63], v[24:27]
    v_mfma_f32_16x16x32_bf16 v[28:31], a[108:111], v[60:63], v[28:31]
    s_waitcnt lgkmcnt(3)
    v_mfma_f32_16x16x32_bf16 v[16:19], a[16:19], v[64:67], v[16:19]
    v_mfma_f32_16x16x32_bf16 v[20:23], a[48:51], v[64:67], v[20:23]
    v_mfma_f32_16x16x32_bf16 v[24:27], a[80:83], v[64:67], v[24:27]
    v_mfma_f32_16x16x32_bf16 v[28:31], a[112:115], v[64:67], v[28:31]
    s_waitcnt lgkmcnt(2)
    v_mfma_f32_16x16x32_bf16 v[16:19], a[20:23], v[68:71], v[16:19]
    v_mfma_f32_16x16x32_bf16 v[20:23], a[52:55], v[68:71], v[20:23]
    v_mfma_f32_16x16x32_bf16 v[24:27], a[84:87], v[68:71], v[24:27]
    v_mfma_f32_16x16x32_bf16 v[28:31], a[116:119], v[68:71], v[28:31]
    s_waitcnt lgkmcnt(1)
    v_mfma_f32_16x16x32_bf16 v[16:19], a[24:27], v[72:75], v[16:19]
    v_mfma_f32_16x16x32_bf16 v[20:23], a[56:59], v[72:75], v[20:23]
    v_mfma_f32_16x16x32_bf16 v[24:27], a[88:91], v[72:75], v[24:27]
    v_mfma_f32_16x16x32_bf16 v[28:31], a[120:123], v[72:75], v[28:31]
    s_waitcnt lgkmcnt(0)
    v_mfma_f32_16x16x32_bf16 v[16:19], a[28:31], v[76:79], v[16:19]
    v_mfma_f32_16x16x32_bf16 v[20:23], a[60:63], v[76:79], v[20:23]
    v_mfma_f32_16x16x32_bf16 v[24:27], a[92:95], v[76:79], v[24:27]
    v_mfma_f32_16x16x32_bf16 v[28:31], a[124:127], v[76:79], v[28:31]
    s_mul_i32 s28, s54, 57344
    s_add_u32 s28, s28, s32
    s_nop 6
    v_pk_mul_f32 v[16:17], v[16:17], s[30:31]
    v_pk_mul_f32 v[18:19], v[18:19], s[30:31]
    v_cvt_pk_bf16_f32 v112, v16, v17
    v_cvt_pk_bf16_f32 v113, v18, v19
    v_pk_mul_f32 v[20:21], v[20:21], s[30:31]
    v_pk_mul_f32 v[22:23], v[22:23], s[30:31]
    v_cvt_pk_bf16_f32 v114, v20, v21
    v_cvt_pk_bf16_f32 v115, v22, v23
    buffer_store_dwordx4 v[112:115], v4, s[4:7], s28 offen offset:0 sc1
    v_pk_mul_f32 v[24:25], v[24:25], s[30:31]
    v_pk_mul_f32 v[26:27], v[26:27], s[30:31]
    v_cvt_pk_bf16_f32 v116, v24, v25
    v_cvt_pk_bf16_f32 v117, v26, v27
    v_pk_mul_f32 v[28:29], v[28:29], s[30:31]
    v_pk_mul_f32 v[30:31], v[30:31], s[30:31]
    v_cvt_pk_bf16_f32 v118, v28, v29
    v_cvt_pk_bf16_f32 v119, v30, v31
    buffer_store_dwordx4 v[116:119], v4, s[4:7], s28 offen offset:1024 sc1
    s_waitcnt vmcnt(3)
    s_lshl_b32 s16, s53, 7
    s_add_u32 s16, s16, s34
    s_mov_b64 exec, 1
    buffer_store_dword v128, v129, s[4:7], s16 offen sc1
    s_mov_b64 exec, -1
    s_waitcnt vmcnt(1)
    s_lshl_b32 s16, s54, 7
    s_add_u32 s16, s16, s34
    s_mov_b64 exec, 1
    buffer_store_dword v128, v129, s[4:7], s16 offen sc1
    s_mov_b64 exec, -1
    s_branch k1_MNend
k1_N:
    s_lshr_b32 s16, s17, 2
    s_add_u32 s25, s16, 4
    s_bitcmp1_b32 s17, 1
    s_cselect_b32 s16, s16, s25
    s_cmp_eq_u32 s16, 7
    s_cselect_b32 s16, 0, s16
    s_add_u32 s48, s16, 0
    s_sub_u32 s25, s48, 7
    s_cmp_ge_u32 s48, 7
    s_cselect_b32 s48, s25, s48
    s_add_u32 s49, s16, 1
    s_sub_u32 s25, s49, 7
    s_cmp_ge_u32 s49, 7
    s_cselect_b32 s49, s25, s49
    s_add_u32 s50, s16, 2
    s_sub_u32 s25, s50, 7
    s_cmp_ge_u32 s50, 7
    s_cselect_b32 s50, s25, s50
    s_add_u32 s51, s16, 3
    s_sub_u32 s25, s51, 7
    s_cmp_ge_u32 s51, 7
    s_cselect_b32 s51, s25, s51
    s_add_u32 s52, s16, 4
    s_sub_u32 s25, s52, 7
    s_cmp_ge_u32 s52, 7
    s_cselect_b32 s52, s25, s52
    s_add_u32 s53, s16, 5
    s_sub_u32 s25, s53, 7
    s_cmp_ge_u32 s53, 7
    s_cselect_b32 s53, s25, s53
    s_add_u32 s54, s16, 6
    s_sub_u32 s25, s54, 7
    s_cmp_ge_u32 s54, 7
    s_cselect_b32 s54, s25, s54
    s_add_u32 s32, s32, 11927552
    s_lshr_b32 s16, s3, 1
    s_mul_i32 s16, s16, 28672
    s_add_u32 s32, s32, s16
    s_and_b32 s16, s3, 1
    s_lshl_b32 s16, s16, 7
    s_add_u32 s32, s32, s16
    v_and_b32 v4, 1, v3
    v_mul_u32_u24 v4, 14336, v4
    v_lshl_add_u32 v4, v2, 8, v4
    v_lshrrev_b32 v5, 1, v3
    v_lshl_add_u32 v4, v5, 4, v4
    v_lshrrev_b32 v6, 3, v0
    v_mul_u32_u24 v6, 896, v6
    v_and_b32 v5, 7, v0
    v_lshl_add_u32 v6, v5, 4, v6
    v_lshlrev_b32 v12, 10, v2
    v_lshrrev_b32 v5, 2, v3
    v_lshl_add_u32 v12, v5, 7, v12
    v_and_b32 v5, 3, v3
    v_lshl_add_u32 v12, v5, 3, v12
    s_lshl_b32 s16, s3, 5
    v_add_u32 v12, s16, v12
    s_mul_i32 s27, s17, 229376
    s_mul_i32 s16, s3, 57344
    s_add_u32 s27, s27, s16
    s_add_u32 s26, s24, 32768
    s_mov_b32 m0, s26
    s_lshl_b32 s25, s48, 7
    s_add_u32 s25, s25, s27
    buffer_load_dwordx4 v6, s[40:43], s25 offen lds
    s_add_u32 s25, s25, 7168
    s_add_u32 m0, m0, 1024
    s_nop 0
    buffer_load_dwordx4 v6, s[40:43], s25 offen lds
    s_add_u32 s25, s25, 7168
    s_add_u32 m0, m0, 1024
    s_nop 0
    buffer_load_dwordx4 v6, s[40:43], s25 offen lds
    s_add_u32 s25, s25, 7168
    s_add_u32 m0, m0, 1024
    s_nop 0
    buffer_load_dwordx4 v6, s[40:43], s25 offen lds
    s_add_u32 s25, s25, 7168
    s_add_u32 m0, m0, 1024
    s_nop 0
    buffer_load_dwordx4 v6, s[40:43], s25 offen lds
    s_add_u32 s25, s25, 7168
    s_add_u32 m0, m0, 1024
    s_nop 0
    buffer_load_dwordx4 v6, s[40:43], s25 offen lds
    s_add_u32 s25, s25, 7168
    s_add_u32 m0, m0, 1024
    s_nop 0
    buffer_load_dwordx4 v6, s[40:43], s25 offen lds
    s_add_u32 s25, s25, 7168
    s_add_u32 m0, m0, 1024
    s_nop 0
    buffer_load_dwordx4 v6, s[40:43], s25 offen lds
    s_add_u32 s25, s25, 7168
    s_add_u32 m0, m0, 1024
    s_nop 0
    s_add_u32 s26, s24, 65536
    s_mov_b32 m0, s26
    s_lshl_b32 s25, s49, 7
    s_add_u32 s25, s25, s27
    buffer_load_dwordx4 v6, s[40:43], s25 offen lds
    s_add_u32 s25, s25, 7168
    s_add_u32 m0, m0, 1024
    s_nop 0
    buffer_load_dwordx4 v6, s[40:43], s25 offen lds
    s_add_u32 s25, s25, 7168
    s_add_u32 m0, m0, 1024
    s_nop 0
    buffer_load_dwordx4 v6, s[40:43], s25 offen lds
    s_add_u32 s25, s25, 7168
    s_add_u32 m0, m0, 1024
    s_nop 0
    buffer_load_dwordx4 v6, s[40:43], s25 offen lds
    s_add_u32 s25, s25, 7168
    s_add_u32 m0, m0, 1024
    s_nop 0
    buffer_load_dwordx4 v6, s[40:43], s25 offen lds
    s_add_u32 s25, s25, 7168
    s_add_u32 m0, m0, 1024
    s_nop 0
    buffer_load_dwordx4 v6, s[40:43], s25 offen lds
    s_add_u32 s25, s25, 7168
    s_add_u32 m0, m0, 1024
    s_nop 0
    buffer_load_dwordx4 v6, s[40:43], s25 offen lds
    s_add_u32 s25, s25, 7168
    s_add_u32 m0, m0, 1024
    s_nop 0
    buffer_load_dwordx4 v6, s[40:43], s25 offen lds
    s_add_u32 s25, s25, 7168
    s_add_u32 m0, m0, 1024
    s_nop 0
    v_mov_b32 v128, 1
    v_mov_b32 v129, 0
    v_mov_b32 v136, -1
    v_mov_b32 v137, -1
    v_mov_b32 v138, -1
    v_mov_b32 v139, -1
    s_lshl_b32 s16, s3, 10
    v_lshlrev_b32 v140, 4, v0
    v_add_u32 v140, s16, v140
    s_mov_b32 s29, s17
    s_lshl_b32 s17, s96, 12
    s_add_u32 s17, s17, 73777152
k1_fillan:
    s_cmp_ge_u32 s17, 73957376
    s_cbranch_scc1 k1_fillean
    buffer_store_dwordx4 v[136:139], v140, s[4:7], s17 offen sc1
    s_add_u32 s17, s17, 917504
    s_branch k1_fillan
k1_fillean:
    s_lshl_b32 s17, s96, 12
    s_add_u32 s17, s17, 62234624
k1_fillbn:
    s_cmp_ge_u32 s17, 62750720
    s_cbranch_scc1 k1_fillebn
    buffer_store_dwordx4 v[136:139], v140, s[4:7], s17 offen sc1
    s_add_u32 s17, s17, 917504
    s_branch k1_fillbn
k1_fillebn:
    s_lshl_b32 s17, s96, 12
    s_add_u32 s17, s17, 62758912
k1_filldn:
    s_cmp_ge_u32 s17, 63275008
    s_cbranch_scc1 k1_filledn
    buffer_store_dwordx4 v[136:139], v140, s[4:7], s17 offen sc1
    s_add_u32 s17, s17, 917504
    s_branch k1_filldn
k1_filledn:
    s_mov_b32 s17, s29
    s_waitcnt vmcnt(16)
    s_barrier
    ds_read_b128 a[0:3], v8 offset:0
    ds_read_b128 a[4:7], v9 offset:0
    ds_read_b128 a[8:11], v10 offset:0
    ds_read_b128 a[12:15], v11 offset:0
    ds_read_b128 a[16:19], v8 offset:256
    ds_read_b128 a[20:23], v9 offset:256
    ds_read_b128 a[24:27], v10 offset:256
    ds_read_b128 a[28:31], v11 offset:256
    ds_read_b128 a[32:35], v8 offset:8192
    ds_read_b128 a[36:39], v9 offset:8192
    ds_read_b128 a[40:43], v10 offset:8192
    ds_read_b128 a[44:47], v11 offset:8192
    ds_read_b128 a[48:51], v8 offset:8448
    ds_read_b128 a[52:55], v9 offset:8448
    ds_read_b128 a[56:59], v10 offset:8448
    ds_read_b128 a[60:63], v11 offset:8448
    ds_read_b128 a[64:67], v8 offset:16384
    ds_read_b128 a[68:71], v9 offset:16384
    ds_read_b128 a[72:75], v10 offset:16384
    ds_read_b128 a[76:79], v11 offset:16384
    ds_read_b128 a[80:83], v8 offset:16640
    ds_read_b128 a[84:87], v9 offset:16640
    ds_read_b128 a[88:91], v10 offset:16640
    ds_read_b128 a[92:95], v11 offset:16640
    ds_read_b128 a[96:99], v8 offset:24576
    ds_read_b128 a[100:103], v9 offset:24576
    ds_read_b128 a[104:107], v10 offset:24576
    ds_read_b128 a[108:111], v11 offset:24576
    ds_read_b128 a[112:115], v8 offset:24832
    ds_read_b128 a[116:119], v9 offset:24832
    ds_read_b128 a[120:123], v10 offset:24832
    ds_read_b128 a[124:127], v11 offset:24832
    s_waitcnt vmcnt(8)
    s_barrier
    v_add_u32 v130, 32768, v12
    ds_read_b64_tr_b16 v[48:49], v130 offset:0
    ds_read_b64_tr_b16 v[50:51], v130 offset:512
    ds_read_b64_tr_b16 v[52:53], v130 offset:4096
    ds_read_b64_tr_b16 v[54:55], v130 offset:4608
    ds_read_b64_tr_b16 v[56:57], v130 offset:8192
    ds_read_b64_tr_b16 v[58:59], v130 offset:8704
    ds_read_b64_tr_b16 v[60:61], v130 offset:12288
    ds_read_b64_tr_b16 v[62:63], v130 offset:12800
    ds_read_b64_tr_b16 v[64:65], v130 offset:16384
    ds_read_b64_tr_b16 v[66:67], v130 offset:16896
    ds_read_b64_tr_b16 v[68:69], v130 offset:20480
    ds_read_b64_tr_b16 v[70:71], v130 offset:20992
    ds_read_b64_tr_b16 v[72:73], v130 offset:24576
    ds_read_b64_tr_b16 v[74:75], v130 offset:25088
    ds_read_b64_tr_b16 v[76:77], v130 offset:28672
    ds_read_b64_tr_b16 v[78:79], v130 offset:29184
    s_add_u32 s26, s24, 98304
    s_mov_b32 m0, s26
    s_lshl_b32 s25, s50, 7
    s_add_u32 s25, s25, s27
    buffer_load_dwordx4 v6, s[40:43], s25 offen lds
    s_add_u32 s25, s25, 7168
    s_add_u32 m0, m0, 1024
    s_nop 0
    buffer_load_dwordx4 v6, s[40:43], s25 offen lds
    s_add_u32 s25, s25, 7168
    s_add_u32 m0, m0, 1024
    s_nop 0
    buffer_load_dwordx4 v6, s[40:43], s25 offen lds
    s_add_u32 s25, s25, 7168
    s_add_u32 m0, m0, 1024
    s_nop 0
    buffer_load_dwordx4 v6, s[40:43], s25 offen lds
    s_add_u32 s25, s25, 7168
    s_add_u32 m0, m0, 1024
    s_nop 0
    buffer_load_dwordx4 v6, s[40:43], s25 offen lds
    s_add_u32 s25, s25, 7168
    s_add_u32 m0, m0, 1024
    s_nop 0
    buffer_load_dwordx4 v6, s[40:43], s25 offen lds
    s_add_u32 s25, s25, 7168
    s_add_u32 m0, m0, 1024
    s_nop 0
    buffer_load_dwordx4 v6, s[40:43], s25 offen lds
    s_add_u32 s25, s25, 7168
    s_add_u32 m0, m0, 1024
    s_nop 0
    buffer_load_dwordx4 v6, s[40:43], s25 offen lds
    s_add_u32 s25, s25, 7168
    s_add_u32 m0, m0, 1024
    s_nop 0
    s_waitcnt lgkmcnt(14)
    v_mfma_f32_16x16x32_bf16 v[16:19], a[0:3], v[48:51], 0
    v_mfma_f32_16x16x32_bf16 v[20:23], a[32:35], v[48:51], 0
    v_mfma_f32_16x16x32_bf16 v[24:27], a[64:67], v[48:51], 0
    v_mfma_f32_16x16x32_bf16 v[28:31], a[96:99], v[48:51], 0
    s_waitcnt lgkmcnt(12)
    v_mfma_f32_16x16x32_bf16 v[16:19], a[4:7], v[52:55], v[16:19]
    v_mfma_f32_16x16x32_bf16 v[20:23], a[36:39], v[52:55], v[20:23]
    v_mfma_f32_16x16x32_bf16 v[24:27], a[68:71], v[52:55], v[24:27]
    v_mfma_f32_16x16x32_bf16 v[28:31], a[100:103], v[52:55], v[28:31]
    s_waitcnt lgkmcnt(10)
    v_mfma_f32_16x16x32_bf16 v[16:19], a[8:11], v[56:59], v[16:19]
    v_mfma_f32_16x16x32_bf16 v[20:23], a[40:43], v[56:59], v[20:23]
    v_mfma_f32_16x16x32_bf16 v[24:27], a[72:75], v[56:59], v[24:27]
    v_mfma_f32_16x16x32_bf16 v[28:31], a[104:107], v[56:59], v[28:31]
    s_waitcnt lgkmcnt(8)
    v_mfma_f32_16x16x32_bf16 v[16:19], a[12:15], v[60:63], v[16:19]
    v_mfma_f32_16x16x32_bf16 v[20:23], a[44:47], v[60:63], v[20:23]
    v_mfma_f32_16x16x32_bf16 v[24:27], a[76:79], v[60:63], v[24:27]
    v_mfma_f32_16x16x32_bf16 v[28:31], a[108:111], v[60:63], v[28:31]
    s_waitcnt lgkmcnt(6)
    v_mfma_f32_16x16x32_bf16 v[16:19], a[16:19], v[64:67], v[16:19]
    v_mfma_f32_16x16x32_bf16 v[20:23], a[48:51], v[64:67], v[20:23]
    v_mfma_f32_16x16x32_bf16 v[24:27], a[80:83], v[64:67], v[24:27]
    v_mfma_f32_16x16x32_bf16 v[28:31], a[112:115], v[64:67], v[28:31]
    s_waitcnt lgkmcnt(4)
    v_mfma_f32_16x16x32_bf16 v[16:19], a[20:23], v[68:71], v[16:19]
    v_mfma_f32_16x16x32_bf16 v[20:23], a[52:55], v[68:71], v[20:23]
    v_mfma_f32_16x16x32_bf16 v[24:27], a[84:87], v[68:71], v[24:27]
    v_mfma_f32_16x16x32_bf16 v[28:31], a[116:119], v[68:71], v[28:31]
    s_waitcnt lgkmcnt(2)
    v_mfma_f32_16x16x32_bf16 v[16:19], a[24:27], v[72:75], v[16:19]
    v_mfma_f32_16x16x32_bf16 v[20:23], a[56:59], v[72:75], v[20:23]
    v_mfma_f32_16x16x32_bf16 v[24:27], a[88:91], v[72:75], v[24:27]
    v_mfma_f32_16x16x32_bf16 v[28:31], a[120:123], v[72:75], v[28:31]
    s_waitcnt lgkmcnt(0)
    v_mfma_f32_16x16x32_bf16 v[16:19], a[28:31], v[76:79], v[16:19]
    v_mfma_f32_16x16x32_bf16 v[20:23], a[60:63], v[76:79], v[20:23]
    v_mfma_f32_16x16x32_bf16 v[24:27], a[92:95], v[76:79], v[24:27]
    v_mfma_f32_16x16x32_bf16 v[28:31], a[124:127], v[76:79], v[28:31]
    s_mul_i32 s28, s48, 57344
    s_add_u32 s28, s28, s32
    s_nop 6
    v_cvt_pk_bf16_f32 v112, v16, v17
    v_cvt_pk_bf16_f32 v113, v18, v19
    v_cvt_pk_bf16_f32 v114, v20, v21
    v_cvt_pk_bf16_f32 v115, v22, v23
    buffer_store_dwordx4 v[112:115], v4, s[4:7], s28 offen offset:0 sc1
    v_cvt_pk_bf16_f32 v116, v24, v25
    v_cvt_pk_bf16_f32 v117, v26, v27
    v_cvt_pk_bf16_f32 v118, v28, v29
    v_cvt_pk_bf16_f32 v119, v30, v31
    buffer_store_dwordx4 v[116:119], v4, s[4:7], s28 offen offset:1024 sc1
    s_waitcnt vmcnt(10)
    s_barrier
    v_add_u32 v130, 65536, v12
    ds_read_b64_tr_b16 v[80:81], v130 offset:0
    ds_read_b64_tr_b16 v[82:83], v130 offset:512
    ds_read_b64_tr_b16 v[84:85], v130 offset:4096
    ds_read_b64_tr_b16 v[86:87], v130 offset:4608
    ds_read_b64_tr_b16 v[88:89], v130 offset:8192
    ds_read_b64_tr_b16 v[90:91], v130 offset:8704
    ds_read_b64_tr_b16 v[92:93], v130 offset:12288
    ds_read_b64_tr_b16 v[94:95], v130 offset:12800
    ds_read_b64_tr_b16 v[96:97], v130 offset:16384
    ds_read_b64_tr_b16 v[98:99], v130 offset:16896
    ds_read_b64_tr_b16 v[100:101], v130 offset:20480
    ds_read_b64_tr_b16 v[102:103], v130 offset:20992
    ds_read_b64_tr_b16 v[104:105], v130 offset:24576
    ds_read_b64_tr_b16 v[106:107], v130 offset:25088
    ds_read_b64_tr_b16 v[108:109], v130 offset:28672
    ds_read_b64_tr_b16 v[110:111], v130 offset:29184
    s_add_u32 s26, s24, 131072
    s_mov_b32 m0, s26
    s_lshl_b32 s25, s51, 7
    s_add_u32 s25, s25, s27
    buffer_load_dwordx4 v6, s[40:43], s25 offen lds
    s_add_u32 s25, s25, 7168
    s_add_u32 m0, m0, 1024
    s_nop 0
    buffer_load_dwordx4 v6, s[40:43], s25 offen lds
    s_add_u32 s25, s25, 7168
    s_add_u32 m0, m0, 1024
    s_nop 0
    buffer_load_dwordx4 v6, s[40:43], s25 offen lds
    s_add_u32 s25, s25, 7168
    s_add_u32 m0, m0, 1024
    s_nop 0
    buffer_load_dwordx4 v6, s[40:43], s25 offen lds
    s_add_u32 s25, s25, 7168
    s_add_u32 m0, m0, 1024
    s_nop 0
    buffer_load_dwordx4 v6, s[40:43], s25 offen lds
    s_add_u32 s25, s25, 7168
    s_add_u32 m0, m0, 1024
    s_nop 0
    buffer_load_dwordx4 v6, s[40:43], s25 offen lds
    s_add_u32 s25, s25, 7168
    s_add_u32 m0, m0, 1024
    s_nop 0
    buffer_load_dwordx4 v6, s[40:43], s25 offen lds
    s_add_u32 s25, s25, 7168
    s_add_u32 m0, m0, 1024
    s_nop 0
    buffer_load_dwordx4 v6, s[40:43], s25 offen lds
    s_add_u32 s25, s25, 7168
    s_add_u32 m0, m0, 1024
    s_nop 0
    s_waitcnt lgkmcnt(14)
    v_mfma_f32_16x16x32_bf16 v[32:35], a[0:3], v[80:83], 0
    v_mfma_f32_16x16x32_bf16 v[36:39], a[32:35], v[80:83], 0
    v_mfma_f32_16x16x32_bf16 v[40:43], a[64:67], v[80:83], 0
    v_mfma_f32_16x16x32_bf16 v[44:47], a[96:99], v[80:83], 0
    s_waitcnt lgkmcnt(12)
    v_mfma_f32_16x16x32_bf16 v[32:35], a[4:7], v[84:87], v[32:35]
    v_mfma_f32_16x16x32_bf16 v[36:39], a[36:39], v[84:87], v[36:39]
    v_mfma_f32_16x16x32_bf16 v[40:43], a[68:71], v[84:87], v[40:43]
    v_mfma_f32_16x16x32_bf16 v[44:47], a[100:103], v[84:87], v[44:47]
    s_waitcnt lgkmcnt(10)
    v_mfma_f32_16x16x32_bf16 v[32:35], a[8:11], v[88:91], v[32:35]
    v_mfma_f32_16x16x32_bf16 v[36:39], a[40:43], v[88:91], v[36:39]
    v_mfma_f32_16x16x32_bf16 v[40:43], a[72:75], v[88:91], v[40:43]
    v_mfma_f32_16x16x32_bf16 v[44:47], a[104:107], v[88:91], v[44:47]
    s_waitcnt lgkmcnt(8)
    v_mfma_f32_16x16x32_bf16 v[32:35], a[12:15], v[92:95], v[32:35]
    v_mfma_f32_16x16x32_bf16 v[36:39], a[44:47], v[92:95], v[36:39]
    v_mfma_f32_16x16x32_bf16 v[40:43], a[76:79], v[92:95], v[40:43]
    v_mfma_f32_16x16x32_bf16 v[44:47], a[108:111], v[92:95], v[44:47]
    s_waitcnt lgkmcnt(6)
    v_mfma_f32_16x16x32_bf16 v[32:35], a[16:19], v[96:99], v[32:35]
    v_mfma_f32_16x16x32_bf16 v[36:39], a[48:51], v[96:99], v[36:39]
    v_mfma_f32_16x16x32_bf16 v[40:43], a[80:83], v[96:99], v[40:43]
    v_mfma_f32_16x16x32_bf16 v[44:47], a[112:115], v[96:99], v[44:47]
    s_waitcnt lgkmcnt(4)
    v_mfma_f32_16x16x32_bf16 v[32:35], a[20:23], v[100:103], v[32:35]
    v_mfma_f32_16x16x32_bf16 v[36:39], a[52:55], v[100:103], v[36:39]
    v_mfma_f32_16x16x32_bf16 v[40:43], a[84:87], v[100:103], v[40:43]
    v_mfma_f32_16x16x32_bf16 v[44:47], a[116:119], v[100:103], v[44:47]
    s_waitcnt lgkmcnt(2)
    v_mfma_f32_16x16x32_bf16 v[32:35], a[24:27], v[104:107], v[32:35]
    v_mfma_f32_16x16x32_bf16 v[36:39], a[56:59], v[104:107], v[36:39]
    v_mfma_f32_16x16x32_bf16 v[40:43], a[88:91], v[104:107], v[40:43]
    v_mfma_f32_16x16x32_bf16 v[44:47], a[120:123], v[104:107], v[44:47]
    s_waitcnt lgkmcnt(0)
    v_mfma_f32_16x16x32_bf16 v[32:35], a[28:31], v[108:111], v[32:35]
    v_mfma_f32_16x16x32_bf16 v[36:39], a[60:63], v[108:111], v[36:39]
    v_mfma_f32_16x16x32_bf16 v[40:43], a[92:95], v[108:111], v[40:43]
    v_mfma_f32_16x16x32_bf16 v[44:47], a[124:127], v[108:111], v[44:47]
    s_mul_i32 s28, s49, 57344
    s_add_u32 s28, s28, s32
    s_nop 6
    v_cvt_pk_bf16_f32 v120, v32, v33
    v_cvt_pk_bf16_f32 v121, v34, v35
    v_cvt_pk_bf16_f32 v122, v36, v37
    v_cvt_pk_bf16_f32 v123, v38, v39
    buffer_store_dwordx4 v[120:123], v4, s[4:7], s28 offen offset:0 sc1
    v_cvt_pk_bf16_f32 v124, v40, v41
    v_cvt_pk_bf16_f32 v125, v42, v43
    v_cvt_pk_bf16_f32 v126, v44, v45
    v_cvt_pk_bf16_f32 v127, v46, v47
    buffer_store_dwordx4 v[124:127], v4, s[4:7], s28 offen offset:1024 sc1
    s_waitcnt vmcnt(12)
    s_waitcnt vmcnt(10)
    v_and_b32 v5, 31, v0
    v_lshlrev_b32 v5, 2, v5
    s_mov_b32 s35, 400000
ww_139:
    buffer_load_dword v1, v5, s[44:47], 0 offen sc1
    s_waitcnt vmcnt(0)
    v_cmp_eq_u32 vcc, 0, v1
    s_cbranch_vccz wwo_140
    s_sleep 4
    s_sub_u32 s35, s35, 1
    s_cmp_lg_u32 s35, 0
    s_cbranch_scc1 ww_139
    s_branch k2_end
wwo_140:
    s_lshl_b32 s16, s96, 2
    s_add_u32 s16, s16, s3
    s_lshl_b32 s16, s16, 2
    s_add_u32 s16, s16, 73977856
    s_mov_b64 exec, 1
    buffer_store_dword v128, v129, s[4:7], s16 offen sc1
    s_mov_b64 exec, -1
    s_lshl_b32 s16, s48, 7
    s_add_u32 s16, s16, s34
    s_mov_b64 exec, 1
    buffer_store_dword v128, v129, s[4:7], s16 offen sc1
    s_mov_b64 exec, -1
    s_barrier
    v_add_u32 v130, 98304, v12
    ds_read_b64_tr_b16 v[48:49], v130 offset:0
    ds_read_b64_tr_b16 v[50:51], v130 offset:512
    ds_read_b64_tr_b16 v[52:53], v130 offset:4096
    ds_read_b64_tr_b16 v[54:55], v130 offset:4608
    ds_read_b64_tr_b16 v[56:57], v130 offset:8192
    ds_read_b64_tr_b16 v[58:59], v130 offset:8704
    ds_read_b64_tr_b16 v[60:61], v130 offset:12288
    ds_read_b64_tr_b16 v[62:63], v130 offset:12800
    ds_read_b64_tr_b16 v[64:65], v130 offset:16384
    ds_read_b64_tr_b16 v[66:67], v130 offset:16896
    ds_read_b64_tr_b16 v[68:69], v130 offset:20480
    ds_read_b64_tr_b16 v[70:71], v130 offset:20992
    ds_read_b64_tr_b16 v[72:73], v130 offset:24576
    ds_read_b64_tr_b16 v[74:75], v130 offset:25088
    ds_read_b64_tr_b16 v[76:77], v130 offset:28672
    ds_read_b64_tr_b16 v[78:79], v130 offset:29184
    s_add_u32 s26, s24, 32768
    s_mov_b32 m0, s26
    s_lshl_b32 s25, s52, 7
    s_add_u32 s25, s25, s27
    buffer_load_dwordx4 v6, s[40:43], s25 offen lds
    s_add_u32 s25, s25, 7168
    s_add_u32 m0, m0, 1024
    s_nop 0
    buffer_load_dwordx4 v6, s[40:43], s25 offen lds
    s_add_u32 s25, s25, 7168
    s_add_u32 m0, m0, 1024
    s_nop 0
    buffer_load_dwordx4 v6, s[40:43], s25 offen lds
    s_add_u32 s25, s25, 7168
    s_add_u32 m0, m0, 1024
    s_nop 0
    buffer_load_dwordx4 v6, s[40:43], s25 offen lds
    s_add_u32 s25, s25, 7168
    s_add_u32 m0, m0, 1024
    s_nop 0
    buffer_load_dwordx4 v6, s[40:43], s25 offen lds
    s_add_u32 s25, s25, 7168
    s_add_u32 m0, m0, 1024
    s_nop 0
    buffer_load_dwordx4 v6, s[40:43], s25 offen lds
    s_add_u32 s25, s25, 7168
    s_add_u32 m0, m0, 1024
    s_nop 0
    buffer_load_dwordx4 v6, s[40:43], s25 offen lds
    s_add_u32 s25, s25, 7168
    s_add_u32 m0, m0, 1024
    s_nop 0
    buffer_load_dwordx4 v6, s[40:43], s25 offen lds
    s_add_u32 s25, s25, 7168
    s_add_u32 m0, m0, 1024
    s_nop 0
    s_waitcnt lgkmcnt(14)
    v_mfma_f32_16x16x32_bf16 v[16:19], a[0:3], v[48:51], 0
    v_mfma_f32_16x16x32_bf16 v[20:23], a[32:35], v[48:51], 0
    v_mfma_f32_16x16x32_bf16 v[24:27], a[64:67], v[48:51], 0
    v_mfma_f32_16x16x32_bf16 v[28:31], a[96:99], v[48:51], 0
    s_waitcnt lgkmcnt(12)
    v_mfma_f32_16x16x32_bf16 v[16:19], a[4:7], v[52:55], v[16:19]
    v_mfma_f32_16x16x32_bf16 v[20:23], a[36:39], v[52:55], v[20:23]
    v_mfma_f32_16x16x32_bf16 v[24:27], a[68:71], v[52:55], v[24:27]
    v_mfma_f32_16x16x32_bf16 v[28:31], a[100:103], v[52:55], v[28:31]
    s_waitcnt lgkmcnt(10)
    v_mfma_f32_16x16x32_bf16 v[16:19], a[8:11], v[56:59], v[16:19]
    v_mfma_f32_16x16x32_bf16 v[20:23], a[40:43], v[56:59], v[20:23]
    v_mfma_f32_16x16x32_bf16 v[24:27], a[72:75], v[56:59], v[24:27]
    v_mfma_f32_16x16x32_bf16 v[28:31], a[104:107], v[56:59], v[28:31]
    s_waitcnt lgkmcnt(8)
    v_mfma_f32_16x16x32_bf16 v[16:19], a[12:15], v[60:63], v[16:19]
    v_mfma_f32_16x16x32_bf16 v[20:23], a[44:47], v[60:63], v[20:23]
    v_mfma_f32_16x16x32_bf16 v[24:27], a[76:79], v[60:63], v[24:27]
    v_mfma_f32_16x16x32_bf16 v[28:31], a[108:111], v[60:63], v[28:31]
    s_waitcnt lgkmcnt(6)
    v_mfma_f32_16x16x32_bf16 v[16:19], a[16:19], v[64:67], v[16:19]
    v_mfma_f32_16x16x32_bf16 v[20:23], a[48:51], v[64:67], v[20:23]
    v_mfma_f32_16x16x32_bf16 v[24:27], a[80:83], v[64:67], v[24:27]
    v_mfma_f32_16x16x32_bf16 v[28:31], a[112:115], v[64:67], v[28:31]
    s_waitcnt lgkmcnt(4)
    v_mfma_f32_16x16x32_bf16 v[16:19], a[20:23], v[68:71], v[16:19]
    v_mfma_f32_16x16x32_bf16 v[20:23], a[52:55], v[68:71], v[20:23]
    v_mfma_f32_16x16x32_bf16 v[24:27], a[84:87], v[68:71], v[24:27]
    v_mfma_f32_16x16x32_bf16 v[28:31], a[116:119], v[68:71], v[28:31]
    s_waitcnt lgkmcnt(2)
    v_mfma_f32_16x16x32_bf16 v[16:19], a[24:27], v[72:75], v[16:19]
    v_mfma_f32_16x16x32_bf16 v[20:23], a[56:59], v[72:75], v[20:23]
    v_mfma_f32_16x16x32_bf16 v[24:27], a[88:91], v[72:75], v[24:27]
    v_mfma_f32_16x16x32_bf16 v[28:31], a[120:123], v[72:75], v[28:31]
    s_waitcnt lgkmcnt(0)
    v_mfma_f32_16x16x32_bf16 v[16:19], a[28:31], v[76:79], v[16:19]
    v_mfma_f32_16x16x32_bf16 v[20:23], a[60:63], v[76:79], v[20:23]
    v_mfma_f32_16x16x32_bf16 v[24:27], a[92:95], v[76:79], v[24:27]
    v_mfma_f32_16x16x32_bf16 v[28:31], a[124:127], v[76:79], v[28:31]
    s_mul_i32 s28, s50, 57344
    s_add_u32 s28, s28, s32
    s_nop 6
    v_cvt_pk_bf16_f32 v112, v16, v17
    v_cvt_pk_bf16_f32 v113, v18, v19
    v_cvt_pk_bf16_f32 v114, v20, v21
    v_cvt_pk_bf16_f32 v115, v22, v23
    buffer_store_dwordx4 v[112:115], v4, s[4:7], s28 offen offset:0 sc1
    v_cvt_pk_bf16_f32 v116, v24, v25
    v_cvt_pk_bf16_f32 v117, v26, v27
    v_cvt_pk_bf16_f32 v118, v28, v29
    v_cvt_pk_bf16_f32 v119, v30, v31
    buffer_store_dwordx4 v[116:119], v4, s[4:7], s28 offen offset:1024 sc1
    s_lshl_b32 s16, s49, 7
    s_add_u32 s16, s16, s34
    s_mov_b64 exec, 1
    buffer_store_dword v128, v129, s[4:7], s16 offen sc1
    s_mov_b64 exec, -1
    s_barrier
    v_add_u32 v130, 131072, v12
    ds_read_b64_tr_b16 v[80:81], v130 offset:0
    ds_read_b64_tr_b16 v[82:83], v130 offset:512
    ds_read_b64_tr_b16 v[84:85], v130 offset:4096
    ds_read_b64_tr_b16 v[86:87], v130 offset:4608
    ds_read_b64_tr_b16 v[88:89], v130 offset:8192
    ds_read_b64_tr_b16 v[90:91], v130 offset:8704
    ds_read_b64_tr_b16 v[92:93], v130 offset:12288
    ds_read_b64_tr_b16 v[94:95], v130 offset:12800
    ds_read_b64_tr_b16 v[96:97], v130 offset:16384
    ds_read_b64_tr_b16 v[98:99], v130 offset:16896
    ds_read_b64_tr_b16 v[100:101], v130 offset:20480
    ds_read_b64_tr_b16 v[102:103], v130 offset:20992
    ds_read_b64_tr_b16 v[104:105], v130 offset:24576
    ds_read_b64_tr_b16 v[106:107], v130 offset:25088
    ds_read_b64_tr_b16 v[108:109], v130 offset:28672
    ds_read_b64_tr_b16 v[110:111], v130 offset:29184
    s_add_u32 s26, s24, 65536
    s_mov_b32 m0, s26
    s_lshl_b32 s25, s53, 7
    s_add_u32 s25, s25, s27
    buffer_load_dwordx4 v6, s[40:43], s25 offen lds
    s_add_u32 s25, s25, 7168
    s_add_u32 m0, m0, 1024
    s_nop 0
    buffer_load_dwordx4 v6, s[40:43], s25 offen lds
    s_add_u32 s25, s25, 7168
    s_add_u32 m0, m0, 1024
    s_nop 0
    buffer_load_dwordx4 v6, s[40:43], s25 offen lds
    s_add_u32 s25, s25, 7168
    s_add_u32 m0, m0, 1024
    s_nop 0
    buffer_load_dwordx4 v6, s[40:43], s25 offen lds
    s_add_u32 s25, s25, 7168
    s_add_u32 m0, m0, 1024
    s_nop 0
    buffer_load_dwordx4 v6, s[40:43], s25 offen lds
    s_add_u32 s25, s25, 7168
    s_add_u32 m0, m0, 1024
    s_nop 0
    buffer_load_dwordx4 v6, s[40:43], s25 offen lds
    s_add_u32 s25, s25, 7168
    s_add_u32 m0, m0, 1024
    s_nop 0
    buffer_load_dwordx4 v6, s[40:43], s25 offen lds
    s_add_u32 s25, s25, 7168
    s_add_u32 m0, m0, 1024
    s_nop 0
    buffer_load_dwordx4 v6, s[40:43], s25 offen lds
    s_add_u32 s25, s25, 7168
    s_add_u32 m0, m0, 1024
    s_nop 0
    s_waitcnt lgkmcnt(14)
    v_mfma_f32_16x16x32_bf16 v[32:35], a[0:3], v[80:83], 0
    v_mfma_f32_16x16x32_bf16 v[36:39], a[32:35], v[80:83], 0
    v_mfma_f32_16x16x32_bf16 v[40:43], a[64:67], v[80:83], 0
    v_mfma_f32_16x16x32_bf16 v[44:47], a[96:99], v[80:83], 0
    s_waitcnt lgkmcnt(12)
    v_mfma_f32_16x16x32_bf16 v[32:35], a[4:7], v[84:87], v[32:35]
    v_mfma_f32_16x16x32_bf16 v[36:39], a[36:39], v[84:87], v[36:39]
    v_mfma_f32_16x16x32_bf16 v[40:43], a[68:71], v[84:87], v[40:43]
    v_mfma_f32_16x16x32_bf16 v[44:47], a[100:103], v[84:87], v[44:47]
    s_waitcnt lgkmcnt(10)
    v_mfma_f32_16x16x32_bf16 v[32:35], a[8:11], v[88:91], v[32:35]
    v_mfma_f32_16x16x32_bf16 v[36:39], a[40:43], v[88:91], v[36:39]
    v_mfma_f32_16x16x32_bf16 v[40:43], a[72:75], v[88:91], v[40:43]
    v_mfma_f32_16x16x32_bf16 v[44:47], a[104:107], v[88:91], v[44:47]
    s_waitcnt lgkmcnt(8)
    v_mfma_f32_16x16x32_bf16 v[32:35], a[12:15], v[92:95], v[32:35]
    v_mfma_f32_16x16x32_bf16 v[36:39], a[44:47], v[92:95], v[36:39]
    v_mfma_f32_16x16x32_bf16 v[40:43], a[76:79], v[92:95], v[40:43]
    v_mfma_f32_16x16x32_bf16 v[44:47], a[108:111], v[92:95], v[44:47]
    s_waitcnt lgkmcnt(6)
    v_mfma_f32_16x16x32_bf16 v[32:35], a[16:19], v[96:99], v[32:35]
    v_mfma_f32_16x16x32_bf16 v[36:39], a[48:51], v[96:99], v[36:39]
    v_mfma_f32_16x16x32_bf16 v[40:43], a[80:83], v[96:99], v[40:43]
    v_mfma_f32_16x16x32_bf16 v[44:47], a[112:115], v[96:99], v[44:47]
    s_waitcnt lgkmcnt(4)
    v_mfma_f32_16x16x32_bf16 v[32:35], a[20:23], v[100:103], v[32:35]
    v_mfma_f32_16x16x32_bf16 v[36:39], a[52:55], v[100:103], v[36:39]
    v_mfma_f32_16x16x32_bf16 v[40:43], a[84:87], v[100:103], v[40:43]
    v_mfma_f32_16x16x32_bf16 v[44:47], a[116:119], v[100:103], v[44:47]
    s_waitcnt lgkmcnt(2)
    v_mfma_f32_16x16x32_bf16 v[32:35], a[24:27], v[104:107], v[32:35]
    v_mfma_f32_16x16x32_bf16 v[36:39], a[56:59], v[104:107], v[36:39]
    v_mfma_f32_16x16x32_bf16 v[40:43], a[88:91], v[104:107], v[40:43]
    v_mfma_f32_16x16x32_bf16 v[44:47], a[120:123], v[104:107], v[44:47]
    s_waitcnt lgkmcnt(0)
    v_mfma_f32_16x16x32_bf16 v[32:35], a[28:31], v[108:111], v[32:35]
    v_mfma_f32_16x16x32_bf16 v[36:39], a[60:63], v[108:111], v[36:39]
    v_mfma_f32_16x16x32_bf16 v[40:43], a[92:95], v[108:111], v[40:43]
    v_mfma_f32_16x16x32_bf16 v[44:47], a[124:127], v[108:111], v[44:47]
    s_mul_i32 s28, s51, 57344
    s_add_u32 s28, s28, s32
    s_nop 6
    v_cvt_pk_bf16_f32 v120, v32, v33
    v_cvt_pk_bf16_f32 v121, v34, v35
    v_cvt_pk_bf16_f32 v122, v36, v37
    v_cvt_pk_bf16_f32 v123, v38, v39
    buffer_store_dwordx4 v[120:123], v4, s[4:7], s28 offen offset:0 sc1
    v_cvt_pk_bf16_f32 v124, v40, v41
    v_cvt_pk_bf16_f32 v125, v42, v43
    v_cvt_pk_bf16_f32 v126, v44, v45
    v_cvt_pk_bf16_f32 v127, v46, v47
    buffer_store_dwordx4 v[124:127], v4, s[4:7], s28 offen offset:1024 sc1
    s_waitcnt vmcnt(13)
    s_waitcnt vmcnt(11)
    s_lshl_b32 s16, s50, 7
    s_add_u32 s16, s16, s34
    s_mov_b64 exec, 1
    buffer_store_dword v128, v129, s[4:7], s16 offen sc1
    s_mov_b64 exec, -1
    s_barrier
    v_add_u32 v130, 32768, v12
    ds_read_b64_tr_b16 v[48:49], v130 offset:0
    ds_read_b64_tr_b16 v[50:51], v130 offset:512
    ds_read_b64_tr_b16 v[52:53], v130 offset:4096
    ds_read_b64_tr_b16 v[54:55], v130 offset:4608
    ds_read_b64_tr_b16 v[56:57], v130 offset:8192
    ds_read_b64_tr_b16 v[58:59], v130 offset:8704
    ds_read_b64_tr_b16 v[60:61], v130 offset:12288
    ds_read_b64_tr_b16 v[62:63], v130 offset:12800
    ds_read_b64_tr_b16 v[64:65], v130 offset:16384
    ds_read_b64_tr_b16 v[66:67], v130 offset:16896
    ds_read_b64_tr_b16 v[68:69], v130 offset:20480
    ds_read_b64_tr_b16 v[70:71], v130 offset:20992
    ds_read_b64_tr_b16 v[72:73], v130 offset:24576
    ds_read_b64_tr_b16 v[74:75], v130 offset:25088
    ds_read_b64_tr_b16 v[76:77], v130 offset:28672
    ds_read_b64_tr_b16 v[78:79], v130 offset:29184
    s_add_u32 s26, s24, 98304
    s_mov_b32 m0, s26
    s_lshl_b32 s25, s54, 7
    s_add_u32 s25, s25, s27
    buffer_load_dwordx4 v6, s[40:43], s25 offen lds
    s_add_u32 s25, s25, 7168
    s_add_u32 m0, m0, 1024
    s_nop 0
    buffer_load_dwordx4 v6, s[40:43], s25 offen lds
    s_add_u32 s25, s25, 7168
    s_add_u32 m0, m0, 1024
    s_nop 0
    buffer_load_dwordx4 v6, s[40:43], s25 offen lds
    s_add_u32 s25, s25, 7168
    s_add_u32 m0, m0, 1024
    s_nop 0
    buffer_load_dwordx4 v6, s[40:43], s25 offen lds
    s_add_u32 s25, s25, 7168
    s_add_u32 m0, m0, 1024
    s_nop 0
    buffer_load_dwordx4 v6, s[40:43], s25 offen lds
    s_add_u32 s25, s25, 7168
    s_add_u32 m0, m0, 1024
    s_nop 0
    buffer_load_dwordx4 v6, s[40:43], s25 offen lds
    s_add_u32 s25, s25, 7168
    s_add_u32 m0, m0, 1024
    s_nop 0
    buffer_load_dwordx4 v6, s[40:43], s25 offen lds
    s_add_u32 s25, s25, 7168
    s_add_u32 m0, m0, 1024
    s_nop 0
    buffer_load_dwordx4 v6, s[40:43], s25 offen lds
    s_add_u32 s25, s25, 7168
    s_add_u32 m0, m0, 1024
    s_nop 0
    s_waitcnt lgkmcnt(14)
    v_mfma_f32_16x16x32_bf16 v[16:19], a[0:3], v[48:51], 0
    v_mfma_f32_16x16x32_bf16 v[20:23], a[32:35], v[48:51], 0
    v_mfma_f32_16x16x32_bf16 v[24:27], a[64:67], v[48:51], 0
    v_mfma_f32_16x16x32_bf16 v[28:31], a[96:99], v[48:51], 0
    s_waitcnt lgkmcnt(12)
    v_mfma_f32_16x16x32_bf16 v[16:19], a[4:7], v[52:55], v[16:19]
    v_mfma_f32_16x16x32_bf16 v[20:23], a[36:39], v[52:55], v[20:23]
    v_mfma_f32_16x16x32_bf16 v[24:27], a[68:71], v[52:55], v[24:27]
    v_mfma_f32_16x16x32_bf16 v[28:31], a[100:103], v[52:55], v[28:31]
    s_waitcnt lgkmcnt(10)
    v_mfma_f32_16x16x32_bf16 v[16:19], a[8:11], v[56:59], v[16:19]
    v_mfma_f32_16x16x32_bf16 v[20:23], a[40:43], v[56:59], v[20:23]
    v_mfma_f32_16x16x32_bf16 v[24:27], a[72:75], v[56:59], v[24:27]
    v_mfma_f32_16x16x32_bf16 v[28:31], a[104:107], v[56:59], v[28:31]
    s_waitcnt lgkmcnt(8)
    v_mfma_f32_16x16x32_bf16 v[16:19], a[12:15], v[60:63], v[16:19]
    v_mfma_f32_16x16x32_bf16 v[20:23], a[44:47], v[60:63], v[20:23]
    v_mfma_f32_16x16x32_bf16 v[24:27], a[76:79], v[60:63], v[24:27]
    v_mfma_f32_16x16x32_bf16 v[28:31], a[108:111], v[60:63], v[28:31]
    s_waitcnt lgkmcnt(6)
    v_mfma_f32_16x16x32_bf16 v[16:19], a[16:19], v[64:67], v[16:19]
    v_mfma_f32_16x16x32_bf16 v[20:23], a[48:51], v[64:67], v[20:23]
    v_mfma_f32_16x16x32_bf16 v[24:27], a[80:83], v[64:67], v[24:27]
    v_mfma_f32_16x16x32_bf16 v[28:31], a[112:115], v[64:67], v[28:31]
    s_waitcnt lgkmcnt(4)
    v_mfma_f32_16x16x32_bf16 v[16:19], a[20:23], v[68:71], v[16:19]
    v_mfma_f32_16x16x32_bf16 v[20:23], a[52:55], v[68:71], v[20:23]
    v_mfma_f32_16x16x32_bf16 v[24:27], a[84:87], v[68:71], v[24:27]
    v_mfma_f32_16x16x32_bf16 v[28:31], a[116:119], v[68:71], v[28:31]
    s_waitcnt lgkmcnt(2)
    v_mfma_f32_16x16x32_bf16 v[16:19], a[24:27], v[72:75], v[16:19]
    v_mfma_f32_16x16x32_bf16 v[20:23], a[56:59], v[72:75], v[20:23]
    v_mfma_f32_16x16x32_bf16 v[24:27], a[88:91], v[72:75], v[24:27]
    v_mfma_f32_16x16x32_bf16 v[28:31], a[120:123], v[72:75], v[28:31]
    s_waitcnt lgkmcnt(0)
    v_mfma_f32_16x16x32_bf16 v[16:19], a[28:31], v[76:79], v[16:19]
    v_mfma_f32_16x16x32_bf16 v[20:23], a[60:63], v[76:79], v[20:23]
    v_mfma_f32_16x16x32_bf16 v[24:27], a[92:95], v[76:79], v[24:27]
    v_mfma_f32_16x16x32_bf16 v[28:31], a[124:127], v[76:79], v[28:31]
    s_mul_i32 s28, s52, 57344
    s_add_u32 s28, s28, s32
    s_nop 6
    v_cvt_pk_bf16_f32 v112, v16, v17
    v_cvt_pk_bf16_f32 v113, v18, v19
    v_cvt_pk_bf16_f32 v114, v20, v21
    v_cvt_pk_bf16_f32 v115, v22, v23
    buffer_store_dwordx4 v[112:115], v4, s[4:7], s28 offen offset:0 sc1
    v_cvt_pk_bf16_f32 v116, v24, v25
    v_cvt_pk_bf16_f32 v117, v26, v27
    v_cvt_pk_bf16_f32 v118, v28, v29
    v_cvt_pk_bf16_f32 v119, v30, v31
    buffer_store_dwordx4 v[116:119], v4, s[4:7], s28 offen offset:1024 sc1
    s_waitcnt vmcnt(13)
    s_waitcnt vmcnt(11)
    s_lshl_b32 s16, s51, 7
    s_add_u32 s16, s16, s34
    s_mov_b64 exec, 1
    buffer_store_dword v128, v129, s[4:7], s16 offen sc1
    s_mov_b64 exec, -1
    s_barrier
    v_add_u32 v130, 65536, v12
    ds_read_b64_tr_b16 v[80:81], v130 offset:0
    ds_read_b64_tr_b16 v[82:83], v130 offset:512
    ds_read_b64_tr_b16 v[84:85], v130 offset:4096
    ds_read_b64_tr_b16 v[86:87], v130 offset:4608
    ds_read_b64_tr_b16 v[88:89], v130 offset:8192
    ds_read_b64_tr_b16 v[90:91], v130 offset:8704
    ds_read_b64_tr_b16 v[92:93], v130 offset:12288
    ds_read_b64_tr_b16 v[94:95], v130 offset:12800
    ds_read_b64_tr_b16 v[96:97], v130 offset:16384
    ds_read_b64_tr_b16 v[98:99], v130 offset:16896
    ds_read_b64_tr_b16 v[100:101], v130 offset:20480
    ds_read_b64_tr_b16 v[102:103], v130 offset:20992
    ds_read_b64_tr_b16 v[104:105], v130 offset:24576
    ds_read_b64_tr_b16 v[106:107], v130 offset:25088
    ds_read_b64_tr_b16 v[108:109], v130 offset:28672
    ds_read_b64_tr_b16 v[110:111], v130 offset:29184
    s_waitcnt lgkmcnt(14)
    v_mfma_f32_16x16x32_bf16 v[32:35], a[0:3], v[80:83], 0
    v_mfma_f32_16x16x32_bf16 v[36:39], a[32:35], v[80:83], 0
    v_mfma_f32_16x16x32_bf16 v[40:43], a[64:67], v[80:83], 0
    v_mfma_f32_16x16x32_bf16 v[44:47], a[96:99], v[80:83], 0
    s_waitcnt lgkmcnt(12)
    v_mfma_f32_16x16x32_bf16 v[32:35], a[4:7], v[84:87], v[32:35]
    v_mfma_f32_16x16x32_bf16 v[36:39], a[36:39], v[84:87], v[36:39]
    v_mfma_f32_16x16x32_bf16 v[40:43], a[68:71], v[84:87], v[40:43]
    v_mfma_f32_16x16x32_bf16 v[44:47], a[100:103], v[84:87], v[44:47]
    s_waitcnt lgkmcnt(10)
    v_mfma_f32_16x16x32_bf16 v[32:35], a[8:11], v[88:91], v[32:35]
    v_mfma_f32_16x16x32_bf16 v[36:39], a[40:43], v[88:91], v[36:39]
    v_mfma_f32_16x16x32_bf16 v[40:43], a[72:75], v[88:91], v[40:43]
    v_mfma_f32_16x16x32_bf16 v[44:47], a[104:107], v[88:91], v[44:47]
    s_waitcnt lgkmcnt(8)
    v_mfma_f32_16x16x32_bf16 v[32:35], a[12:15], v[92:95], v[32:35]
    v_mfma_f32_16x16x32_bf16 v[36:39], a[44:47], v[92:95], v[36:39]
    v_mfma_f32_16x16x32_bf16 v[40:43], a[76:79], v[92:95], v[40:43]
    v_mfma_f32_16x16x32_bf16 v[44:47], a[108:111], v[92:95], v[44:47]
    s_waitcnt lgkmcnt(6)
    v_mfma_f32_16x16x32_bf16 v[32:35], a[16:19], v[96:99], v[32:35]
    v_mfma_f32_16x16x32_bf16 v[36:39], a[48:51], v[96:99], v[36:39]
    v_mfma_f32_16x16x32_bf16 v[40:43], a[80:83], v[96:99], v[40:43]
    v_mfma_f32_16x16x32_bf16 v[44:47], a[112:115], v[96:99], v[44:47]
    s_waitcnt lgkmcnt(4)
    v_mfma_f32_16x16x32_bf16 v[32:35], a[20:23], v[100:103], v[32:35]
    v_mfma_f32_16x16x32_bf16 v[36:39], a[52:55], v[100:103], v[36:39]
    v_mfma_f32_16x16x32_bf16 v[40:43], a[84:87], v[100:103], v[40:43]
    v_mfma_f32_16x16x32_bf16 v[44:47], a[116:119], v[100:103], v[44:47]
    s_waitcnt lgkmcnt(2)
    v_mfma_f32_16x16x32_bf16 v[32:35], a[24:27], v[104:107], v[32:35]
    v_mfma_f32_16x16x32_bf16 v[36:39], a[56:59], v[104:107], v[36:39]
    v_mfma_f32_16x16x32_bf16 v[40:43], a[88:91], v[104:107], v[40:43]
    v_mfma_f32_16x16x32_bf16 v[44:47], a[120:123], v[104:107], v[44:47]
    s_waitcnt lgkmcnt(0)
    v_mfma_f32_16x16x32_bf16 v[32:35], a[28:31], v[108:111], v[32:35]
    v_mfma_f32_16x16x32_bf16 v[36:39], a[60:63], v[108:111], v[36:39]
    v_mfma_f32_16x16x32_bf16 v[40:43], a[92:95], v[108:111], v[40:43]
    v_mfma_f32_16x16x32_bf16 v[44:47], a[124:127], v[108:111], v[44:47]
    s_mul_i32 s28, s53, 57344
    s_add_u32 s28, s28, s32
    s_nop 6
    v_cvt_pk_bf16_f32 v120, v32, v33
    v_cvt_pk_bf16_f32 v121, v34, v35
    v_cvt_pk_bf16_f32 v122, v36, v37
    v_cvt_pk_bf16_f32 v123, v38, v39
    buffer_store_dwordx4 v[120:123], v4, s[4:7], s28 offen offset:0 sc1
    v_cvt_pk_bf16_f32 v124, v40, v41
    v_cvt_pk_bf16_f32 v125, v42, v43
    v_cvt_pk_bf16_f32 v126, v44, v45
    v_cvt_pk_bf16_f32 v127, v46, v47
    buffer_store_dwordx4 v[124:127], v4, s[4:7], s28 offen offset:1024 sc1
    s_waitcnt vmcnt(5)
    s_waitcnt vmcnt(3)
    s_lshl_b32 s16, s52, 7
    s_add_u32 s16, s16, s34
    s_mov_b64 exec, 1
    buffer_store_dword v128, v129, s[4:7], s16 offen sc1
    s_mov_b64 exec, -1
    s_barrier
    v_add_u32 v130, 98304, v12
    ds_read_b64_tr_b16 v[48:49], v130 offset:0
    ds_read_b64_tr_b16 v[50:51], v130 offset:512
    ds_read_b64_tr_b16 v[52:53], v130 offset:4096
    ds_read_b64_tr_b16 v[54:55], v130 offset:4608
    ds_read_b64_tr_b16 v[56:57], v130 offset:8192
    ds_read_b64_tr_b16 v[58:59], v130 offset:8704
    ds_read_b64_tr_b16 v[60:61], v130 offset:12288
    ds_read_b64_tr_b16 v[62:63], v130 offset:12800
    ds_read_b64_tr_b16 v[64:65], v130 offset:16384
    ds_read_b64_tr_b16 v[66:67], v130 offset:16896
    ds_read_b64_tr_b16 v[68:69], v130 offset:20480
    ds_read_b64_tr_b16 v[70:71], v130 offset:20992
    ds_read_b64_tr_b16 v[72:73], v130 offset:24576
    ds_read_b64_tr_b16 v[74:75], v130 offset:25088
    ds_read_b64_tr_b16 v[76:77], v130 offset:28672
    ds_read_b64_tr_b16 v[78:79], v130 offset:29184
    s_waitcnt lgkmcnt(14)
    v_mfma_f32_16x16x32_bf16 v[16:19], a[0:3], v[48:51], 0
    v_mfma_f32_16x16x32_bf16 v[20:23], a[32:35], v[48:51], 0
    v_mfma_f32_16x16x32_bf16 v[24:27], a[64:67], v[48:51], 0
    v_mfma_f32_16x16x32_bf16 v[28:31], a[96:99], v[48:51], 0
    s_waitcnt lgkmcnt(12)
    v_mfma_f32_16x16x32_bf16 v[16:19], a[4:7], v[52:55], v[16:19]
    v_mfma_f32_16x16x32_bf16 v[20:23], a[36:39], v[52:55], v[20:23]
    v_mfma_f32_16x16x32_bf16 v[24:27], a[68:71], v[52:55], v[24:27]
    v_mfma_f32_16x16x32_bf16 v[28:31], a[100:103], v[52:55], v[28:31]
    s_waitcnt lgkmcnt(10)
    v_mfma_f32_16x16x32_bf16 v[16:19], a[8:11], v[56:59], v[16:19]
    v_mfma_f32_16x16x32_bf16 v[20:23], a[40:43], v[56:59], v[20:23]
    v_mfma_f32_16x16x32_bf16 v[24:27], a[72:75], v[56:59], v[24:27]
    v_mfma_f32_16x16x32_bf16 v[28:31], a[104:107], v[56:59], v[28:31]
    s_waitcnt lgkmcnt(8)
    v_mfma_f32_16x16x32_bf16 v[16:19], a[12:15], v[60:63], v[16:19]
    v_mfma_f32_16x16x32_bf16 v[20:23], a[44:47], v[60:63], v[20:23]
    v_mfma_f32_16x16x32_bf16 v[24:27], a[76:79], v[60:63], v[24:27]
    v_mfma_f32_16x16x32_bf16 v[28:31], a[108:111], v[60:63], v[28:31]
    s_waitcnt lgkmcnt(6)
    v_mfma_f32_16x16x32_bf16 v[16:19], a[16:19], v[64:67], v[16:19]
    v_mfma_f32_16x16x32_bf16 v[20:23], a[48:51], v[64:67], v[20:23]
    v_mfma_f32_16x16x32_bf16 v[24:27], a[80:83], v[64:67], v[24:27]
    v_mfma_f32_16x16x32_bf16 v[28:31], a[112:115], v[64:67], v[28:31]
    s_waitcnt lgkmcnt(4)
    v_mfma_f32_16x16x32_bf16 v[16:19], a[20:23], v[68:71], v[16:19]
    v_mfma_f32_16x16x32_bf16 v[20:23], a[52:55], v[68:71], v[20:23]
    v_mfma_f32_16x16x32_bf16 v[24:27], a[84:87], v[68:71], v[24:27]
    v_mfma_f32_16x16x32_bf16 v[28:31], a[116:119], v[68:71], v[28:31]
    s_waitcnt lgkmcnt(2)
    v_mfma_f32_16x16x32_bf16 v[16:19], a[24:27], v[72:75], v[16:19]
    v_mfma_f32_16x16x32_bf16 v[20:23], a[56:59], v[72:75], v[20:23]
    v_mfma_f32_16x16x32_bf16 v[24:27], a[88:91], v[72:75], v[24:27]
    v_mfma_f32_16x16x32_bf16 v[28:31], a[120:123], v[72:75], v[28:31]
    s_waitcnt lgkmcnt(0)
    v_mfma_f32_16x16x32_bf16 v[16:19], a[28:31], v[76:79], v[16:19]
    v_mfma_f32_16x16x32_bf16 v[20:23], a[60:63], v[76:79], v[20:23]
    v_mfma_f32_16x16x32_bf16 v[24:27], a[92:95], v[76:79], v[24:27]
    v_mfma_f32_16x16x32_bf16 v[28:31], a[124:127], v[76:79], v[28:31]
    s_mul_i32 s28, s54, 57344
    s_add_u32 s28, s28, s32
    s_nop 6
    v_cvt_pk_bf16_f32 v112, v16, v17
    v_cvt_pk_bf16_f32 v113, v18, v19
    v_cvt_pk_bf16_f32 v114, v20, v21
    v_cvt_pk_bf16_f32 v115, v22, v23
    buffer_store_dwordx4 v[112:115], v4, s[4:7], s28 offen offset:0 sc1
    v_cvt_pk_bf16_f32 v116, v24, v25
    v_cvt_pk_bf16_f32 v117, v26, v27
    v_cvt_pk_bf16_f32 v118, v28, v29
    v_cvt_pk_bf16_f32 v119, v30, v31
    buffer_store_dwordx4 v[116:119], v4, s[4:7], s28 offen offset:1024 sc1
    s_waitcnt vmcnt(3)
    s_lshl_b32 s16, s53, 7
    s_add_u32 s16, s16, s34
    s_mov_b64 exec, 1
    buffer_store_dword v128, v129, s[4:7], s16 offen sc1
    s_mov_b64 exec, -1
    s_waitcnt vmcnt(1)
    s_lshl_b32 s16, s54, 7
    s_add_u32 s16, s16, s34
    s_mov_b64 exec, 1
    buffer_store_dword v128, v129, s[4:7], s16 offen sc1
    s_mov_b64 exec, -1
k1_MNend:
    v_lshlrev_b32 v1, 4, v0
    s_and_b32 s16, s92, 7
    s_lshr_b32 s17, s92, 3
    s_lshl_b32 s18, s91, 2
    s_add_u32 s17, s17, s18
    s_lshl_b32 s17, s17, 2
    s_add_u32 s17, s17, s3
    s_mul_i32 s22, s17, 147
    s_lshr_b32 s22, s22, 11
    s_mul_i32 s23, s22, 14
    s_sub_u32 s23, s17, s23
    s_lshl_b32 s18, s22, 1
    s_add_u32 s18, s18, 16
    s_lshl_b32 s18, s18, 3
    s_lshr_b32 s19, s23, 1
    s_add_u32 s18, s18, s19
    s_lshl_b32 s18, s18, 7
    v_and_b32 v2, 31, v0
    v_min_u32 v2, 27, v2
    v_lshlrev_b32 v2, 2, v2
    v_lshrrev_b32 v3, 5, v0
    v_lshl_add_u32 v2, v3, 10, v2
    s_add_u32 s18, s18, 74055680
    v_add_u32 v2, s18, v2
    v_lshlrev_b32 v4, 3, v0
    v_add_u32 v4, 74051584, v4
    s_mov_b32 s35, 400000
ww_141:
    buffer_load_dword v3, v2, s[4:7], 0 offen sc1
    buffer_load_dwordx2 v[6:7], v4, s[4:7], 0 offen sc1
    s_waitcnt vmcnt(0)
    v_min3_u32 v3, v3, v6, v7
    v_cmp_eq_u32 vcc, 0, v3
    s_cbranch_vccz wwo_142
    s_sleep 16
    s_sub_u32 s35, s35, 1
    s_cmp_lg_u32 s35, 0
    s_cbranch_scc1 ww_141
    s_branch k2_end
wwo_142:
    s_mul_i32 s18, s22, 802816
    s_mul_i32 s23, s23, 28672
    s_add_u32 s18, s18, s23
    s_add_u32 s18, s18, 11927552
    s_mul_i32 s24, s3, 7168
    s_mul_i32 s19, s16, 28672
    s_add_u32 s19, s19, s24
    s_add_u32 s19, s19, 1835008
    s_barrier
    s_add_u32 s22, s24, 0
    s_mov_b32 m0, s22
    s_add_u32 s23, s19, 0
    buffer_load_dwordx4 v1, s[4:7], s23 offen offset:0 lds
    buffer_load_dwordx4 v1, s[4:7], s23 offen offset:1024 lds
    buffer_load_dwordx4 v1, s[4:7], s23 offen offset:2048 lds
    buffer_load_dwordx4 v1, s[4:7], s23 offen offset:3072 lds
    s_add_u32 s22, s24, 4096
    s_mov_b32 m0, s22
    s_add_u32 s23, s19, 4096
    buffer_load_dwordx4 v1, s[4:7], s23 offen offset:0 lds
    buffer_load_dwordx4 v1, s[4:7], s23 offen offset:1024 lds
    buffer_load_dwordx4 v1, s[4:7], s23 offen offset:2048 lds
    s_add_u32 s26, s18, 0
    s_add_u32 s27, s18, 14336
    s_add_u32 s28, s18, 401408
    s_add_u32 s29, s18, 415744
    buffer_load_dwordx4 a[0:3], v1, s[4:7], s26 offen offset:0
    buffer_load_dwordx4 a[4:7], v1, s[4:7], s26 offen offset:1024
    buffer_load_dwordx4 a[8:11], v1, s[4:7], s26 offen offset:2048
    buffer_load_dwordx4 a[12:15], v1, s[4:7], s26 offen offset:3072
    s_add_u32 s26, s26, 4096
    buffer_load_dwordx4 a[56:59], v1, s[4:7], s27 offen offset:0
    buffer_load_dwordx4 a[60:63], v1, s[4:7], s27 offen offset:1024
    buffer_load_dwordx4 a[64:67], v1, s[4:7], s27 offen offset:2048
    buffer_load_dwordx4 a[68:71], v1, s[4:7], s27 offen offset:3072
    s_add_u32 s27, s27, 4096
    buffer_load_dwordx4 a[112:115], v1, s[4:7], s28 offen offset:0
    buffer_load_dwordx4 a[116:119], v1, s[4:7], s28 offen offset:1024
    buffer_load_dwordx4 a[120:123], v1, s[4:7], s28 offen offset:2048
    buffer_load_dwordx4 a[124:127], v1, s[4:7], s28 offen offset:3072
    s_add_u32 s28, s28, 4096
    buffer_load_dwordx4 a[168:171], v1, s[4:7], s29 offen offset:0
    buffer_load_dwordx4 a[172:175], v1, s[4:7], s29 offen offset:1024
    buffer_load_dwordx4 a[176:179], v1, s[4:7], s29 offen offset:2048
    buffer_load_dwordx4 a[180:183], v1, s[4:7], s29 offen offset:3072
    s_add_u32 s29, s29, 4096
    buffer_load_dwordx4 a[16:19], v1, s[4:7], s26 offen offset:0
    buffer_load_dwordx4 a[20:23], v1, s[4:7], s26 offen offset:1024
    buffer_load_dwordx4 a[24:27], v1, s[4:7], s26 offen offset:2048
    buffer_load_dwordx4 a[28:31], v1, s[4:7], s26 offen offset:3072
    s_add_u32 s26, s26, 4096
    buffer_load_dwordx4 a[72:75], v1, s[4:7], s27 offen offset:0
    buffer_load_dwordx4 a[76:79], v1, s[4:7], s27 offen offset:1024
    buffer_load_dwordx4 a[80:83], v1, s[4:7], s27 offen offset:2048
    buffer_load_dwordx4 a[84:87], v1, s[4:7], s27 offen offset:3072
    s_add_u32 s27, s27, 4096
    buffer_load_dwordx4 a[128:131], v1, s[4:7], s28 offen offset:0
    buffer_load_dwordx4 a[132:135], v1, s[4:7], s28 offen offset:1024
    buffer_load_dwordx4 a[136:139], v1, s[4:7], s28 offen offset:2048
    buffer_load_dwordx4 a[140:143], v1, s[4:7], s28 offen offset:3072
    s_add_u32 s28, s28, 4096
    buffer_load_dwordx4 a[184:187], v1, s[4:7], s29 offen offset:0
    buffer_load_dwordx4 a[188:191], v1, s[4:7], s29 offen offset:1024
    buffer_load_dwordx4 a[192:195], v1, s[4:7], s29 offen offset:2048
    buffer_load_dwordx4 a[196:199], v1, s[4:7], s29 offen offset:3072
    s_add_u32 s29, s29, 4096
    buffer_load_dwordx4 a[32:35], v1, s[4:7], s26 offen offset:0
    buffer_load_dwordx4 a[36:39], v1, s[4:7], s26 offen offset:1024
    buffer_load_dwordx4 a[40:43], v1, s[4:7], s26 offen offset:2048
    buffer_load_dwordx4 a[44:47], v1, s[4:7], s26 offen offset:3072
    s_add_u32 s26, s26, 4096
    buffer_load_dwordx4 a[88:91], v1, s[4:7], s27 offen offset:0
    buffer_load_dwordx4 a[92:95], v1, s[4:7], s27 offen offset:1024
    buffer_load_dwordx4 a[96:99], v1, s[4:7], s27 offen offset:2048
    buffer_load_dwordx4 a[100:103], v1, s[4:7], s27 offen offset:3072
    s_add_u32 s27, s27, 4096
    buffer_load_dwordx4 a[144:147], v1, s[4:7], s28 offen offset:0
    buffer_load_dwordx4 a[148:151], v1, s[4:7], s28 offen offset:1024
    buffer_load_dwordx4 a[152:155], v1, s[4:7], s28 offen offset:2048
    buffer_load_dwordx4 a[156:159], v1, s[4:7], s28 offen offset:3072
    s_add_u32 s28, s28, 4096
    buffer_load_dwordx4 a[200:203], v1, s[4:7], s29 offen offset:0
    buffer_load_dwordx4 a[204:207], v1, s[4:7], s29 offen offset:1024
    buffer_load_dwordx4 a[208:211], v1, s[4:7], s29 offen offset:2048
    buffer_load_dwordx4 a[212:215], v1, s[4:7], s29 offen offset:3072
    s_add_u32 s29, s29, 4096
    buffer_load_dwordx4 a[48:51], v1, s[4:7], s26 offen offset:0
    buffer_load_dwordx4 a[52:55], v1, s[4:7], s26 offen offset:1024
    buffer_load_dwordx4 a[104:107], v1, s[4:7], s27 offen offset:0
    buffer_load_dwordx4 a[108:111], v1, s[4:7], s27 offen offset:1024
    buffer_load_dwordx4 a[160:163], v1, s[4:7], s28 offen offset:0
    buffer_load_dwordx4 a[164:167], v1, s[4:7], s28 offen offset:1024
    buffer_load_dwordx4 a[216:219], v1, s[4:7], s29 offen offset:0
    buffer_load_dwordx4 a[220:223], v1, s[4:7], s29 offen offset:1024
    s_mul_i32 s21, s16, 462848
    s_lshl_b32 s22, s17, 12
    s_add_u32 s21, s21, s22
    s_add_u32 s21, s21, 23166976
    s_mul_i32 s22, s17, 147
    s_lshr_b32 s22, s22, 11
    s_mul_i32 s23, s22, 14
    s_sub_u32 s23, s17, s23
    s_lshl_b32 s25, s22, 3
    s_add_u32 s25, s25, s16
    s_lshl_b32 s25, s25, 2
    s_lshl_b32 s23, s23, 8
    s_add_u32 s25, s25, s23
    s_add_u32 s25, s25, 74022912
    v_mov_b32 v2, 1
    v_mov_b32 v3, 0
    v_add_u32 v4, 57344, v1
    s_waitcnt vmcnt(56)
    s_barrier
    s_add_u32 s22, s24, 28672
    s_mov_b32 m0, s22
    s_add_u32 s23, s19, 229376
    buffer_load_dwordx4 v1, s[4:7], s23 offen offset:0 lds
    buffer_load_dwordx4 v1, s[4:7], s23 offen offset:1024 lds
    buffer_load_dwordx4 v1, s[4:7], s23 offen offset:2048 lds
    buffer_load_dwordx4 v1, s[4:7], s23 offen offset:3072 lds
    s_add_u32 s22, s24, 32768
    s_mov_b32 m0, s22
    s_add_u32 s23, s19, 233472
    buffer_load_dwordx4 v1, s[4:7], s23 offen offset:0 lds
    buffer_load_dwordx4 v1, s[4:7], s23 offen offset:1024 lds
    buffer_load_dwordx4 v1, s[4:7], s23 offen offset:2048 lds
    s_add_u32 s22, s24, 57344
    s_mov_b32 m0, s22
    s_add_u32 s23, s19, 458752
    buffer_load_dwordx4 v1, s[4:7], s23 offen offset:0 lds
    buffer_load_dwordx4 v1, s[4:7], s23 offen offset:1024 lds
    buffer_load_dwordx4 v1, s[4:7], s23 offen offset:2048 lds
    buffer_load_dwordx4 v1, s[4:7], s23 offen offset:3072 lds
    s_add_u32 s22, s24, 61440
    s_mov_b32 m0, s22
    s_add_u32 s23, s19, 462848
    buffer_load_dwordx4 v1, s[4:7], s23 offen offset:0 lds
    buffer_load_dwordx4 v1, s[4:7], s23 offen offset:1024 lds
    buffer_load_dwordx4 v1, s[4:7], s23 offen offset:2048 lds
    ds_read_b128 v[96:99], v1 offset:0
    ds_read_b128 v[100:103], v1 offset:14336
    ds_read_b128 v[104:107], v1 offset:1024
    ds_read_b128 v[108:111], v1 offset:15360
    ds_read_b128 v[112:115], v1 offset:2048
    ds_read_b128 v[116:119], v1 offset:16384
    s_waitcnt vmcnt(54)
    ds_read_b128 v[120:123], v1 offset:3072
    ds_read_b128 v[124:127], v1 offset:17408
    s_waitcnt lgkmcnt(6)
    v_mfma_f32_16x16x32_bf16 v[16:19], v[96:99], a[0:3], 0
    v_mfma_f32_16x16x32_bf16 v[20:23], v[100:103], a[0:3], 0
    v_mfma_f32_16x16x32_bf16 v[24:27], v[96:99], a[56:59], 0
    v_mfma_f32_16x16x32_bf16 v[28:31], v[100:103], a[56:59], 0
    v_mfma_f32_16x16x32_bf16 v[32:35], v[96:99], a[112:115], 0
    v_mfma_f32_16x16x32_bf16 v[36:39], v[100:103], a[112:115], 0
    v_mfma_f32_16x16x32_bf16 v[40:43], v[96:99], a[168:171], 0
    v_mfma_f32_16x16x32_bf16 v[44:47], v[100:103], a[168:171], 0
    ds_read_b128 v[96:99], v1 offset:4096
    ds_read_b128 v[100:103], v1 offset:18432
    s_waitcnt lgkmcnt(6)
    v_mfma_f32_16x16x32_bf16 v[16:19], v[104:107], a[4:7], v[16:19]
    v_mfma_f32_16x16x32_bf16 v[20:23], v[108:111], a[4:7], v[20:23]
    v_mfma_f32_16x16x32_bf16 v[24:27], v[104:107], a[60:63], v[24:27]
    v_mfma_f32_16x16x32_bf16 v[28:31], v[108:111], a[60:63], v[28:31]
    v_mfma_f32_16x16x32_bf16 v[32:35], v[104:107], a[116:119], v[32:35]
    v_mfma_f32_16x16x32_bf16 v[36:39], v[108:111], a[116:119], v[36:39]
    v_mfma_f32_16x16x32_bf16 v[40:43], v[104:107], a[172:175], v[40:43]
    v_mfma_f32_16x16x32_bf16 v[44:47], v[108:111], a[172:175], v[44:47]
    ds_read_b128 v[104:107], v1 offset:5120
    ds_read_b128 v[108:111], v1 offset:19456
    s_waitcnt lgkmcnt(6)
    v_mfma_f32_16x16x32_bf16 v[16:19], v[112:115], a[8:11], v[16:19]
    v_mfma_f32_16x16x32_bf16 v[20:23], v[116:119], a[8:11], v[20:23]
    v_mfma_f32_16x16x32_bf16 v[24:27], v[112:115], a[64:67], v[24:27]
    v_mfma_f32_16x16x32_bf16 v[28:31], v[116:119], a[64:67], v[28:31]
    v_mfma_f32_16x16x32_bf16 v[32:35], v[112:115], a[120:123], v[32:35]
    v_mfma_f32_16x16x32_bf16 v[36:39], v[116:119], a[120:123], v[36:39]
    v_mfma_f32_16x16x32_bf16 v[40:43], v[112:115], a[176:179], v[40:43]
    v_mfma_f32_16x16x32_bf16 v[44:47], v[116:119], a[176:179], v[44:47]
    ds_read_b128 v[112:115], v1 offset:6144
    ds_read_b128 v[116:119], v1 offset:20480
    s_waitcnt lgkmcnt(6)
    v_mfma_f32_16x16x32_bf16 v[16:19], v[120:123], a[12:15], v[16:19]
    v_mfma_f32_16x16x32_bf16 v[20:23], v[124:127], a[12:15], v[20:23]
    v_mfma_f32_16x16x32_bf16 v[24:27], v[120:123], a[68:71], v[24:27]
    v_mfma_f32_16x16x32_bf16 v[28:31], v[124:127], a[68:71], v[28:31]
    v_mfma_f32_16x16x32_bf16 v[32:35], v[120:123], a[124:127], v[32:35]
    v_mfma_f32_16x16x32_bf16 v[36:39], v[124:127], a[124:127], v[36:39]
    v_mfma_f32_16x16x32_bf16 v[40:43], v[120:123], a[180:183], v[40:43]
    v_mfma_f32_16x16x32_bf16 v[44:47], v[124:127], a[180:183], v[44:47]
    s_waitcnt vmcnt(38)
    ds_read_b128 v[120:123], v1 offset:7168
    ds_read_b128 v[124:127], v1 offset:21504
    s_waitcnt lgkmcnt(6)
    v_mfma_f32_16x16x32_bf16 v[16:19], v[96:99], a[16:19], v[16:19]
    v_mfma_f32_16x16x32_bf16 v[20:23], v[100:103], a[16:19], v[20:23]
    v_mfma_f32_16x16x32_bf16 v[24:27], v[96:99], a[72:75], v[24:27]
    v_mfma_f32_16x16x32_bf16 v[28:31], v[100:103], a[72:75], v[28:31]
    v_mfma_f32_16x16x32_bf16 v[32:35], v[96:99], a[128:131], v[32:35]
    v_mfma_f32_16x16x32_bf16 v[36:39], v[100:103], a[128:131], v[36:39]
    v_mfma_f32_16x16x32_bf16 v[40:43], v[96:99], a[184:187], v[40:43]
    v_mfma_f32_16x16x32_bf16 v[44:47], v[100:103], a[184:187], v[44:47]
    ds_read_b128 v[96:99], v1 offset:8192
    ds_read_b128 v[100:103], v1 offset:22528
    s_waitcnt lgkmcnt(6)
    v_mfma_f32_16x16x32_bf16 v[16:19], v[104:107], a[20:23], v[16:19]
    v_mfma_f32_16x16x32_bf16 v[20:23], v[108:111], a[20:23], v[20:23]
    v_mfma_f32_16x16x32_bf16 v[24:27], v[104:107], a[76:79], v[24:27]
    v_mfma_f32_16x16x32_bf16 v[28:31], v[108:111], a[76:79], v[28:31]
    v_mfma_f32_16x16x32_bf16 v[32:35], v[104:107], a[132:135], v[32:35]
    v_mfma_f32_16x16x32_bf16 v[36:39], v[108:111], a[132:135], v[36:39]
    v_mfma_f32_16x16x32_bf16 v[40:43], v[104:107], a[188:191], v[40:43]
    v_mfma_f32_16x16x32_bf16 v[44:47], v[108:111], a[188:191], v[44:47]
    ds_read_b128 v[104:107], v1 offset:9216
    ds_read_b128 v[108:111], v1 offset:23552
    s_waitcnt lgkmcnt(6)
    v_mfma_f32_16x16x32_bf16 v[16:19], v[112:115], a[24:27], v[16:19]
    v_mfma_f32_16x16x32_bf16 v[20:23], v[116:119], a[24:27], v[20:23]
    v_mfma_f32_16x16x32_bf16 v[24:27], v[112:115], a[80:83], v[24:27]
    v_mfma_f32_16x16x32_bf16 v[28:31], v[116:119], a[80:83], v[28:31]
    v_mfma_f32_16x16x32_bf16 v[32:35], v[112:115], a[136:139], v[32:35]
    v_mfma_f32_16x16x32_bf16 v[36:39], v[116:119], a[136:139], v[36:39]
    v_mfma_f32_16x16x32_bf16 v[40:43], v[112:115], a[192:195], v[40:43]
    v_mfma_f32_16x16x32_bf16 v[44:47], v[116:119], a[192:195], v[44:47]
    ds_read_b128 v[112:115], v1 offset:10240
    ds_read_b128 v[116:119], v1 offset:24576
    s_waitcnt lgkmcnt(6)
    v_mfma_f32_16x16x32_bf16 v[16:19], v[120:123], a[28:31], v[16:19]
    v_mfma_f32_16x16x32_bf16 v[20:23], v[124:127], a[28:31], v[20:23]
    v_mfma_f32_16x16x32_bf16 v[24:27], v[120:123], a[84:87], v[24:27]
    v_mfma_f32_16x16x32_bf16 v[28:31], v[124:127], a[84:87], v[28:31]
    v_mfma_f32_16x16x32_bf16 v[32:35], v[120:123], a[140:143], v[32:35]
    v_mfma_f32_16x16x32_bf16 v[36:39], v[124:127], a[140:143], v[36:39]
    v_mfma_f32_16x16x32_bf16 v[40:43], v[120:123], a[196:199], v[40:43]
    v_mfma_f32_16x16x32_bf16 v[44:47], v[124:127], a[196:199], v[44:47]
    s_waitcnt vmcnt(22)
    ds_read_b128 v[120:123], v1 offset:11264
    ds_read_b128 v[124:127], v1 offset:25600
    s_waitcnt lgkmcnt(6)
    v_mfma_f32_16x16x32_bf16 v[16:19], v[96:99], a[32:35], v[16:19]
    v_mfma_f32_16x16x32_bf16 v[20:23], v[100:103], a[32:35], v[20:23]
    v_mfma_f32_16x16x32_bf16 v[24:27], v[96:99], a[88:91], v[24:27]
    v_mfma_f32_16x16x32_bf16 v[28:31], v[100:103], a[88:91], v[28:31]
    v_mfma_f32_16x16x32_bf16 v[32:35], v[96:99], a[144:147], v[32:35]
    v_mfma_f32_16x16x32_bf16 v[36:39], v[100:103], a[144:147], v[36:39]
    v_mfma_f32_16x16x32_bf16 v[40:43], v[96:99], a[200:203], v[40:43]
    v_mfma_f32_16x16x32_bf16 v[44:47], v[100:103], a[200:203], v[44:47]
    ds_read_b128 v[96:99], v1 offset:12288
    ds_read_b128 v[100:103], v1 offset:26624
    s_waitcnt lgkmcnt(6)
    v_mfma_f32_16x16x32_bf16 v[16:19], v[104:107], a[36:39], v[16:19]
    v_mfma_f32_16x16x32_bf16 v[20:23], v[108:111], a[36:39], v[20:23]
    v_mfma_f32_16x16x32_bf16 v[24:27], v[104:107], a[92:95], v[24:27]
    v_mfma_f32_16x16x32_bf16 v[28:31], v[108:111], a[92:95], v[28:31]
    v_mfma_f32_16x16x32_bf16 v[32:35], v[104:107], a[148:151], v[32:35]
    v_mfma_f32_16x16x32_bf16 v[36:39], v[108:111], a[148:151], v[36:39]
    v_mfma_f32_16x16x32_bf16 v[40:43], v[104:107], a[204:207], v[40:43]
    v_mfma_f32_16x16x32_bf16 v[44:47], v[108:111], a[204:207], v[44:47]
    ds_read_b128 v[104:107], v1 offset:13312
    ds_read_b128 v[108:111], v1 offset:27648
    s_waitcnt lgkmcnt(6)
    v_mfma_f32_16x16x32_bf16 v[16:19], v[112:115], a[40:43], v[16:19]
    v_mfma_f32_16x16x32_bf16 v[20:23], v[116:119], a[40:43], v[20:23]
    v_mfma_f32_16x16x32_bf16 v[24:27], v[112:115], a[96:99], v[24:27]
    v_mfma_f32_16x16x32_bf16 v[28:31], v[116:119], a[96:99], v[28:31]
    v_mfma_f32_16x16x32_bf16 v[32:35], v[112:115], a[152:155], v[32:35]
    v_mfma_f32_16x16x32_bf16 v[36:39], v[116:119], a[152:155], v[36:39]
    v_mfma_f32_16x16x32_bf16 v[40:43], v[112:115], a[208:211], v[40:43]
    v_mfma_f32_16x16x32_bf16 v[44:47], v[116:119], a[208:211], v[44:47]
    s_waitcnt lgkmcnt(4)
    v_mfma_f32_16x16x32_bf16 v[16:19], v[120:123], a[44:47], v[16:19]
    v_mfma_f32_16x16x32_bf16 v[20:23], v[124:127], a[44:47], v[20:23]
    v_mfma_f32_16x16x32_bf16 v[24:27], v[120:123], a[100:103], v[24:27]
    v_mfma_f32_16x16x32_bf16 v[28:31], v[124:127], a[100:103], v[28:31]
    v_mfma_f32_16x16x32_bf16 v[32:35], v[120:123], a[156:159], v[32:35]
    v_mfma_f32_16x16x32_bf16 v[36:39], v[124:127], a[156:159], v[36:39]
    v_mfma_f32_16x16x32_bf16 v[40:43], v[120:123], a[212:215], v[40:43]
    v_mfma_f32_16x16x32_bf16 v[44:47], v[124:127], a[212:215], v[44:47]
    s_waitcnt vmcnt(14)
    s_waitcnt lgkmcnt(2)
    v_mfma_f32_16x16x32_bf16 v[16:19], v[96:99], a[48:51], v[16:19]
    v_mfma_f32_16x16x32_bf16 v[20:23], v[100:103], a[48:51], v[20:23]
    v_mfma_f32_16x16x32_bf16 v[24:27], v[96:99], a[104:107], v[24:27]
    v_mfma_f32_16x16x32_bf16 v[28:31], v[100:103], a[104:107], v[28:31]
    v_mfma_f32_16x16x32_bf16 v[32:35], v[96:99], a[160:163], v[32:35]
    v_mfma_f32_16x16x32_bf16 v[36:39], v[100:103], a[160:163], v[36:39]
    v_mfma_f32_16x16x32_bf16 v[40:43], v[96:99], a[216:219], v[40:43]
    v_mfma_f32_16x16x32_bf16 v[44:47], v[100:103], a[216:219], v[44:47]
    s_waitcnt lgkmcnt(0)
    v_mfma_f32_16x16x32_bf16 v[16:19], v[104:107], a[52:55], v[16:19]
    v_mfma_f32_16x16x32_bf16 v[20:23], v[108:111], a[52:55], v[20:23]
    v_mfma_f32_16x16x32_bf16 v[24:27], v[104:107], a[108:111], v[24:27]
    v_mfma_f32_16x16x32_bf16 v[28:31], v[108:111], a[108:111], v[28:31]
    v_mfma_f32_16x16x32_bf16 v[32:35], v[104:107], a[164:167], v[32:35]
    v_mfma_f32_16x16x32_bf16 v[36:39], v[108:111], a[164:167], v[36:39]
    v_mfma_f32_16x16x32_bf16 v[40:43], v[104:107], a[220:223], v[40:43]
    v_mfma_f32_16x16x32_bf16 v[44:47], v[108:111], a[220:223], v[44:47]
    s_waitcnt vmcnt(7)
    s_barrier
    s_add_u32 s22, s24, 86016
    s_mov_b32 m0, s22
    s_add_u32 s23, s19, 688128
    buffer_load_dwordx4 v1, s[4:7], s23 offen offset:0 lds
    buffer_load_dwordx4 v1, s[4:7], s23 offen offset:1024 lds
    buffer_load_dwordx4 v1, s[4:7], s23 offen offset:2048 lds
    buffer_load_dwordx4 v1, s[4:7], s23 offen offset:3072 lds
    s_add_u32 s22, s24, 90112
    s_mov_b32 m0, s22
    s_add_u32 s23, s19, 692224
    buffer_load_dwordx4 v1, s[4:7], s23 offen offset:0 lds
    buffer_load_dwordx4 v1, s[4:7], s23 offen offset:1024 lds
    buffer_load_dwordx4 v1, s[4:7], s23 offen offset:2048 lds
    ds_read_b128 v[96:99], v1 offset:28672
    ds_read_b128 v[100:103], v1 offset:43008
    ds_read_b128 v[104:107], v1 offset:29696
    ds_read_b128 v[108:111], v1 offset:44032
    ds_read_b128 v[112:115], v1 offset:30720
    ds_read_b128 v[116:119], v1 offset:45056
    ds_read_b128 v[120:123], v1 offset:31744
    ds_read_b128 v[124:127], v1 offset:46080
    s_waitcnt lgkmcnt(6)
    v_mfma_f32_16x16x32_bf16 v[48:51], v[96:99], a[0:3], 0
    v_mfma_f32_16x16x32_bf16 v[52:55], v[100:103], a[0:3], 0
    v_mfma_f32_16x16x32_bf16 v[56:59], v[96:99], a[56:59], 0
    v_mfma_f32_16x16x32_bf16 v[60:63], v[100:103], a[56:59], 0
    v_mfma_f32_16x16x32_bf16 v[64:67], v[96:99], a[112:115], 0
    v_mfma_f32_16x16x32_bf16 v[68:71], v[100:103], a[112:115], 0
    v_mfma_f32_16x16x32_bf16 v[72:75], v[96:99], a[168:171], 0
    v_mfma_f32_16x16x32_bf16 v[76:79], v[100:103], a[168:171], 0
    ds_read_b128 v[96:99], v1 offset:32768
    ds_read_b128 v[100:103], v1 offset:47104
    s_waitcnt lgkmcnt(6)
    v_mfma_f32_16x16x32_bf16 v[48:51], v[104:107], a[4:7], v[48:51]
    v_cvt_pk_bf16_f32 v80, v16, v17
    v_mfma_f32_16x16x32_bf16 v[52:55], v[108:111], a[4:7], v[52:55]
    v_cvt_pk_bf16_f32 v81, v32, v33
    v_mfma_f32_16x16x32_bf16 v[56:59], v[104:107], a[60:63], v[56:59]
    v_cvt_pk_bf16_f32 v82, v18, v19
    v_mfma_f32_16x16x32_bf16 v[60:63], v[108:111], a[60:63], v[60:63]
    v_cvt_pk_bf16_f32 v83, v34, v35
    v_mfma_f32_16x16x32_bf16 v[64:67], v[104:107], a[116:119], v[64:67]
    buffer_store_dwordx4 v[80:83], v1, s[4:7], s21 offen offset:0 sc1
    v_mfma_f32_16x16x32_bf16 v[68:71], v[108:111], a[116:119], v[68:71]
    v_cvt_pk_bf16_f32 v84, v20, v21
    v_mfma_f32_16x16x32_bf16 v[72:75], v[104:107], a[172:175], v[72:75]
    v_cvt_pk_bf16_f32 v85, v36, v37
    v_mfma_f32_16x16x32_bf16 v[76:79], v[108:111], a[172:175], v[76:79]
    v_cvt_pk_bf16_f32 v86, v22, v23
    ds_read_b128 v[104:107], v1 offset:33792
    ds_read_b128 v[108:111], v1 offset:48128
    s_waitcnt lgkmcnt(6)
    v_mfma_f32_16x16x32_bf16 v[48:51], v[112:115], a[8:11], v[48:51]
    v_cvt_pk_bf16_f32 v87, v38, v39
    v_mfma_f32_16x16x32_bf16 v[52:55], v[116:119], a[8:11], v[52:55]
    buffer_store_dwordx4 v[84:87], v1, s[4:7], s21 offen offset:1024 sc1
    v_mfma_f32_16x16x32_bf16 v[56:59], v[112:115], a[64:67], v[56:59]
    v_cvt_pk_bf16_f32 v88, v24, v25
    v_mfma_f32_16x16x32_bf16 v[60:63], v[116:119], a[64:67], v[60:63]
    v_cvt_pk_bf16_f32 v89, v40, v41
    v_mfma_f32_16x16x32_bf16 v[64:67], v[112:115], a[120:123], v[64:67]
    v_cvt_pk_bf16_f32 v90, v26, v27
    v_mfma_f32_16x16x32_bf16 v[68:71], v[116:119], a[120:123], v[68:71]
    v_cvt_pk_bf16_f32 v91, v42, v43
    v_mfma_f32_16x16x32_bf16 v[72:75], v[112:115], a[176:179], v[72:75]
    buffer_store_dwordx4 v[88:91], v1, s[4:7], s21 offen offset:2048 sc1
    v_mfma_f32_16x16x32_bf16 v[76:79], v[116:119], a[176:179], v[76:79]
    v_cvt_pk_bf16_f32 v92, v28, v29
    ds_read_b128 v[112:115], v1 offset:34816
    ds_read_b128 v[116:119], v1 offset:49152
    s_waitcnt lgkmcnt(6)
    v_mfma_f32_16x16x32_bf16 v[48:51], v[120:123], a[12:15], v[48:51]
    v_cvt_pk_bf16_f32 v93, v44, v45
    v_mfma_f32_16x16x32_bf16 v[52:55], v[124:127], a[12:15], v[52:55]
    v_cvt_pk_bf16_f32 v94, v30, v31
    v_mfma_f32_16x16x32_bf16 v[56:59], v[120:123], a[68:71], v[56:59]
    v_cvt_pk_bf16_f32 v95, v46, v47
    v_mfma_f32_16x16x32_bf16 v[60:63], v[124:127], a[68:71], v[60:63]
    buffer_store_dwordx4 v[92:95], v1, s[4:7], s21 offen offset:3072 sc1
    v_mfma_f32_16x16x32_bf16 v[64:67], v[120:123], a[124:127], v[64:67]
    s_add_u32 s21, s21, 3702784
    v_mfma_f32_16x16x32_bf16 v[68:71], v[124:127], a[124:127], v[68:71]
    v_mfma_f32_16x16x32_bf16 v[72:75], v[120:123], a[180:183], v[72:75]
    v_mfma_f32_16x16x32_bf16 v[76:79], v[124:127], a[180:183], v[76:79]
    ds_read_b128 v[120:123], v1 offset:35840
    ds_read_b128 v[124:127], v1 offset:50176
    s_waitcnt lgkmcnt(6)
    v_mfma_f32_16x16x32_bf16 v[48:51], v[96:99], a[16:19], v[48:51]
    v_mfma_f32_16x16x32_bf16 v[52:55], v[100:103], a[16:19], v[52:55]
    v_mfma_f32_16x16x32_bf16 v[56:59], v[96:99], a[72:75], v[56:59]
    v_mfma_f32_16x16x32_bf16 v[60:63], v[100:103], a[72:75], v[60:63]
    v_mfma_f32_16x16x32_bf16 v[64:67], v[96:99], a[128:131], v[64:67]
    v_mfma_f32_16x16x32_bf16 v[68:71], v[100:103], a[128:131], v[68:71]
    v_mfma_f32_16x16x32_bf16 v[72:75], v[96:99], a[184:187], v[72:75]
    v_mfma_f32_16x16x32_bf16 v[76:79], v[100:103], a[184:187], v[76:79]
    ds_read_b128 v[96:99], v1 offset:36864
    ds_read_b128 v[100:103], v1 offset:51200
    s_waitcnt lgkmcnt(6)
    v_mfma_f32_16x16x32_bf16 v[48:51], v[104:107], a[20:23], v[48:51]
    v_mfma_f32_16x16x32_bf16 v[52:55], v[108:111], a[20:23], v[52:55]
    v_mfma_f32_16x16x32_bf16 v[56:59], v[104:107], a[76:79], v[56:59]
    v_mfma_f32_16x16x32_bf16 v[60:63], v[108:111], a[76:79], v[60:63]
    v_mfma_f32_16x16x32_bf16 v[64:67], v[104:107], a[132:135], v[64:67]
    v_mfma_f32_16x16x32_bf16 v[68:71], v[108:111], a[132:135], v[68:71]
    v_mfma_f32_16x16x32_bf16 v[72:75], v[104:107], a[188:191], v[72:75]
    v_mfma_f32_16x16x32_bf16 v[76:79], v[108:111], a[188:191], v[76:79]
    s_waitcnt vmcnt(0)
    s_mov_b64 exec, 1
    s_add_u32 s22, s25, 0
    buffer_store_dword v2, v3, s[4:7], s22 offen sc1
    s_mov_b64 exec, -1
    ds_read_b128 v[104:107], v1 offset:37888
    ds_read_b128 v[108:111], v1 offset:52224
    s_waitcnt lgkmcnt(6)
    v_mfma_f32_16x16x32_bf16 v[48:51], v[112:115], a[24:27], v[48:51]
    v_mfma_f32_16x16x32_bf16 v[52:55], v[116:119], a[24:27], v[52:55]
    v_mfma_f32_16x16x32_bf16 v[56:59], v[112:115], a[80:83], v[56:59]
    v_mfma_f32_16x16x32_bf16 v[60:63], v[116:119], a[80:83], v[60:63]
    v_mfma_f32_16x16x32_bf16 v[64:67], v[112:115], a[136:139], v[64:67]
    v_mfma_f32_16x16x32_bf16 v[68:71], v[116:119], a[136:139], v[68:71]
    v_mfma_f32_16x16x32_bf16 v[72:75], v[112:115], a[192:195], v[72:75]
    v_mfma_f32_16x16x32_bf16 v[76:79], v[116:119], a[192:195], v[76:79]
    ds_read_b128 v[112:115], v1 offset:38912
    ds_read_b128 v[116:119], v1 offset:53248
    s_waitcnt lgkmcnt(6)
    v_mfma_f32_16x16x32_bf16 v[48:51], v[120:123], a[28:31], v[48:51]
    v_mfma_f32_16x16x32_bf16 v[52:55], v[124:127], a[28:31], v[52:55]
    v_mfma_f32_16x16x32_bf16 v[56:59], v[120:123], a[84:87], v[56:59]
    v_mfma_f32_16x16x32_bf16 v[60:63], v[124:127], a[84:87], v[60:63]
    v_mfma_f32_16x16x32_bf16 v[64:67], v[120:123], a[140:143], v[64:67]
    v_mfma_f32_16x16x32_bf16 v[68:71], v[124:127], a[140:143], v[68:71]
    v_mfma_f32_16x16x32_bf16 v[72:75], v[120:123], a[196:199], v[72:75]
    v_mfma_f32_16x16x32_bf16 v[76:79], v[124:127], a[196:199], v[76:79]
    ds_read_b128 v[120:123], v1 offset:39936
    ds_read_b128 v[124:127], v1 offset:54272
    s_waitcnt lgkmcnt(6)
    v_mfma_f32_16x16x32_bf16 v[48:51], v[96:99], a[32:35], v[48:51]
    v_mfma_f32_16x16x32_bf16 v[52:55], v[100:103], a[32:35], v[52:55]
    v_mfma_f32_16x16x32_bf16 v[56:59], v[96:99], a[88:91], v[56:59]
    v_mfma_f32_16x16x32_bf16 v[60:63], v[100:103], a[88:91], v[60:63]
    v_mfma_f32_16x16x32_bf16 v[64:67], v[96:99], a[144:147], v[64:67]
    v_mfma_f32_16x16x32_bf16 v[68:71], v[100:103], a[144:147], v[68:71]
    v_mfma_f32_16x16x32_bf16 v[72:75], v[96:99], a[200:203], v[72:75]
    v_mfma_f32_16x16x32_bf16 v[76:79], v[100:103], a[200:203], v[76:79]
    ds_read_b128 v[96:99], v1 offset:40960
    ds_read_b128 v[100:103], v1 offset:55296
    s_waitcnt lgkmcnt(6)
    v_mfma_f32_16x16x32_bf16 v[48:51], v[104:107], a[36:39], v[48:51]
    v_mfma_f32_16x16x32_bf16 v[52:55], v[108:111], a[36:39], v[52:55]
    v_mfma_f32_16x16x32_bf16 v[56:59], v[104:107], a[92:95], v[56:59]
    v_mfma_f32_16x16x32_bf16 v[60:63], v[108:111], a[92:95], v[60:63]
    v_mfma_f32_16x16x32_bf16 v[64:67], v[104:107], a[148:151], v[64:67]
    v_mfma_f32_16x16x32_bf16 v[68:71], v[108:111], a[148:151], v[68:71]
    v_mfma_f32_16x16x32_bf16 v[72:75], v[104:107], a[204:207], v[72:75]
    v_mfma_f32_16x16x32_bf16 v[76:79], v[108:111], a[204:207], v[76:79]
    ds_read_b128 v[104:107], v1 offset:41984
    ds_read_b128 v[108:111], v1 offset:56320
    s_waitcnt lgkmcnt(6)
    v_mfma_f32_16x16x32_bf16 v[48:51], v[112:115], a[40:43], v[48:51]
    v_mfma_f32_16x16x32_bf16 v[52:55], v[116:119], a[40:43], v[52:55]
    v_mfma_f32_16x16x32_bf16 v[56:59], v[112:115], a[96:99], v[56:59]
    v_mfma_f32_16x16x32_bf16 v[60:63], v[116:119], a[96:99], v[60:63]
    v_mfma_f32_16x16x32_bf16 v[64:67], v[112:115], a[152:155], v[64:67]
    v_mfma_f32_16x16x32_bf16 v[68:71], v[116:119], a[152:155], v[68:71]
    v_mfma_f32_16x16x32_bf16 v[72:75], v[112:115], a[208:211], v[72:75]
    v_mfma_f32_16x16x32_bf16 v[76:79], v[116:119], a[208:211], v[76:79]
    s_waitcnt lgkmcnt(4)
    v_mfma_f32_16x16x32_bf16 v[48:51], v[120:123], a[44:47], v[48:51]
    v_mfma_f32_16x16x32_bf16 v[52:55], v[124:127], a[44:47], v[52:55]
    v_mfma_f32_16x16x32_bf16 v[56:59], v[120:123], a[100:103], v[56:59]
    v_mfma_f32_16x16x32_bf16 v[60:63], v[124:127], a[100:103], v[60:63]
    v_mfma_f32_16x16x32_bf16 v[64:67], v[120:123], a[156:159], v[64:67]
    v_mfma_f32_16x16x32_bf16 v[68:71], v[124:127], a[156:159], v[68:71]
    v_mfma_f32_16x16x32_bf16 v[72:75], v[120:123], a[212:215], v[72:75]
    v_mfma_f32_16x16x32_bf16 v[76:79], v[124:127], a[212:215], v[76:79]
    s_waitcnt lgkmcnt(2)
    v_mfma_f32_16x16x32_bf16 v[48:51], v[96:99], a[48:51], v[48:51]
    v_mfma_f32_16x16x32_bf16 v[52:55], v[100:103], a[48:51], v[52:55]
    v_mfma_f32_16x16x32_bf16 v[56:59], v[96:99], a[104:107], v[56:59]
    v_mfma_f32_16x16x32_bf16 v[60:63], v[100:103], a[104:107], v[60:63]
    v_mfma_f32_16x16x32_bf16 v[64:67], v[96:99], a[160:163], v[64:67]
    v_mfma_f32_16x16x32_bf16 v[68:71], v[100:103], a[160:163], v[68:71]
    v_mfma_f32_16x16x32_bf16 v[72:75], v[96:99], a[216:219], v[72:75]
    v_mfma_f32_16x16x32_bf16 v[76:79], v[100:103], a[216:219], v[76:79]
    s_waitcnt lgkmcnt(0)
    v_mfma_f32_16x16x32_bf16 v[48:51], v[104:107], a[52:55], v[48:51]
    v_mfma_f32_16x16x32_bf16 v[52:55], v[108:111], a[52:55], v[52:55]
    v_mfma_f32_16x16x32_bf16 v[56:59], v[104:107], a[108:111], v[56:59]
    v_mfma_f32_16x16x32_bf16 v[60:63], v[108:111], a[108:111], v[60:63]
    v_mfma_f32_16x16x32_bf16 v[64:67], v[104:107], a[164:167], v[64:67]
    v_mfma_f32_16x16x32_bf16 v[68:71], v[108:111], a[164:167], v[68:71]
    v_mfma_f32_16x16x32_bf16 v[72:75], v[104:107], a[220:223], v[72:75]
    v_mfma_f32_16x16x32_bf16 v[76:79], v[108:111], a[220:223], v[76:79]
    s_barrier
    s_add_u32 s22, s24, 0
    s_mov_b32 m0, s22
    s_add_u32 s23, s19, 917504
    buffer_load_dwordx4 v1, s[4:7], s23 offen offset:0 lds
    buffer_load_dwordx4 v1, s[4:7], s23 offen offset:1024 lds
    buffer_load_dwordx4 v1, s[4:7], s23 offen offset:2048 lds
    buffer_load_dwordx4 v1, s[4:7], s23 offen offset:3072 lds
    s_add_u32 s22, s24, 4096
    s_mov_b32 m0, s22
    s_add_u32 s23, s19, 921600
    buffer_load_dwordx4 v1, s[4:7], s23 offen offset:0 lds
    buffer_load_dwordx4 v1, s[4:7], s23 offen offset:1024 lds
    buffer_load_dwordx4 v1, s[4:7], s23 offen offset:2048 lds
    ds_read_b128 v[96:99], v4 offset:0
    ds_read_b128 v[100:103], v4 offset:14336
    ds_read_b128 v[104:107], v4 offset:1024
    ds_read_b128 v[108:111], v4 offset:15360
    ds_read_b128 v[112:115], v4 offset:2048
    ds_read_b128 v[116:119], v4 offset:16384
    ds_read_b128 v[120:123], v4 offset:3072
    ds_read_b128 v[124:127], v4 offset:17408
    s_waitcnt lgkmcnt(6)
    v_mfma_f32_16x16x32_bf16 v[16:19], v[96:99], a[0:3], 0
    v_mfma_f32_16x16x32_bf16 v[20:23], v[100:103], a[0:3], 0
    v_mfma_f32_16x16x32_bf16 v[24:27], v[96:99], a[56:59], 0
    v_mfma_f32_16x16x32_bf16 v[28:31], v[100:103], a[56:59], 0
    v_mfma_f32_16x16x32_bf16 v[32:35], v[96:99], a[112:115], 0
    v_mfma_f32_16x16x32_bf16 v[36:39], v[100:103], a[112:115], 0
    v_mfma_f32_16x16x32_bf16 v[40:43], v[96:99], a[168:171], 0
    v_mfma_f32_16x16x32_bf16 v[44:47], v[100:103], a[168:171], 0
    ds_read_b128 v[96:99], v4 offset:4096
    ds_read_b128 v[100:103], v4 offset:18432
    s_waitcnt lgkmcnt(6)
    v_mfma_f32_16x16x32_bf16 v[16:19], v[104:107], a[4:7], v[16:19]
    v_cvt_pk_bf16_f32 v80, v48, v49
    v_mfma_f32_16x16x32_bf16 v[20:23], v[108:111], a[4:7], v[20:23]
    v_cvt_pk_bf16_f32 v81, v64, v65
    v_mfma_f32_16x16x32_bf16 v[24:27], v[104:107], a[60:63], v[24:27]
    v_cvt_pk_bf16_f32 v82, v50, v51
    v_mfma_f32_16x16x32_bf16 v[28:31], v[108:111], a[60:63], v[28:31]
    v_cvt_pk_bf16_f32 v83, v66, v67
    v_mfma_f32_16x16x32_bf16 v[32:35], v[104:107], a[116:119], v[32:35]
    buffer_store_dwordx4 v[80:83], v1, s[4:7], s21 offen offset:0 sc1
    v_mfma_f32_16x16x32_bf16 v[36:39], v[108:111], a[116:119], v[36:39]
    v_cvt_pk_bf16_f32 v84, v52, v53
    v_mfma_f32_16x16x32_bf16 v[40:43], v[104:107], a[172:175], v[40:43]
    v_cvt_pk_bf16_f32 v85, v68, v69
    v_mfma_f32_16x16x32_bf16 v[44:47], v[108:111], a[172:175], v[44:47]
    v_cvt_pk_bf16_f32 v86, v54, v55
    ds_read_b128 v[104:107], v4 offset:5120
    ds_read_b128 v[108:111], v4 offset:19456
    s_waitcnt lgkmcnt(6)
    v_mfma_f32_16x16x32_bf16 v[16:19], v[112:115], a[8:11], v[16:19]
    v_cvt_pk_bf16_f32 v87, v70, v71
    v_mfma_f32_16x16x32_bf16 v[20:23], v[116:119], a[8:11], v[20:23]
    buffer_store_dwordx4 v[84:87], v1, s[4:7], s21 offen offset:1024 sc1
    v_mfma_f32_16x16x32_bf16 v[24:27], v[112:115], a[64:67], v[24:27]
    v_cvt_pk_bf16_f32 v88, v56, v57
    v_mfma_f32_16x16x32_bf16 v[28:31], v[116:119], a[64:67], v[28:31]
    v_cvt_pk_bf16_f32 v89, v72, v73
    v_mfma_f32_16x16x32_bf16 v[32:35], v[112:115], a[120:123], v[32:35]
    v_cvt_pk_bf16_f32 v90, v58, v59
    v_mfma_f32_16x16x32_bf16 v[36:39], v[116:119], a[120:123], v[36:39]
    v_cvt_pk_bf16_f32 v91, v74, v75
    v_mfma_f32_16x16x32_bf16 v[40:43], v[112:115], a[176:179], v[40:43]
    buffer_store_dwordx4 v[88:91], v1, s[4:7], s21 offen offset:2048 sc1
    v_mfma_f32_16x16x32_bf16 v[44:47], v[116:119], a[176:179], v[44:47]
    v_cvt_pk_bf16_f32 v92, v60, v61
    ds_read_b128 v[112:115], v4 offset:6144
    ds_read_b128 v[116:119], v4 offset:20480
    s_waitcnt lgkmcnt(6)
    v_mfma_f32_16x16x32_bf16 v[16:19], v[120:123], a[12:15], v[16:19]
    v_cvt_pk_bf16_f32 v93, v76, v77
    v_mfma_f32_16x16x32_bf16 v[20:23], v[124:127], a[12:15], v[20:23]
    v_cvt_pk_bf16_f32 v94, v62, v63
    v_mfma_f32_16x16x32_bf16 v[24:27], v[120:123], a[68:71], v[24:27]
    v_cvt_pk_bf16_f32 v95, v78, v79
    v_mfma_f32_16x16x32_bf16 v[28:31], v[124:127], a[68:71], v[28:31]
    buffer_store_dwordx4 v[92:95], v1, s[4:7], s21 offen offset:3072 sc1
    v_mfma_f32_16x16x32_bf16 v[32:35], v[120:123], a[124:127], v[32:35]
    s_add_u32 s21, s21, 3702784
    v_mfma_f32_16x16x32_bf16 v[36:39], v[124:127], a[124:127], v[36:39]
    v_mfma_f32_16x16x32_bf16 v[40:43], v[120:123], a[180:183], v[40:43]
    v_mfma_f32_16x16x32_bf16 v[44:47], v[124:127], a[180:183], v[44:47]
    ds_read_b128 v[120:123], v4 offset:7168
    ds_read_b128 v[124:127], v4 offset:21504
    s_waitcnt lgkmcnt(6)
    v_mfma_f32_16x16x32_bf16 v[16:19], v[96:99], a[16:19], v[16:19]
    v_mfma_f32_16x16x32_bf16 v[20:23], v[100:103], a[16:19], v[20:23]
    v_mfma_f32_16x16x32_bf16 v[24:27], v[96:99], a[72:75], v[24:27]
    v_mfma_f32_16x16x32_bf16 v[28:31], v[100:103], a[72:75], v[28:31]
    v_mfma_f32_16x16x32_bf16 v[32:35], v[96:99], a[128:131], v[32:35]
    v_mfma_f32_16x16x32_bf16 v[36:39], v[100:103], a[128:131], v[36:39]
    v_mfma_f32_16x16x32_bf16 v[40:43], v[96:99], a[184:187], v[40:43]
    v_mfma_f32_16x16x32_bf16 v[44:47], v[100:103], a[184:187], v[44:47]
    ds_read_b128 v[96:99], v4 offset:8192
    ds_read_b128 v[100:103], v4 offset:22528
    s_waitcnt lgkmcnt(6)
    v_mfma_f32_16x16x32_bf16 v[16:19], v[104:107], a[20:23], v[16:19]
    v_mfma_f32_16x16x32_bf16 v[20:23], v[108:111], a[20:23], v[20:23]
    v_mfma_f32_16x16x32_bf16 v[24:27], v[104:107], a[76:79], v[24:27]
    v_mfma_f32_16x16x32_bf16 v[28:31], v[108:111], a[76:79], v[28:31]
    v_mfma_f32_16x16x32_bf16 v[32:35], v[104:107], a[132:135], v[32:35]
    v_mfma_f32_16x16x32_bf16 v[36:39], v[108:111], a[132:135], v[36:39]
    v_mfma_f32_16x16x32_bf16 v[40:43], v[104:107], a[188:191], v[40:43]
    v_mfma_f32_16x16x32_bf16 v[44:47], v[108:111], a[188:191], v[44:47]
    ds_read_b128 v[104:107], v4 offset:9216
    ds_read_b128 v[108:111], v4 offset:23552
    s_waitcnt lgkmcnt(6)
    v_mfma_f32_16x16x32_bf16 v[16:19], v[112:115], a[24:27], v[16:19]
    v_mfma_f32_16x16x32_bf16 v[20:23], v[116:119], a[24:27], v[20:23]
    v_mfma_f32_16x16x32_bf16 v[24:27], v[112:115], a[80:83], v[24:27]
    v_mfma_f32_16x16x32_bf16 v[28:31], v[116:119], a[80:83], v[28:31]
    v_mfma_f32_16x16x32_bf16 v[32:35], v[112:115], a[136:139], v[32:35]
    v_mfma_f32_16x16x32_bf16 v[36:39], v[116:119], a[136:139], v[36:39]
    v_mfma_f32_16x16x32_bf16 v[40:43], v[112:115], a[192:195], v[40:43]
    v_mfma_f32_16x16x32_bf16 v[44:47], v[116:119], a[192:195], v[44:47]
    ds_read_b128 v[112:115], v4 offset:10240
    ds_read_b128 v[116:119], v4 offset:24576
    s_waitcnt lgkmcnt(6)
    v_mfma_f32_16x16x32_bf16 v[16:19], v[120:123], a[28:31], v[16:19]
    v_mfma_f32_16x16x32_bf16 v[20:23], v[124:127], a[28:31], v[20:23]
    v_mfma_f32_16x16x32_bf16 v[24:27], v[120:123], a[84:87], v[24:27]
    v_mfma_f32_16x16x32_bf16 v[28:31], v[124:127], a[84:87], v[28:31]
    v_mfma_f32_16x16x32_bf16 v[32:35], v[120:123], a[140:143], v[32:35]
    v_mfma_f32_16x16x32_bf16 v[36:39], v[124:127], a[140:143], v[36:39]
    v_mfma_f32_16x16x32_bf16 v[40:43], v[120:123], a[196:199], v[40:43]
    v_mfma_f32_16x16x32_bf16 v[44:47], v[124:127], a[196:199], v[44:47]
    ds_read_b128 v[120:123], v4 offset:11264
    ds_read_b128 v[124:127], v4 offset:25600
    s_waitcnt lgkmcnt(6)
    v_mfma_f32_16x16x32_bf16 v[16:19], v[96:99], a[32:35], v[16:19]
    v_mfma_f32_16x16x32_bf16 v[20:23], v[100:103], a[32:35], v[20:23]
    v_mfma_f32_16x16x32_bf16 v[24:27], v[96:99], a[88:91], v[24:27]
    v_mfma_f32_16x16x32_bf16 v[28:31], v[100:103], a[88:91], v[28:31]
    v_mfma_f32_16x16x32_bf16 v[32:35], v[96:99], a[144:147], v[32:35]
    v_mfma_f32_16x16x32_bf16 v[36:39], v[100:103], a[144:147], v[36:39]
    v_mfma_f32_16x16x32_bf16 v[40:43], v[96:99], a[200:203], v[40:43]
    v_mfma_f32_16x16x32_bf16 v[44:47], v[100:103], a[200:203], v[44:47]
    ds_read_b128 v[96:99], v4 offset:12288
    ds_read_b128 v[100:103], v4 offset:26624
    s_waitcnt lgkmcnt(6)
    v_mfma_f32_16x16x32_bf16 v[16:19], v[104:107], a[36:39], v[16:19]
    v_mfma_f32_16x16x32_bf16 v[20:23], v[108:111], a[36:39], v[20:23]
    v_mfma_f32_16x16x32_bf16 v[24:27], v[104:107], a[92:95], v[24:27]
    v_mfma_f32_16x16x32_bf16 v[28:31], v[108:111], a[92:95], v[28:31]
    v_mfma_f32_16x16x32_bf16 v[32:35], v[104:107], a[148:151], v[32:35]
    v_mfma_f32_16x16x32_bf16 v[36:39], v[108:111], a[148:151], v[36:39]
    v_mfma_f32_16x16x32_bf16 v[40:43], v[104:107], a[204:207], v[40:43]
    v_mfma_f32_16x16x32_bf16 v[44:47], v[108:111], a[204:207], v[44:47]
    ds_read_b128 v[104:107], v4 offset:13312
    ds_read_b128 v[108:111], v4 offset:27648
    s_waitcnt lgkmcnt(6)
    v_mfma_f32_16x16x32_bf16 v[16:19], v[112:115], a[40:43], v[16:19]
    v_mfma_f32_16x16x32_bf16 v[20:23], v[116:119], a[40:43], v[20:23]
    v_mfma_f32_16x16x32_bf16 v[24:27], v[112:115], a[96:99], v[24:27]
    v_mfma_f32_16x16x32_bf16 v[28:31], v[116:119], a[96:99], v[28:31]
    v_mfma_f32_16x16x32_bf16 v[32:35], v[112:115], a[152:155], v[32:35]
    v_mfma_f32_16x16x32_bf16 v[36:39], v[116:119], a[152:155], v[36:39]
    v_mfma_f32_16x16x32_bf16 v[40:43], v[112:115], a[208:211], v[40:43]
    v_mfma_f32_16x16x32_bf16 v[44:47], v[116:119], a[208:211], v[44:47]
    s_waitcnt lgkmcnt(4)
    v_mfma_f32_16x16x32_bf16 v[16:19], v[120:123], a[44:47], v[16:19]
    v_mfma_f32_16x16x32_bf16 v[20:23], v[124:127], a[44:47], v[20:23]
    v_mfma_f32_16x16x32_bf16 v[24:27], v[120:123], a[100:103], v[24:27]
    v_mfma_f32_16x16x32_bf16 v[28:31], v[124:127], a[100:103], v[28:31]
    v_mfma_f32_16x16x32_bf16 v[32:35], v[120:123], a[156:159], v[32:35]
    v_mfma_f32_16x16x32_bf16 v[36:39], v[124:127], a[156:159], v[36:39]
    v_mfma_f32_16x16x32_bf16 v[40:43], v[120:123], a[212:215], v[40:43]
    v_mfma_f32_16x16x32_bf16 v[44:47], v[124:127], a[212:215], v[44:47]
    s_waitcnt lgkmcnt(2)
    v_mfma_f32_16x16x32_bf16 v[16:19], v[96:99], a[48:51], v[16:19]
    v_mfma_f32_16x16x32_bf16 v[20:23], v[100:103], a[48:51], v[20:23]
    v_mfma_f32_16x16x32_bf16 v[24:27], v[96:99], a[104:107], v[24:27]
    v_mfma_f32_16x16x32_bf16 v[28:31], v[100:103], a[104:107], v[28:31]
    v_mfma_f32_16x16x32_bf16 v[32:35], v[96:99], a[160:163], v[32:35]
    v_mfma_f32_16x16x32_bf16 v[36:39], v[100:103], a[160:163], v[36:39]
    v_mfma_f32_16x16x32_bf16 v[40:43], v[96:99], a[216:219], v[40:43]
    v_mfma_f32_16x16x32_bf16 v[44:47], v[100:103], a[216:219], v[44:47]
    s_waitcnt lgkmcnt(0)
    v_mfma_f32_16x16x32_bf16 v[16:19], v[104:107], a[52:55], v[16:19]
    v_mfma_f32_16x16x32_bf16 v[20:23], v[108:111], a[52:55], v[20:23]
    v_mfma_f32_16x16x32_bf16 v[24:27], v[104:107], a[108:111], v[24:27]
    v_mfma_f32_16x16x32_bf16 v[28:31], v[108:111], a[108:111], v[28:31]
    v_mfma_f32_16x16x32_bf16 v[32:35], v[104:107], a[164:167], v[32:35]
    v_mfma_f32_16x16x32_bf16 v[36:39], v[108:111], a[164:167], v[36:39]
    v_mfma_f32_16x16x32_bf16 v[40:43], v[104:107], a[220:223], v[40:43]
    v_mfma_f32_16x16x32_bf16 v[44:47], v[108:111], a[220:223], v[44:47]
    s_waitcnt vmcnt(0)
    s_mov_b64 exec, 1
    s_add_u32 s22, s25, 3584
    buffer_store_dword v2, v3, s[4:7], s22 offen sc1
    s_mov_b64 exec, -1
    s_barrier
    s_add_u32 s22, s24, 28672
    s_mov_b32 m0, s22
    s_add_u32 s23, s19, 1146880
    buffer_load_dwordx4 v1, s[4:7], s23 offen offset:0 lds
    buffer_load_dwordx4 v1, s[4:7], s23 offen offset:1024 lds
    buffer_load_dwordx4 v1, s[4:7], s23 offen offset:2048 lds
    buffer_load_dwordx4 v1, s[4:7], s23 offen offset:3072 lds
    s_add_u32 s22, s24, 32768
    s_mov_b32 m0, s22
    s_add_u32 s23, s19, 1150976
    buffer_load_dwordx4 v1, s[4:7], s23 offen offset:0 lds
    buffer_load_dwordx4 v1, s[4:7], s23 offen offset:1024 lds
    buffer_load_dwordx4 v1, s[4:7], s23 offen offset:2048 lds
    ds_read_b128 v[96:99], v4 offset:28672
    ds_read_b128 v[100:103], v4 offset:43008
    ds_read_b128 v[104:107], v4 offset:29696
    ds_read_b128 v[108:111], v4 offset:44032
    ds_read_b128 v[112:115], v4 offset:30720
    ds_read_b128 v[116:119], v4 offset:45056
    ds_read_b128 v[120:123], v4 offset:31744
    ds_read_b128 v[124:127], v4 offset:46080
    s_waitcnt lgkmcnt(6)
    v_mfma_f32_16x16x32_bf16 v[48:51], v[96:99], a[0:3], 0
    v_mfma_f32_16x16x32_bf16 v[52:55], v[100:103], a[0:3], 0
    v_mfma_f32_16x16x32_bf16 v[56:59], v[96:99], a[56:59], 0
    v_mfma_f32_16x16x32_bf16 v[60:63], v[100:103], a[56:59], 0
    v_mfma_f32_16x16x32_bf16 v[64:67], v[96:99], a[112:115], 0
    v_mfma_f32_16x16x32_bf16 v[68:71], v[100:103], a[112:115], 0
    v_mfma_f32_16x16x32_bf16 v[72:75], v[96:99], a[168:171], 0
    v_mfma_f32_16x16x32_bf16 v[76:79], v[100:103], a[168:171], 0
    ds_read_b128 v[96:99], v4 offset:32768
    ds_read_b128 v[100:103], v4 offset:47104
    s_waitcnt lgkmcnt(6)
    v_mfma_f32_16x16x32_bf16 v[48:51], v[104:107], a[4:7], v[48:51]
    v_cvt_pk_bf16_f32 v80, v16, v17
    v_mfma_f32_16x16x32_bf16 v[52:55], v[108:111], a[4:7], v[52:55]
    v_cvt_pk_bf16_f32 v81, v32, v33
    v_mfma_f32_16x16x32_bf16 v[56:59], v[104:107], a[60:63], v[56:59]
    v_cvt_pk_bf16_f32 v82, v18, v19
    v_mfma_f32_16x16x32_bf16 v[60:63], v[108:111], a[60:63], v[60:63]
    v_cvt_pk_bf16_f32 v83, v34, v35
    v_mfma_f32_16x16x32_bf16 v[64:67], v[104:107], a[116:119], v[64:67]
    buffer_store_dwordx4 v[80:83], v1, s[4:7], s21 offen offset:0 sc1
    v_mfma_f32_16x16x32_bf16 v[68:71], v[108:111], a[116:119], v[68:71]
    v_cvt_pk_bf16_f32 v84, v20, v21
    v_mfma_f32_16x16x32_bf16 v[72:75], v[104:107], a[172:175], v[72:75]
    v_cvt_pk_bf16_f32 v85, v36, v37
    v_mfma_f32_16x16x32_bf16 v[76:79], v[108:111], a[172:175], v[76:79]
    v_cvt_pk_bf16_f32 v86, v22, v23
    ds_read_b128 v[104:107], v4 offset:33792
    ds_read_b128 v[108:111], v4 offset:48128
    s_waitcnt lgkmcnt(6)
    v_mfma_f32_16x16x32_bf16 v[48:51], v[112:115], a[8:11], v[48:51]
    v_cvt_pk_bf16_f32 v87, v38, v39
    v_mfma_f32_16x16x32_bf16 v[52:55], v[116:119], a[8:11], v[52:55]
    buffer_store_dwordx4 v[84:87], v1, s[4:7], s21 offen offset:1024 sc1
    v_mfma_f32_16x16x32_bf16 v[56:59], v[112:115], a[64:67], v[56:59]
    v_cvt_pk_bf16_f32 v88, v24, v25
    v_mfma_f32_16x16x32_bf16 v[60:63], v[116:119], a[64:67], v[60:63]
    v_cvt_pk_bf16_f32 v89, v40, v41
    v_mfma_f32_16x16x32_bf16 v[64:67], v[112:115], a[120:123], v[64:67]
    v_cvt_pk_bf16_f32 v90, v26, v27
    v_mfma_f32_16x16x32_bf16 v[68:71], v[116:119], a[120:123], v[68:71]
    v_cvt_pk_bf16_f32 v91, v42, v43
    v_mfma_f32_16x16x32_bf16 v[72:75], v[112:115], a[176:179], v[72:75]
    buffer_store_dwordx4 v[88:91], v1, s[4:7], s21 offen offset:2048 sc1
    v_mfma_f32_16x16x32_bf16 v[76:79], v[116:119], a[176:179], v[76:79]
    v_cvt_pk_bf16_f32 v92, v28, v29
    ds_read_b128 v[112:115], v4 offset:34816
    ds_read_b128 v[116:119], v4 offset:49152
    s_waitcnt lgkmcnt(6)
    v_mfma_f32_16x16x32_bf16 v[48:51], v[120:123], a[12:15], v[48:51]
    v_cvt_pk_bf16_f32 v93, v44, v45
    v_mfma_f32_16x16x32_bf16 v[52:55], v[124:127], a[12:15], v[52:55]
    v_cvt_pk_bf16_f32 v94, v30, v31
    v_mfma_f32_16x16x32_bf16 v[56:59], v[120:123], a[68:71], v[56:59]
    v_cvt_pk_bf16_f32 v95, v46, v47
    v_mfma_f32_16x16x32_bf16 v[60:63], v[124:127], a[68:71], v[60:63]
    buffer_store_dwordx4 v[92:95], v1, s[4:7], s21 offen offset:3072 sc1
    v_mfma_f32_16x16x32_bf16 v[64:67], v[120:123], a[124:127], v[64:67]
    s_add_u32 s21, s21, 3702784
    v_mfma_f32_16x16x32_bf16 v[68:71], v[124:127], a[124:127], v[68:71]
    v_mfma_f32_16x16x32_bf16 v[72:75], v[120:123], a[180:183], v[72:75]
    v_mfma_f32_16x16x32_bf16 v[76:79], v[124:127], a[180:183], v[76:79]
    ds_read_b128 v[120:123], v4 offset:35840
    ds_read_b128 v[124:127], v4 offset:50176
    s_waitcnt lgkmcnt(6)
    v_mfma_f32_16x16x32_bf16 v[48:51], v[96:99], a[16:19], v[48:51]
    v_mfma_f32_16x16x32_bf16 v[52:55], v[100:103], a[16:19], v[52:55]
    v_mfma_f32_16x16x32_bf16 v[56:59], v[96:99], a[72:75], v[56:59]
    v_mfma_f32_16x16x32_bf16 v[60:63], v[100:103], a[72:75], v[60:63]
    v_mfma_f32_16x16x32_bf16 v[64:67], v[96:99], a[128:131], v[64:67]
    v_mfma_f32_16x16x32_bf16 v[68:71], v[100:103], a[128:131], v[68:71]
    v_mfma_f32_16x16x32_bf16 v[72:75], v[96:99], a[184:187], v[72:75]
    v_mfma_f32_16x16x32_bf16 v[76:79], v[100:103], a[184:187], v[76:79]
    ds_read_b128 v[96:99], v4 offset:36864
    ds_read_b128 v[100:103], v4 offset:51200
    s_waitcnt lgkmcnt(6)
    v_mfma_f32_16x16x32_bf16 v[48:51], v[104:107], a[20:23], v[48:51]
    v_mfma_f32_16x16x32_bf16 v[52:55], v[108:111], a[20:23], v[52:55]
    v_mfma_f32_16x16x32_bf16 v[56:59], v[104:107], a[76:79], v[56:59]
    v_mfma_f32_16x16x32_bf16 v[60:63], v[108:111], a[76:79], v[60:63]
    v_mfma_f32_16x16x32_bf16 v[64:67], v[104:107], a[132:135], v[64:67]
    v_mfma_f32_16x16x32_bf16 v[68:71], v[108:111], a[132:135], v[68:71]
    v_mfma_f32_16x16x32_bf16 v[72:75], v[104:107], a[188:191], v[72:75]
    v_mfma_f32_16x16x32_bf16 v[76:79], v[108:111], a[188:191], v[76:79]
    ds_read_b128 v[104:107], v4 offset:37888
    ds_read_b128 v[108:111], v4 offset:52224
    s_waitcnt lgkmcnt(6)
    v_mfma_f32_16x16x32_bf16 v[48:51], v[112:115], a[24:27], v[48:51]
    v_mfma_f32_16x16x32_bf16 v[52:55], v[116:119], a[24:27], v[52:55]
    v_mfma_f32_16x16x32_bf16 v[56:59], v[112:115], a[80:83], v[56:59]
    v_mfma_f32_16x16x32_bf16 v[60:63], v[116:119], a[80:83], v[60:63]
    v_mfma_f32_16x16x32_bf16 v[64:67], v[112:115], a[136:139], v[64:67]
    v_mfma_f32_16x16x32_bf16 v[68:71], v[116:119], a[136:139], v[68:71]
    v_mfma_f32_16x16x32_bf16 v[72:75], v[112:115], a[192:195], v[72:75]
    v_mfma_f32_16x16x32_bf16 v[76:79], v[116:119], a[192:195], v[76:79]
    ds_read_b128 v[112:115], v4 offset:38912
    ds_read_b128 v[116:119], v4 offset:53248
    s_waitcnt lgkmcnt(6)
    v_mfma_f32_16x16x32_bf16 v[48:51], v[120:123], a[28:31], v[48:51]
    v_mfma_f32_16x16x32_bf16 v[52:55], v[124:127], a[28:31], v[52:55]
    v_mfma_f32_16x16x32_bf16 v[56:59], v[120:123], a[84:87], v[56:59]
    v_mfma_f32_16x16x32_bf16 v[60:63], v[124:127], a[84:87], v[60:63]
    v_mfma_f32_16x16x32_bf16 v[64:67], v[120:123], a[140:143], v[64:67]
    v_mfma_f32_16x16x32_bf16 v[68:71], v[124:127], a[140:143], v[68:71]
    v_mfma_f32_16x16x32_bf16 v[72:75], v[120:123], a[196:199], v[72:75]
    v_mfma_f32_16x16x32_bf16 v[76:79], v[124:127], a[196:199], v[76:79]
    ds_read_b128 v[120:123], v4 offset:39936
    ds_read_b128 v[124:127], v4 offset:54272
    s_waitcnt lgkmcnt(6)
    v_mfma_f32_16x16x32_bf16 v[48:51], v[96:99], a[32:35], v[48:51]
    v_mfma_f32_16x16x32_bf16 v[52:55], v[100:103], a[32:35], v[52:55]
    v_mfma_f32_16x16x32_bf16 v[56:59], v[96:99], a[88:91], v[56:59]
    v_mfma_f32_16x16x32_bf16 v[60:63], v[100:103], a[88:91], v[60:63]
    v_mfma_f32_16x16x32_bf16 v[64:67], v[96:99], a[144:147], v[64:67]
    v_mfma_f32_16x16x32_bf16 v[68:71], v[100:103], a[144:147], v[68:71]
    v_mfma_f32_16x16x32_bf16 v[72:75], v[96:99], a[200:203], v[72:75]
    v_mfma_f32_16x16x32_bf16 v[76:79], v[100:103], a[200:203], v[76:79]
    ds_read_b128 v[96:99], v4 offset:40960
    ds_read_b128 v[100:103], v4 offset:55296
    s_waitcnt lgkmcnt(6)
    v_mfma_f32_16x16x32_bf16 v[48:51], v[104:107], a[36:39], v[48:51]
    v_mfma_f32_16x16x32_bf16 v[52:55], v[108:111], a[36:39], v[52:55]
    v_mfma_f32_16x16x32_bf16 v[56:59], v[104:107], a[92:95], v[56:59]
    v_mfma_f32_16x16x32_bf16 v[60:63], v[108:111], a[92:95], v[60:63]
    v_mfma_f32_16x16x32_bf16 v[64:67], v[104:107], a[148:151], v[64:67]
    v_mfma_f32_16x16x32_bf16 v[68:71], v[108:111], a[148:151], v[68:71]
    v_mfma_f32_16x16x32_bf16 v[72:75], v[104:107], a[204:207], v[72:75]
    v_mfma_f32_16x16x32_bf16 v[76:79], v[108:111], a[204:207], v[76:79]
    ds_read_b128 v[104:107], v4 offset:41984
    ds_read_b128 v[108:111], v4 offset:56320
    s_waitcnt lgkmcnt(6)
    v_mfma_f32_16x16x32_bf16 v[48:51], v[112:115], a[40:43], v[48:51]
    v_mfma_f32_16x16x32_bf16 v[52:55], v[116:119], a[40:43], v[52:55]
    v_mfma_f32_16x16x32_bf16 v[56:59], v[112:115], a[96:99], v[56:59]
    v_mfma_f32_16x16x32_bf16 v[60:63], v[116:119], a[96:99], v[60:63]
    v_mfma_f32_16x16x32_bf16 v[64:67], v[112:115], a[152:155], v[64:67]
    v_mfma_f32_16x16x32_bf16 v[68:71], v[116:119], a[152:155], v[68:71]
    v_mfma_f32_16x16x32_bf16 v[72:75], v[112:115], a[208:211], v[72:75]
    v_mfma_f32_16x16x32_bf16 v[76:79], v[116:119], a[208:211], v[76:79]
    s_waitcnt lgkmcnt(4)
    v_mfma_f32_16x16x32_bf16 v[48:51], v[120:123], a[44:47], v[48:51]
    v_mfma_f32_16x16x32_bf16 v[52:55], v[124:127], a[44:47], v[52:55]
    v_mfma_f32_16x16x32_bf16 v[56:59], v[120:123], a[100:103], v[56:59]
    v_mfma_f32_16x16x32_bf16 v[60:63], v[124:127], a[100:103], v[60:63]
    v_mfma_f32_16x16x32_bf16 v[64:67], v[120:123], a[156:159], v[64:67]
    v_mfma_f32_16x16x32_bf16 v[68:71], v[124:127], a[156:159], v[68:71]
    v_mfma_f32_16x16x32_bf16 v[72:75], v[120:123], a[212:215], v[72:75]
    v_mfma_f32_16x16x32_bf16 v[76:79], v[124:127], a[212:215], v[76:79]
    s_waitcnt lgkmcnt(2)
    v_mfma_f32_16x16x32_bf16 v[48:51], v[96:99], a[48:51], v[48:51]
    v_mfma_f32_16x16x32_bf16 v[52:55], v[100:103], a[48:51], v[52:55]
    v_mfma_f32_16x16x32_bf16 v[56:59], v[96:99], a[104:107], v[56:59]
    v_mfma_f32_16x16x32_bf16 v[60:63], v[100:103], a[104:107], v[60:63]
    v_mfma_f32_16x16x32_bf16 v[64:67], v[96:99], a[160:163], v[64:67]
    v_mfma_f32_16x16x32_bf16 v[68:71], v[100:103], a[160:163], v[68:71]
    v_mfma_f32_16x16x32_bf16 v[72:75], v[96:99], a[216:219], v[72:75]
    v_mfma_f32_16x16x32_bf16 v[76:79], v[100:103], a[216:219], v[76:79]
    s_waitcnt lgkmcnt(0)
    v_mfma_f32_16x16x32_bf16 v[48:51], v[104:107], a[52:55], v[48:51]
    v_mfma_f32_16x16x32_bf16 v[52:55], v[108:111], a[52:55], v[52:55]
    v_mfma_f32_16x16x32_bf16 v[56:59], v[104:107], a[108:111], v[56:59]
    v_mfma_f32_16x16x32_bf16 v[60:63], v[108:111], a[108:111], v[60:63]
    v_mfma_f32_16x16x32_bf16 v[64:67], v[104:107], a[164:167], v[64:67]
    v_mfma_f32_16x16x32_bf16 v[68:71], v[108:111], a[164:167], v[68:71]
    v_mfma_f32_16x16x32_bf16 v[72:75], v[104:107], a[220:223], v[72:75]
    v_mfma_f32_16x16x32_bf16 v[76:79], v[108:111], a[220:223], v[76:79]
    s_waitcnt vmcnt(0)
    s_mov_b64 exec, 1
    s_add_u32 s22, s25, 7168
    buffer_store_dword v2, v3, s[4:7], s22 offen sc1
    s_mov_b64 exec, -1
    s_barrier
    s_add_u32 s22, s24, 57344
    s_mov_b32 m0, s22
    s_add_u32 s23, s19, 1376256
    buffer_load_dwordx4 v1, s[4:7], s23 offen offset:0 lds
    buffer_load_dwordx4 v1, s[4:7], s23 offen offset:1024 lds
    buffer_load_dwordx4 v1, s[4:7], s23 offen offset:2048 lds
    buffer_load_dwordx4 v1, s[4:7], s23 offen offset:3072 lds
    s_add_u32 s22, s24, 61440
    s_mov_b32 m0, s22
    s_add_u32 s23, s19, 1380352
    buffer_load_dwordx4 v1, s[4:7], s23 offen offset:0 lds
    buffer_load_dwordx4 v1, s[4:7], s23 offen offset:1024 lds
    buffer_load_dwordx4 v1, s[4:7], s23 offen offset:2048 lds
    ds_read_b128 v[96:99], v1 offset:0
    ds_read_b128 v[100:103], v1 offset:14336
    ds_read_b128 v[104:107], v1 offset:1024
    ds_read_b128 v[108:111], v1 offset:15360
    ds_read_b128 v[112:115], v1 offset:2048
    ds_read_b128 v[116:119], v1 offset:16384
    ds_read_b128 v[120:123], v1 offset:3072
    ds_read_b128 v[124:127], v1 offset:17408
    s_waitcnt lgkmcnt(6)
    v_mfma_f32_16x16x32_bf16 v[16:19], v[96:99], a[0:3], 0
    v_mfma_f32_16x16x32_bf16 v[20:23], v[100:103], a[0:3], 0
    v_mfma_f32_16x16x32_bf16 v[24:27], v[96:99], a[56:59], 0
    v_mfma_f32_16x16x32_bf16 v[28:31], v[100:103], a[56:59], 0
    v_mfma_f32_16x16x32_bf16 v[32:35], v[96:99], a[112:115], 0
    v_mfma_f32_16x16x32_bf16 v[36:39], v[100:103], a[112:115], 0
    v_mfma_f32_16x16x32_bf16 v[40:43], v[96:99], a[168:171], 0
    v_mfma_f32_16x16x32_bf16 v[44:47], v[100:103], a[168:171], 0
    ds_read_b128 v[96:99], v1 offset:4096
    ds_read_b128 v[100:103], v1 offset:18432
    s_waitcnt lgkmcnt(6)
    v_mfma_f32_16x16x32_bf16 v[16:19], v[104:107], a[4:7], v[16:19]
    v_cvt_pk_bf16_f32 v80, v48, v49
    v_mfma_f32_16x16x32_bf16 v[20:23], v[108:111], a[4:7], v[20:23]
    v_cvt_pk_bf16_f32 v81, v64, v65
    v_mfma_f32_16x16x32_bf16 v[24:27], v[104:107], a[60:63], v[24:27]
    v_cvt_pk_bf16_f32 v82, v50, v51
    v_mfma_f32_16x16x32_bf16 v[28:31], v[108:111], a[60:63], v[28:31]
    v_cvt_pk_bf16_f32 v83, v66, v67
    v_mfma_f32_16x16x32_bf16 v[32:35], v[104:107], a[116:119], v[32:35]
    buffer_store_dwordx4 v[80:83], v1, s[4:7], s21 offen offset:0 sc1
    v_mfma_f32_16x16x32_bf16 v[36:39], v[108:111], a[116:119], v[36:39]
    v_cvt_pk_bf16_f32 v84, v52, v53
    v_mfma_f32_16x16x32_bf16 v[40:43], v[104:107], a[172:175], v[40:43]
    v_cvt_pk_bf16_f32 v85, v68, v69
    v_mfma_f32_16x16x32_bf16 v[44:47], v[108:111], a[172:175], v[44:47]
    v_cvt_pk_bf16_f32 v86, v54, v55
    ds_read_b128 v[104:107], v1 offset:5120
    ds_read_b128 v[108:111], v1 offset:19456
    s_waitcnt lgkmcnt(6)
    v_mfma_f32_16x16x32_bf16 v[16:19], v[112:115], a[8:11], v[16:19]
    v_cvt_pk_bf16_f32 v87, v70, v71
    v_mfma_f32_16x16x32_bf16 v[20:23], v[116:119], a[8:11], v[20:23]
    buffer_store_dwordx4 v[84:87], v1, s[4:7], s21 offen offset:1024 sc1
    v_mfma_f32_16x16x32_bf16 v[24:27], v[112:115], a[64:67], v[24:27]
    v_cvt_pk_bf16_f32 v88, v56, v57
    v_mfma_f32_16x16x32_bf16 v[28:31], v[116:119], a[64:67], v[28:31]
    v_cvt_pk_bf16_f32 v89, v72, v73
    v_mfma_f32_16x16x32_bf16 v[32:35], v[112:115], a[120:123], v[32:35]
    v_cvt_pk_bf16_f32 v90, v58, v59
    v_mfma_f32_16x16x32_bf16 v[36:39], v[116:119], a[120:123], v[36:39]
    v_cvt_pk_bf16_f32 v91, v74, v75
    v_mfma_f32_16x16x32_bf16 v[40:43], v[112:115], a[176:179], v[40:43]
    buffer_store_dwordx4 v[88:91], v1, s[4:7], s21 offen offset:2048 sc1
    v_mfma_f32_16x16x32_bf16 v[44:47], v[116:119], a[176:179], v[44:47]
    v_cvt_pk_bf16_f32 v92, v60, v61
    ds_read_b128 v[112:115], v1 offset:6144
    ds_read_b128 v[116:119], v1 offset:20480
    s_waitcnt lgkmcnt(6)
    v_mfma_f32_16x16x32_bf16 v[16:19], v[120:123], a[12:15], v[16:19]
    v_cvt_pk_bf16_f32 v93, v76, v77
    v_mfma_f32_16x16x32_bf16 v[20:23], v[124:127], a[12:15], v[20:23]
    v_cvt_pk_bf16_f32 v94, v62, v63
    v_mfma_f32_16x16x32_bf16 v[24:27], v[120:123], a[68:71], v[24:27]
    v_cvt_pk_bf16_f32 v95, v78, v79
    v_mfma_f32_16x16x32_bf16 v[28:31], v[124:127], a[68:71], v[28:31]
    buffer_store_dwordx4 v[92:95], v1, s[4:7], s21 offen offset:3072 sc1
    v_mfma_f32_16x16x32_bf16 v[32:35], v[120:123], a[124:127], v[32:35]
    s_add_u32 s21, s21, 3702784
    v_mfma_f32_16x16x32_bf16 v[36:39], v[124:127], a[124:127], v[36:39]
    v_mfma_f32_16x16x32_bf16 v[40:43], v[120:123], a[180:183], v[40:43]
    v_mfma_f32_16x16x32_bf16 v[44:47], v[124:127], a[180:183], v[44:47]
    ds_read_b128 v[120:123], v1 offset:7168
    ds_read_b128 v[124:127], v1 offset:21504
    s_waitcnt lgkmcnt(6)
    v_mfma_f32_16x16x32_bf16 v[16:19], v[96:99], a[16:19], v[16:19]
    v_mfma_f32_16x16x32_bf16 v[20:23], v[100:103], a[16:19], v[20:23]
    v_mfma_f32_16x16x32_bf16 v[24:27], v[96:99], a[72:75], v[24:27]
    v_mfma_f32_16x16x32_bf16 v[28:31], v[100:103], a[72:75], v[28:31]
    v_mfma_f32_16x16x32_bf16 v[32:35], v[96:99], a[128:131], v[32:35]
    v_mfma_f32_16x16x32_bf16 v[36:39], v[100:103], a[128:131], v[36:39]
    v_mfma_f32_16x16x32_bf16 v[40:43], v[96:99], a[184:187], v[40:43]
    v_mfma_f32_16x16x32_bf16 v[44:47], v[100:103], a[184:187], v[44:47]
    ds_read_b128 v[96:99], v1 offset:8192
    ds_read_b128 v[100:103], v1 offset:22528
    s_waitcnt lgkmcnt(6)
    v_mfma_f32_16x16x32_bf16 v[16:19], v[104:107], a[20:23], v[16:19]
    v_mfma_f32_16x16x32_bf16 v[20:23], v[108:111], a[20:23], v[20:23]
    v_mfma_f32_16x16x32_bf16 v[24:27], v[104:107], a[76:79], v[24:27]
    v_mfma_f32_16x16x32_bf16 v[28:31], v[108:111], a[76:79], v[28:31]
    v_mfma_f32_16x16x32_bf16 v[32:35], v[104:107], a[132:135], v[32:35]
    v_mfma_f32_16x16x32_bf16 v[36:39], v[108:111], a[132:135], v[36:39]
    v_mfma_f32_16x16x32_bf16 v[40:43], v[104:107], a[188:191], v[40:43]
    v_mfma_f32_16x16x32_bf16 v[44:47], v[108:111], a[188:191], v[44:47]
    ds_read_b128 v[104:107], v1 offset:9216
    ds_read_b128 v[108:111], v1 offset:23552
    s_waitcnt lgkmcnt(6)
    v_mfma_f32_16x16x32_bf16 v[16:19], v[112:115], a[24:27], v[16:19]
    v_mfma_f32_16x16x32_bf16 v[20:23], v[116:119], a[24:27], v[20:23]
    v_mfma_f32_16x16x32_bf16 v[24:27], v[112:115], a[80:83], v[24:27]
    v_mfma_f32_16x16x32_bf16 v[28:31], v[116:119], a[80:83], v[28:31]
    v_mfma_f32_16x16x32_bf16 v[32:35], v[112:115], a[136:139], v[32:35]
    v_mfma_f32_16x16x32_bf16 v[36:39], v[116:119], a[136:139], v[36:39]
    v_mfma_f32_16x16x32_bf16 v[40:43], v[112:115], a[192:195], v[40:43]
    v_mfma_f32_16x16x32_bf16 v[44:47], v[116:119], a[192:195], v[44:47]
    ds_read_b128 v[112:115], v1 offset:10240
    ds_read_b128 v[116:119], v1 offset:24576
    s_waitcnt lgkmcnt(6)
    v_mfma_f32_16x16x32_bf16 v[16:19], v[120:123], a[28:31], v[16:19]
    v_mfma_f32_16x16x32_bf16 v[20:23], v[124:127], a[28:31], v[20:23]
    v_mfma_f32_16x16x32_bf16 v[24:27], v[120:123], a[84:87], v[24:27]
    v_mfma_f32_16x16x32_bf16 v[28:31], v[124:127], a[84:87], v[28:31]
    v_mfma_f32_16x16x32_bf16 v[32:35], v[120:123], a[140:143], v[32:35]
    v_mfma_f32_16x16x32_bf16 v[36:39], v[124:127], a[140:143], v[36:39]
    v_mfma_f32_16x16x32_bf16 v[40:43], v[120:123], a[196:199], v[40:43]
    v_mfma_f32_16x16x32_bf16 v[44:47], v[124:127], a[196:199], v[44:47]
    ds_read_b128 v[120:123], v1 offset:11264
    ds_read_b128 v[124:127], v1 offset:25600
    s_waitcnt lgkmcnt(6)
    v_mfma_f32_16x16x32_bf16 v[16:19], v[96:99], a[32:35], v[16:19]
    v_mfma_f32_16x16x32_bf16 v[20:23], v[100:103], a[32:35], v[20:23]
    v_mfma_f32_16x16x32_bf16 v[24:27], v[96:99], a[88:91], v[24:27]
    v_mfma_f32_16x16x32_bf16 v[28:31], v[100:103], a[88:91], v[28:31]
    v_mfma_f32_16x16x32_bf16 v[32:35], v[96:99], a[144:147], v[32:35]
    v_mfma_f32_16x16x32_bf16 v[36:39], v[100:103], a[144:147], v[36:39]
    v_mfma_f32_16x16x32_bf16 v[40:43], v[96:99], a[200:203], v[40:43]
    v_mfma_f32_16x16x32_bf16 v[44:47], v[100:103], a[200:203], v[44:47]
    ds_read_b128 v[96:99], v1 offset:12288
    ds_read_b128 v[100:103], v1 offset:26624
    s_waitcnt lgkmcnt(6)
    v_mfma_f32_16x16x32_bf16 v[16:19], v[104:107], a[36:39], v[16:19]
    v_mfma_f32_16x16x32_bf16 v[20:23], v[108:111], a[36:39], v[20:23]
    v_mfma_f32_16x16x32_bf16 v[24:27], v[104:107], a[92:95], v[24:27]
    v_mfma_f32_16x16x32_bf16 v[28:31], v[108:111], a[92:95], v[28:31]
    v_mfma_f32_16x16x32_bf16 v[32:35], v[104:107], a[148:151], v[32:35]
    v_mfma_f32_16x16x32_bf16 v[36:39], v[108:111], a[148:151], v[36:39]
    v_mfma_f32_16x16x32_bf16 v[40:43], v[104:107], a[204:207], v[40:43]
    v_mfma_f32_16x16x32_bf16 v[44:47], v[108:111], a[204:207], v[44:47]
    ds_read_b128 v[104:107], v1 offset:13312
    ds_read_b128 v[108:111], v1 offset:27648
    s_waitcnt lgkmcnt(6)
    v_mfma_f32_16x16x32_bf16 v[16:19], v[112:115], a[40:43], v[16:19]
    v_mfma_f32_16x16x32_bf16 v[20:23], v[116:119], a[40:43], v[20:23]
    v_mfma_f32_16x16x32_bf16 v[24:27], v[112:115], a[96:99], v[24:27]
    v_mfma_f32_16x16x32_bf16 v[28:31], v[116:119], a[96:99], v[28:31]
    v_mfma_f32_16x16x32_bf16 v[32:35], v[112:115], a[152:155], v[32:35]
    v_mfma_f32_16x16x32_bf16 v[36:39], v[116:119], a[152:155], v[36:39]
    v_mfma_f32_16x16x32_bf16 v[40:43], v[112:115], a[208:211], v[40:43]
    v_mfma_f32_16x16x32_bf16 v[44:47], v[116:119], a[208:211], v[44:47]
    s_waitcnt lgkmcnt(4)
    v_mfma_f32_16x16x32_bf16 v[16:19], v[120:123], a[44:47], v[16:19]
    v_mfma_f32_16x16x32_bf16 v[20:23], v[124:127], a[44:47], v[20:23]
    v_mfma_f32_16x16x32_bf16 v[24:27], v[120:123], a[100:103], v[24:27]
    v_mfma_f32_16x16x32_bf16 v[28:31], v[124:127], a[100:103], v[28:31]
    v_mfma_f32_16x16x32_bf16 v[32:35], v[120:123], a[156:159], v[32:35]
    v_mfma_f32_16x16x32_bf16 v[36:39], v[124:127], a[156:159], v[36:39]
    v_mfma_f32_16x16x32_bf16 v[40:43], v[120:123], a[212:215], v[40:43]
    v_mfma_f32_16x16x32_bf16 v[44:47], v[124:127], a[212:215], v[44:47]
    s_waitcnt lgkmcnt(2)
    v_mfma_f32_16x16x32_bf16 v[16:19], v[96:99], a[48:51], v[16:19]
    v_mfma_f32_16x16x32_bf16 v[20:23], v[100:103], a[48:51], v[20:23]
    v_mfma_f32_16x16x32_bf16 v[24:27], v[96:99], a[104:107], v[24:27]
    v_mfma_f32_16x16x32_bf16 v[28:31], v[100:103], a[104:107], v[28:31]
    v_mfma_f32_16x16x32_bf16 v[32:35], v[96:99], a[160:163], v[32:35]
    v_mfma_f32_16x16x32_bf16 v[36:39], v[100:103], a[160:163], v[36:39]
    v_mfma_f32_16x16x32_bf16 v[40:43], v[96:99], a[216:219], v[40:43]
    v_mfma_f32_16x16x32_bf16 v[44:47], v[100:103], a[216:219], v[44:47]
    s_waitcnt lgkmcnt(0)
    v_mfma_f32_16x16x32_bf16 v[16:19], v[104:107], a[52:55], v[16:19]
    v_mfma_f32_16x16x32_bf16 v[20:23], v[108:111], a[52:55], v[20:23]
    v_mfma_f32_16x16x32_bf16 v[24:27], v[104:107], a[108:111], v[24:27]
    v_mfma_f32_16x16x32_bf16 v[28:31], v[108:111], a[108:111], v[28:31]
    v_mfma_f32_16x16x32_bf16 v[32:35], v[104:107], a[164:167], v[32:35]
    v_mfma_f32_16x16x32_bf16 v[36:39], v[108:111], a[164:167], v[36:39]
    v_mfma_f32_16x16x32_bf16 v[40:43], v[104:107], a[220:223], v[40:43]
    v_mfma_f32_16x16x32_bf16 v[44:47], v[108:111], a[220:223], v[44:47]
    s_waitcnt vmcnt(0)
    s_mov_b64 exec, 1
    s_add_u32 s22, s25, 10752
    buffer_store_dword v2, v3, s[4:7], s22 offen sc1
    s_mov_b64 exec, -1
    s_barrier
    s_add_u32 s22, s24, 86016
    s_mov_b32 m0, s22
    s_add_u32 s23, s19, 1605632
    buffer_load_dwordx4 v1, s[4:7], s23 offen offset:0 lds
    buffer_load_dwordx4 v1, s[4:7], s23 offen offset:1024 lds
    buffer_load_dwordx4 v1, s[4:7], s23 offen offset:2048 lds
    buffer_load_dwordx4 v1, s[4:7], s23 offen offset:3072 lds
    s_add_u32 s22, s24, 90112
    s_mov_b32 m0, s22
    s_add_u32 s23, s19, 1609728
    buffer_load_dwordx4 v1, s[4:7], s23 offen offset:0 lds
    buffer_load_dwordx4 v1, s[4:7], s23 offen offset:1024 lds
    buffer_load_dwordx4 v1, s[4:7], s23 offen offset:2048 lds
    ds_read_b128 v[96:99], v1 offset:28672
    ds_read_b128 v[100:103], v1 offset:43008
    ds_read_b128 v[104:107], v1 offset:29696
    ds_read_b128 v[108:111], v1 offset:44032
    ds_read_b128 v[112:115], v1 offset:30720
    ds_read_b128 v[116:119], v1 offset:45056
    ds_read_b128 v[120:123], v1 offset:31744
    ds_read_b128 v[124:127], v1 offset:46080
    s_waitcnt lgkmcnt(6)
    v_mfma_f32_16x16x32_bf16 v[48:51], v[96:99], a[0:3], 0
    v_mfma_f32_16x16x32_bf16 v[52:55], v[100:103], a[0:3], 0
    v_mfma_f32_16x16x32_bf16 v[56:59], v[96:99], a[56:59], 0
    v_mfma_f32_16x16x32_bf16 v[60:63], v[100:103], a[56:59], 0
    v_mfma_f32_16x16x32_bf16 v[64:67], v[96:99], a[112:115], 0
    v_mfma_f32_16x16x32_bf16 v[68:71], v[100:103], a[112:115], 0
    v_mfma_f32_16x16x32_bf16 v[72:75], v[96:99], a[168:171], 0
    v_mfma_f32_16x16x32_bf16 v[76:79], v[100:103], a[168:171], 0
    ds_read_b128 v[96:99], v1 offset:32768
    ds_read_b128 v[100:103], v1 offset:47104
    s_waitcnt lgkmcnt(6)
    v_mfma_f32_16x16x32_bf16 v[48:51], v[104:107], a[4:7], v[48:51]
    v_cvt_pk_bf16_f32 v80, v16, v17
    v_mfma_f32_16x16x32_bf16 v[52:55], v[108:111], a[4:7], v[52:55]
    v_cvt_pk_bf16_f32 v81, v32, v33
    v_mfma_f32_16x16x32_bf16 v[56:59], v[104:107], a[60:63], v[56:59]
    v_cvt_pk_bf16_f32 v82, v18, v19
    v_mfma_f32_16x16x32_bf16 v[60:63], v[108:111], a[60:63], v[60:63]
    v_cvt_pk_bf16_f32 v83, v34, v35
    v_mfma_f32_16x16x32_bf16 v[64:67], v[104:107], a[116:119], v[64:67]
    buffer_store_dwordx4 v[80:83], v1, s[4:7], s21 offen offset:0 sc1
    v_mfma_f32_16x16x32_bf16 v[68:71], v[108:111], a[116:119], v[68:71]
    v_cvt_pk_bf16_f32 v84, v20, v21
    v_mfma_f32_16x16x32_bf16 v[72:75], v[104:107], a[172:175], v[72:75]
    v_cvt_pk_bf16_f32 v85, v36, v37
    v_mfma_f32_16x16x32_bf16 v[76:79], v[108:111], a[172:175], v[76:79]
    v_cvt_pk_bf16_f32 v86, v22, v23
    ds_read_b128 v[104:107], v1 offset:33792
    ds_read_b128 v[108:111], v1 offset:48128
    s_waitcnt lgkmcnt(6)
    v_mfma_f32_16x16x32_bf16 v[48:51], v[112:115], a[8:11], v[48:51]
    v_cvt_pk_bf16_f32 v87, v38, v39
    v_mfma_f32_16x16x32_bf16 v[52:55], v[116:119], a[8:11], v[52:55]
    buffer_store_dwordx4 v[84:87], v1, s[4:7], s21 offen offset:1024 sc1
    v_mfma_f32_16x16x32_bf16 v[56:59], v[112:115], a[64:67], v[56:59]
    v_cvt_pk_bf16_f32 v88, v24, v25
    v_mfma_f32_16x16x32_bf16 v[60:63], v[116:119], a[64:67], v[60:63]
    v_cvt_pk_bf16_f32 v89, v40, v41
    v_mfma_f32_16x16x32_bf16 v[64:67], v[112:115], a[120:123], v[64:67]
    v_cvt_pk_bf16_f32 v90, v26, v27
    v_mfma_f32_16x16x32_bf16 v[68:71], v[116:119], a[120:123], v[68:71]
    v_cvt_pk_bf16_f32 v91, v42, v43
    v_mfma_f32_16x16x32_bf16 v[72:75], v[112:115], a[176:179], v[72:75]
    buffer_store_dwordx4 v[88:91], v1, s[4:7], s21 offen offset:2048 sc1
    v_mfma_f32_16x16x32_bf16 v[76:79], v[116:119], a[176:179], v[76:79]
    v_cvt_pk_bf16_f32 v92, v28, v29
    ds_read_b128 v[112:115], v1 offset:34816
    ds_read_b128 v[116:119], v1 offset:49152
    s_waitcnt lgkmcnt(6)
    v_mfma_f32_16x16x32_bf16 v[48:51], v[120:123], a[12:15], v[48:51]
    v_cvt_pk_bf16_f32 v93, v44, v45
    v_mfma_f32_16x16x32_bf16 v[52:55], v[124:127], a[12:15], v[52:55]
    v_cvt_pk_bf16_f32 v94, v30, v31
    v_mfma_f32_16x16x32_bf16 v[56:59], v[120:123], a[68:71], v[56:59]
    v_cvt_pk_bf16_f32 v95, v46, v47
    v_mfma_f32_16x16x32_bf16 v[60:63], v[124:127], a[68:71], v[60:63]
    buffer_store_dwordx4 v[92:95], v1, s[4:7], s21 offen offset:3072 sc1
    v_mfma_f32_16x16x32_bf16 v[64:67], v[120:123], a[124:127], v[64:67]
    s_add_u32 s21, s21, 3702784
    v_mfma_f32_16x16x32_bf16 v[68:71], v[124:127], a[124:127], v[68:71]
    v_mfma_f32_16x16x32_bf16 v[72:75], v[120:123], a[180:183], v[72:75]
    v_mfma_f32_16x16x32_bf16 v[76:79], v[124:127], a[180:183], v[76:79]
    ds_read_b128 v[120:123], v1 offset:35840
    ds_read_b128 v[124:127], v1 offset:50176
    s_waitcnt lgkmcnt(6)
    v_mfma_f32_16x16x32_bf16 v[48:51], v[96:99], a[16:19], v[48:51]
    v_mfma_f32_16x16x32_bf16 v[52:55], v[100:103], a[16:19], v[52:55]
    v_mfma_f32_16x16x32_bf16 v[56:59], v[96:99], a[72:75], v[56:59]
    v_mfma_f32_16x16x32_bf16 v[60:63], v[100:103], a[72:75], v[60:63]
    v_mfma_f32_16x16x32_bf16 v[64:67], v[96:99], a[128:131], v[64:67]
    v_mfma_f32_16x16x32_bf16 v[68:71], v[100:103], a[128:131], v[68:71]
    v_mfma_f32_16x16x32_bf16 v[72:75], v[96:99], a[184:187], v[72:75]
    v_mfma_f32_16x16x32_bf16 v[76:79], v[100:103], a[184:187], v[76:79]
    ds_read_b128 v[96:99], v1 offset:36864
    ds_read_b128 v[100:103], v1 offset:51200
    s_waitcnt lgkmcnt(6)
    v_mfma_f32_16x16x32_bf16 v[48:51], v[104:107], a[20:23], v[48:51]
    v_mfma_f32_16x16x32_bf16 v[52:55], v[108:111], a[20:23], v[52:55]
    v_mfma_f32_16x16x32_bf16 v[56:59], v[104:107], a[76:79], v[56:59]
    v_mfma_f32_16x16x32_bf16 v[60:63], v[108:111], a[76:79], v[60:63]
    v_mfma_f32_16x16x32_bf16 v[64:67], v[104:107], a[132:135], v[64:67]
    v_mfma_f32_16x16x32_bf16 v[68:71], v[108:111], a[132:135], v[68:71]
    v_mfma_f32_16x16x32_bf16 v[72:75], v[104:107], a[188:191], v[72:75]
    v_mfma_f32_16x16x32_bf16 v[76:79], v[108:111], a[188:191], v[76:79]
    ds_read_b128 v[104:107], v1 offset:37888
    ds_read_b128 v[108:111], v1 offset:52224
    s_waitcnt lgkmcnt(6)
    v_mfma_f32_16x16x32_bf16 v[48:51], v[112:115], a[24:27], v[48:51]
    v_mfma_f32_16x16x32_bf16 v[52:55], v[116:119], a[24:27], v[52:55]
    v_mfma_f32_16x16x32_bf16 v[56:59], v[112:115], a[80:83], v[56:59]
    v_mfma_f32_16x16x32_bf16 v[60:63], v[116:119], a[80:83], v[60:63]
    v_mfma_f32_16x16x32_bf16 v[64:67], v[112:115], a[136:139], v[64:67]
    v_mfma_f32_16x16x32_bf16 v[68:71], v[116:119], a[136:139], v[68:71]
    v_mfma_f32_16x16x32_bf16 v[72:75], v[112:115], a[192:195], v[72:75]
    v_mfma_f32_16x16x32_bf16 v[76:79], v[116:119], a[192:195], v[76:79]
    ds_read_b128 v[112:115], v1 offset:38912
    ds_read_b128 v[116:119], v1 offset:53248
    s_waitcnt lgkmcnt(6)
    v_mfma_f32_16x16x32_bf16 v[48:51], v[120:123], a[28:31], v[48:51]
    v_mfma_f32_16x16x32_bf16 v[52:55], v[124:127], a[28:31], v[52:55]
    v_mfma_f32_16x16x32_bf16 v[56:59], v[120:123], a[84:87], v[56:59]
    v_mfma_f32_16x16x32_bf16 v[60:63], v[124:127], a[84:87], v[60:63]
    v_mfma_f32_16x16x32_bf16 v[64:67], v[120:123], a[140:143], v[64:67]
    v_mfma_f32_16x16x32_bf16 v[68:71], v[124:127], a[140:143], v[68:71]
    v_mfma_f32_16x16x32_bf16 v[72:75], v[120:123], a[196:199], v[72:75]
    v_mfma_f32_16x16x32_bf16 v[76:79], v[124:127], a[196:199], v[76:79]
    ds_read_b128 v[120:123], v1 offset:39936
    ds_read_b128 v[124:127], v1 offset:54272
    s_waitcnt lgkmcnt(6)
    v_mfma_f32_16x16x32_bf16 v[48:51], v[96:99], a[32:35], v[48:51]
    v_mfma_f32_16x16x32_bf16 v[52:55], v[100:103], a[32:35], v[52:55]
    v_mfma_f32_16x16x32_bf16 v[56:59], v[96:99], a[88:91], v[56:59]
    v_mfma_f32_16x16x32_bf16 v[60:63], v[100:103], a[88:91], v[60:63]
    v_mfma_f32_16x16x32_bf16 v[64:67], v[96:99], a[144:147], v[64:67]
    v_mfma_f32_16x16x32_bf16 v[68:71], v[100:103], a[144:147], v[68:71]
    v_mfma_f32_16x16x32_bf16 v[72:75], v[96:99], a[200:203], v[72:75]
    v_mfma_f32_16x16x32_bf16 v[76:79], v[100:103], a[200:203], v[76:79]
    ds_read_b128 v[96:99], v1 offset:40960
    ds_read_b128 v[100:103], v1 offset:55296
    s_waitcnt lgkmcnt(6)
    v_mfma_f32_16x16x32_bf16 v[48:51], v[104:107], a[36:39], v[48:51]
    v_mfma_f32_16x16x32_bf16 v[52:55], v[108:111], a[36:39], v[52:55]
    v_mfma_f32_16x16x32_bf16 v[56:59], v[104:107], a[92:95], v[56:59]
    v_mfma_f32_16x16x32_bf16 v[60:63], v[108:111], a[92:95], v[60:63]
    v_mfma_f32_16x16x32_bf16 v[64:67], v[104:107], a[148:151], v[64:67]
    v_mfma_f32_16x16x32_bf16 v[68:71], v[108:111], a[148:151], v[68:71]
    v_mfma_f32_16x16x32_bf16 v[72:75], v[104:107], a[204:207], v[72:75]
    v_mfma_f32_16x16x32_bf16 v[76:79], v[108:111], a[204:207], v[76:79]
    ds_read_b128 v[104:107], v1 offset:41984
    ds_read_b128 v[108:111], v1 offset:56320
    s_waitcnt lgkmcnt(6)
    v_mfma_f32_16x16x32_bf16 v[48:51], v[112:115], a[40:43], v[48:51]
    v_mfma_f32_16x16x32_bf16 v[52:55], v[116:119], a[40:43], v[52:55]
    v_mfma_f32_16x16x32_bf16 v[56:59], v[112:115], a[96:99], v[56:59]
    v_mfma_f32_16x16x32_bf16 v[60:63], v[116:119], a[96:99], v[60:63]
    v_mfma_f32_16x16x32_bf16 v[64:67], v[112:115], a[152:155], v[64:67]
    v_mfma_f32_16x16x32_bf16 v[68:71], v[116:119], a[152:155], v[68:71]
    v_mfma_f32_16x16x32_bf16 v[72:75], v[112:115], a[208:211], v[72:75]
    v_mfma_f32_16x16x32_bf16 v[76:79], v[116:119], a[208:211], v[76:79]
    s_waitcnt lgkmcnt(4)
    v_mfma_f32_16x16x32_bf16 v[48:51], v[120:123], a[44:47], v[48:51]
    v_mfma_f32_16x16x32_bf16 v[52:55], v[124:127], a[44:47], v[52:55]
    v_mfma_f32_16x16x32_bf16 v[56:59], v[120:123], a[100:103], v[56:59]
    v_mfma_f32_16x16x32_bf16 v[60:63], v[124:127], a[100:103], v[60:63]
    v_mfma_f32_16x16x32_bf16 v[64:67], v[120:123], a[156:159], v[64:67]
    v_mfma_f32_16x16x32_bf16 v[68:71], v[124:127], a[156:159], v[68:71]
    v_mfma_f32_16x16x32_bf16 v[72:75], v[120:123], a[212:215], v[72:75]
    v_mfma_f32_16x16x32_bf16 v[76:79], v[124:127], a[212:215], v[76:79]
    s_waitcnt lgkmcnt(2)
    v_mfma_f32_16x16x32_bf16 v[48:51], v[96:99], a[48:51], v[48:51]
    v_mfma_f32_16x16x32_bf16 v[52:55], v[100:103], a[48:51], v[52:55]
    v_mfma_f32_16x16x32_bf16 v[56:59], v[96:99], a[104:107], v[56:59]
    v_mfma_f32_16x16x32_bf16 v[60:63], v[100:103], a[104:107], v[60:63]
    v_mfma_f32_16x16x32_bf16 v[64:67], v[96:99], a[160:163], v[64:67]
    v_mfma_f32_16x16x32_bf16 v[68:71], v[100:103], a[160:163], v[68:71]
    v_mfma_f32_16x16x32_bf16 v[72:75], v[96:99], a[216:219], v[72:75]
    v_mfma_f32_16x16x32_bf16 v[76:79], v[100:103], a[216:219], v[76:79]
    s_waitcnt lgkmcnt(0)
    v_mfma_f32_16x16x32_bf16 v[48:51], v[104:107], a[52:55], v[48:51]
    v_mfma_f32_16x16x32_bf16 v[52:55], v[108:111], a[52:55], v[52:55]
    v_mfma_f32_16x16x32_bf16 v[56:59], v[104:107], a[108:111], v[56:59]
    v_mfma_f32_16x16x32_bf16 v[60:63], v[108:111], a[108:111], v[60:63]
    v_mfma_f32_16x16x32_bf16 v[64:67], v[104:107], a[164:167], v[64:67]
    v_mfma_f32_16x16x32_bf16 v[68:71], v[108:111], a[164:167], v[68:71]
    v_mfma_f32_16x16x32_bf16 v[72:75], v[104:107], a[220:223], v[72:75]
    v_mfma_f32_16x16x32_bf16 v[76:79], v[108:111], a[220:223], v[76:79]
    s_waitcnt vmcnt(0)
    s_mov_b64 exec, 1
    s_add_u32 s22, s25, 14336
    buffer_store_dword v2, v3, s[4:7], s22 offen sc1
    s_mov_b64 exec, -1
    s_barrier
    ds_read_b128 v[96:99], v4 offset:0
    ds_read_b128 v[100:103], v4 offset:14336
    ds_read_b128 v[104:107], v4 offset:1024
    ds_read_b128 v[108:111], v4 offset:15360
    ds_read_b128 v[112:115], v4 offset:2048
    ds_read_b128 v[116:119], v4 offset:16384
    ds_read_b128 v[120:123], v4 offset:3072
    ds_read_b128 v[124:127], v4 offset:17408
    s_waitcnt lgkmcnt(6)
    v_mfma_f32_16x16x32_bf16 v[16:19], v[96:99], a[0:3], 0
    v_mfma_f32_16x16x32_bf16 v[20:23], v[100:103], a[0:3], 0
    v_mfma_f32_16x16x32_bf16 v[24:27], v[96:99], a[56:59], 0
    v_mfma_f32_16x16x32_bf16 v[28:31], v[100:103], a[56:59], 0
    v_mfma_f32_16x16x32_bf16 v[32:35], v[96:99], a[112:115], 0
    v_mfma_f32_16x16x32_bf16 v[36:39], v[100:103], a[112:115], 0
    v_mfma_f32_16x16x32_bf16 v[40:43], v[96:99], a[168:171], 0
    v_mfma_f32_16x16x32_bf16 v[44:47], v[100:103], a[168:171], 0
    ds_read_b128 v[96:99], v4 offset:4096
    ds_read_b128 v[100:103], v4 offset:18432
    s_waitcnt lgkmcnt(6)
    v_mfma_f32_16x16x32_bf16 v[16:19], v[104:107], a[4:7], v[16:19]
    v_cvt_pk_bf16_f32 v80, v48, v49
    v_mfma_f32_16x16x32_bf16 v[20:23], v[108:111], a[4:7], v[20:23]
    v_cvt_pk_bf16_f32 v81, v64, v65
    v_mfma_f32_16x16x32_bf16 v[24:27], v[104:107], a[60:63], v[24:27]
    v_cvt_pk_bf16_f32 v82, v50, v51
    v_mfma_f32_16x16x32_bf16 v[28:31], v[108:111], a[60:63], v[28:31]
    v_cvt_pk_bf16_f32 v83, v66, v67
    v_mfma_f32_16x16x32_bf16 v[32:35], v[104:107], a[116:119], v[32:35]
    buffer_store_dwordx4 v[80:83], v1, s[4:7], s21 offen offset:0 sc1
    v_mfma_f32_16x16x32_bf16 v[36:39], v[108:111], a[116:119], v[36:39]
    v_cvt_pk_bf16_f32 v84, v52, v53
    v_mfma_f32_16x16x32_bf16 v[40:43], v[104:107], a[172:175], v[40:43]
    v_cvt_pk_bf16_f32 v85, v68, v69
    v_mfma_f32_16x16x32_bf16 v[44:47], v[108:111], a[172:175], v[44:47]
    v_cvt_pk_bf16_f32 v86, v54, v55
    ds_read_b128 v[104:107], v4 offset:5120
    ds_read_b128 v[108:111], v4 offset:19456
    s_waitcnt lgkmcnt(6)
    v_mfma_f32_16x16x32_bf16 v[16:19], v[112:115], a[8:11], v[16:19]
    v_cvt_pk_bf16_f32 v87, v70, v71
    v_mfma_f32_16x16x32_bf16 v[20:23], v[116:119], a[8:11], v[20:23]
    buffer_store_dwordx4 v[84:87], v1, s[4:7], s21 offen offset:1024 sc1
    v_mfma_f32_16x16x32_bf16 v[24:27], v[112:115], a[64:67], v[24:27]
    v_cvt_pk_bf16_f32 v88, v56, v57
    v_mfma_f32_16x16x32_bf16 v[28:31], v[116:119], a[64:67], v[28:31]
    v_cvt_pk_bf16_f32 v89, v72, v73
    v_mfma_f32_16x16x32_bf16 v[32:35], v[112:115], a[120:123], v[32:35]
    v_cvt_pk_bf16_f32 v90, v58, v59
    v_mfma_f32_16x16x32_bf16 v[36:39], v[116:119], a[120:123], v[36:39]
    v_cvt_pk_bf16_f32 v91, v74, v75
    v_mfma_f32_16x16x32_bf16 v[40:43], v[112:115], a[176:179], v[40:43]
    buffer_store_dwordx4 v[88:91], v1, s[4:7], s21 offen offset:2048 sc1
    v_mfma_f32_16x16x32_bf16 v[44:47], v[116:119], a[176:179], v[44:47]
    v_cvt_pk_bf16_f32 v92, v60, v61
    ds_read_b128 v[112:115], v4 offset:6144
    ds_read_b128 v[116:119], v4 offset:20480
    s_waitcnt lgkmcnt(6)
    v_mfma_f32_16x16x32_bf16 v[16:19], v[120:123], a[12:15], v[16:19]
    v_cvt_pk_bf16_f32 v93, v76, v77
    v_mfma_f32_16x16x32_bf16 v[20:23], v[124:127], a[12:15], v[20:23]
    v_cvt_pk_bf16_f32 v94, v62, v63
    v_mfma_f32_16x16x32_bf16 v[24:27], v[120:123], a[68:71], v[24:27]
    v_cvt_pk_bf16_f32 v95, v78, v79
    v_mfma_f32_16x16x32_bf16 v[28:31], v[124:127], a[68:71], v[28:31]
    buffer_store_dwordx4 v[92:95], v1, s[4:7], s21 offen offset:3072 sc1
    v_mfma_f32_16x16x32_bf16 v[32:35], v[120:123], a[124:127], v[32:35]
    s_add_u32 s21, s21, 3702784
    v_mfma_f32_16x16x32_bf16 v[36:39], v[124:127], a[124:127], v[36:39]
    v_mfma_f32_16x16x32_bf16 v[40:43], v[120:123], a[180:183], v[40:43]
    v_mfma_f32_16x16x32_bf16 v[44:47], v[124:127], a[180:183], v[44:47]
    ds_read_b128 v[120:123], v4 offset:7168
    ds_read_b128 v[124:127], v4 offset:21504
    s_waitcnt lgkmcnt(6)
    v_mfma_f32_16x16x32_bf16 v[16:19], v[96:99], a[16:19], v[16:19]
    v_mfma_f32_16x16x32_bf16 v[20:23], v[100:103], a[16:19], v[20:23]
    v_mfma_f32_16x16x32_bf16 v[24:27], v[96:99], a[72:75], v[24:27]
    v_mfma_f32_16x16x32_bf16 v[28:31], v[100:103], a[72:75], v[28:31]
    v_mfma_f32_16x16x32_bf16 v[32:35], v[96:99], a[128:131], v[32:35]
    v_mfma_f32_16x16x32_bf16 v[36:39], v[100:103], a[128:131], v[36:39]
    v_mfma_f32_16x16x32_bf16 v[40:43], v[96:99], a[184:187], v[40:43]
    v_mfma_f32_16x16x32_bf16 v[44:47], v[100:103], a[184:187], v[44:47]
    ds_read_b128 v[96:99], v4 offset:8192
    ds_read_b128 v[100:103], v4 offset:22528
    s_waitcnt lgkmcnt(6)
    v_mfma_f32_16x16x32_bf16 v[16:19], v[104:107], a[20:23], v[16:19]
    v_mfma_f32_16x16x32_bf16 v[20:23], v[108:111], a[20:23], v[20:23]
    v_mfma_f32_16x16x32_bf16 v[24:27], v[104:107], a[76:79], v[24:27]
    v_mfma_f32_16x16x32_bf16 v[28:31], v[108:111], a[76:79], v[28:31]
    v_mfma_f32_16x16x32_bf16 v[32:35], v[104:107], a[132:135], v[32:35]
    v_mfma_f32_16x16x32_bf16 v[36:39], v[108:111], a[132:135], v[36:39]
    v_mfma_f32_16x16x32_bf16 v[40:43], v[104:107], a[188:191], v[40:43]
    v_mfma_f32_16x16x32_bf16 v[44:47], v[108:111], a[188:191], v[44:47]
    ds_read_b128 v[104:107], v4 offset:9216
    ds_read_b128 v[108:111], v4 offset:23552
    s_waitcnt lgkmcnt(6)
    v_mfma_f32_16x16x32_bf16 v[16:19], v[112:115], a[24:27], v[16:19]
    v_mfma_f32_16x16x32_bf16 v[20:23], v[116:119], a[24:27], v[20:23]
    v_mfma_f32_16x16x32_bf16 v[24:27], v[112:115], a[80:83], v[24:27]
    v_mfma_f32_16x16x32_bf16 v[28:31], v[116:119], a[80:83], v[28:31]
    v_mfma_f32_16x16x32_bf16 v[32:35], v[112:115], a[136:139], v[32:35]
    v_mfma_f32_16x16x32_bf16 v[36:39], v[116:119], a[136:139], v[36:39]
    v_mfma_f32_16x16x32_bf16 v[40:43], v[112:115], a[192:195], v[40:43]
    v_mfma_f32_16x16x32_bf16 v[44:47], v[116:119], a[192:195], v[44:47]
    ds_read_b128 v[112:115], v4 offset:10240
    ds_read_b128 v[116:119], v4 offset:24576
    s_waitcnt lgkmcnt(6)
    v_mfma_f32_16x16x32_bf16 v[16:19], v[120:123], a[28:31], v[16:19]
    v_mfma_f32_16x16x32_bf16 v[20:23], v[124:127], a[28:31], v[20:23]
    v_mfma_f32_16x16x32_bf16 v[24:27], v[120:123], a[84:87], v[24:27]
    v_mfma_f32_16x16x32_bf16 v[28:31], v[124:127], a[84:87], v[28:31]
    v_mfma_f32_16x16x32_bf16 v[32:35], v[120:123], a[140:143], v[32:35]
    v_mfma_f32_16x16x32_bf16 v[36:39], v[124:127], a[140:143], v[36:39]
    v_mfma_f32_16x16x32_bf16 v[40:43], v[120:123], a[196:199], v[40:43]
    v_mfma_f32_16x16x32_bf16 v[44:47], v[124:127], a[196:199], v[44:47]
    ds_read_b128 v[120:123], v4 offset:11264
    ds_read_b128 v[124:127], v4 offset:25600
    s_waitcnt lgkmcnt(6)
    v_mfma_f32_16x16x32_bf16 v[16:19], v[96:99], a[32:35], v[16:19]
    v_mfma_f32_16x16x32_bf16 v[20:23], v[100:103], a[32:35], v[20:23]
    v_mfma_f32_16x16x32_bf16 v[24:27], v[96:99], a[88:91], v[24:27]
    v_mfma_f32_16x16x32_bf16 v[28:31], v[100:103], a[88:91], v[28:31]
    v_mfma_f32_16x16x32_bf16 v[32:35], v[96:99], a[144:147], v[32:35]
    v_mfma_f32_16x16x32_bf16 v[36:39], v[100:103], a[144:147], v[36:39]
    v_mfma_f32_16x16x32_bf16 v[40:43], v[96:99], a[200:203], v[40:43]
    v_mfma_f32_16x16x32_bf16 v[44:47], v[100:103], a[200:203], v[44:47]
    ds_read_b128 v[96:99], v4 offset:12288
    ds_read_b128 v[100:103], v4 offset:26624
    s_waitcnt lgkmcnt(6)
    v_mfma_f32_16x16x32_bf16 v[16:19], v[104:107], a[36:39], v[16:19]
    v_mfma_f32_16x16x32_bf16 v[20:23], v[108:111], a[36:39], v[20:23]
    v_mfma_f32_16x16x32_bf16 v[24:27], v[104:107], a[92:95], v[24:27]
    v_mfma_f32_16x16x32_bf16 v[28:31], v[108:111], a[92:95], v[28:31]
    v_mfma_f32_16x16x32_bf16 v[32:35], v[104:107], a[148:151], v[32:35]
    v_mfma_f32_16x16x32_bf16 v[36:39], v[108:111], a[148:151], v[36:39]
    v_mfma_f32_16x16x32_bf16 v[40:43], v[104:107], a[204:207], v[40:43]
    v_mfma_f32_16x16x32_bf16 v[44:47], v[108:111], a[204:207], v[44:47]
    ds_read_b128 v[104:107], v4 offset:13312
    ds_read_b128 v[108:111], v4 offset:27648
    s_waitcnt lgkmcnt(6)
    v_mfma_f32_16x16x32_bf16 v[16:19], v[112:115], a[40:43], v[16:19]
    v_mfma_f32_16x16x32_bf16 v[20:23], v[116:119], a[40:43], v[20:23]
    v_mfma_f32_16x16x32_bf16 v[24:27], v[112:115], a[96:99], v[24:27]
    v_mfma_f32_16x16x32_bf16 v[28:31], v[116:119], a[96:99], v[28:31]
    v_mfma_f32_16x16x32_bf16 v[32:35], v[112:115], a[152:155], v[32:35]
    v_mfma_f32_16x16x32_bf16 v[36:39], v[116:119], a[152:155], v[36:39]
    v_mfma_f32_16x16x32_bf16 v[40:43], v[112:115], a[208:211], v[40:43]
    v_mfma_f32_16x16x32_bf16 v[44:47], v[116:119], a[208:211], v[44:47]
    s_waitcnt lgkmcnt(4)
    v_mfma_f32_16x16x32_bf16 v[16:19], v[120:123], a[44:47], v[16:19]
    v_mfma_f32_16x16x32_bf16 v[20:23], v[124:127], a[44:47], v[20:23]
    v_mfma_f32_16x16x32_bf16 v[24:27], v[120:123], a[100:103], v[24:27]
    v_mfma_f32_16x16x32_bf16 v[28:31], v[124:127], a[100:103], v[28:31]
    v_mfma_f32_16x16x32_bf16 v[32:35], v[120:123], a[156:159], v[32:35]
    v_mfma_f32_16x16x32_bf16 v[36:39], v[124:127], a[156:159], v[36:39]
    v_mfma_f32_16x16x32_bf16 v[40:43], v[120:123], a[212:215], v[40:43]
    v_mfma_f32_16x16x32_bf16 v[44:47], v[124:127], a[212:215], v[44:47]
    s_waitcnt lgkmcnt(2)
    v_mfma_f32_16x16x32_bf16 v[16:19], v[96:99], a[48:51], v[16:19]
    v_mfma_f32_16x16x32_bf16 v[20:23], v[100:103], a[48:51], v[20:23]
    v_mfma_f32_16x16x32_bf16 v[24:27], v[96:99], a[104:107], v[24:27]
    v_mfma_f32_16x16x32_bf16 v[28:31], v[100:103], a[104:107], v[28:31]
    v_mfma_f32_16x16x32_bf16 v[32:35], v[96:99], a[160:163], v[32:35]
    v_mfma_f32_16x16x32_bf16 v[36:39], v[100:103], a[160:163], v[36:39]
    v_mfma_f32_16x16x32_bf16 v[40:43], v[96:99], a[216:219], v[40:43]
    v_mfma_f32_16x16x32_bf16 v[44:47], v[100:103], a[216:219], v[44:47]
    s_waitcnt lgkmcnt(0)
    v_mfma_f32_16x16x32_bf16 v[16:19], v[104:107], a[52:55], v[16:19]
    v_mfma_f32_16x16x32_bf16 v[20:23], v[108:111], a[52:55], v[20:23]
    v_mfma_f32_16x16x32_bf16 v[24:27], v[104:107], a[108:111], v[24:27]
    v_mfma_f32_16x16x32_bf16 v[28:31], v[108:111], a[108:111], v[28:31]
    v_mfma_f32_16x16x32_bf16 v[32:35], v[104:107], a[164:167], v[32:35]
    v_mfma_f32_16x16x32_bf16 v[36:39], v[108:111], a[164:167], v[36:39]
    v_mfma_f32_16x16x32_bf16 v[40:43], v[104:107], a[220:223], v[40:43]
    v_mfma_f32_16x16x32_bf16 v[44:47], v[108:111], a[220:223], v[44:47]
    s_waitcnt vmcnt(0)
    s_mov_b64 exec, 1
    s_add_u32 s22, s25, 17920
    buffer_store_dword v2, v3, s[4:7], s22 offen sc1
    s_mov_b64 exec, -1
    s_barrier
    ds_read_b128 v[96:99], v4 offset:28672
    ds_read_b128 v[100:103], v4 offset:43008
    ds_read_b128 v[104:107], v4 offset:29696
    ds_read_b128 v[108:111], v4 offset:44032
    ds_read_b128 v[112:115], v4 offset:30720
    ds_read_b128 v[116:119], v4 offset:45056
    ds_read_b128 v[120:123], v4 offset:31744
    ds_read_b128 v[124:127], v4 offset:46080
    s_waitcnt lgkmcnt(6)
    v_mfma_f32_16x16x32_bf16 v[48:51], v[96:99], a[0:3], 0
    v_mfma_f32_16x16x32_bf16 v[52:55], v[100:103], a[0:3], 0
    v_mfma_f32_16x16x32_bf16 v[56:59], v[96:99], a[56:59], 0
    v_mfma_f32_16x16x32_bf16 v[60:63], v[100:103], a[56:59], 0
    v_mfma_f32_16x16x32_bf16 v[64:67], v[96:99], a[112:115], 0
    v_mfma_f32_16x16x32_bf16 v[68:71], v[100:103], a[112:115], 0
    v_mfma_f32_16x16x32_bf16 v[72:75], v[96:99], a[168:171], 0
    v_mfma_f32_16x16x32_bf16 v[76:79], v[100:103], a[168:171], 0
    ds_read_b128 v[96:99], v4 offset:32768
    ds_read_b128 v[100:103], v4 offset:47104
    s_waitcnt lgkmcnt(6)
    v_mfma_f32_16x16x32_bf16 v[48:51], v[104:107], a[4:7], v[48:51]
    v_cvt_pk_bf16_f32 v80, v16, v17
    v_mfma_f32_16x16x32_bf16 v[52:55], v[108:111], a[4:7], v[52:55]
    v_cvt_pk_bf16_f32 v81, v32, v33
    v_mfma_f32_16x16x32_bf16 v[56:59], v[104:107], a[60:63], v[56:59]
    v_cvt_pk_bf16_f32 v82, v18, v19
    v_mfma_f32_16x16x32_bf16 v[60:63], v[108:111], a[60:63], v[60:63]
    v_cvt_pk_bf16_f32 v83, v34, v35
    v_mfma_f32_16x16x32_bf16 v[64:67], v[104:107], a[116:119], v[64:67]
    buffer_store_dwordx4 v[80:83], v1, s[4:7], s21 offen offset:0 sc1
    v_mfma_f32_16x16x32_bf16 v[68:71], v[108:111], a[116:119], v[68:71]
    v_cvt_pk_bf16_f32 v84, v20, v21
    v_mfma_f32_16x16x32_bf16 v[72:75], v[104:107], a[172:175], v[72:75]
    v_cvt_pk_bf16_f32 v85, v36, v37
    v_mfma_f32_16x16x32_bf16 v[76:79], v[108:111], a[172:175], v[76:79]
    v_cvt_pk_bf16_f32 v86, v22, v23
    ds_read_b128 v[104:107], v4 offset:33792
    ds_read_b128 v[108:111], v4 offset:48128
    s_waitcnt lgkmcnt(6)
    v_mfma_f32_16x16x32_bf16 v[48:51], v[112:115], a[8:11], v[48:51]
    v_cvt_pk_bf16_f32 v87, v38, v39
    v_mfma_f32_16x16x32_bf16 v[52:55], v[116:119], a[8:11], v[52:55]
    buffer_store_dwordx4 v[84:87], v1, s[4:7], s21 offen offset:1024 sc1
    v_mfma_f32_16x16x32_bf16 v[56:59], v[112:115], a[64:67], v[56:59]
    v_cvt_pk_bf16_f32 v88, v24, v25
    v_mfma_f32_16x16x32_bf16 v[60:63], v[116:119], a[64:67], v[60:63]
    v_cvt_pk_bf16_f32 v89, v40, v41
    v_mfma_f32_16x16x32_bf16 v[64:67], v[112:115], a[120:123], v[64:67]
    v_cvt_pk_bf16_f32 v90, v26, v27
    v_mfma_f32_16x16x32_bf16 v[68:71], v[116:119], a[120:123], v[68:71]
    v_cvt_pk_bf16_f32 v91, v42, v43
    v_mfma_f32_16x16x32_bf16 v[72:75], v[112:115], a[176:179], v[72:75]
    buffer_store_dwordx4 v[88:91], v1, s[4:7], s21 offen offset:2048 sc1
    v_mfma_f32_16x16x32_bf16 v[76:79], v[116:119], a[176:179], v[76:79]
    v_cvt_pk_bf16_f32 v92, v28, v29
    ds_read_b128 v[112:115], v4 offset:34816
    ds_read_b128 v[116:119], v4 offset:49152
    s_waitcnt lgkmcnt(6)
    v_mfma_f32_16x16x32_bf16 v[48:51], v[120:123], a[12:15], v[48:51]
    v_cvt_pk_bf16_f32 v93, v44, v45
    v_mfma_f32_16x16x32_bf16 v[52:55], v[124:127], a[12:15], v[52:55]
    v_cvt_pk_bf16_f32 v94, v30, v31
    v_mfma_f32_16x16x32_bf16 v[56:59], v[120:123], a[68:71], v[56:59]
    v_cvt_pk_bf16_f32 v95, v46, v47
    v_mfma_f32_16x16x32_bf16 v[60:63], v[124:127], a[68:71], v[60:63]
    buffer_store_dwordx4 v[92:95], v1, s[4:7], s21 offen offset:3072 sc1
    v_mfma_f32_16x16x32_bf16 v[64:67], v[120:123], a[124:127], v[64:67]
    s_add_u32 s21, s21, 3702784
    v_mfma_f32_16x16x32_bf16 v[68:71], v[124:127], a[124:127], v[68:71]
    v_mfma_f32_16x16x32_bf16 v[72:75], v[120:123], a[180:183], v[72:75]
    v_mfma_f32_16x16x32_bf16 v[76:79], v[124:127], a[180:183], v[76:79]
    ds_read_b128 v[120:123], v4 offset:35840
    ds_read_b128 v[124:127], v4 offset:50176
    s_waitcnt lgkmcnt(6)
    v_mfma_f32_16x16x32_bf16 v[48:51], v[96:99], a[16:19], v[48:51]
    v_mfma_f32_16x16x32_bf16 v[52:55], v[100:103], a[16:19], v[52:55]
    v_mfma_f32_16x16x32_bf16 v[56:59], v[96:99], a[72:75], v[56:59]
    v_mfma_f32_16x16x32_bf16 v[60:63], v[100:103], a[72:75], v[60:63]
    v_mfma_f32_16x16x32_bf16 v[64:67], v[96:99], a[128:131], v[64:67]
    v_mfma_f32_16x16x32_bf16 v[68:71], v[100:103], a[128:131], v[68:71]
    v_mfma_f32_16x16x32_bf16 v[72:75], v[96:99], a[184:187], v[72:75]
    v_mfma_f32_16x16x32_bf16 v[76:79], v[100:103], a[184:187], v[76:79]
    ds_read_b128 v[96:99], v4 offset:36864
    ds_read_b128 v[100:103], v4 offset:51200
    s_waitcnt lgkmcnt(6)
    v_mfma_f32_16x16x32_bf16 v[48:51], v[104:107], a[20:23], v[48:51]
    v_mfma_f32_16x16x32_bf16 v[52:55], v[108:111], a[20:23], v[52:55]
    v_mfma_f32_16x16x32_bf16 v[56:59], v[104:107], a[76:79], v[56:59]
    v_mfma_f32_16x16x32_bf16 v[60:63], v[108:111], a[76:79], v[60:63]
    v_mfma_f32_16x16x32_bf16 v[64:67], v[104:107], a[132:135], v[64:67]
    v_mfma_f32_16x16x32_bf16 v[68:71], v[108:111], a[132:135], v[68:71]
    v_mfma_f32_16x16x32_bf16 v[72:75], v[104:107], a[188:191], v[72:75]
    v_mfma_f32_16x16x32_bf16 v[76:79], v[108:111], a[188:191], v[76:79]
    ds_read_b128 v[104:107], v4 offset:37888
    ds_read_b128 v[108:111], v4 offset:52224
    s_waitcnt lgkmcnt(6)
    v_mfma_f32_16x16x32_bf16 v[48:51], v[112:115], a[24:27], v[48:51]
    v_mfma_f32_16x16x32_bf16 v[52:55], v[116:119], a[24:27], v[52:55]
    v_mfma_f32_16x16x32_bf16 v[56:59], v[112:115], a[80:83], v[56:59]
    v_mfma_f32_16x16x32_bf16 v[60:63], v[116:119], a[80:83], v[60:63]
    v_mfma_f32_16x16x32_bf16 v[64:67], v[112:115], a[136:139], v[64:67]
    v_mfma_f32_16x16x32_bf16 v[68:71], v[116:119], a[136:139], v[68:71]
    v_mfma_f32_16x16x32_bf16 v[72:75], v[112:115], a[192:195], v[72:75]
    v_mfma_f32_16x16x32_bf16 v[76:79], v[116:119], a[192:195], v[76:79]
    ds_read_b128 v[112:115], v4 offset:38912
    ds_read_b128 v[116:119], v4 offset:53248
    s_waitcnt lgkmcnt(6)
    v_mfma_f32_16x16x32_bf16 v[48:51], v[120:123], a[28:31], v[48:51]
    v_mfma_f32_16x16x32_bf16 v[52:55], v[124:127], a[28:31], v[52:55]
    v_mfma_f32_16x16x32_bf16 v[56:59], v[120:123], a[84:87], v[56:59]
    v_mfma_f32_16x16x32_bf16 v[60:63], v[124:127], a[84:87], v[60:63]
    v_mfma_f32_16x16x32_bf16 v[64:67], v[120:123], a[140:143], v[64:67]
    v_mfma_f32_16x16x32_bf16 v[68:71], v[124:127], a[140:143], v[68:71]
    v_mfma_f32_16x16x32_bf16 v[72:75], v[120:123], a[196:199], v[72:75]
    v_mfma_f32_16x16x32_bf16 v[76:79], v[124:127], a[196:199], v[76:79]
    ds_read_b128 v[120:123], v4 offset:39936
    ds_read_b128 v[124:127], v4 offset:54272
    s_waitcnt lgkmcnt(6)
    v_mfma_f32_16x16x32_bf16 v[48:51], v[96:99], a[32:35], v[48:51]
    v_mfma_f32_16x16x32_bf16 v[52:55], v[100:103], a[32:35], v[52:55]
    v_mfma_f32_16x16x32_bf16 v[56:59], v[96:99], a[88:91], v[56:59]
    v_mfma_f32_16x16x32_bf16 v[60:63], v[100:103], a[88:91], v[60:63]
    v_mfma_f32_16x16x32_bf16 v[64:67], v[96:99], a[144:147], v[64:67]
    v_mfma_f32_16x16x32_bf16 v[68:71], v[100:103], a[144:147], v[68:71]
    v_mfma_f32_16x16x32_bf16 v[72:75], v[96:99], a[200:203], v[72:75]
    v_mfma_f32_16x16x32_bf16 v[76:79], v[100:103], a[200:203], v[76:79]
    ds_read_b128 v[96:99], v4 offset:40960
    ds_read_b128 v[100:103], v4 offset:55296
    s_waitcnt lgkmcnt(6)
    v_mfma_f32_16x16x32_bf16 v[48:51], v[104:107], a[36:39], v[48:51]
    v_mfma_f32_16x16x32_bf16 v[52:55], v[108:111], a[36:39], v[52:55]
    v_mfma_f32_16x16x32_bf16 v[56:59], v[104:107], a[92:95], v[56:59]
    v_mfma_f32_16x16x32_bf16 v[60:63], v[108:111], a[92:95], v[60:63]
    v_mfma_f32_16x16x32_bf16 v[64:67], v[104:107], a[148:151], v[64:67]
    v_mfma_f32_16x16x32_bf16 v[68:71], v[108:111], a[148:151], v[68:71]
    v_mfma_f32_16x16x32_bf16 v[72:75], v[104:107], a[204:207], v[72:75]
    v_mfma_f32_16x16x32_bf16 v[76:79], v[108:111], a[204:207], v[76:79]
    ds_read_b128 v[104:107], v4 offset:41984
    ds_read_b128 v[108:111], v4 offset:56320
    s_waitcnt lgkmcnt(6)
    v_mfma_f32_16x16x32_bf16 v[48:51], v[112:115], a[40:43], v[48:51]
    v_mfma_f32_16x16x32_bf16 v[52:55], v[116:119], a[40:43], v[52:55]
    v_mfma_f32_16x16x32_bf16 v[56:59], v[112:115], a[96:99], v[56:59]
    v_mfma_f32_16x16x32_bf16 v[60:63], v[116:119], a[96:99], v[60:63]
    v_mfma_f32_16x16x32_bf16 v[64:67], v[112:115], a[152:155], v[64:67]
    v_mfma_f32_16x16x32_bf16 v[68:71], v[116:119], a[152:155], v[68:71]
    v_mfma_f32_16x16x32_bf16 v[72:75], v[112:115], a[208:211], v[72:75]
    v_mfma_f32_16x16x32_bf16 v[76:79], v[116:119], a[208:211], v[76:79]
    s_waitcnt lgkmcnt(4)
    v_mfma_f32_16x16x32_bf16 v[48:51], v[120:123], a[44:47], v[48:51]
    v_mfma_f32_16x16x32_bf16 v[52:55], v[124:127], a[44:47], v[52:55]
    v_mfma_f32_16x16x32_bf16 v[56:59], v[120:123], a[100:103], v[56:59]
    v_mfma_f32_16x16x32_bf16 v[60:63], v[124:127], a[100:103], v[60:63]
    v_mfma_f32_16x16x32_bf16 v[64:67], v[120:123], a[156:159], v[64:67]
    v_mfma_f32_16x16x32_bf16 v[68:71], v[124:127], a[156:159], v[68:71]
    v_mfma_f32_16x16x32_bf16 v[72:75], v[120:123], a[212:215], v[72:75]
    v_mfma_f32_16x16x32_bf16 v[76:79], v[124:127], a[212:215], v[76:79]
    s_waitcnt lgkmcnt(2)
    v_mfma_f32_16x16x32_bf16 v[48:51], v[96:99], a[48:51], v[48:51]
    v_mfma_f32_16x16x32_bf16 v[52:55], v[100:103], a[48:51], v[52:55]
    v_mfma_f32_16x16x32_bf16 v[56:59], v[96:99], a[104:107], v[56:59]
    v_mfma_f32_16x16x32_bf16 v[60:63], v[100:103], a[104:107], v[60:63]
    v_mfma_f32_16x16x32_bf16 v[64:67], v[96:99], a[160:163], v[64:67]
    v_mfma_f32_16x16x32_bf16 v[68:71], v[100:103], a[160:163], v[68:71]
    v_mfma_f32_16x16x32_bf16 v[72:75], v[96:99], a[216:219], v[72:75]
    v_mfma_f32_16x16x32_bf16 v[76:79], v[100:103], a[216:219], v[76:79]
    s_waitcnt lgkmcnt(0)
    v_mfma_f32_16x16x32_bf16 v[48:51], v[104:107], a[52:55], v[48:51]
    v_mfma_f32_16x16x32_bf16 v[52:55], v[108:111], a[52:55], v[52:55]
    v_mfma_f32_16x16x32_bf16 v[56:59], v[104:107], a[108:111], v[56:59]
    v_mfma_f32_16x16x32_bf16 v[60:63], v[108:111], a[108:111], v[60:63]
    v_mfma_f32_16x16x32_bf16 v[64:67], v[104:107], a[164:167], v[64:67]
    v_mfma_f32_16x16x32_bf16 v[68:71], v[108:111], a[164:167], v[68:71]
    v_mfma_f32_16x16x32_bf16 v[72:75], v[104:107], a[220:223], v[72:75]
    v_mfma_f32_16x16x32_bf16 v[76:79], v[108:111], a[220:223], v[76:79]
    s_waitcnt vmcnt(0)
    s_mov_b64 exec, 1
    s_add_u32 s22, s25, 21504
    buffer_store_dword v2, v3, s[4:7], s22 offen sc1
    s_mov_b64 exec, -1
    s_nop 7
    v_cvt_pk_bf16_f32 v80, v48, v49
    v_cvt_pk_bf16_f32 v81, v64, v65
    v_cvt_pk_bf16_f32 v82, v50, v51
    v_cvt_pk_bf16_f32 v83, v66, v67
    buffer_store_dwordx4 v[80:83], v1, s[4:7], s21 offen offset:0 sc1
    v_cvt_pk_bf16_f32 v84, v52, v53
    v_cvt_pk_bf16_f32 v85, v68, v69
    v_cvt_pk_bf16_f32 v86, v54, v55
    v_cvt_pk_bf16_f32 v87, v70, v71
    buffer_store_dwordx4 v[84:87], v1, s[4:7], s21 offen offset:1024 sc1
    v_cvt_pk_bf16_f32 v88, v56, v57
    v_cvt_pk_bf16_f32 v89, v72, v73
    v_cvt_pk_bf16_f32 v90, v58, v59
    v_cvt_pk_bf16_f32 v91, v74, v75
    buffer_store_dwordx4 v[88:91], v1, s[4:7], s21 offen offset:2048 sc1
    v_cvt_pk_bf16_f32 v92, v60, v61
    v_cvt_pk_bf16_f32 v93, v76, v77
    v_cvt_pk_bf16_f32 v94, v62, v63
    v_cvt_pk_bf16_f32 v95, v78, v79
    buffer_store_dwordx4 v[92:95], v1, s[4:7], s21 offen offset:3072 sc1
    s_add_u32 s21, s21, 3702784
    s_waitcnt vmcnt(0)
    s_mov_b64 exec, 1
    s_add_u32 s22, s25, 25088
    buffer_store_dword v2, v3, s[4:7], s22 offen sc1
    s_mov_b64 exec, -1
    s_mov_b32 s20, 0x05040100
    s_mov_b32 s21, 0x07060302
    s_lshl_b32 s16, s96, 2
    s_add_u32 s16, s16, s3
    s_cmp_ge_u32 s16, 294
    s_cbranch_scc1 rf_end
    s_mul_i32 s17, s16, 335
    s_lshr_b32 s17, s17, 15
    s_mul_i32 s18, s17, 98
    s_sub_u32 s18, s16, s18
    s_lshl_b32 s19, s17, 3
    s_add_u32 s19, s19, 64
    s_load_dwordx2 s[36:37], s[0:1], s19
    s_mov_b32 s38, 1605632
    s_mov_b32 s39, 0x00020000
    s_cmp_eq_u32 s17, 2
    s_cbranch_scc1 k1_rw2
    s_mul_i32 s19, s18, 147
    s_lshr_b32 s19, s19, 10
    s_mul_i32 s22, s19, 7
    s_sub_u32 s22, s18, s22
    v_lshrrev_b32 v5, 5, v0
    v_and_b32 v6, 31, v0
    v_mul_u32_u24 v7, 14336, v5
    v_lshl_add_u32 v7, v6, 4, v7
    s_mul_i32 s23, s19, 114688
    s_lshl_b32 s24, s22, 9
    s_add_u32 s23, s23, s24
    s_waitcnt lgkmcnt(0)
    s_add_u32 s24, s23, 0
    buffer_load_dwordx4 v[8:11], v7, s[36:39], s24 offen
    s_add_u32 s24, s23, 3584
    buffer_load_dwordx4 v[12:15], v7, s[36:39], s24 offen
    s_add_u32 s24, s23, 7168
    buffer_load_dwordx4 v[16:19], v7, s[36:39], s24 offen
    s_add_u32 s24, s23, 10752
    buffer_load_dwordx4 v[20:23], v7, s[36:39], s24 offen
    s_add_u32 s24, s23, 57344
    buffer_load_dwordx4 v[24:27], v7, s[36:39], s24 offen
    s_add_u32 s24, s23, 60928
    buffer_load_dwordx4 v[28:31], v7, s[36:39], s24 offen
    s_add_u32 s24, s23, 64512
    buffer_load_dwordx4 v[32:35], v7, s[36:39], s24 offen
    s_add_u32 s24, s23, 68096
    buffer_load_dwordx4 v[36:39], v7, s[36:39], s24 offen
    s_add_u32 s24, s23, 28672
    buffer_load_dwordx4 v[40:43], v7, s[36:39], s24 offen
    s_add_u32 s24, s23, 32256
    buffer_load_dwordx4 v[44:47], v7, s[36:39], s24 offen
    s_add_u32 s24, s23, 35840
    buffer_load_dwordx4 v[48:51], v7, s[36:39], s24 offen
    s_add_u32 s24, s23, 39424
    buffer_load_dwordx4 v[52:55], v7, s[36:39], s24 offen
    s_add_u32 s24, s23, 86016
    buffer_load_dwordx4 v[56:59], v7, s[36:39], s24 offen
    s_add_u32 s24, s23, 89600
    buffer_load_dwordx4 v[60:63], v7, s[36:39], s24 offen
    s_add_u32 s24, s23, 93184
    buffer_load_dwordx4 v[64:67], v7, s[36:39], s24 offen
    s_add_u32 s24, s23, 96768
    buffer_load_dwordx4 v[68:71], v7, s[36:39], s24 offen
    v_lshrrev_b32 v1, 2, v6
    v_mul_u32_u24 v1, 57344, v1
    v_and_b32 v6, 3, v6
    v_lshl_add_u32 v1, v6, 6, v1
    v_lshl_add_u32 v1, v5, 8, v1
    s_mul_i32 s24, s22, 458752
    s_mul_i32 s25, s17, 14336
    s_add_u32 s24, s24, s25
    s_lshl_b32 s25, s19, 10
    s_add_u32 s24, s24, s25
    s_add_u32 s24, s24, 18350080
    s_add_u32 s25, s24, 28672
    s_waitcnt vmcnt(8)
    v_perm_b32 v72, v12, v8, s20
    v_perm_b32 v73, v20, v16, s20
    v_perm_b32 v74, v28, v24, s20
    v_perm_b32 v75, v36, v32, s20
    v_perm_b32 v76, v12, v8, s21
    v_perm_b32 v77, v20, v16, s21
    v_perm_b32 v78, v28, v24, s21
    v_perm_b32 v79, v36, v32, s21
    v_perm_b32 v80, v13, v9, s20
    v_perm_b32 v81, v21, v17, s20
    v_perm_b32 v82, v29, v25, s20
    v_perm_b32 v83, v37, v33, s20
    v_perm_b32 v84, v13, v9, s21
    v_perm_b32 v85, v21, v17, s21
    v_perm_b32 v86, v29, v25, s21
    v_perm_b32 v87, v37, v33, s21
    v_perm_b32 v88, v14, v10, s20
    v_perm_b32 v89, v22, v18, s20
    v_perm_b32 v90, v30, v26, s20
    v_perm_b32 v91, v38, v34, s20
    v_perm_b32 v92, v14, v10, s21
    v_perm_b32 v93, v22, v18, s21
    v_perm_b32 v94, v30, v26, s21
    v_perm_b32 v95, v38, v34, s21
    v_perm_b32 v96, v15, v11, s20
    v_perm_b32 v97, v23, v19, s20
    v_perm_b32 v98, v31, v27, s20
    v_perm_b32 v99, v39, v35, s20
    v_perm_b32 v100, v15, v11, s21
    v_perm_b32 v101, v23, v19, s21
    v_perm_b32 v102, v31, v27, s21
    v_perm_b32 v103, v39, v35, s21
    buffer_store_dwordx4 v[72:75], v1, s[4:7], s24 offen offset:0
    buffer_store_dwordx4 v[76:79], v1, s[4:7], s24 offen offset:16
    buffer_store_dwordx4 v[80:83], v1, s[4:7], s24 offen offset:32
    buffer_store_dwordx4 v[84:87], v1, s[4:7], s24 offen offset:48
    buffer_store_dwordx4 v[88:91], v1, s[4:7], s25 offen offset:0
    buffer_store_dwordx4 v[92:95], v1, s[4:7], s25 offen offset:16
    buffer_store_dwordx4 v[96:99], v1, s[4:7], s25 offen offset:32
    buffer_store_dwordx4 v[100:103], v1, s[4:7], s25 offen offset:48
    s_waitcnt vmcnt(8)
    v_perm_b32 v104, v44, v40, s20
    v_perm_b32 v105, v52, v48, s20
    v_perm_b32 v106, v60, v56, s20
    v_perm_b32 v107, v68, v64, s20
    v_perm_b32 v108, v44, v40, s21
    v_perm_b32 v109, v52, v48, s21
    v_perm_b32 v110, v60, v56, s21
    v_perm_b32 v111, v68, v64, s21
    v_perm_b32 v112, v45, v41, s20
    v_perm_b32 v113, v53, v49, s20
    v_perm_b32 v114, v61, v57, s20
    v_perm_b32 v115, v69, v65, s20
    v_perm_b32 v116, v45, v41, s21
    v_perm_b32 v117, v53, v49, s21
    v_perm_b32 v118, v61, v57, s21
    v_perm_b32 v119, v69, v65, s21
    v_perm_b32 v120, v46, v42, s20
    v_perm_b32 v121, v54, v50, s20
    v_perm_b32 v122, v62, v58, s20
    v_perm_b32 v123, v70, v66, s20
    v_perm_b32 v124, v46, v42, s21
    v_perm_b32 v125, v54, v50, s21
    v_perm_b32 v126, v62, v58, s21
    v_perm_b32 v127, v70, v66, s21
    v_perm_b32 v128, v47, v43, s20
    v_perm_b32 v129, v55, v51, s20
    v_perm_b32 v130, v63, v59, s20
    v_perm_b32 v131, v71, v67, s20
    v_perm_b32 v132, v47, v43, s21
    v_perm_b32 v133, v55, v51, s21
    v_perm_b32 v134, v63, v59, s21
    v_perm_b32 v135, v71, v67, s21
    buffer_store_dwordx4 v[104:107], v1, s[4:7], s24 offen offset:512
    buffer_store_dwordx4 v[108:111], v1, s[4:7], s24 offen offset:528
    buffer_store_dwordx4 v[112:115], v1, s[4:7], s24 offen offset:544
    buffer_store_dwordx4 v[116:119], v1, s[4:7], s24 offen offset:560
    buffer_store_dwordx4 v[120:123], v1, s[4:7], s25 offen offset:512
    buffer_store_dwordx4 v[124:127], v1, s[4:7], s25 offen offset:528
    buffer_store_dwordx4 v[128:131], v1, s[4:7], s25 offen offset:544
    buffer_store_dwordx4 v[132:135], v1, s[4:7], s25 offen offset:560
    s_branch rf_end
k1_rw2:
    s_mul_i32 s19, s18, 147
    s_lshr_b32 s19, s19, 10
    s_mul_i32 s22, s19, 7
    s_sub_u32 s22, s18, s22
    v_lshrrev_b32 v5, 3, v0
    v_and_b32 v6, 7, v0
    v_mul_u32_u24 v7, 7168, v5
    v_lshl_add_u32 v7, v6, 4, v7
    s_mul_i32 s23, s19, 114688
    s_lshl_b32 s24, s22, 7
    s_add_u32 s23, s23, s24
    s_waitcnt lgkmcnt(0)
    s_add_u32 s24, s23, 0
    buffer_load_dwordx4 v[8:11], v7, s[36:39], s24 offen
    s_add_u32 s24, s23, 896
    buffer_load_dwordx4 v[12:15], v7, s[36:39], s24 offen
    s_add_u32 s24, s23, 1792
    buffer_load_dwordx4 v[16:19], v7, s[36:39], s24 offen
    s_add_u32 s24, s23, 2688
    buffer_load_dwordx4 v[20:23], v7, s[36:39], s24 offen
    s_add_u32 s24, s23, 3584
    buffer_load_dwordx4 v[24:27], v7, s[36:39], s24 offen
    s_add_u32 s24, s23, 4480
    buffer_load_dwordx4 v[28:31], v7, s[36:39], s24 offen
    s_add_u32 s24, s23, 5376
    buffer_load_dwordx4 v[32:35], v7, s[36:39], s24 offen
    s_add_u32 s24, s23, 6272
    buffer_load_dwordx4 v[36:39], v7, s[36:39], s24 offen
    s_add_u32 s24, s23, 57344
    buffer_load_dwordx4 v[40:43], v7, s[36:39], s24 offen
    s_add_u32 s24, s23, 58240
    buffer_load_dwordx4 v[44:47], v7, s[36:39], s24 offen
    s_add_u32 s24, s23, 59136
    buffer_load_dwordx4 v[48:51], v7, s[36:39], s24 offen
    s_add_u32 s24, s23, 60032
    buffer_load_dwordx4 v[52:55], v7, s[36:39], s24 offen
    s_add_u32 s24, s23, 60928
    buffer_load_dwordx4 v[56:59], v7, s[36:39], s24 offen
    s_add_u32 s24, s23, 61824
    buffer_load_dwordx4 v[60:63], v7, s[36:39], s24 offen
    s_add_u32 s24, s23, 62720
    buffer_load_dwordx4 v[64:67], v7, s[36:39], s24 offen
    s_add_u32 s24, s23, 63616
    buffer_load_dwordx4 v[68:71], v7, s[36:39], s24 offen
    v_lshrrev_b32 v1, 2, v5
    v_lshlrev_b32 v1, 10, v1
    v_and_b32 v5, 3, v5
    v_lshl_add_u32 v1, v5, 8, v1
    v_and_b32 v5, 3, v6
    v_lshl_add_u32 v1, v5, 6, v1
    v_lshrrev_b32 v5, 2, v6
    v_mul_u32_u24 v5, 114688, v5
    v_add_u32 v1, v1, v5
    s_mul_i32 s24, s22, 229376
    s_lshl_b32 s25, s19, 12
    s_add_u32 s24, s24, s25
    s_add_u32 s24, s24, 21561344
    s_add_u32 s25, s24, 57344
    s_waitcnt vmcnt(8)
    v_perm_b32 v72, v12, v8, s20
    v_perm_b32 v73, v20, v16, s20
    v_perm_b32 v74, v28, v24, s20
    v_perm_b32 v75, v36, v32, s20
    v_perm_b32 v76, v12, v8, s21
    v_perm_b32 v77, v20, v16, s21
    v_perm_b32 v78, v28, v24, s21
    v_perm_b32 v79, v36, v32, s21
    v_perm_b32 v80, v13, v9, s20
    v_perm_b32 v81, v21, v17, s20
    v_perm_b32 v82, v29, v25, s20
    v_perm_b32 v83, v37, v33, s20
    v_perm_b32 v84, v13, v9, s21
    v_perm_b32 v85, v21, v17, s21
    v_perm_b32 v86, v29, v25, s21
    v_perm_b32 v87, v37, v33, s21
    v_perm_b32 v88, v14, v10, s20
    v_perm_b32 v89, v22, v18, s20
    v_perm_b32 v90, v30, v26, s20
    v_perm_b32 v91, v38, v34, s20
    v_perm_b32 v92, v14, v10, s21
    v_perm_b32 v93, v22, v18, s21
    v_perm_b32 v94, v30, v26, s21
    v_perm_b32 v95, v38, v34, s21
    v_perm_b32 v96, v15, v11, s20
    v_perm_b32 v97, v23, v19, s20
    v_perm_b32 v98, v31, v27, s20
    v_perm_b32 v99, v39, v35, s20
    v_perm_b32 v100, v15, v11, s21
    v_perm_b32 v101, v23, v19, s21
    v_perm_b32 v102, v31, v27, s21
    v_perm_b32 v103, v39, v35, s21
    buffer_store_dwordx4 v[72:75], v1, s[4:7], s24 offen offset:0
    buffer_store_dwordx4 v[76:79], v1, s[4:7], s25 offen offset:0
    buffer_store_dwordx4 v[80:83], v1, s[4:7], s24 offen offset:16
    buffer_store_dwordx4 v[84:87], v1, s[4:7], s25 offen offset:16
    buffer_store_dwordx4 v[88:91], v1, s[4:7], s24 offen offset:32
    buffer_store_dwordx4 v[92:95], v1, s[4:7], s25 offen offset:32
    buffer_store_dwordx4 v[96:99], v1, s[4:7], s24 offen offset:48
    buffer_store_dwordx4 v[100:103], v1, s[4:7], s25 offen offset:48
    s_waitcnt vmcnt(8)
    v_perm_b32 v104, v44, v40, s20
    v_perm_b32 v105, v52, v48, s20
    v_perm_b32 v106, v60, v56, s20
    v_perm_b32 v107, v68, v64, s20
    v_perm_b32 v108, v44, v40, s21
    v_perm_b32 v109, v52, v48, s21
    v_perm_b32 v110, v60, v56, s21
    v_perm_b32 v111, v68, v64, s21
    v_perm_b32 v112, v45, v41, s20
    v_perm_b32 v113, v53, v49, s20
    v_perm_b32 v114, v61, v57, s20
    v_perm_b32 v115, v69, v65, s20
    v_perm_b32 v116, v45, v41, s21
    v_perm_b32 v117, v53, v49, s21
    v_perm_b32 v118, v61, v57, s21
    v_perm_b32 v119, v69, v65, s21
    v_perm_b32 v120, v46, v42, s20
    v_perm_b32 v121, v54, v50, s20
    v_perm_b32 v122, v62, v58, s20
    v_perm_b32 v123, v70, v66, s20
    v_perm_b32 v124, v46, v42, s21
    v_perm_b32 v125, v54, v50, s21
    v_perm_b32 v126, v62, v58, s21
    v_perm_b32 v127, v70, v66, s21
    v_perm_b32 v128, v47, v43, s20
    v_perm_b32 v129, v55, v51, s20
    v_perm_b32 v130, v63, v59, s20
    v_perm_b32 v131, v71, v67, s20
    v_perm_b32 v132, v47, v43, s21
    v_perm_b32 v133, v55, v51, s21
    v_perm_b32 v134, v63, v59, s21
    v_perm_b32 v135, v71, v67, s21
    buffer_store_dwordx4 v[104:107], v1, s[4:7], s24 offen offset:2048
    buffer_store_dwordx4 v[108:111], v1, s[4:7], s25 offen offset:2048
    buffer_store_dwordx4 v[112:115], v1, s[4:7], s24 offen offset:2064
    buffer_store_dwordx4 v[116:119], v1, s[4:7], s25 offen offset:2064
    buffer_store_dwordx4 v[120:123], v1, s[4:7], s24 offen offset:2080
    buffer_store_dwordx4 v[124:127], v1, s[4:7], s25 offen offset:2080
    buffer_store_dwordx4 v[128:131], v1, s[4:7], s24 offen offset:2096
    buffer_store_dwordx4 v[132:135], v1, s[4:7], s25 offen offset:2096
rf_end:
    v_lshlrev_b32 v1, 4, v0
    s_waitcnt vmcnt(0)
    s_barrier
    s_cmp_lg_u32 s3, 0
    s_cbranch_scc1 sf_143
    s_cmp_ge_u32 s96, 74
    s_cbranch_scc1 sfr_144
    buffer_wbl2 sc1
    s_waitcnt vmcnt(0)
sfr_144:
    v_mov_b32 v2, 1
    s_lshl_b32 s16, s96, 2
    s_add_u32 s16, s16, 73985024
    v_mov_b32 v3, 0
    s_mov_b64 exec, 1
    buffer_store_dword v2, v3, s[4:7], s16 offen sc1
    s_mov_b64 exec, -1
sf_143:
    s_cmp_lg_u32 s3, 0
    s_cbranch_scc1 wfl_145
    v_mbcnt_lo_u32_b32 v2, -1, 0
    v_mbcnt_hi_u32_b32 v2, -1, v2
    v_min_u32 v2, 55, v2
    v_lshlrev_b32 v2, 4, v2
    s_mov_b32 s16, 73985024
    s_mov_b32 s30, 400000
sw_146:
    buffer_load_dwordx4 v[4:7], v2, s[4:7], s16 offen sc1
    s_waitcnt vmcnt(0)
    v_min_u32 v4, v4, v5
    v_min3_u32 v4, v4, v6, v7
    v_cmp_eq_u32 vcc, 0, v4
    s_cbranch_vccz swo_147
    s_sleep 16
    s_sub_u32 s30, s30, 1
    s_cmp_lg_u32 s30, 0
    s_cbranch_scc1 sw_146
    s_branch k2_end
swo_147:
wfl_145:
    s_barrier
    s_and_b32 s16, s92, 15
    s_lshr_b32 s17, s92, 4
    s_lshl_b32 s18, s91, 1
    s_add_u32 s17, s17, s18
    s_lshl_b32 s17, s17, 2
    s_add_u32 s17, s17, s3
    s_mul_i32 s18, s17, 57344
    s_add_u32 s18, s18, 18350080
    s_mul_i32 s24, s3, 7168
    s_mul_i32 s19, s16, 28672
    s_add_u32 s19, s19, s24
    s_add_u32 s19, s19, 1835008
    s_barrier
    s_add_u32 s22, s24, 0
    s_mov_b32 m0, s22
    s_add_u32 s23, s19, 0
    buffer_load_dwordx4 v1, s[4:7], s23 offen offset:0 lds
    buffer_load_dwordx4 v1, s[4:7], s23 offen offset:1024 lds
    buffer_load_dwordx4 v1, s[4:7], s23 offen offset:2048 lds
    buffer_load_dwordx4 v1, s[4:7], s23 offen offset:3072 lds
    s_add_u32 s22, s24, 4096
    s_mov_b32 m0, s22
    s_add_u32 s23, s19, 4096
    buffer_load_dwordx4 v1, s[4:7], s23 offen offset:0 lds
    buffer_load_dwordx4 v1, s[4:7], s23 offen offset:1024 lds
    buffer_load_dwordx4 v1, s[4:7], s23 offen offset:2048 lds
    s_add_u32 s26, s18, 0
    s_add_u32 s27, s18, 14336
    s_add_u32 s28, s18, 28672
    s_add_u32 s29, s18, 43008
    buffer_load_dwordx4 a[0:3], v1, s[4:7], s26 offen offset:0
    buffer_load_dwordx4 a[4:7], v1, s[4:7], s26 offen offset:1024
    buffer_load_dwordx4 a[8:11], v1, s[4:7], s26 offen offset:2048
    buffer_load_dwordx4 a[12:15], v1, s[4:7], s26 offen offset:3072
    s_add_u32 s26, s26, 4096
    buffer_load_dwordx4 a[56:59], v1, s[4:7], s27 offen offset:0
    buffer_load_dwordx4 a[60:63], v1, s[4:7], s27 offen offset:1024
    buffer_load_dwordx4 a[64:67], v1, s[4:7], s27 offen offset:2048
    buffer_load_dwordx4 a[68:71], v1, s[4:7], s27 offen offset:3072
    s_add_u32 s27, s27, 4096
    buffer_load_dwordx4 a[112:115], v1, s[4:7], s28 offen offset:0
    buffer_load_dwordx4 a[116:119], v1, s[4:7], s28 offen offset:1024
    buffer_load_dwordx4 a[120:123], v1, s[4:7], s28 offen offset:2048
    buffer_load_dwordx4 a[124:127], v1, s[4:7], s28 offen offset:3072
    s_add_u32 s28, s28, 4096
    buffer_load_dwordx4 a[168:171], v1, s[4:7], s29 offen offset:0
    buffer_load_dwordx4 a[172:175], v1, s[4:7], s29 offen offset:1024
    buffer_load_dwordx4 a[176:179], v1, s[4:7], s29 offen offset:2048
    buffer_load_dwordx4 a[180:183], v1, s[4:7], s29 offen offset:3072
    s_add_u32 s29, s29, 4096
    buffer_load_dwordx4 a[16:19], v1, s[4:7], s26 offen offset:0
    buffer_load_dwordx4 a[20:23], v1, s[4:7], s26 offen offset:1024
    buffer_load_dwordx4 a[24:27], v1, s[4:7], s26 offen offset:2048
    buffer_load_dwordx4 a[28:31], v1, s[4:7], s26 offen offset:3072
    s_add_u32 s26, s26, 4096
    buffer_load_dwordx4 a[72:75], v1, s[4:7], s27 offen offset:0
    buffer_load_dwordx4 a[76:79], v1, s[4:7], s27 offen offset:1024
    buffer_load_dwordx4 a[80:83], v1, s[4:7], s27 offen offset:2048
    buffer_load_dwordx4 a[84:87], v1, s[4:7], s27 offen offset:3072
    s_add_u32 s27, s27, 4096
    buffer_load_dwordx4 a[128:131], v1, s[4:7], s28 offen offset:0
    buffer_load_dwordx4 a[132:135], v1, s[4:7], s28 offen offset:1024
    buffer_load_dwordx4 a[136:139], v1, s[4:7], s28 offen offset:2048
    buffer_load_dwordx4 a[140:143], v1, s[4:7], s28 offen offset:3072
    s_add_u32 s28, s28, 4096
    buffer_load_dwordx4 a[184:187], v1, s[4:7], s29 offen offset:0
    buffer_load_dwordx4 a[188:191], v1, s[4:7], s29 offen offset:1024
    buffer_load_dwordx4 a[192:195], v1, s[4:7], s29 offen offset:2048
    buffer_load_dwordx4 a[196:199], v1, s[4:7], s29 offen offset:3072
    s_add_u32 s29, s29, 4096
    buffer_load_dwordx4 a[32:35], v1, s[4:7], s26 offen offset:0
    buffer_load_dwordx4 a[36:39], v1, s[4:7], s26 offen offset:1024
    buffer_load_dwordx4 a[40:43], v1, s[4:7], s26 offen offset:2048
    buffer_load_dwordx4 a[44:47], v1, s[4:7], s26 offen offset:3072
    s_add_u32 s26, s26, 4096
    buffer_load_dwordx4 a[88:91], v1, s[4:7], s27 offen offset:0
    buffer_load_dwordx4 a[92:95], v1, s[4:7], s27 offen offset:1024
    buffer_load_dwordx4 a[96:99], v1, s[4:7], s27 offen offset:2048
    buffer_load_dwordx4 a[100:103], v1, s[4:7], s27 offen offset:3072
    s_add_u32 s27, s27, 4096
    buffer_load_dwordx4 a[144:147], v1, s[4:7], s28 offen offset:0
    buffer_load_dwordx4 a[148:151], v1, s[4:7], s28 offen offset:1024
    buffer_load_dwordx4 a[152:155], v1, s[4:7], s28 offen offset:2048
    buffer_load_dwordx4 a[156:159], v1, s[4:7], s28 offen offset:3072
    s_add_u32 s28, s28, 4096
    buffer_load_dwordx4 a[200:203], v1, s[4:7], s29 offen offset:0
    buffer_load_dwordx4 a[204:207], v1, s[4:7], s29 offen offset:1024
    buffer_load_dwordx4 a[208:211], v1, s[4:7], s29 offen offset:2048
    buffer_load_dwordx4 a[212:215], v1, s[4:7], s29 offen offset:3072
    s_add_u32 s29, s29, 4096
    buffer_load_dwordx4 a[48:51], v1, s[4:7], s26 offen offset:0
    buffer_load_dwordx4 a[52:55], v1, s[4:7], s26 offen offset:1024
    buffer_load_dwordx4 a[104:107], v1, s[4:7], s27 offen offset:0
    buffer_load_dwordx4 a[108:111], v1, s[4:7], s27 offen offset:1024
    buffer_load_dwordx4 a[160:163], v1, s[4:7], s28 offen offset:0
    buffer_load_dwordx4 a[164:167], v1, s[4:7], s28 offen offset:1024
    buffer_load_dwordx4 a[216:219], v1, s[4:7], s29 offen offset:0
    buffer_load_dwordx4 a[220:223], v1, s[4:7], s29 offen offset:1024
    s_mul_i32 s21, s16, 114688
    s_lshl_b32 s22, s17, 10
    s_add_u32 s21, s21, s22
    s_add_u32 s21, s21, 52789248
    v_add_u32 v4, 57344, v1
    s_waitcnt vmcnt(56)
    s_barrier
    s_add_u32 s22, s24, 28672
    s_mov_b32 m0, s22
    s_add_u32 s23, s19, 458752
    buffer_load_dwordx4 v1, s[4:7], s23 offen offset:0 lds
    buffer_load_dwordx4 v1, s[4:7], s23 offen offset:1024 lds
    buffer_load_dwordx4 v1, s[4:7], s23 offen offset:2048 lds
    buffer_load_dwordx4 v1, s[4:7], s23 offen offset:3072 lds
    s_add_u32 s22, s24, 32768
    s_mov_b32 m0, s22
    s_add_u32 s23, s19, 462848
    buffer_load_dwordx4 v1, s[4:7], s23 offen offset:0 lds
    buffer_load_dwordx4 v1, s[4:7], s23 offen offset:1024 lds
    buffer_load_dwordx4 v1, s[4:7], s23 offen offset:2048 lds
    s_add_u32 s22, s24, 57344
    s_mov_b32 m0, s22
    s_add_u32 s23, s19, 917504
    buffer_load_dwordx4 v1, s[4:7], s23 offen offset:0 lds
    buffer_load_dwordx4 v1, s[4:7], s23 offen offset:1024 lds
    buffer_load_dwordx4 v1, s[4:7], s23 offen offset:2048 lds
    buffer_load_dwordx4 v1, s[4:7], s23 offen offset:3072 lds
    s_add_u32 s22, s24, 61440
    s_mov_b32 m0, s22
    s_add_u32 s23, s19, 921600
    buffer_load_dwordx4 v1, s[4:7], s23 offen offset:0 lds
    buffer_load_dwordx4 v1, s[4:7], s23 offen offset:1024 lds
    buffer_load_dwordx4 v1, s[4:7], s23 offen offset:2048 lds
    ds_read_b128 v[96:99], v1 offset:0
    ds_read_b128 v[100:103], v1 offset:14336
    ds_read_b128 v[104:107], v1 offset:1024
    ds_read_b128 v[108:111], v1 offset:15360
    ds_read_b128 v[112:115], v1 offset:2048
    ds_read_b128 v[116:119], v1 offset:16384
    s_waitcnt vmcnt(54)
    ds_read_b128 v[120:123], v1 offset:3072
    ds_read_b128 v[124:127], v1 offset:17408
    s_waitcnt lgkmcnt(6)
    v_mfma_f32_16x16x32_bf16 v[16:19], a[0:3], v[96:99], 0
    v_mfma_f32_16x16x32_bf16 v[20:23], a[0:3], v[100:103], 0
    v_mfma_f32_16x16x32_bf16 v[24:27], a[56:59], v[96:99], 0
    v_mfma_f32_16x16x32_bf16 v[28:31], a[56:59], v[100:103], 0
    v_mfma_f32_16x16x32_bf16 v[32:35], a[112:115], v[96:99], 0
    v_mfma_f32_16x16x32_bf16 v[36:39], a[112:115], v[100:103], 0
    v_mfma_f32_16x16x32_bf16 v[40:43], a[168:171], v[96:99], 0
    v_mfma_f32_16x16x32_bf16 v[44:47], a[168:171], v[100:103], 0
    ds_read_b128 v[96:99], v1 offset:4096
    ds_read_b128 v[100:103], v1 offset:18432
    s_waitcnt lgkmcnt(6)
    v_mfma_f32_16x16x32_bf16 v[16:19], a[4:7], v[104:107], v[16:19]
    v_mfma_f32_16x16x32_bf16 v[20:23], a[4:7], v[108:111], v[20:23]
    v_mfma_f32_16x16x32_bf16 v[24:27], a[60:63], v[104:107], v[24:27]
    v_mfma_f32_16x16x32_bf16 v[28:31], a[60:63], v[108:111], v[28:31]
    v_mfma_f32_16x16x32_bf16 v[32:35], a[116:119], v[104:107], v[32:35]
    v_mfma_f32_16x16x32_bf16 v[36:39], a[116:119], v[108:111], v[36:39]
    v_mfma_f32_16x16x32_bf16 v[40:43], a[172:175], v[104:107], v[40:43]
    v_mfma_f32_16x16x32_bf16 v[44:47], a[172:175], v[108:111], v[44:47]
    ds_read_b128 v[104:107], v1 offset:5120
    ds_read_b128 v[108:111], v1 offset:19456
    s_waitcnt lgkmcnt(6)
    v_mfma_f32_16x16x32_bf16 v[16:19], a[8:11], v[112:115], v[16:19]
    v_mfma_f32_16x16x32_bf16 v[20:23], a[8:11], v[116:119], v[20:23]
    v_mfma_f32_16x16x32_bf16 v[24:27], a[64:67], v[112:115], v[24:27]
    v_mfma_f32_16x16x32_bf16 v[28:31], a[64:67], v[116:119], v[28:31]
    v_mfma_f32_16x16x32_bf16 v[32:35], a[120:123], v[112:115], v[32:35]
    v_mfma_f32_16x16x32_bf16 v[36:39], a[120:123], v[116:119], v[36:39]
    v_mfma_f32_16x16x32_bf16 v[40:43], a[176:179], v[112:115], v[40:43]
    v_mfma_f32_16x16x32_bf16 v[44:47], a[176:179], v[116:119], v[44:47]
    ds_read_b128 v[112:115], v1 offset:6144
    ds_read_b128 v[116:119], v1 offset:20480
    s_waitcnt lgkmcnt(6)
    v_mfma_f32_16x16x32_bf16 v[16:19], a[12:15], v[120:123], v[16:19]
    v_mfma_f32_16x16x32_bf16 v[20:23], a[12:15], v[124:127], v[20:23]
    v_mfma_f32_16x16x32_bf16 v[24:27], a[68:71], v[120:123], v[24:27]
    v_mfma_f32_16x16x32_bf16 v[28:31], a[68:71], v[124:127], v[28:31]
    v_mfma_f32_16x16x32_bf16 v[32:35], a[124:127], v[120:123], v[32:35]
    v_mfma_f32_16x16x32_bf16 v[36:39], a[124:127], v[124:127], v[36:39]
    v_mfma_f32_16x16x32_bf16 v[40:43], a[180:183], v[120:123], v[40:43]
    v_mfma_f32_16x16x32_bf16 v[44:47], a[180:183], v[124:127], v[44:47]
    s_waitcnt vmcnt(38)
    ds_read_b128 v[120:123], v1 offset:7168
    ds_read_b128 v[124:127], v1 offset:21504
    s_waitcnt lgkmcnt(6)
    v_mfma_f32_16x16x32_bf16 v[16:19], a[16:19], v[96:99], v[16:19]
    v_mfma_f32_16x16x32_bf16 v[20:23], a[16:19], v[100:103], v[20:23]
    v_mfma_f32_16x16x32_bf16 v[24:27], a[72:75], v[96:99], v[24:27]
    v_mfma_f32_16x16x32_bf16 v[28:31], a[72:75], v[100:103], v[28:31]
    v_mfma_f32_16x16x32_bf16 v[32:35], a[128:131], v[96:99], v[32:35]
    v_mfma_f32_16x16x32_bf16 v[36:39], a[128:131], v[100:103], v[36:39]
    v_mfma_f32_16x16x32_bf16 v[40:43], a[184:187], v[96:99], v[40:43]
    v_mfma_f32_16x16x32_bf16 v[44:47], a[184:187], v[100:103], v[44:47]
    ds_read_b128 v[96:99], v1 offset:8192
    ds_read_b128 v[100:103], v1 offset:22528
    s_waitcnt lgkmcnt(6)
    v_mfma_f32_16x16x32_bf16 v[16:19], a[20:23], v[104:107], v[16:19]
    v_mfma_f32_16x16x32_bf16 v[20:23], a[20:23], v[108:111], v[20:23]
    v_mfma_f32_16x16x32_bf16 v[24:27], a[76:79], v[104:107], v[24:27]
    v_mfma_f32_16x16x32_bf16 v[28:31], a[76:79], v[108:111], v[28:31]
    v_mfma_f32_16x16x32_bf16 v[32:35], a[132:135], v[104:107], v[32:35]
    v_mfma_f32_16x16x32_bf16 v[36:39], a[132:135], v[108:111], v[36:39]
    v_mfma_f32_16x16x32_bf16 v[40:43], a[188:191], v[104:107], v[40:43]
    v_mfma_f32_16x16x32_bf16 v[44:47], a[188:191], v[108:111], v[44:47]
    ds_read_b128 v[104:107], v1 offset:9216
    ds_read_b128 v[108:111], v1 offset:23552
    s_waitcnt lgkmcnt(6)
    v_mfma_f32_16x16x32_bf16 v[16:19], a[24:27], v[112:115], v[16:19]
    v_mfma_f32_16x16x32_bf16 v[20:23], a[24:27], v[116:119], v[20:23]
    v_mfma_f32_16x16x32_bf16 v[24:27], a[80:83], v[112:115], v[24:27]
    v_mfma_f32_16x16x32_bf16 v[28:31], a[80:83], v[116:119], v[28:31]
    v_mfma_f32_16x16x32_bf16 v[32:35], a[136:139], v[112:115], v[32:35]
    v_mfma_f32_16x16x32_bf16 v[36:39], a[136:139], v[116:119], v[36:39]
    v_mfma_f32_16x16x32_bf16 v[40:43], a[192:195], v[112:115], v[40:43]
    v_mfma_f32_16x16x32_bf16 v[44:47], a[192:195], v[116:119], v[44:47]
    ds_read_b128 v[112:115], v1 offset:10240
    ds_read_b128 v[116:119], v1 offset:24576
    s_waitcnt lgkmcnt(6)
    v_mfma_f32_16x16x32_bf16 v[16:19], a[28:31], v[120:123], v[16:19]
    v_mfma_f32_16x16x32_bf16 v[20:23], a[28:31], v[124:127], v[20:23]
    v_mfma_f32_16x16x32_bf16 v[24:27], a[84:87], v[120:123], v[24:27]
    v_mfma_f32_16x16x32_bf16 v[28:31], a[84:87], v[124:127], v[28:31]
    v_mfma_f32_16x16x32_bf16 v[32:35], a[140:143], v[120:123], v[32:35]
    v_mfma_f32_16x16x32_bf16 v[36:39], a[140:143], v[124:127], v[36:39]
    v_mfma_f32_16x16x32_bf16 v[40:43], a[196:199], v[120:123], v[40:43]
    v_mfma_f32_16x16x32_bf16 v[44:47], a[196:199], v[124:127], v[44:47]
    s_waitcnt vmcnt(22)
    ds_read_b128 v[120:123], v1 offset:11264
    ds_read_b128 v[124:127], v1 offset:25600
    s_waitcnt lgkmcnt(6)
    v_mfma_f32_16x16x32_bf16 v[16:19], a[32:35], v[96:99], v[16:19]
    v_mfma_f32_16x16x32_bf16 v[20:23], a[32:35], v[100:103], v[20:23]
    v_mfma_f32_16x16x32_bf16 v[24:27], a[88:91], v[96:99], v[24:27]
    v_mfma_f32_16x16x32_bf16 v[28:31], a[88:91], v[100:103], v[28:31]
    v_mfma_f32_16x16x32_bf16 v[32:35], a[144:147], v[96:99], v[32:35]
    v_mfma_f32_16x16x32_bf16 v[36:39], a[144:147], v[100:103], v[36:39]
    v_mfma_f32_16x16x32_bf16 v[40:43], a[200:203], v[96:99], v[40:43]
    v_mfma_f32_16x16x32_bf16 v[44:47], a[200:203], v[100:103], v[44:47]
    ds_read_b128 v[96:99], v1 offset:12288
    ds_read_b128 v[100:103], v1 offset:26624
    s_waitcnt lgkmcnt(6)
    v_mfma_f32_16x16x32_bf16 v[16:19], a[36:39], v[104:107], v[16:19]
    v_mfma_f32_16x16x32_bf16 v[20:23], a[36:39], v[108:111], v[20:23]
    v_mfma_f32_16x16x32_bf16 v[24:27], a[92:95], v[104:107], v[24:27]
    v_mfma_f32_16x16x32_bf16 v[28:31], a[92:95], v[108:111], v[28:31]
    v_mfma_f32_16x16x32_bf16 v[32:35], a[148:151], v[104:107], v[32:35]
    v_mfma_f32_16x16x32_bf16 v[36:39], a[148:151], v[108:111], v[36:39]
    v_mfma_f32_16x16x32_bf16 v[40:43], a[204:207], v[104:107], v[40:43]
    v_mfma_f32_16x16x32_bf16 v[44:47], a[204:207], v[108:111], v[44:47]
    ds_read_b128 v[104:107], v1 offset:13312
    ds_read_b128 v[108:111], v1 offset:27648
    s_waitcnt lgkmcnt(6)
    v_mfma_f32_16x16x32_bf16 v[16:19], a[40:43], v[112:115], v[16:19]
    v_mfma_f32_16x16x32_bf16 v[20:23], a[40:43], v[116:119], v[20:23]
    v_mfma_f32_16x16x32_bf16 v[24:27], a[96:99], v[112:115], v[24:27]
    v_mfma_f32_16x16x32_bf16 v[28:31], a[96:99], v[116:119], v[28:31]
    v_mfma_f32_16x16x32_bf16 v[32:35], a[152:155], v[112:115], v[32:35]
    v_mfma_f32_16x16x32_bf16 v[36:39], a[152:155], v[116:119], v[36:39]
    v_mfma_f32_16x16x32_bf16 v[40:43], a[208:211], v[112:115], v[40:43]
    v_mfma_f32_16x16x32_bf16 v[44:47], a[208:211], v[116:119], v[44:47]
    s_waitcnt lgkmcnt(4)
    v_mfma_f32_16x16x32_bf16 v[16:19], a[44:47], v[120:123], v[16:19]
    v_mfma_f32_16x16x32_bf16 v[20:23], a[44:47], v[124:127], v[20:23]
    v_mfma_f32_16x16x32_bf16 v[24:27], a[100:103], v[120:123], v[24:27]
    v_mfma_f32_16x16x32_bf16 v[28:31], a[100:103], v[124:127], v[28:31]
    v_mfma_f32_16x16x32_bf16 v[32:35], a[156:159], v[120:123], v[32:35]
    v_mfma_f32_16x16x32_bf16 v[36:39], a[156:159], v[124:127], v[36:39]
    v_mfma_f32_16x16x32_bf16 v[40:43], a[212:215], v[120:123], v[40:43]
    v_mfma_f32_16x16x32_bf16 v[44:47], a[212:215], v[124:127], v[44:47]
    s_waitcnt vmcnt(14)
    s_waitcnt lgkmcnt(2)
    v_mfma_f32_16x16x32_bf16 v[16:19], a[48:51], v[96:99], v[16:19]
    v_mfma_f32_16x16x32_bf16 v[20:23], a[48:51], v[100:103], v[20:23]
    v_mfma_f32_16x16x32_bf16 v[24:27], a[104:107], v[96:99], v[24:27]
    v_mfma_f32_16x16x32_bf16 v[28:31], a[104:107], v[100:103], v[28:31]
    v_mfma_f32_16x16x32_bf16 v[32:35], a[160:163], v[96:99], v[32:35]
    v_mfma_f32_16x16x32_bf16 v[36:39], a[160:163], v[100:103], v[36:39]
    v_mfma_f32_16x16x32_bf16 v[40:43], a[216:219], v[96:99], v[40:43]
    v_mfma_f32_16x16x32_bf16 v[44:47], a[216:219], v[100:103], v[44:47]
    s_waitcnt lgkmcnt(0)
    v_mfma_f32_16x16x32_bf16 v[16:19], a[52:55], v[104:107], v[16:19]
    v_mfma_f32_16x16x32_bf16 v[20:23], a[52:55], v[108:111], v[20:23]
    v_mfma_f32_16x16x32_bf16 v[24:27], a[108:111], v[104:107], v[24:27]
    v_mfma_f32_16x16x32_bf16 v[28:31], a[108:111], v[108:111], v[28:31]
    v_mfma_f32_16x16x32_bf16 v[32:35], a[164:167], v[104:107], v[32:35]
    v_mfma_f32_16x16x32_bf16 v[36:39], a[164:167], v[108:111], v[36:39]
    v_mfma_f32_16x16x32_bf16 v[40:43], a[220:223], v[104:107], v[40:43]
    v_mfma_f32_16x16x32_bf16 v[44:47], a[220:223], v[108:111], v[44:47]
    s_waitcnt vmcnt(7)
    s_barrier
    s_add_u32 s22, s24, 86016
    s_mov_b32 m0, s22
    s_add_u32 s23, s19, 1376256
    buffer_load_dwordx4 v1, s[4:7], s23 offen offset:0 lds
    buffer_load_dwordx4 v1, s[4:7], s23 offen offset:1024 lds
    buffer_load_dwordx4 v1, s[4:7], s23 offen offset:2048 lds
    buffer_load_dwordx4 v1, s[4:7], s23 offen offset:3072 lds
    s_add_u32 s22, s24, 90112
    s_mov_b32 m0, s22
    s_add_u32 s23, s19, 1380352
    buffer_load_dwordx4 v1, s[4:7], s23 offen offset:0 lds
    buffer_load_dwordx4 v1, s[4:7], s23 offen offset:1024 lds
    buffer_load_dwordx4 v1, s[4:7], s23 offen offset:2048 lds
    ds_read_b128 v[96:99], v1 offset:28672
    ds_read_b128 v[100:103], v1 offset:43008
    ds_read_b128 v[104:107], v1 offset:29696
    ds_read_b128 v[108:111], v1 offset:44032
    ds_read_b128 v[112:115], v1 offset:30720
    ds_read_b128 v[116:119], v1 offset:45056
    ds_read_b128 v[120:123], v1 offset:31744
    ds_read_b128 v[124:127], v1 offset:46080
    s_waitcnt lgkmcnt(6)
    v_mfma_f32_16x16x32_bf16 v[48:51], a[0:3], v[96:99], 0
    v_mfma_f32_16x16x32_bf16 v[52:55], a[0:3], v[100:103], 0
    v_mfma_f32_16x16x32_bf16 v[56:59], a[56:59], v[96:99], 0
    v_mfma_f32_16x16x32_bf16 v[60:63], a[56:59], v[100:103], 0
    v_mfma_f32_16x16x32_bf16 v[64:67], a[112:115], v[96:99], 0
    v_mfma_f32_16x16x32_bf16 v[68:71], a[112:115], v[100:103], 0
    v_mfma_f32_16x16x32_bf16 v[72:75], a[168:171], v[96:99], 0
    v_mfma_f32_16x16x32_bf16 v[76:79], a[168:171], v[100:103], 0
    ds_read_b128 v[96:99], v1 offset:32768
    ds_read_b128 v[100:103], v1 offset:47104
    s_waitcnt lgkmcnt(6)
    v_mfma_f32_16x16x32_bf16 v[48:51], a[4:7], v[104:107], v[48:51]
    v_cvt_pk_bf16_f32 v8, v16, v17
    v_cvt_pk_bf16_f32 v9, v24, v25
    v_lshlrev_b32 v16, 16, v8
    v_mfma_f32_16x16x32_bf16 v[52:55], a[4:7], v[108:111], v[52:55]
    v_and_b32 v17, 0xffff0000, v8
    v_lshlrev_b32 v24, 16, v9
    v_and_b32 v25, 0xffff0000, v9
    v_mfma_f32_16x16x32_bf16 v[56:59], a[60:63], v[104:107], v[56:59]
    v_mul_f32 v10, 0xbfb8aa3b, v16
    v_exp_f32 v10, v10
    s_nop 0
    v_mfma_f32_16x16x32_bf16 v[60:63], a[60:63], v[108:111], v[60:63]
    v_add_f32 v10, 1.0, v10
    v_rcp_f32 v10, v10
    s_nop 0
    v_mfma_f32_16x16x32_bf16 v[64:67], a[116:119], v[104:107], v[64:67]
    v_mul_f32 v16, v16, v10
    v_mul_f32 v11, 0xbfb8aa3b, v17
    v_exp_f32 v11, v11
    v_mfma_f32_16x16x32_bf16 v[68:71], a[116:119], v[108:111], v[68:71]
    s_nop 0
    v_add_f32 v11, 1.0, v11
    v_rcp_f32 v11, v11
    v_mfma_f32_16x16x32_bf16 v[72:75], a[172:175], v[104:107], v[72:75]
    s_nop 0
    v_mul_f32 v17, v17, v11
    v_cvt_pk_bf16_f32 v8, v16, v17
    v_mfma_f32_16x16x32_bf16 v[76:79], a[172:175], v[108:111], v[76:79]
    v_lshlrev_b32 v16, 16, v8
    v_and_b32 v17, 0xffff0000, v8
    v_mul_f32 v16, v16, v24
    ds_read_b128 v[104:107], v1 offset:33792
    ds_read_b128 v[108:111], v1 offset:48128
    s_waitcnt lgkmcnt(6)
    v_mfma_f32_16x16x32_bf16 v[48:51], a[8:11], v[112:115], v[48:51]
    v_mul_f32 v17, v17, v25
    v_cvt_pk_bf16_f32 v80, v16, v17
    v_cvt_pk_bf16_f32 v8, v18, v19
    v_mfma_f32_16x16x32_bf16 v[52:55], a[8:11], v[116:119], v[52:55]
    v_cvt_pk_bf16_f32 v9, v26, v27
    v_lshlrev_b32 v18, 16, v8
    v_and_b32 v19, 0xffff0000, v8
    v_mfma_f32_16x16x32_bf16 v[56:59], a[64:67], v[112:115], v[56:59]
    v_lshlrev_b32 v26, 16, v9
    v_and_b32 v27, 0xffff0000, v9
    v_mul_f32 v10, 0xbfb8aa3b, v18
    v_mfma_f32_16x16x32_bf16 v[60:63], a[64:67], v[116:119], v[60:63]
    v_exp_f32 v10, v10
    s_nop 0
    v_add_f32 v10, 1.0, v10
    v_mfma_f32_16x16x32_bf16 v[64:67], a[120:123], v[112:115], v[64:67]
    v_rcp_f32 v10, v10
    s_nop 0
    v_mul_f32 v18, v18, v10
    v_mfma_f32_16x16x32_bf16 v[68:71], a[120:123], v[116:119], v[68:71]
    v_mul_f32 v11, 0xbfb8aa3b, v19
    v_exp_f32 v11, v11
    s_nop 0
    v_mfma_f32_16x16x32_bf16 v[72:75], a[176:179], v[112:115], v[72:75]
    v_add_f32 v11, 1.0, v11
    v_rcp_f32 v11, v11
    s_nop 0
    v_mfma_f32_16x16x32_bf16 v[76:79], a[176:179], v[116:119], v[76:79]
    v_mul_f32 v19, v19, v11
    v_cvt_pk_bf16_f32 v8, v18, v19
    v_lshlrev_b32 v18, 16, v8
    ds_read_b128 v[112:115], v1 offset:34816
    ds_read_b128 v[116:119], v1 offset:49152
    s_waitcnt lgkmcnt(6)
    v_mfma_f32_16x16x32_bf16 v[48:51], a[12:15], v[120:123], v[48:51]
    v_and_b32 v19, 0xffff0000, v8
    v_mul_f32 v18, v18, v26
    v_mul_f32 v19, v19, v27
    v_mfma_f32_16x16x32_bf16 v[52:55], a[12:15], v[124:127], v[52:55]
    v_cvt_pk_bf16_f32 v81, v18, v19
    v_cvt_pk_bf16_f32 v8, v32, v33
    v_cvt_pk_bf16_f32 v9, v40, v41
    v_mfma_f32_16x16x32_bf16 v[56:59], a[68:71], v[120:123], v[56:59]
    v_lshlrev_b32 v32, 16, v8
    v_and_b32 v33, 0xffff0000, v8
    v_lshlrev_b32 v40, 16, v9
    v_mfma_f32_16x16x32_bf16 v[60:63], a[68:71], v[124:127], v[60:63]
    v_and_b32 v41, 0xffff0000, v9
    v_mul_f32 v10, 0xbfb8aa3b, v32
    v_exp_f32 v10, v10
    v_mfma_f32_16x16x32_bf16 v[64:67], a[124:127], v[120:123], v[64:67]
    s_nop 0
    v_add_f32 v10, 1.0, v10
    v_rcp_f32 v10, v10
    v_mfma_f32_16x16x32_bf16 v[68:71], a[124:127], v[124:127], v[68:71]
    s_nop 0
    v_mul_f32 v32, v32, v10
    v_mul_f32 v11, 0xbfb8aa3b, v33
    v_mfma_f32_16x16x32_bf16 v[72:75], a[180:183], v[120:123], v[72:75]
    v_exp_f32 v11, v11
    s_nop 0
    v_add_f32 v11, 1.0, v11
    v_mfma_f32_16x16x32_bf16 v[76:79], a[180:183], v[124:127], v[76:79]
    v_rcp_f32 v11, v11
    s_nop 0
    v_mul_f32 v33, v33, v11
    ds_read_b128 v[120:123], v1 offset:35840
    ds_read_b128 v[124:127], v1 offset:50176
    s_waitcnt lgkmcnt(6)
    v_mfma_f32_16x16x32_bf16 v[48:51], a[16:19], v[96:99], v[48:51]
    v_cvt_pk_bf16_f32 v8, v32, v33
    v_lshlrev_b32 v32, 16, v8
    v_and_b32 v33, 0xffff0000, v8
    v_mfma_f32_16x16x32_bf16 v[52:55], a[16:19], v[100:103], v[52:55]
    v_mul_f32 v32, v32, v40
    v_mul_f32 v33, v33, v41
    v_cvt_pk_bf16_f32 v82, v32, v33
    v_mfma_f32_16x16x32_bf16 v[56:59], a[72:75], v[96:99], v[56:59]
    v_cvt_pk_bf16_f32 v8, v34, v35
    v_cvt_pk_bf16_f32 v9, v42, v43
    v_lshlrev_b32 v34, 16, v8
    v_mfma_f32_16x16x32_bf16 v[60:63], a[72:75], v[100:103], v[60:63]
    v_and_b32 v35, 0xffff0000, v8
    v_lshlrev_b32 v42, 16, v9
    v_and_b32 v43, 0xffff0000, v9
    v_mfma_f32_16x16x32_bf16 v[64:67], a[128:131], v[96:99], v[64:67]
    v_mul_f32 v10, 0xbfb8aa3b, v34
    v_exp_f32 v10, v10
    s_nop 0
    v_mfma_f32_16x16x32_bf16 v[68:71], a[128:131], v[100:103], v[68:71]
    v_add_f32 v10, 1.0, v10
    v_rcp_f32 v10, v10
    s_nop 0
    v_mfma_f32_16x16x32_bf16 v[72:75], a[184:187], v[96:99], v[72:75]
    v_mul_f32 v34, v34, v10
    v_mul_f32 v11, 0xbfb8aa3b, v35
    v_exp_f32 v11, v11
    v_mfma_f32_16x16x32_bf16 v[76:79], a[184:187], v[100:103], v[76:79]
    s_nop 0
    v_add_f32 v11, 1.0, v11
    v_rcp_f32 v11, v11
    ds_read_b128 v[96:99], v1 offset:36864
    ds_read_b128 v[100:103], v1 offset:51200
    s_waitcnt lgkmcnt(6)
    v_mfma_f32_16x16x32_bf16 v[48:51], a[20:23], v[104:107], v[48:51]
    s_nop 0
    v_mul_f32 v35, v35, v11
    v_cvt_pk_bf16_f32 v8, v34, v35
    v_mfma_f32_16x16x32_bf16 v[52:55], a[20:23], v[108:111], v[52:55]
    v_lshlrev_b32 v34, 16, v8
    v_and_b32 v35, 0xffff0000, v8
    v_mul_f32 v34, v34, v42
    v_mfma_f32_16x16x32_bf16 v[56:59], a[76:79], v[104:107], v[56:59]
    v_mul_f32 v35, v35, v43
    v_cvt_pk_bf16_f32 v83, v34, v35
    buffer_store_dwordx4 v[80:83], v1, s[4:7], s21 offen sc1
    v_mfma_f32_16x16x32_bf16 v[60:63], a[76:79], v[108:111], v[60:63]
    v_cvt_pk_bf16_f32 v8, v20, v21
    v_cvt_pk_bf16_f32 v9, v28, v29
    v_lshlrev_b32 v20, 16, v8
    v_mfma_f32_16x16x32_bf16 v[64:67], a[132:135], v[104:107], v[64:67]
    v_and_b32 v21, 0xffff0000, v8
    v_lshlrev_b32 v28, 16, v9
    v_and_b32 v29, 0xffff0000, v9
    v_mfma_f32_16x16x32_bf16 v[68:71], a[132:135], v[108:111], v[68:71]
    v_mul_f32 v10, 0xbfb8aa3b, v20
    v_exp_f32 v10, v10
    s_nop 0
    v_mfma_f32_16x16x32_bf16 v[72:75], a[188:191], v[104:107], v[72:75]
    v_add_f32 v10, 1.0, v10
    v_rcp_f32 v10, v10
    s_nop 0
    v_mfma_f32_16x16x32_bf16 v[76:79], a[188:191], v[108:111], v[76:79]
    v_mul_f32 v20, v20, v10
    v_mul_f32 v11, 0xbfb8aa3b, v21
    v_exp_f32 v11, v11
    ds_read_b128 v[104:107], v1 offset:37888
    ds_read_b128 v[108:111], v1 offset:52224
    s_waitcnt lgkmcnt(6)
    v_mfma_f32_16x16x32_bf16 v[48:51], a[24:27], v[112:115], v[48:51]
    s_nop 0
    v_add_f32 v11, 1.0, v11
    v_rcp_f32 v11, v11
    v_mfma_f32_16x16x32_bf16 v[52:55], a[24:27], v[116:119], v[52:55]
    s_nop 0
    v_mul_f32 v21, v21, v11
    v_cvt_pk_bf16_f32 v8, v20, v21
    v_mfma_f32_16x16x32_bf16 v[56:59], a[80:83], v[112:115], v[56:59]
    v_lshlrev_b32 v20, 16, v8
    v_and_b32 v21, 0xffff0000, v8
    v_mul_f32 v20, v20, v28
    v_mfma_f32_16x16x32_bf16 v[60:63], a[80:83], v[116:119], v[60:63]
    v_mul_f32 v21, v21, v29
    v_cvt_pk_bf16_f32 v84, v20, v21
    v_cvt_pk_bf16_f32 v8, v22, v23
    v_mfma_f32_16x16x32_bf16 v[64:67], a[136:139], v[112:115], v[64:67]
    v_cvt_pk_bf16_f32 v9, v30, v31
    v_lshlrev_b32 v22, 16, v8
    v_and_b32 v23, 0xffff0000, v8
    v_mfma_f32_16x16x32_bf16 v[68:71], a[136:139], v[116:119], v[68:71]
    v_lshlrev_b32 v30, 16, v9
    v_and_b32 v31, 0xffff0000, v9
    v_mul_f32 v10, 0xbfb8aa3b, v22
    v_mfma_f32_16x16x32_bf16 v[72:75], a[192:195], v[112:115], v[72:75]
    v_exp_f32 v10, v10
    s_nop 0
    v_add_f32 v10, 1.0, v10
    v_mfma_f32_16x16x32_bf16 v[76:79], a[192:195], v[116:119], v[76:79]
    v_rcp_f32 v10, v10
    s_nop 0
    v_mul_f32 v22, v22, v10
    ds_read_b128 v[112:115], v1 offset:38912
    ds_read_b128 v[116:119], v1 offset:53248
    s_waitcnt lgkmcnt(6)
    v_mfma_f32_16x16x32_bf16 v[48:51], a[28:31], v[120:123], v[48:51]
    v_mul_f32 v11, 0xbfb8aa3b, v23
    v_exp_f32 v11, v11
    s_nop 0
    v_mfma_f32_16x16x32_bf16 v[52:55], a[28:31], v[124:127], v[52:55]
    v_add_f32 v11, 1.0, v11
    v_rcp_f32 v11, v11
    s_nop 0
    v_mfma_f32_16x16x32_bf16 v[56:59], a[84:87], v[120:123], v[56:59]
    v_mul_f32 v23, v23, v11
    v_cvt_pk_bf16_f32 v8, v22, v23
    v_lshlrev_b32 v22, 16, v8
    v_mfma_f32_16x16x32_bf16 v[60:63], a[84:87], v[124:127], v[60:63]
    v_and_b32 v23, 0xffff0000, v8
    v_mul_f32 v22, v22, v30
    v_mul_f32 v23, v23, v31
    v_mfma_f32_16x16x32_bf16 v[64:67], a[140:143], v[120:123], v[64:67]
    v_cvt_pk_bf16_f32 v85, v22, v23
    v_cvt_pk_bf16_f32 v8, v36, v37
    v_cvt_pk_bf16_f32 v9, v44, v45
    v_mfma_f32_16x16x32_bf16 v[68:71], a[140:143], v[124:127], v[68:71]
    v_lshlrev_b32 v36, 16, v8
    v_and_b32 v37, 0xffff0000, v8
    v_lshlrev_b32 v44, 16, v9
    v_mfma_f32_16x16x32_bf16 v[72:75], a[196:199], v[120:123], v[72:75]
    v_and_b32 v45, 0xffff0000, v9
    v_mul_f32 v10, 0xbfb8aa3b, v36
    v_exp_f32 v10, v10
    v_mfma_f32_16x16x32_bf16 v[76:79], a[196:199], v[124:127], v[76:79]
    s_nop 0
    v_add_f32 v10, 1.0, v10
    v_rcp_f32 v10, v10
    ds_read_b128 v[120:123], v1 offset:39936
    ds_read_b128 v[124:127], v1 offset:54272
    s_waitcnt lgkmcnt(6)
    v_mfma_f32_16x16x32_bf16 v[48:51], a[32:35], v[96:99], v[48:51]
    s_nop 0
    v_mul_f32 v36, v36, v10
    v_mul_f32 v11, 0xbfb8aa3b, v37
    v_mfma_f32_16x16x32_bf16 v[52:55], a[32:35], v[100:103], v[52:55]
    v_exp_f32 v11, v11
    s_nop 0
    v_add_f32 v11, 1.0, v11
    v_mfma_f32_16x16x32_bf16 v[56:59], a[88:91], v[96:99], v[56:59]
    v_rcp_f32 v11, v11
    s_nop 0
    v_mul_f32 v37, v37, v11
    v_mfma_f32_16x16x32_bf16 v[60:63], a[88:91], v[100:103], v[60:63]
    v_cvt_pk_bf16_f32 v8, v36, v37
    v_lshlrev_b32 v36, 16, v8
    v_and_b32 v37, 0xffff0000, v8
    v_mfma_f32_16x16x32_bf16 v[64:67], a[144:147], v[96:99], v[64:67]
    v_mul_f32 v36, v36, v44
    v_mul_f32 v37, v37, v45
    v_cvt_pk_bf16_f32 v86, v36, v37
    v_mfma_f32_16x16x32_bf16 v[68:71], a[144:147], v[100:103], v[68:71]
    v_cvt_pk_bf16_f32 v8, v38, v39
    v_cvt_pk_bf16_f32 v9, v46, v47
    v_lshlrev_b32 v38, 16, v8
    v_mfma_f32_16x16x32_bf16 v[72:75], a[200:203], v[96:99], v[72:75]
    v_and_b32 v39, 0xffff0000, v8
    v_lshlrev_b32 v46, 16, v9
    v_and_b32 v47, 0xffff0000, v9
    v_mfma_f32_16x16x32_bf16 v[76:79], a[200:203], v[100:103], v[76:79]
    v_mul_f32 v10, 0xbfb8aa3b, v38
    v_exp_f32 v10, v10
    s_nop 0
    ds_read_b128 v[96:99], v1 offset:40960
    ds_read_b128 v[100:103], v1 offset:55296
    s_waitcnt lgkmcnt(6)
    v_mfma_f32_16x16x32_bf16 v[48:51], a[36:39], v[104:107], v[48:51]
    v_add_f32 v10, 1.0, v10
    v_rcp_f32 v10, v10
    s_nop 0
    v_mfma_f32_16x16x32_bf16 v[52:55], a[36:39], v[108:111], v[52:55]
    v_mul_f32 v38, v38, v10
    v_mul_f32 v11, 0xbfb8aa3b, v39
    v_exp_f32 v11, v11
    v_mfma_f32_16x16x32_bf16 v[56:59], a[92:95], v[104:107], v[56:59]
    s_nop 0
    v_add_f32 v11, 1.0, v11
    v_rcp_f32 v11, v11
    v_mfma_f32_16x16x32_bf16 v[60:63], a[92:95], v[108:111], v[60:63]
    s_nop 0
    v_mul_f32 v39, v39, v11
    v_cvt_pk_bf16_f32 v8, v38, v39
    v_mfma_f32_16x16x32_bf16 v[64:67], a[148:151], v[104:107], v[64:67]
    v_lshlrev_b32 v38, 16, v8
    v_and_b32 v39, 0xffff0000, v8
    v_mul_f32 v38, v38, v46
    v_mfma_f32_16x16x32_bf16 v[68:71], a[148:151], v[108:111], v[68:71]
    v_mul_f32 v39, v39, v47
    v_cvt_pk_bf16_f32 v87, v38, v39
    s_add_u32 s22, s21, 57344
    v_mfma_f32_16x16x32_bf16 v[72:75], a[204:207], v[104:107], v[72:75]
    buffer_store_dwordx4 v[84:87], v1, s[4:7], s22 offen sc1
    s_add_u32 s21, s21, 1835008
    v_mfma_f32_16x16x32_bf16 v[76:79], a[204:207], v[108:111], v[76:79]
    ds_read_b128 v[104:107], v1 offset:41984
    ds_read_b128 v[108:111], v1 offset:56320
    s_waitcnt lgkmcnt(6)
    v_mfma_f32_16x16x32_bf16 v[48:51], a[40:43], v[112:115], v[48:51]
    v_mfma_f32_16x16x32_bf16 v[52:55], a[40:43], v[116:119], v[52:55]
    v_mfma_f32_16x16x32_bf16 v[56:59], a[96:99], v[112:115], v[56:59]
    v_mfma_f32_16x16x32_bf16 v[60:63], a[96:99], v[116:119], v[60:63]
    v_mfma_f32_16x16x32_bf16 v[64:67], a[152:155], v[112:115], v[64:67]
    v_mfma_f32_16x16x32_bf16 v[68:71], a[152:155], v[116:119], v[68:71]
    v_mfma_f32_16x16x32_bf16 v[72:75], a[208:211], v[112:115], v[72:75]
    v_mfma_f32_16x16x32_bf16 v[76:79], a[208:211], v[116:119], v[76:79]
    s_waitcnt lgkmcnt(4)
    v_mfma_f32_16x16x32_bf16 v[48:51], a[44:47], v[120:123], v[48:51]
    v_mfma_f32_16x16x32_bf16 v[52:55], a[44:47], v[124:127], v[52:55]
    v_mfma_f32_16x16x32_bf16 v[56:59], a[100:103], v[120:123], v[56:59]
    v_mfma_f32_16x16x32_bf16 v[60:63], a[100:103], v[124:127], v[60:63]
    v_mfma_f32_16x16x32_bf16 v[64:67], a[156:159], v[120:123], v[64:67]
    v_mfma_f32_16x16x32_bf16 v[68:71], a[156:159], v[124:127], v[68:71]
    v_mfma_f32_16x16x32_bf16 v[72:75], a[212:215], v[120:123], v[72:75]
    v_mfma_f32_16x16x32_bf16 v[76:79], a[212:215], v[124:127], v[76:79]
    s_waitcnt lgkmcnt(2)
    v_mfma_f32_16x16x32_bf16 v[48:51], a[48:51], v[96:99], v[48:51]
    v_mfma_f32_16x16x32_bf16 v[52:55], a[48:51], v[100:103], v[52:55]
    v_mfma_f32_16x16x32_bf16 v[56:59], a[104:107], v[96:99], v[56:59]
    v_mfma_f32_16x16x32_bf16 v[60:63], a[104:107], v[100:103], v[60:63]
    v_mfma_f32_16x16x32_bf16 v[64:67], a[160:163], v[96:99], v[64:67]
    v_mfma_f32_16x16x32_bf16 v[68:71], a[160:163], v[100:103], v[68:71]
    v_mfma_f32_16x16x32_bf16 v[72:75], a[216:219], v[96:99], v[72:75]
    v_mfma_f32_16x16x32_bf16 v[76:79], a[216:219], v[100:103], v[76:79]
    s_waitcnt lgkmcnt(0)
    v_mfma_f32_16x16x32_bf16 v[48:51], a[52:55], v[104:107], v[48:51]
    v_mfma_f32_16x16x32_bf16 v[52:55], a[52:55], v[108:111], v[52:55]
    v_mfma_f32_16x16x32_bf16 v[56:59], a[108:111], v[104:107], v[56:59]
    v_mfma_f32_16x16x32_bf16 v[60:63], a[108:111], v[108:111], v[60:63]
    v_mfma_f32_16x16x32_bf16 v[64:67], a[164:167], v[104:107], v[64:67]
    v_mfma_f32_16x16x32_bf16 v[68:71], a[164:167], v[108:111], v[68:71]
    v_mfma_f32_16x16x32_bf16 v[72:75], a[220:223], v[104:107], v[72:75]
    v_mfma_f32_16x16x32_bf16 v[76:79], a[220:223], v[108:111], v[76:79]
    s_waitcnt vmcnt(9)
    s_barrier
    ds_read_b128 v[96:99], v4 offset:0
    ds_read_b128 v[100:103], v4 offset:14336
    ds_read_b128 v[104:107], v4 offset:1024
    ds_read_b128 v[108:111], v4 offset:15360
    ds_read_b128 v[112:115], v4 offset:2048
    ds_read_b128 v[116:119], v4 offset:16384
    ds_read_b128 v[120:123], v4 offset:3072
    ds_read_b128 v[124:127], v4 offset:17408
    s_waitcnt lgkmcnt(6)
    v_mfma_f32_16x16x32_bf16 v[16:19], a[0:3], v[96:99], 0
    v_mfma_f32_16x16x32_bf16 v[20:23], a[0:3], v[100:103], 0
    v_mfma_f32_16x16x32_bf16 v[24:27], a[56:59], v[96:99], 0
    v_mfma_f32_16x16x32_bf16 v[28:31], a[56:59], v[100:103], 0
    v_mfma_f32_16x16x32_bf16 v[32:35], a[112:115], v[96:99], 0
    v_mfma_f32_16x16x32_bf16 v[36:39], a[112:115], v[100:103], 0
    v_mfma_f32_16x16x32_bf16 v[40:43], a[168:171], v[96:99], 0
    v_mfma_f32_16x16x32_bf16 v[44:47], a[168:171], v[100:103], 0
    ds_read_b128 v[96:99], v4 offset:4096
    ds_read_b128 v[100:103], v4 offset:18432
    s_waitcnt lgkmcnt(6)
    v_mfma_f32_16x16x32_bf16 v[16:19], a[4:7], v[104:107], v[16:19]
    v_cvt_pk_bf16_f32 v8, v48, v49
    v_cvt_pk_bf16_f32 v9, v56, v57
    v_lshlrev_b32 v48, 16, v8
    v_mfma_f32_16x16x32_bf16 v[20:23], a[4:7], v[108:111], v[20:23]
    v_and_b32 v49, 0xffff0000, v8
    v_lshlrev_b32 v56, 16, v9
    v_and_b32 v57, 0xffff0000, v9
    v_mfma_f32_16x16x32_bf16 v[24:27], a[60:63], v[104:107], v[24:27]
    v_mul_f32 v10, 0xbfb8aa3b, v48
    v_exp_f32 v10, v10
    s_nop 0
    v_mfma_f32_16x16x32_bf16 v[28:31], a[60:63], v[108:111], v[28:31]
    v_add_f32 v10, 1.0, v10
    v_rcp_f32 v10, v10
    s_nop 0
    v_mfma_f32_16x16x32_bf16 v[32:35], a[116:119], v[104:107], v[32:35]
    v_mul_f32 v48, v48, v10
    v_mul_f32 v11, 0xbfb8aa3b, v49
    v_exp_f32 v11, v11
    v_mfma_f32_16x16x32_bf16 v[36:39], a[116:119], v[108:111], v[36:39]
    s_nop 0
    v_add_f32 v11, 1.0, v11
    v_rcp_f32 v11, v11
    v_mfma_f32_16x16x32_bf16 v[40:43], a[172:175], v[104:107], v[40:43]
    s_nop 0
    v_mul_f32 v49, v49, v11
    v_cvt_pk_bf16_f32 v8, v48, v49
    v_mfma_f32_16x16x32_bf16 v[44:47], a[172:175], v[108:111], v[44:47]
    v_lshlrev_b32 v48, 16, v8
    v_and_b32 v49, 0xffff0000, v8
    v_mul_f32 v48, v48, v56
    ds_read_b128 v[104:107], v4 offset:5120
    ds_read_b128 v[108:111], v4 offset:19456
    s_waitcnt lgkmcnt(6)
    v_mfma_f32_16x16x32_bf16 v[16:19], a[8:11], v[112:115], v[16:19]
    v_mul_f32 v49, v49, v57
    v_cvt_pk_bf16_f32 v80, v48, v49
    v_cvt_pk_bf16_f32 v8, v50, v51
    v_mfma_f32_16x16x32_bf16 v[20:23], a[8:11], v[116:119], v[20:23]
    v_cvt_pk_bf16_f32 v9, v58, v59
    v_lshlrev_b32 v50, 16, v8
    v_and_b32 v51, 0xffff0000, v8
    v_mfma_f32_16x16x32_bf16 v[24:27], a[64:67], v[112:115], v[24:27]
    v_lshlrev_b32 v58, 16, v9
    v_and_b32 v59, 0xffff0000, v9
    v_mul_f32 v10, 0xbfb8aa3b, v50
    v_mfma_f32_16x16x32_bf16 v[28:31], a[64:67], v[116:119], v[28:31]
    v_exp_f32 v10, v10
    s_nop 0
    v_add_f32 v10, 1.0, v10
    v_mfma_f32_16x16x32_bf16 v[32:35], a[120:123], v[112:115], v[32:35]
    v_rcp_f32 v10, v10
    s_nop 0
    v_mul_f32 v50, v50, v10
    v_mfma_f32_16x16x32_bf16 v[36:39], a[120:123], v[116:119], v[36:39]
    v_mul_f32 v11, 0xbfb8aa3b, v51
    v_exp_f32 v11, v11
    s_nop 0
    v_mfma_f32_16x16x32_bf16 v[40:43], a[176:179], v[112:115], v[40:43]
    v_add_f32 v11, 1.0, v11
    v_rcp_f32 v11, v11
    s_nop 0
    v_mfma_f32_16x16x32_bf16 v[44:47], a[176:179], v[116:119], v[44:47]
    v_mul_f32 v51, v51, v11
    v_cvt_pk_bf16_f32 v8, v50, v51
    v_lshlrev_b32 v50, 16, v8
    ds_read_b128 v[112:115], v4 offset:6144
    ds_read_b128 v[116:119], v4 offset:20480
    s_waitcnt lgkmcnt(6)
    v_mfma_f32_16x16x32_bf16 v[16:19], a[12:15], v[120:123], v[16:19]
    v_and_b32 v51, 0xffff0000, v8
    v_mul_f32 v50, v50, v58
    v_mul_f32 v51, v51, v59
    v_mfma_f32_16x16x32_bf16 v[20:23], a[12:15], v[124:127], v[20:23]
    v_cvt_pk_bf16_f32 v81, v50, v51
    v_cvt_pk_bf16_f32 v8, v64, v65
    v_cvt_pk_bf16_f32 v9, v72, v73
    v_mfma_f32_16x16x32_bf16 v[24:27], a[68:71], v[120:123], v[24:27]
    v_lshlrev_b32 v64, 16, v8
    v_and_b32 v65, 0xffff0000, v8
    v_lshlrev_b32 v72, 16, v9
    v_mfma_f32_16x16x32_bf16 v[28:31], a[68:71], v[124:127], v[28:31]
    v_and_b32 v73, 0xffff0000, v9
    v_mul_f32 v10, 0xbfb8aa3b, v64
    v_exp_f32 v10, v10
    v_mfma_f32_16x16x32_bf16 v[32:35], a[124:127], v[120:123], v[32:35]
    s_nop 0
    v_add_f32 v10, 1.0, v10
    v_rcp_f32 v10, v10
    v_mfma_f32_16x16x32_bf16 v[36:39], a[124:127], v[124:127], v[36:39]
    s_nop 0
    v_mul_f32 v64, v64, v10
    v_mul_f32 v11, 0xbfb8aa3b, v65
    v_mfma_f32_16x16x32_bf16 v[40:43], a[180:183], v[120:123], v[40:43]
    v_exp_f32 v11, v11
    s_nop 0
    v_add_f32 v11, 1.0, v11
    v_mfma_f32_16x16x32_bf16 v[44:47], a[180:183], v[124:127], v[44:47]
    v_rcp_f32 v11, v11
    s_nop 0
    v_mul_f32 v65, v65, v11
    ds_read_b128 v[120:123], v4 offset:7168
    ds_read_b128 v[124:127], v4 offset:21504
    s_waitcnt lgkmcnt(6)
    v_mfma_f32_16x16x32_bf16 v[16:19], a[16:19], v[96:99], v[16:19]
    v_cvt_pk_bf16_f32 v8, v64, v65
    v_lshlrev_b32 v64, 16, v8
    v_and_b32 v65, 0xffff0000, v8
    v_mfma_f32_16x16x32_bf16 v[20:23], a[16:19], v[100:103], v[20:23]
    v_mul_f32 v64, v64, v72
    v_mul_f32 v65, v65, v73
    v_cvt_pk_bf16_f32 v82, v64, v65
    v_mfma_f32_16x16x32_bf16 v[24:27], a[72:75], v[96:99], v[24:27]
    v_cvt_pk_bf16_f32 v8, v66, v67
    v_cvt_pk_bf16_f32 v9, v74, v75
    v_lshlrev_b32 v66, 16, v8
    v_mfma_f32_16x16x32_bf16 v[28:31], a[72:75], v[100:103], v[28:31]
    v_and_b32 v67, 0xffff0000, v8
    v_lshlrev_b32 v74, 16, v9
    v_and_b32 v75, 0xffff0000, v9
    v_mfma_f32_16x16x32_bf16 v[32:35], a[128:131], v[96:99], v[32:35]
    v_mul_f32 v10, 0xbfb8aa3b, v66
    v_exp_f32 v10, v10
    s_nop 0
    v_mfma_f32_16x16x32_bf16 v[36:39], a[128:131], v[100:103], v[36:39]
    v_add_f32 v10, 1.0, v10
    v_rcp_f32 v10, v10
    s_nop 0
    v_mfma_f32_16x16x32_bf16 v[40:43], a[184:187], v[96:99], v[40:43]
    v_mul_f32 v66, v66, v10
    v_mul_f32 v11, 0xbfb8aa3b, v67
    v_exp_f32 v11, v11
    v_mfma_f32_16x16x32_bf16 v[44:47], a[184:187], v[100:103], v[44:47]
    s_nop 0
    v_add_f32 v11, 1.0, v11
    v_rcp_f32 v11, v11
    ds_read_b128 v[96:99], v4 offset:8192
    ds_read_b128 v[100:103], v4 offset:22528
    s_waitcnt lgkmcnt(6)
    v_mfma_f32_16x16x32_bf16 v[16:19], a[20:23], v[104:107], v[16:19]
    s_nop 0
    v_mul_f32 v67, v67, v11
    v_cvt_pk_bf16_f32 v8, v66, v67
    v_mfma_f32_16x16x32_bf16 v[20:23], a[20:23], v[108:111], v[20:23]
    v_lshlrev_b32 v66, 16, v8
    v_and_b32 v67, 0xffff0000, v8
    v_mul_f32 v66, v66, v74
    v_mfma_f32_16x16x32_bf16 v[24:27], a[76:79], v[104:107], v[24:27]
    v_mul_f32 v67, v67, v75
    v_cvt_pk_bf16_f32 v83, v66, v67
    buffer_store_dwordx4 v[80:83], v1, s[4:7], s21 offen sc1
    v_mfma_f32_16x16x32_bf16 v[28:31], a[76:79], v[108:111], v[28:31]
    v_cvt_pk_bf16_f32 v8, v52, v53
    v_cvt_pk_bf16_f32 v9, v60, v61
    v_lshlrev_b32 v52, 16, v8
    v_mfma_f32_16x16x32_bf16 v[32:35], a[132:135], v[104:107], v[32:35]
    v_and_b32 v53, 0xffff0000, v8
    v_lshlrev_b32 v60, 16, v9
    v_and_b32 v61, 0xffff0000, v9
    v_mfma_f32_16x16x32_bf16 v[36:39], a[132:135], v[108:111], v[36:39]
    v_mul_f32 v10, 0xbfb8aa3b, v52
    v_exp_f32 v10, v10
    s_nop 0
    v_mfma_f32_16x16x32_bf16 v[40:43], a[188:191], v[104:107], v[40:43]
    v_add_f32 v10, 1.0, v10
    v_rcp_f32 v10, v10
    s_nop 0
    v_mfma_f32_16x16x32_bf16 v[44:47], a[188:191], v[108:111], v[44:47]
    v_mul_f32 v52, v52, v10
    v_mul_f32 v11, 0xbfb8aa3b, v53
    v_exp_f32 v11, v11
    ds_read_b128 v[104:107], v4 offset:9216
    ds_read_b128 v[108:111], v4 offset:23552
    s_waitcnt lgkmcnt(6)
    v_mfma_f32_16x16x32_bf16 v[16:19], a[24:27], v[112:115], v[16:19]
    s_nop 0
    v_add_f32 v11, 1.0, v11
    v_rcp_f32 v11, v11
    v_mfma_f32_16x16x32_bf16 v[20:23], a[24:27], v[116:119], v[20:23]
    s_nop 0
    v_mul_f32 v53, v53, v11
    v_cvt_pk_bf16_f32 v8, v52, v53
    v_mfma_f32_16x16x32_bf16 v[24:27], a[80:83], v[112:115], v[24:27]
    v_lshlrev_b32 v52, 16, v8
    v_and_b32 v53, 0xffff0000, v8
    v_mul_f32 v52, v52, v60
    v_mfma_f32_16x16x32_bf16 v[28:31], a[80:83], v[116:119], v[28:31]
    v_mul_f32 v53, v53, v61
    v_cvt_pk_bf16_f32 v84, v52, v53
    v_cvt_pk_bf16_f32 v8, v54, v55
    v_mfma_f32_16x16x32_bf16 v[32:35], a[136:139], v[112:115], v[32:35]
    v_cvt_pk_bf16_f32 v9, v62, v63
    v_lshlrev_b32 v54, 16, v8
    v_and_b32 v55, 0xffff0000, v8
    v_mfma_f32_16x16x32_bf16 v[36:39], a[136:139], v[116:119], v[36:39]
    v_lshlrev_b32 v62, 16, v9
    v_and_b32 v63, 0xffff0000, v9
    v_mul_f32 v10, 0xbfb8aa3b, v54
    v_mfma_f32_16x16x32_bf16 v[40:43], a[192:195], v[112:115], v[40:43]
    v_exp_f32 v10, v10
    s_nop 0
    v_add_f32 v10, 1.0, v10
    v_mfma_f32_16x16x32_bf16 v[44:47], a[192:195], v[116:119], v[44:47]
    v_rcp_f32 v10, v10
    s_nop 0
    v_mul_f32 v54, v54, v10
    ds_read_b128 v[112:115], v4 offset:10240
    ds_read_b128 v[116:119], v4 offset:24576
    s_waitcnt lgkmcnt(6)
    v_mfma_f32_16x16x32_bf16 v[16:19], a[28:31], v[120:123], v[16:19]
    v_mul_f32 v11, 0xbfb8aa3b, v55
    v_exp_f32 v11, v11
    s_nop 0
    v_mfma_f32_16x16x32_bf16 v[20:23], a[28:31], v[124:127], v[20:23]
    v_add_f32 v11, 1.0, v11
    v_rcp_f32 v11, v11
    s_nop 0
    v_mfma_f32_16x16x32_bf16 v[24:27], a[84:87], v[120:123], v[24:27]
    v_mul_f32 v55, v55, v11
    v_cvt_pk_bf16_f32 v8, v54, v55
    v_lshlrev_b32 v54, 16, v8
    v_mfma_f32_16x16x32_bf16 v[28:31], a[84:87], v[124:127], v[28:31]
    v_and_b32 v55, 0xffff0000, v8
    v_mul_f32 v54, v54, v62
    v_mul_f32 v55, v55, v63
    v_mfma_f32_16x16x32_bf16 v[32:35], a[140:143], v[120:123], v[32:35]
    v_cvt_pk_bf16_f32 v85, v54, v55
    v_cvt_pk_bf16_f32 v8, v68, v69
    v_cvt_pk_bf16_f32 v9, v76, v77
    v_mfma_f32_16x16x32_bf16 v[36:39], a[140:143], v[124:127], v[36:39]
    v_lshlrev_b32 v68, 16, v8
    v_and_b32 v69, 0xffff0000, v8
    v_lshlrev_b32 v76, 16, v9
    v_mfma_f32_16x16x32_bf16 v[40:43], a[196:199], v[120:123], v[40:43]
    v_and_b32 v77, 0xffff0000, v9
    v_mul_f32 v10, 0xbfb8aa3b, v68
    v_exp_f32 v10, v10
    v_mfma_f32_16x16x32_bf16 v[44:47], a[196:199], v[124:127], v[44:47]
    s_nop 0
    v_add_f32 v10, 1.0, v10
    v_rcp_f32 v10, v10
    ds_read_b128 v[120:123], v4 offset:11264
    ds_read_b128 v[124:127], v4 offset:25600
    s_waitcnt lgkmcnt(6)
    v_mfma_f32_16x16x32_bf16 v[16:19], a[32:35], v[96:99], v[16:19]
    s_nop 0
    v_mul_f32 v68, v68, v10
    v_mul_f32 v11, 0xbfb8aa3b, v69
    v_mfma_f32_16x16x32_bf16 v[20:23], a[32:35], v[100:103], v[20:23]
    v_exp_f32 v11, v11
    s_nop 0
    v_add_f32 v11, 1.0, v11
    v_mfma_f32_16x16x32_bf16 v[24:27], a[88:91], v[96:99], v[24:27]
    v_rcp_f32 v11, v11
    s_nop 0
    v_mul_f32 v69, v69, v11
    v_mfma_f32_16x16x32_bf16 v[28:31], a[88:91], v[100:103], v[28:31]
    v_cvt_pk_bf16_f32 v8, v68, v69
    v_lshlrev_b32 v68, 16, v8
    v_and_b32 v69, 0xffff0000, v8
    v_mfma_f32_16x16x32_bf16 v[32:35], a[144:147], v[96:99], v[32:35]
    v_mul_f32 v68, v68, v76
    v_mul_f32 v69, v69, v77
    v_cvt_pk_bf16_f32 v86, v68, v69
    v_mfma_f32_16x16x32_bf16 v[36:39], a[144:147], v[100:103], v[36:39]
    v_cvt_pk_bf16_f32 v8, v70, v71
    v_cvt_pk_bf16_f32 v9, v78, v79
    v_lshlrev_b32 v70, 16, v8
    v_mfma_f32_16x16x32_bf16 v[40:43], a[200:203], v[96:99], v[40:43]
    v_and_b32 v71, 0xffff0000, v8
    v_lshlrev_b32 v78, 16, v9
    v_and_b32 v79, 0xffff0000, v9
    v_mfma_f32_16x16x32_bf16 v[44:47], a[200:203], v[100:103], v[44:47]
    v_mul_f32 v10, 0xbfb8aa3b, v70
    v_exp_f32 v10, v10
    s_nop 0
    ds_read_b128 v[96:99], v4 offset:12288
    ds_read_b128 v[100:103], v4 offset:26624
    s_waitcnt lgkmcnt(6)
    v_mfma_f32_16x16x32_bf16 v[16:19], a[36:39], v[104:107], v[16:19]
    v_add_f32 v10, 1.0, v10
    v_rcp_f32 v10, v10
    s_nop 0
    v_mfma_f32_16x16x32_bf16 v[20:23], a[36:39], v[108:111], v[20:23]
    v_mul_f32 v70, v70, v10
    v_mul_f32 v11, 0xbfb8aa3b, v71
    v_exp_f32 v11, v11
    v_mfma_f32_16x16x32_bf16 v[24:27], a[92:95], v[104:107], v[24:27]
    s_nop 0
    v_add_f32 v11, 1.0, v11
    v_rcp_f32 v11, v11
    v_mfma_f32_16x16x32_bf16 v[28:31], a[92:95], v[108:111], v[28:31]
    s_nop 0
    v_mul_f32 v71, v71, v11
    v_cvt_pk_bf16_f32 v8, v70, v71
    v_mfma_f32_16x16x32_bf16 v[32:35], a[148:151], v[104:107], v[32:35]
    v_lshlrev_b32 v70, 16, v8
    v_and_b32 v71, 0xffff0000, v8
    v_mul_f32 v70, v70, v78
    v_mfma_f32_16x16x32_bf16 v[36:39], a[148:151], v[108:111], v[36:39]
    v_mul_f32 v71, v71, v79
    v_cvt_pk_bf16_f32 v87, v70, v71
    s_add_u32 s22, s21, 57344
    v_mfma_f32_16x16x32_bf16 v[40:43], a[204:207], v[104:107], v[40:43]
    buffer_store_dwordx4 v[84:87], v1, s[4:7], s22 offen sc1
    s_add_u32 s21, s21, 1835008
    v_mfma_f32_16x16x32_bf16 v[44:47], a[204:207], v[108:111], v[44:47]
    ds_read_b128 v[104:107], v4 offset:13312
    ds_read_b128 v[108:111], v4 offset:27648
    s_waitcnt lgkmcnt(6)
    v_mfma_f32_16x16x32_bf16 v[16:19], a[40:43], v[112:115], v[16:19]
    v_mfma_f32_16x16x32_bf16 v[20:23], a[40:43], v[116:119], v[20:23]
    v_mfma_f32_16x16x32_bf16 v[24:27], a[96:99], v[112:115], v[24:27]
    v_mfma_f32_16x16x32_bf16 v[28:31], a[96:99], v[116:119], v[28:31]
    v_mfma_f32_16x16x32_bf16 v[32:35], a[152:155], v[112:115], v[32:35]
    v_mfma_f32_16x16x32_bf16 v[36:39], a[152:155], v[116:119], v[36:39]
    v_mfma_f32_16x16x32_bf16 v[40:43], a[208:211], v[112:115], v[40:43]
    v_mfma_f32_16x16x32_bf16 v[44:47], a[208:211], v[116:119], v[44:47]
    s_waitcnt lgkmcnt(4)
    v_mfma_f32_16x16x32_bf16 v[16:19], a[44:47], v[120:123], v[16:19]
    v_mfma_f32_16x16x32_bf16 v[20:23], a[44:47], v[124:127], v[20:23]
    v_mfma_f32_16x16x32_bf16 v[24:27], a[100:103], v[120:123], v[24:27]
    v_mfma_f32_16x16x32_bf16 v[28:31], a[100:103], v[124:127], v[28:31]
    v_mfma_f32_16x16x32_bf16 v[32:35], a[156:159], v[120:123], v[32:35]
    v_mfma_f32_16x16x32_bf16 v[36:39], a[156:159], v[124:127], v[36:39]
    v_mfma_f32_16x16x32_bf16 v[40:43], a[212:215], v[120:123], v[40:43]
    v_mfma_f32_16x16x32_bf16 v[44:47], a[212:215], v[124:127], v[44:47]
    s_waitcnt lgkmcnt(2)
    v_mfma_f32_16x16x32_bf16 v[16:19], a[48:51], v[96:99], v[16:19]
    v_mfma_f32_16x16x32_bf16 v[20:23], a[48:51], v[100:103], v[20:23]
    v_mfma_f32_16x16x32_bf16 v[24:27], a[104:107], v[96:99], v[24:27]
    v_mfma_f32_16x16x32_bf16 v[28:31], a[104:107], v[100:103], v[28:31]
    v_mfma_f32_16x16x32_bf16 v[32:35], a[160:163], v[96:99], v[32:35]
    v_mfma_f32_16x16x32_bf16 v[36:39], a[160:163], v[100:103], v[36:39]
    v_mfma_f32_16x16x32_bf16 v[40:43], a[216:219], v[96:99], v[40:43]
    v_mfma_f32_16x16x32_bf16 v[44:47], a[216:219], v[100:103], v[44:47]
    s_waitcnt lgkmcnt(0)
    v_mfma_f32_16x16x32_bf16 v[16:19], a[52:55], v[104:107], v[16:19]
    v_mfma_f32_16x16x32_bf16 v[20:23], a[52:55], v[108:111], v[20:23]
    v_mfma_f32_16x16x32_bf16 v[24:27], a[108:111], v[104:107], v[24:27]
    v_mfma_f32_16x16x32_bf16 v[28:31], a[108:111], v[108:111], v[28:31]
    v_mfma_f32_16x16x32_bf16 v[32:35], a[164:167], v[104:107], v[32:35]
    v_mfma_f32_16x16x32_bf16 v[36:39], a[164:167], v[108:111], v[36:39]
    v_mfma_f32_16x16x32_bf16 v[40:43], a[220:223], v[104:107], v[40:43]
    v_mfma_f32_16x16x32_bf16 v[44:47], a[220:223], v[108:111], v[44:47]
    s_waitcnt vmcnt(4)
    s_barrier
    ds_read_b128 v[96:99], v4 offset:28672
    ds_read_b128 v[100:103], v4 offset:43008
    ds_read_b128 v[104:107], v4 offset:29696
    ds_read_b128 v[108:111], v4 offset:44032
    ds_read_b128 v[112:115], v4 offset:30720
    ds_read_b128 v[116:119], v4 offset:45056
    ds_read_b128 v[120:123], v4 offset:31744
    ds_read_b128 v[124:127], v4 offset:46080
    s_waitcnt lgkmcnt(6)
    v_mfma_f32_16x16x32_bf16 v[48:51], a[0:3], v[96:99], 0
    v_mfma_f32_16x16x32_bf16 v[52:55], a[0:3], v[100:103], 0
    v_mfma_f32_16x16x32_bf16 v[56:59], a[56:59], v[96:99], 0
    v_mfma_f32_16x16x32_bf16 v[60:63], a[56:59], v[100:103], 0
    v_mfma_f32_16x16x32_bf16 v[64:67], a[112:115], v[96:99], 0
    v_mfma_f32_16x16x32_bf16 v[68:71], a[112:115], v[100:103], 0
    v_mfma_f32_16x16x32_bf16 v[72:75], a[168:171], v[96:99], 0
    v_mfma_f32_16x16x32_bf16 v[76:79], a[168:171], v[100:103], 0
    ds_read_b128 v[96:99], v4 offset:32768
    ds_read_b128 v[100:103], v4 offset:47104
    s_waitcnt lgkmcnt(6)
    v_mfma_f32_16x16x32_bf16 v[48:51], a[4:7], v[104:107], v[48:51]
    v_cvt_pk_bf16_f32 v8, v16, v17
    v_cvt_pk_bf16_f32 v9, v24, v25
    v_lshlrev_b32 v16, 16, v8
    v_mfma_f32_16x16x32_bf16 v[52:55], a[4:7], v[108:111], v[52:55]
    v_and_b32 v17, 0xffff0000, v8
    v_lshlrev_b32 v24, 16, v9
    v_and_b32 v25, 0xffff0000, v9
    v_mfma_f32_16x16x32_bf16 v[56:59], a[60:63], v[104:107], v[56:59]
    v_mul_f32 v10, 0xbfb8aa3b, v16
    v_exp_f32 v10, v10
    s_nop 0
    v_mfma_f32_16x16x32_bf16 v[60:63], a[60:63], v[108:111], v[60:63]
    v_add_f32 v10, 1.0, v10
    v_rcp_f32 v10, v10
    s_nop 0
    v_mfma_f32_16x16x32_bf16 v[64:67], a[116:119], v[104:107], v[64:67]
    v_mul_f32 v16, v16, v10
    v_mul_f32 v11, 0xbfb8aa3b, v17
    v_exp_f32 v11, v11
    v_mfma_f32_16x16x32_bf16 v[68:71], a[116:119], v[108:111], v[68:71]
    s_nop 0
    v_add_f32 v11, 1.0, v11
    v_rcp_f32 v11, v11
    v_mfma_f32_16x16x32_bf16 v[72:75], a[172:175], v[104:107], v[72:75]
    s_nop 0
    v_mul_f32 v17, v17, v11
    v_cvt_pk_bf16_f32 v8, v16, v17
    v_mfma_f32_16x16x32_bf16 v[76:79], a[172:175], v[108:111], v[76:79]
    v_lshlrev_b32 v16, 16, v8
    v_and_b32 v17, 0xffff0000, v8
    v_mul_f32 v16, v16, v24
    ds_read_b128 v[104:107], v4 offset:33792
    ds_read_b128 v[108:111], v4 offset:48128
    s_waitcnt lgkmcnt(6)
    v_mfma_f32_16x16x32_bf16 v[48:51], a[8:11], v[112:115], v[48:51]
    v_mul_f32 v17, v17, v25
    v_cvt_pk_bf16_f32 v80, v16, v17
    v_cvt_pk_bf16_f32 v8, v18, v19
    v_mfma_f32_16x16x32_bf16 v[52:55], a[8:11], v[116:119], v[52:55]
    v_cvt_pk_bf16_f32 v9, v26, v27
    v_lshlrev_b32 v18, 16, v8
    v_and_b32 v19, 0xffff0000, v8
    v_mfma_f32_16x16x32_bf16 v[56:59], a[64:67], v[112:115], v[56:59]
    v_lshlrev_b32 v26, 16, v9
    v_and_b32 v27, 0xffff0000, v9
    v_mul_f32 v10, 0xbfb8aa3b, v18
    v_mfma_f32_16x16x32_bf16 v[60:63], a[64:67], v[116:119], v[60:63]
    v_exp_f32 v10, v10
    s_nop 0
    v_add_f32 v10, 1.0, v10
    v_mfma_f32_16x16x32_bf16 v[64:67], a[120:123], v[112:115], v[64:67]
    v_rcp_f32 v10, v10
    s_nop 0
    v_mul_f32 v18, v18, v10
    v_mfma_f32_16x16x32_bf16 v[68:71], a[120:123], v[116:119], v[68:71]
    v_mul_f32 v11, 0xbfb8aa3b, v19
    v_exp_f32 v11, v11
    s_nop 0
    v_mfma_f32_16x16x32_bf16 v[72:75], a[176:179], v[112:115], v[72:75]
    v_add_f32 v11, 1.0, v11
    v_rcp_f32 v11, v11
    s_nop 0
    v_mfma_f32_16x16x32_bf16 v[76:79], a[176:179], v[116:119], v[76:79]
    v_mul_f32 v19, v19, v11
    v_cvt_pk_bf16_f32 v8, v18, v19
    v_lshlrev_b32 v18, 16, v8
    ds_read_b128 v[112:115], v4 offset:34816
    ds_read_b128 v[116:119], v4 offset:49152
    s_waitcnt lgkmcnt(6)
    v_mfma_f32_16x16x32_bf16 v[48:51], a[12:15], v[120:123], v[48:51]
    v_and_b32 v19, 0xffff0000, v8
    v_mul_f32 v18, v18, v26
    v_mul_f32 v19, v19, v27
    v_mfma_f32_16x16x32_bf16 v[52:55], a[12:15], v[124:127], v[52:55]
    v_cvt_pk_bf16_f32 v81, v18, v19
    v_cvt_pk_bf16_f32 v8, v32, v33
    v_cvt_pk_bf16_f32 v9, v40, v41
    v_mfma_f32_16x16x32_bf16 v[56:59], a[68:71], v[120:123], v[56:59]
    v_lshlrev_b32 v32, 16, v8
    v_and_b32 v33, 0xffff0000, v8
    v_lshlrev_b32 v40, 16, v9
    v_mfma_f32_16x16x32_bf16 v[60:63], a[68:71], v[124:127], v[60:63]
    v_and_b32 v41, 0xffff0000, v9
    v_mul_f32 v10, 0xbfb8aa3b, v32
    v_exp_f32 v10, v10
    v_mfma_f32_16x16x32_bf16 v[64:67], a[124:127], v[120:123], v[64:67]
    s_nop 0
    v_add_f32 v10, 1.0, v10
    v_rcp_f32 v10, v10
    v_mfma_f32_16x16x32_bf16 v[68:71], a[124:127], v[124:127], v[68:71]
    s_nop 0
    v_mul_f32 v32, v32, v10
    v_mul_f32 v11, 0xbfb8aa3b, v33
    v_mfma_f32_16x16x32_bf16 v[72:75], a[180:183], v[120:123], v[72:75]
    v_exp_f32 v11, v11
    s_nop 0
    v_add_f32 v11, 1.0, v11
    v_mfma_f32_16x16x32_bf16 v[76:79], a[180:183], v[124:127], v[76:79]
    v_rcp_f32 v11, v11
    s_nop 0
    v_mul_f32 v33, v33, v11
    ds_read_b128 v[120:123], v4 offset:35840
    ds_read_b128 v[124:127], v4 offset:50176
    s_waitcnt lgkmcnt(6)
    v_mfma_f32_16x16x32_bf16 v[48:51], a[16:19], v[96:99], v[48:51]
    v_cvt_pk_bf16_f32 v8, v32, v33
    v_lshlrev_b32 v32, 16, v8
    v_and_b32 v33, 0xffff0000, v8
    v_mfma_f32_16x16x32_bf16 v[52:55], a[16:19], v[100:103], v[52:55]
    v_mul_f32 v32, v32, v40
    v_mul_f32 v33, v33, v41
    v_cvt_pk_bf16_f32 v82, v32, v33
    v_mfma_f32_16x16x32_bf16 v[56:59], a[72:75], v[96:99], v[56:59]
    v_cvt_pk_bf16_f32 v8, v34, v35
    v_cvt_pk_bf16_f32 v9, v42, v43
    v_lshlrev_b32 v34, 16, v8
    v_mfma_f32_16x16x32_bf16 v[60:63], a[72:75], v[100:103], v[60:63]
    v_and_b32 v35, 0xffff0000, v8
    v_lshlrev_b32 v42, 16, v9
    v_and_b32 v43, 0xffff0000, v9
    v_mfma_f32_16x16x32_bf16 v[64:67], a[128:131], v[96:99], v[64:67]
    v_mul_f32 v10, 0xbfb8aa3b, v34
    v_exp_f32 v10, v10
    s_nop 0
    v_mfma_f32_16x16x32_bf16 v[68:71], a[128:131], v[100:103], v[68:71]
    v_add_f32 v10, 1.0, v10
    v_rcp_f32 v10, v10
    s_nop 0
    v_mfma_f32_16x16x32_bf16 v[72:75], a[184:187], v[96:99], v[72:75]
    v_mul_f32 v34, v34, v10
    v_mul_f32 v11, 0xbfb8aa3b, v35
    v_exp_f32 v11, v11
    v_mfma_f32_16x16x32_bf16 v[76:79], a[184:187], v[100:103], v[76:79]
    s_nop 0
    v_add_f32 v11, 1.0, v11
    v_rcp_f32 v11, v11
    ds_read_b128 v[96:99], v4 offset:36864
    ds_read_b128 v[100:103], v4 offset:51200
    s_waitcnt lgkmcnt(6)
    v_mfma_f32_16x16x32_bf16 v[48:51], a[20:23], v[104:107], v[48:51]
    s_nop 0
    v_mul_f32 v35, v35, v11
    v_cvt_pk_bf16_f32 v8, v34, v35
    v_mfma_f32_16x16x32_bf16 v[52:55], a[20:23], v[108:111], v[52:55]
    v_lshlrev_b32 v34, 16, v8
    v_and_b32 v35, 0xffff0000, v8
    v_mul_f32 v34, v34, v42
    v_mfma_f32_16x16x32_bf16 v[56:59], a[76:79], v[104:107], v[56:59]
    v_mul_f32 v35, v35, v43
    v_cvt_pk_bf16_f32 v83, v34, v35
    buffer_store_dwordx4 v[80:83], v1, s[4:7], s21 offen sc1
    v_mfma_f32_16x16x32_bf16 v[60:63], a[76:79], v[108:111], v[60:63]
    v_cvt_pk_bf16_f32 v8, v20, v21
    v_cvt_pk_bf16_f32 v9, v28, v29
    v_lshlrev_b32 v20, 16, v8
    v_mfma_f32_16x16x32_bf16 v[64:67], a[132:135], v[104:107], v[64:67]
    v_and_b32 v21, 0xffff0000, v8
    v_lshlrev_b32 v28, 16, v9
    v_and_b32 v29, 0xffff0000, v9
    v_mfma_f32_16x16x32_bf16 v[68:71], a[132:135], v[108:111], v[68:71]
    v_mul_f32 v10, 0xbfb8aa3b, v20
    v_exp_f32 v10, v10
    s_nop 0
    v_mfma_f32_16x16x32_bf16 v[72:75], a[188:191], v[104:107], v[72:75]
    v_add_f32 v10, 1.0, v10
    v_rcp_f32 v10, v10
    s_nop 0
    v_mfma_f32_16x16x32_bf16 v[76:79], a[188:191], v[108:111], v[76:79]
    v_mul_f32 v20, v20, v10
    v_mul_f32 v11, 0xbfb8aa3b, v21
    v_exp_f32 v11, v11
    ds_read_b128 v[104:107], v4 offset:37888
    ds_read_b128 v[108:111], v4 offset:52224
    s_waitcnt lgkmcnt(6)
    v_mfma_f32_16x16x32_bf16 v[48:51], a[24:27], v[112:115], v[48:51]
    s_nop 0
    v_add_f32 v11, 1.0, v11
    v_rcp_f32 v11, v11
    v_mfma_f32_16x16x32_bf16 v[52:55], a[24:27], v[116:119], v[52:55]
    s_nop 0
    v_mul_f32 v21, v21, v11
    v_cvt_pk_bf16_f32 v8, v20, v21
    v_mfma_f32_16x16x32_bf16 v[56:59], a[80:83], v[112:115], v[56:59]
    v_lshlrev_b32 v20, 16, v8
    v_and_b32 v21, 0xffff0000, v8
    v_mul_f32 v20, v20, v28
    v_mfma_f32_16x16x32_bf16 v[60:63], a[80:83], v[116:119], v[60:63]
    v_mul_f32 v21, v21, v29
    v_cvt_pk_bf16_f32 v84, v20, v21
    v_cvt_pk_bf16_f32 v8, v22, v23
    v_mfma_f32_16x16x32_bf16 v[64:67], a[136:139], v[112:115], v[64:67]
    v_cvt_pk_bf16_f32 v9, v30, v31
    v_lshlrev_b32 v22, 16, v8
    v_and_b32 v23, 0xffff0000, v8
    v_mfma_f32_16x16x32_bf16 v[68:71], a[136:139], v[116:119], v[68:71]
    v_lshlrev_b32 v30, 16, v9
    v_and_b32 v31, 0xffff0000, v9
    v_mul_f32 v10, 0xbfb8aa3b, v22
    v_mfma_f32_16x16x32_bf16 v[72:75], a[192:195], v[112:115], v[72:75]
    v_exp_f32 v10, v10
    s_nop 0
    v_add_f32 v10, 1.0, v10
    v_mfma_f32_16x16x32_bf16 v[76:79], a[192:195], v[116:119], v[76:79]
    v_rcp_f32 v10, v10
    s_nop 0
    v_mul_f32 v22, v22, v10
    ds_read_b128 v[112:115], v4 offset:38912
    ds_read_b128 v[116:119], v4 offset:53248
    s_waitcnt lgkmcnt(6)
    v_mfma_f32_16x16x32_bf16 v[48:51], a[28:31], v[120:123], v[48:51]
    v_mul_f32 v11, 0xbfb8aa3b, v23
    v_exp_f32 v11, v11
    s_nop 0
    v_mfma_f32_16x16x32_bf16 v[52:55], a[28:31], v[124:127], v[52:55]
    v_add_f32 v11, 1.0, v11
    v_rcp_f32 v11, v11
    s_nop 0
    v_mfma_f32_16x16x32_bf16 v[56:59], a[84:87], v[120:123], v[56:59]
    v_mul_f32 v23, v23, v11
    v_cvt_pk_bf16_f32 v8, v22, v23
    v_lshlrev_b32 v22, 16, v8
    v_mfma_f32_16x16x32_bf16 v[60:63], a[84:87], v[124:127], v[60:63]
    v_and_b32 v23, 0xffff0000, v8
    v_mul_f32 v22, v22, v30
    v_mul_f32 v23, v23, v31
    v_mfma_f32_16x16x32_bf16 v[64:67], a[140:143], v[120:123], v[64:67]
    v_cvt_pk_bf16_f32 v85, v22, v23
    v_cvt_pk_bf16_f32 v8, v36, v37
    v_cvt_pk_bf16_f32 v9, v44, v45
    v_mfma_f32_16x16x32_bf16 v[68:71], a[140:143], v[124:127], v[68:71]
    v_lshlrev_b32 v36, 16, v8
    v_and_b32 v37, 0xffff0000, v8
    v_lshlrev_b32 v44, 16, v9
    v_mfma_f32_16x16x32_bf16 v[72:75], a[196:199], v[120:123], v[72:75]
    v_and_b32 v45, 0xffff0000, v9
    v_mul_f32 v10, 0xbfb8aa3b, v36
    v_exp_f32 v10, v10
    v_mfma_f32_16x16x32_bf16 v[76:79], a[196:199], v[124:127], v[76:79]
    s_nop 0
    v_add_f32 v10, 1.0, v10
    v_rcp_f32 v10, v10
    ds_read_b128 v[120:123], v4 offset:39936
    ds_read_b128 v[124:127], v4 offset:54272
    s_waitcnt lgkmcnt(6)
    v_mfma_f32_16x16x32_bf16 v[48:51], a[32:35], v[96:99], v[48:51]
    s_nop 0
    v_mul_f32 v36, v36, v10
    v_mul_f32 v11, 0xbfb8aa3b, v37
    v_mfma_f32_16x16x32_bf16 v[52:55], a[32:35], v[100:103], v[52:55]
    v_exp_f32 v11, v11
    s_nop 0
    v_add_f32 v11, 1.0, v11
    v_mfma_f32_16x16x32_bf16 v[56:59], a[88:91], v[96:99], v[56:59]
    v_rcp_f32 v11, v11
    s_nop 0
    v_mul_f32 v37, v37, v11
    v_mfma_f32_16x16x32_bf16 v[60:63], a[88:91], v[100:103], v[60:63]
    v_cvt_pk_bf16_f32 v8, v36, v37
    v_lshlrev_b32 v36, 16, v8
    v_and_b32 v37, 0xffff0000, v8
    v_mfma_f32_16x16x32_bf16 v[64:67], a[144:147], v[96:99], v[64:67]
    v_mul_f32 v36, v36, v44
    v_mul_f32 v37, v37, v45
    v_cvt_pk_bf16_f32 v86, v36, v37
    v_mfma_f32_16x16x32_bf16 v[68:71], a[144:147], v[100:103], v[68:71]
    v_cvt_pk_bf16_f32 v8, v38, v39
    v_cvt_pk_bf16_f32 v9, v46, v47
    v_lshlrev_b32 v38, 16, v8
    v_mfma_f32_16x16x32_bf16 v[72:75], a[200:203], v[96:99], v[72:75]
    v_and_b32 v39, 0xffff0000, v8
    v_lshlrev_b32 v46, 16, v9
    v_and_b32 v47, 0xffff0000, v9
    v_mfma_f32_16x16x32_bf16 v[76:79], a[200:203], v[100:103], v[76:79]
    v_mul_f32 v10, 0xbfb8aa3b, v38
    v_exp_f32 v10, v10
    s_nop 0
    ds_read_b128 v[96:99], v4 offset:40960
    ds_read_b128 v[100:103], v4 offset:55296
    s_waitcnt lgkmcnt(6)
    v_mfma_f32_16x16x32_bf16 v[48:51], a[36:39], v[104:107], v[48:51]
    v_add_f32 v10, 1.0, v10
    v_rcp_f32 v10, v10
    s_nop 0
    v_mfma_f32_16x16x32_bf16 v[52:55], a[36:39], v[108:111], v[52:55]
    v_mul_f32 v38, v38, v10
    v_mul_f32 v11, 0xbfb8aa3b, v39
    v_exp_f32 v11, v11
    v_mfma_f32_16x16x32_bf16 v[56:59], a[92:95], v[104:107], v[56:59]
    s_nop 0
    v_add_f32 v11, 1.0, v11
    v_rcp_f32 v11, v11
    v_mfma_f32_16x16x32_bf16 v[60:63], a[92:95], v[108:111], v[60:63]
    s_nop 0
    v_mul_f32 v39, v39, v11
    v_cvt_pk_bf16_f32 v8, v38, v39
    v_mfma_f32_16x16x32_bf16 v[64:67], a[148:151], v[104:107], v[64:67]
    v_lshlrev_b32 v38, 16, v8
    v_and_b32 v39, 0xffff0000, v8
    v_mul_f32 v38, v38, v46
    v_mfma_f32_16x16x32_bf16 v[68:71], a[148:151], v[108:111], v[68:71]
    v_mul_f32 v39, v39, v47
    v_cvt_pk_bf16_f32 v87, v38, v39
    s_add_u32 s22, s21, 57344
    v_mfma_f32_16x16x32_bf16 v[72:75], a[204:207], v[104:107], v[72:75]
    buffer_store_dwordx4 v[84:87], v1, s[4:7], s22 offen sc1
    s_add_u32 s21, s21, 1835008
    v_mfma_f32_16x16x32_bf16 v[76:79], a[204:207], v[108:111], v[76:79]
    ds_read_b128 v[104:107], v4 offset:41984
    ds_read_b128 v[108:111], v4 offset:56320
    s_waitcnt lgkmcnt(6)
    v_mfma_f32_16x16x32_bf16 v[48:51], a[40:43], v[112:115], v[48:51]
    v_mfma_f32_16x16x32_bf16 v[52:55], a[40:43], v[116:119], v[52:55]
    v_mfma_f32_16x16x32_bf16 v[56:59], a[96:99], v[112:115], v[56:59]
    v_mfma_f32_16x16x32_bf16 v[60:63], a[96:99], v[116:119], v[60:63]
    v_mfma_f32_16x16x32_bf16 v[64:67], a[152:155], v[112:115], v[64:67]
    v_mfma_f32_16x16x32_bf16 v[68:71], a[152:155], v[116:119], v[68:71]
    v_mfma_f32_16x16x32_bf16 v[72:75], a[208:211], v[112:115], v[72:75]
    v_mfma_f32_16x16x32_bf16 v[76:79], a[208:211], v[116:119], v[76:79]
    s_waitcnt lgkmcnt(4)
    v_mfma_f32_16x16x32_bf16 v[48:51], a[44:47], v[120:123], v[48:51]
    v_mfma_f32_16x16x32_bf16 v[52:55], a[44:47], v[124:127], v[52:55]
    v_mfma_f32_16x16x32_bf16 v[56:59], a[100:103], v[120:123], v[56:59]
    v_mfma_f32_16x16x32_bf16 v[60:63], a[100:103], v[124:127], v[60:63]
    v_mfma_f32_16x16x32_bf16 v[64:67], a[156:159], v[120:123], v[64:67]
    v_mfma_f32_16x16x32_bf16 v[68:71], a[156:159], v[124:127], v[68:71]
    v_mfma_f32_16x16x32_bf16 v[72:75], a[212:215], v[120:123], v[72:75]
    v_mfma_f32_16x16x32_bf16 v[76:79], a[212:215], v[124:127], v[76:79]
    s_waitcnt lgkmcnt(2)
    v_mfma_f32_16x16x32_bf16 v[48:51], a[48:51], v[96:99], v[48:51]
    v_mfma_f32_16x16x32_bf16 v[52:55], a[48:51], v[100:103], v[52:55]
    v_mfma_f32_16x16x32_bf16 v[56:59], a[104:107], v[96:99], v[56:59]
    v_mfma_f32_16x16x32_bf16 v[60:63], a[104:107], v[100:103], v[60:63]
    v_mfma_f32_16x16x32_bf16 v[64:67], a[160:163], v[96:99], v[64:67]
    v_mfma_f32_16x16x32_bf16 v[68:71], a[160:163], v[100:103], v[68:71]
    v_mfma_f32_16x16x32_bf16 v[72:75], a[216:219], v[96:99], v[72:75]
    v_mfma_f32_16x16x32_bf16 v[76:79], a[216:219], v[100:103], v[76:79]
    s_waitcnt lgkmcnt(0)
    v_mfma_f32_16x16x32_bf16 v[48:51], a[52:55], v[104:107], v[48:51]
    v_mfma_f32_16x16x32_bf16 v[52:55], a[52:55], v[108:111], v[52:55]
    v_mfma_f32_16x16x32_bf16 v[56:59], a[108:111], v[104:107], v[56:59]
    v_mfma_f32_16x16x32_bf16 v[60:63], a[108:111], v[108:111], v[60:63]
    v_mfma_f32_16x16x32_bf16 v[64:67], a[164:167], v[104:107], v[64:67]
    v_mfma_f32_16x16x32_bf16 v[68:71], a[164:167], v[108:111], v[68:71]
    v_mfma_f32_16x16x32_bf16 v[72:75], a[220:223], v[104:107], v[72:75]
    v_mfma_f32_16x16x32_bf16 v[76:79], a[220:223], v[108:111], v[76:79]
    s_nop 7
    v_cvt_pk_bf16_f32 v8, v48, v49
    v_cvt_pk_bf16_f32 v9, v56, v57
    v_lshlrev_b32 v48, 16, v8
    v_and_b32 v49, 0xffff0000, v8
    v_lshlrev_b32 v56, 16, v9
    v_and_b32 v57, 0xffff0000, v9
    v_mul_f32 v10, 0xbfb8aa3b, v48
    v_exp_f32 v10, v10
    s_nop 0
    v_add_f32 v10, 1.0, v10
    v_rcp_f32 v10, v10
    s_nop 0
    v_mul_f32 v48, v48, v10
    v_mul_f32 v11, 0xbfb8aa3b, v49
    v_exp_f32 v11, v11
    s_nop 0
    v_add_f32 v11, 1.0, v11
    v_rcp_f32 v11, v11
    s_nop 0
    v_mul_f32 v49, v49, v11
    v_cvt_pk_bf16_f32 v8, v48, v49
    v_lshlrev_b32 v48, 16, v8
    v_and_b32 v49, 0xffff0000, v8
    v_mul_f32 v48, v48, v56
    v_mul_f32 v49, v49, v57
    v_cvt_pk_bf16_f32 v80, v48, v49
    v_cvt_pk_bf16_f32 v8, v50, v51
    v_cvt_pk_bf16_f32 v9, v58, v59
    v_lshlrev_b32 v50, 16, v8
    v_and_b32 v51, 0xffff0000, v8
    v_lshlrev_b32 v58, 16, v9
    v_and_b32 v59, 0xffff0000, v9
    v_mul_f32 v10, 0xbfb8aa3b, v50
    v_exp_f32 v10, v10
    s_nop 0
    v_add_f32 v10, 1.0, v10
    v_rcp_f32 v10, v10
    s_nop 0
    v_mul_f32 v50, v50, v10
    v_mul_f32 v11, 0xbfb8aa3b, v51
    v_exp_f32 v11, v11
    s_nop 0
    v_add_f32 v11, 1.0, v11
    v_rcp_f32 v11, v11
    s_nop 0
    v_mul_f32 v51, v51, v11
    v_cvt_pk_bf16_f32 v8, v50, v51
    v_lshlrev_b32 v50, 16, v8
    v_and_b32 v51, 0xffff0000, v8
    v_mul_f32 v50, v50, v58
    v_mul_f32 v51, v51, v59
    v_cvt_pk_bf16_f32 v81, v50, v51
    v_cvt_pk_bf16_f32 v8, v64, v65
    v_cvt_pk_bf16_f32 v9, v72, v73
    v_lshlrev_b32 v64, 16, v8
    v_and_b32 v65, 0xffff0000, v8
    v_lshlrev_b32 v72, 16, v9
    v_and_b32 v73, 0xffff0000, v9
    v_mul_f32 v10, 0xbfb8aa3b, v64
    v_exp_f32 v10, v10
    s_nop 0
    v_add_f32 v10, 1.0, v10
    v_rcp_f32 v10, v10
    s_nop 0
    v_mul_f32 v64, v64, v10
    v_mul_f32 v11, 0xbfb8aa3b, v65
    v_exp_f32 v11, v11
    s_nop 0
    v_add_f32 v11, 1.0, v11
    v_rcp_f32 v11, v11
    s_nop 0
    v_mul_f32 v65, v65, v11
    v_cvt_pk_bf16_f32 v8, v64, v65
    v_lshlrev_b32 v64, 16, v8
    v_and_b32 v65, 0xffff0000, v8
    v_mul_f32 v64, v64, v72
    v_mul_f32 v65, v65, v73
    v_cvt_pk_bf16_f32 v82, v64, v65
    v_cvt_pk_bf16_f32 v8, v66, v67
    v_cvt_pk_bf16_f32 v9, v74, v75
    v_lshlrev_b32 v66, 16, v8
    v_and_b32 v67, 0xffff0000, v8
    v_lshlrev_b32 v74, 16, v9
    v_and_b32 v75, 0xffff0000, v9
    v_mul_f32 v10, 0xbfb8aa3b, v66
    v_exp_f32 v10, v10
    s_nop 0
    v_add_f32 v10, 1.0, v10
    v_rcp_f32 v10, v10
    s_nop 0
    v_mul_f32 v66, v66, v10
    v_mul_f32 v11, 0xbfb8aa3b, v67
    v_exp_f32 v11, v11
    s_nop 0
    v_add_f32 v11, 1.0, v11
    v_rcp_f32 v11, v11
    s_nop 0
    v_mul_f32 v67, v67, v11
    v_cvt_pk_bf16_f32 v8, v66, v67
    v_lshlrev_b32 v66, 16, v8
    v_and_b32 v67, 0xffff0000, v8
    v_mul_f32 v66, v66, v74
    v_mul_f32 v67, v67, v75
    v_cvt_pk_bf16_f32 v83, v66, v67
    buffer_store_dwordx4 v[80:83], v1, s[4:7], s21 offen sc1
    v_cvt_pk_bf16_f32 v8, v52, v53
    v_cvt_pk_bf16_f32 v9, v60, v61
    v_lshlrev_b32 v52, 16, v8
    v_and_b32 v53, 0xffff0000, v8
    v_lshlrev_b32 v60, 16, v9
    v_and_b32 v61, 0xffff0000, v9
    v_mul_f32 v10, 0xbfb8aa3b, v52
    v_exp_f32 v10, v10
    s_nop 0
    v_add_f32 v10, 1.0, v10
    v_rcp_f32 v10, v10
    s_nop 0
    v_mul_f32 v52, v52, v10
    v_mul_f32 v11, 0xbfb8aa3b, v53
    v_exp_f32 v11, v11
    s_nop 0
    v_add_f32 v11, 1.0, v11
    v_rcp_f32 v11, v11
    s_nop 0
    v_mul_f32 v53, v53, v11
    v_cvt_pk_bf16_f32 v8, v52, v53
    v_lshlrev_b32 v52, 16, v8
    v_and_b32 v53, 0xffff0000, v8
    v_mul_f32 v52, v52, v60
    v_mul_f32 v53, v53, v61
    v_cvt_pk_bf16_f32 v84, v52, v53
    v_cvt_pk_bf16_f32 v8, v54, v55
    v_cvt_pk_bf16_f32 v9, v62, v63
    v_lshlrev_b32 v54, 16, v8
    v_and_b32 v55, 0xffff0000, v8
    v_lshlrev_b32 v62, 16, v9
    v_and_b32 v63, 0xffff0000, v9
    v_mul_f32 v10, 0xbfb8aa3b, v54
    v_exp_f32 v10, v10
    s_nop 0
    v_add_f32 v10, 1.0, v10
    v_rcp_f32 v10, v10
    s_nop 0
    v_mul_f32 v54, v54, v10
    v_mul_f32 v11, 0xbfb8aa3b, v55
    v_exp_f32 v11, v11
    s_nop 0
    v_add_f32 v11, 1.0, v11
    v_rcp_f32 v11, v11
    s_nop 0
    v_mul_f32 v55, v55, v11
    v_cvt_pk_bf16_f32 v8, v54, v55
    v_lshlrev_b32 v54, 16, v8
    v_and_b32 v55, 0xffff0000, v8
    v_mul_f32 v54, v54, v62
    v_mul_f32 v55, v55, v63
    v_cvt_pk_bf16_f32 v85, v54, v55
    v_cvt_pk_bf16_f32 v8, v68, v69
    v_cvt_pk_bf16_f32 v9, v76, v77
    v_lshlrev_b32 v68, 16, v8
    v_and_b32 v69, 0xffff0000, v8
    v_lshlrev_b32 v76, 16, v9
    v_and_b32 v77, 0xffff0000, v9
    v_mul_f32 v10, 0xbfb8aa3b, v68
    v_exp_f32 v10, v10
    s_nop 0
    v_add_f32 v10, 1.0, v10
    v_rcp_f32 v10, v10
    s_nop 0
    v_mul_f32 v68, v68, v10
    v_mul_f32 v11, 0xbfb8aa3b, v69
    v_exp_f32 v11, v11
    s_nop 0
    v_add_f32 v11, 1.0, v11
    v_rcp_f32 v11, v11
    s_nop 0
    v_mul_f32 v69, v69, v11
    v_cvt_pk_bf16_f32 v8, v68, v69
    v_lshlrev_b32 v68, 16, v8
    v_and_b32 v69, 0xffff0000, v8
    v_mul_f32 v68, v68, v76
    v_mul_f32 v69, v69, v77
    v_cvt_pk_bf16_f32 v86, v68, v69
    v_cvt_pk_bf16_f32 v8, v70, v71
    v_cvt_pk_bf16_f32 v9, v78, v79
    v_lshlrev_b32 v70, 16, v8
    v_and_b32 v71, 0xffff0000, v8
    v_lshlrev_b32 v78, 16, v9
    v_and_b32 v79, 0xffff0000, v9
    v_mul_f32 v10, 0xbfb8aa3b, v70
    v_exp_f32 v10, v10
    s_nop 0
    v_add_f32 v10, 1.0, v10
    v_rcp_f32 v10, v10
    s_nop 0
    v_mul_f32 v70, v70, v10
    v_mul_f32 v11, 0xbfb8aa3b, v71
    v_exp_f32 v11, v11
    s_nop 0
    v_add_f32 v11, 1.0, v11
    v_rcp_f32 v11, v11
    s_nop 0
    v_mul_f32 v71, v71, v11
    v_cvt_pk_bf16_f32 v8, v70, v71
    v_lshlrev_b32 v70, 16, v8
    v_and_b32 v71, 0xffff0000, v8
    v_mul_f32 v70, v70, v78
    v_mul_f32 v71, v71, v79
    v_cvt_pk_bf16_f32 v87, v70, v71
    s_add_u32 s22, s21, 57344
    buffer_store_dwordx4 v[84:87], v1, s[4:7], s22 offen sc1
    s_add_u32 s21, s21, 1835008
    s_waitcnt vmcnt(0)
    s_barrier
    s_cmp_lg_u32 s3, 0
    s_cbranch_scc1 sf_148
    v_mov_b32 v2, 1
    s_lshl_b32 s16, s96, 2
    s_add_u32 s16, s16, 73982976
    v_mov_b32 v3, 0
    s_mov_b64 exec, 1
    buffer_store_dword v2, v3, s[4:7], s16 offen sc1
    s_mov_b64 exec, -1
sf_148:
    s_cmp_lg_u32 s3, 0
    s_cbranch_scc1 wfl_149
    v_mbcnt_lo_u32_b32 v2, -1, 0
    v_mbcnt_hi_u32_b32 v2, -1, v2
    v_min_u32 v2, 55, v2
    v_lshlrev_b32 v2, 4, v2
    s_mov_b32 s16, 73982976
    s_mov_b32 s30, 400000
sw_150:
    buffer_load_dwordx4 v[4:7], v2, s[4:7], s16 offen sc1
    s_waitcnt vmcnt(0)
    v_min_u32 v4, v4, v5
    v_min3_u32 v4, v4, v6, v7
    v_cmp_eq_u32 vcc, 0, v4
    s_cbranch_vccz swo_151
    s_sleep 16
    s_sub_u32 s30, s30, 1
    s_cmp_lg_u32 s30, 0
    s_cbranch_scc1 sw_150
    s_branch k2_end
swo_151:
wfl_149:
    s_barrier
    s_lshl_b32 s90, s91, 5
    s_add_u32 s90, s90, s92
    s_mul_i32 s16, s90, 293
    s_lshr_b32 s16, s16, 11
    s_mul_i32 s17, s16, 7
    s_sub_u32 s17, s90, s17
    s_mul_i32 s18, s16, 229376
    s_mul_i32 s19, s3, 14336
    s_add_u32 s18, s18, s19
    s_add_u32 s18, s18, 52789248
    s_mul_i32 s21, s17, 229376
    s_add_u32 s21, s21, s19
    s_add_u32 s21, s21, 21561344
    s_add_u32 s22, s21, 0
    s_mov_b32 s20, s22
    buffer_load_dwordx4 v[8:11], v1, s[4:7], s20 offen offset:0
    buffer_load_dwordx4 v[12:15], v1, s[4:7], s20 offen offset:1024
    buffer_load_dwordx4 v[16:19], v1, s[4:7], s20 offen offset:2048
    buffer_load_dwordx4 v[20:23], v1, s[4:7], s20 offen offset:3072
    s_add_u32 s20, s20, 4096
    buffer_load_dwordx4 v[24:27], v1, s[4:7], s20 offen offset:0
    buffer_load_dwordx4 v[28:31], v1, s[4:7], s20 offen offset:1024
    buffer_load_dwordx4 v[32:35], v1, s[4:7], s20 offen offset:2048
    s_add_u32 s22, s21, 57344
    s_mov_b32 s20, s22
    buffer_load_dwordx4 v[36:39], v1, s[4:7], s20 offen offset:0
    buffer_load_dwordx4 v[40:43], v1, s[4:7], s20 offen offset:1024
    buffer_load_dwordx4 v[44:47], v1, s[4:7], s20 offen offset:2048
    buffer_load_dwordx4 v[48:51], v1, s[4:7], s20 offen offset:3072
    s_add_u32 s20, s20, 4096
    buffer_load_dwordx4 v[52:55], v1, s[4:7], s20 offen offset:0
    buffer_load_dwordx4 v[56:59], v1, s[4:7], s20 offen offset:1024
    buffer_load_dwordx4 v[60:63], v1, s[4:7], s20 offen offset:2048
    s_add_u32 s22, s21, 114688
    s_mov_b32 s20, s22
    buffer_load_dwordx4 v[64:67], v1, s[4:7], s20 offen offset:0
    buffer_load_dwordx4 v[68:71], v1, s[4:7], s20 offen offset:1024
    buffer_load_dwordx4 v[72:75], v1, s[4:7], s20 offen offset:2048
    buffer_load_dwordx4 v[76:79], v1, s[4:7], s20 offen offset:3072
    s_add_u32 s20, s20, 4096
    buffer_load_dwordx4 v[80:83], v1, s[4:7], s20 offen offset:0
    buffer_load_dwordx4 v[84:87], v1, s[4:7], s20 offen offset:1024
    buffer_load_dwordx4 v[88:91], v1, s[4:7], s20 offen offset:2048
    s_add_u32 s22, s21, 172032
    s_mov_b32 s20, s22
    buffer_load_dwordx4 v[92:95], v1, s[4:7], s20 offen offset:0
    buffer_load_dwordx4 v[96:99], v1, s[4:7], s20 offen offset:1024
    buffer_load_dwordx4 v[100:103], v1, s[4:7], s20 offen offset:2048
    buffer_load_dwordx4 v[104:107], v1, s[4:7], s20 offen offset:3072
    s_add_u32 s20, s20, 4096
    buffer_load_dwordx4 v[108:111], v1, s[4:7], s20 offen offset:0
    buffer_load_dwordx4 v[112:115], v1, s[4:7], s20 offen offset:1024
    buffer_load_dwordx4 v[116:119], v1, s[4:7], s20 offen offset:2048
    s_add_u32 s22, s18, 0
    s_mov_b32 s20, s22
    buffer_load_dwordx4 a[0:3], v1, s[4:7], s20 offen offset:0
    buffer_load_dwordx4 a[4:7], v1, s[4:7], s20 offen offset:1024
    buffer_load_dwordx4 a[8:11], v1, s[4:7], s20 offen offset:2048
    buffer_load_dwordx4 a[12:15], v1, s[4:7], s20 offen offset:3072
    s_add_u32 s20, s20, 4096
    buffer_load_dwordx4 a[16:19], v1, s[4:7], s20 offen offset:0
    buffer_load_dwordx4 a[20:23], v1, s[4:7], s20 offen offset:1024
    buffer_load_dwordx4 a[24:27], v1, s[4:7], s20 offen offset:2048
    buffer_load_dwordx4 a[28:31], v1, s[4:7], s20 offen offset:3072
    s_add_u32 s20, s20, 4096
    buffer_load_dwordx4 a[32:35], v1, s[4:7], s20 offen offset:0
    buffer_load_dwordx4 a[36:39], v1, s[4:7], s20 offen offset:1024
    buffer_load_dwordx4 a[40:43], v1, s[4:7], s20 offen offset:2048
    buffer_load_dwordx4 a[44:47], v1, s[4:7], s20 offen offset:3072
    s_add_u32 s20, s20, 4096
    buffer_load_dwordx4 a[48:51], v1, s[4:7], s20 offen offset:0
    buffer_load_dwordx4 a[52:55], v1, s[4:7], s20 offen offset:1024
    s_add_u32 s22, s18, 57344
    s_mov_b32 s20, s22
    buffer_load_dwordx4 a[56:59], v1, s[4:7], s20 offen offset:0
    buffer_load_dwordx4 a[60:63], v1, s[4:7], s20 offen offset:1024
    buffer_load_dwordx4 a[64:67], v1, s[4:7], s20 offen offset:2048
    buffer_load_dwordx4 a[68:71], v1, s[4:7], s20 offen offset:3072
    s_add_u32 s20, s20, 4096
    buffer_load_dwordx4 a[72:75], v1, s[4:7], s20 offen offset:0
    buffer_load_dwordx4 a[76:79], v1, s[4:7], s20 offen offset:1024
    buffer_load_dwordx4 a[80:83], v1, s[4:7], s20 offen offset:2048
    buffer_load_dwordx4 a[84:87], v1, s[4:7], s20 offen offset:3072
    s_add_u32 s20, s20, 4096
    buffer_load_dwordx4 a[88:91], v1, s[4:7], s20 offen offset:0
    buffer_load_dwordx4 a[92:95], v1, s[4:7], s20 offen offset:1024
    buffer_load_dwordx4 a[96:99], v1, s[4:7], s20 offen offset:2048
    buffer_load_dwordx4 a[100:103], v1, s[4:7], s20 offen offset:3072
    s_add_u32 s20, s20, 4096
    buffer_load_dwordx4 a[104:107], v1, s[4:7], s20 offen offset:0
    buffer_load_dwordx4 a[108:111], v1, s[4:7], s20 offen offset:1024
    s_add_u32 s22, s18, 114688
    s_mov_b32 s20, s22
    buffer_load_dwordx4 a[112:115], v1, s[4:7], s20 offen offset:0
    buffer_load_dwordx4 a[116:119], v1, s[4:7], s20 offen offset:1024
    buffer_load_dwordx4 a[120:123], v1, s[4:7], s20 offen offset:2048
    buffer_load_dwordx4 a[124:127], v1, s[4:7], s20 offen offset:3072
    s_add_u32 s20, s20, 4096
    buffer_load_dwordx4 a[128:131], v1, s[4:7], s20 offen offset:0
    buffer_load_dwordx4 a[132:135], v1, s[4:7], s20 offen offset:1024
    buffer_load_dwordx4 a[136:139], v1, s[4:7], s20 offen offset:2048
    buffer_load_dwordx4 a[140:143], v1, s[4:7], s20 offen offset:3072
    s_add_u32 s20, s20, 4096
    buffer_load_dwordx4 a[144:147], v1, s[4:7], s20 offen offset:0
    buffer_load_dwordx4 a[148:151], v1, s[4:7], s20 offen offset:1024
    buffer_load_dwordx4 a[152:155], v1, s[4:7], s20 offen offset:2048
    buffer_load_dwordx4 a[156:159], v1, s[4:7], s20 offen offset:3072
    s_add_u32 s20, s20, 4096
    buffer_load_dwordx4 a[160:163], v1, s[4:7], s20 offen offset:0
    buffer_load_dwordx4 a[164:167], v1, s[4:7], s20 offen offset:1024
    s_add_u32 s22, s18, 172032
    s_mov_b32 s20, s22
    buffer_load_dwordx4 a[168:171], v1, s[4:7], s20 offen offset:0
    buffer_load_dwordx4 a[172:175], v1, s[4:7], s20 offen offset:1024
    buffer_load_dwordx4 a[176:179], v1, s[4:7], s20 offen offset:2048
    buffer_load_dwordx4 a[180:183], v1, s[4:7], s20 offen offset:3072
    s_add_u32 s20, s20, 4096
    buffer_load_dwordx4 a[184:187], v1, s[4:7], s20 offen offset:0
    buffer_load_dwordx4 a[188:191], v1, s[4:7], s20 offen offset:1024
    buffer_load_dwordx4 a[192:195], v1, s[4:7], s20 offen offset:2048
    buffer_load_dwordx4 a[196:199], v1, s[4:7], s20 offen offset:3072
    s_add_u32 s20, s20, 4096
    buffer_load_dwordx4 a[200:203], v1, s[4:7], s20 offen offset:0
    buffer_load_dwordx4 a[204:207], v1, s[4:7], s20 offen offset:1024
    buffer_load_dwordx4 a[208:211], v1, s[4:7], s20 offen offset:2048
    buffer_load_dwordx4 a[212:215], v1, s[4:7], s20 offen offset:3072
    s_add_u32 s20, s20, 4096
    buffer_load_dwordx4 a[216:219], v1, s[4:7], s20 offen offset:0
    buffer_load_dwordx4 a[220:223], v1, s[4:7], s20 offen offset:1024
    s_add_u32 s22, s21, 7168
    s_mov_b32 s20, s22
    buffer_load_dwordx4 v[120:123], v1, s[4:7], s20 offen offset:0
    buffer_load_dwordx4 v[124:127], v1, s[4:7], s20 offen offset:1024
    buffer_load_dwordx4 v[128:131], v1, s[4:7], s20 offen offset:2048
    buffer_load_dwordx4 v[132:135], v1, s[4:7], s20 offen offset:3072
    s_add_u32 s20, s20, 4096
    buffer_load_dwordx4 v[136:139], v1, s[4:7], s20 offen offset:0
    buffer_load_dwordx4 v[140:143], v1, s[4:7], s20 offen offset:1024
    buffer_load_dwordx4 v[144:147], v1, s[4:7], s20 offen offset:2048
    s_add_u32 s22, s21, 64512
    s_mov_b32 s20, s22
    buffer_load_dwordx4 v[148:151], v1, s[4:7], s20 offen offset:0
    buffer_load_dwordx4 v[152:155], v1, s[4:7], s20 offen offset:1024
    buffer_load_dwordx4 v[156:159], v1, s[4:7], s20 offen offset:2048
    buffer_load_dwordx4 v[160:163], v1, s[4:7], s20 offen offset:3072
    s_add_u32 s20, s20, 4096
    buffer_load_dwordx4 v[164:167], v1, s[4:7], s20 offen offset:0
    buffer_load_dwordx4 v[168:171], v1, s[4:7], s20 offen offset:1024
    buffer_load_dwordx4 v[172:175], v1, s[4:7], s20 offen offset:2048
    s_add_u32 s22, s21, 121856
    s_mov_b32 s20, s22
    buffer_load_dwordx4 v[176:179], v1, s[4:7], s20 offen offset:0
    buffer_load_dwordx4 v[180:183], v1, s[4:7], s20 offen offset:1024
    buffer_load_dwordx4 v[184:187], v1, s[4:7], s20 offen offset:2048
    buffer_load_dwordx4 v[188:191], v1, s[4:7], s20 offen offset:3072
    s_add_u32 s20, s20, 4096
    buffer_load_dwordx4 a[224:227], v1, s[4:7], s20 offen offset:0
    buffer_load_dwordx4 a[228:231], v1, s[4:7], s20 offen offset:1024
    buffer_load_dwordx4 a[232:235], v1, s[4:7], s20 offen offset:2048
    s_add_u32 s22, s21, 179200
    s_mov_b32 s20, s22
    buffer_load_dwordx4 a[236:239], v1, s[4:7], s20 offen offset:0
    buffer_load_dwordx4 a[240:243], v1, s[4:7], s20 offen offset:1024
    buffer_load_dwordx4 a[244:247], v1, s[4:7], s20 offen offset:2048
    buffer_load_dwordx4 a[248:251], v1, s[4:7], s20 offen offset:3072
    s_add_u32 s20, s20, 4096
    buffer_load_dwordx4 a[252:255], v1, s[4:7], s20 offen offset:0
    s_waitcnt vmcnt(26)
    v_mfma_f32_16x16x32_bf16 v[192:195], a[0:3], v[8:11], 0
    v_mfma_f32_16x16x32_bf16 v[196:199], a[0:3], v[36:39], 0
    v_mfma_f32_16x16x32_bf16 v[200:203], a[0:3], v[64:67], 0
    v_mfma_f32_16x16x32_bf16 v[204:207], a[0:3], v[92:95], 0
    v_mfma_f32_16x16x32_bf16 v[208:211], a[56:59], v[8:11], 0
    v_mfma_f32_16x16x32_bf16 v[212:215], a[56:59], v[36:39], 0
    v_mfma_f32_16x16x32_bf16 v[216:219], a[56:59], v[64:67], 0
    v_mfma_f32_16x16x32_bf16 v[220:223], a[56:59], v[92:95], 0
    v_mfma_f32_16x16x32_bf16 v[224:227], a[112:115], v[8:11], 0
    v_mfma_f32_16x16x32_bf16 v[228:231], a[112:115], v[36:39], 0
    v_mfma_f32_16x16x32_bf16 v[232:235], a[112:115], v[64:67], 0
    v_mfma_f32_16x16x32_bf16 v[236:239], a[112:115], v[92:95], 0
    v_mfma_f32_16x16x32_bf16 v[240:243], a[168:171], v[8:11], 0
    v_mfma_f32_16x16x32_bf16 v[244:247], a[168:171], v[36:39], 0
    v_mfma_f32_16x16x32_bf16 v[248:251], a[168:171], v[64:67], 0
    v_mfma_f32_16x16x32_bf16 v[252:255], a[168:171], v[92:95], 0
    v_mfma_f32_16x16x32_bf16 v[192:195], a[4:7], v[12:15], v[192:195]
    v_mfma_f32_16x16x32_bf16 v[196:199], a[4:7], v[40:43], v[196:199]
    v_mfma_f32_16x16x32_bf16 v[200:203], a[4:7], v[68:71], v[200:203]
    v_mfma_f32_16x16x32_bf16 v[204:207], a[4:7], v[96:99], v[204:207]
    v_mfma_f32_16x16x32_bf16 v[208:211], a[60:63], v[12:15], v[208:211]
    v_mfma_f32_16x16x32_bf16 v[212:215], a[60:63], v[40:43], v[212:215]
    v_mfma_f32_16x16x32_bf16 v[216:219], a[60:63], v[68:71], v[216:219]
    v_mfma_f32_16x16x32_bf16 v[220:223], a[60:63], v[96:99], v[220:223]
    v_mfma_f32_16x16x32_bf16 v[224:227], a[116:119], v[12:15], v[224:227]
    v_mfma_f32_16x16x32_bf16 v[228:231], a[116:119], v[40:43], v[228:231]
    v_mfma_f32_16x16x32_bf16 v[232:235], a[116:119], v[68:71], v[232:235]
    v_mfma_f32_16x16x32_bf16 v[236:239], a[116:119], v[96:99], v[236:239]
    v_mfma_f32_16x16x32_bf16 v[240:243], a[172:175], v[12:15], v[240:243]
    v_mfma_f32_16x16x32_bf16 v[244:247], a[172:175], v[40:43], v[244:247]
    v_mfma_f32_16x16x32_bf16 v[248:251], a[172:175], v[68:71], v[248:251]
    v_mfma_f32_16x16x32_bf16 v[252:255], a[172:175], v[96:99], v[252:255]
    v_mfma_f32_16x16x32_bf16 v[192:195], a[8:11], v[16:19], v[192:195]
    v_mfma_f32_16x16x32_bf16 v[196:199], a[8:11], v[44:47], v[196:199]
    v_mfma_f32_16x16x32_bf16 v[200:203], a[8:11], v[72:75], v[200:203]
    v_mfma_f32_16x16x32_bf16 v[204:207], a[8:11], v[100:103], v[204:207]
    v_mfma_f32_16x16x32_bf16 v[208:211], a[64:67], v[16:19], v[208:211]
    v_mfma_f32_16x16x32_bf16 v[212:215], a[64:67], v[44:47], v[212:215]
    v_mfma_f32_16x16x32_bf16 v[216:219], a[64:67], v[72:75], v[216:219]
    v_mfma_f32_16x16x32_bf16 v[220:223], a[64:67], v[100:103], v[220:223]
    v_mfma_f32_16x16x32_bf16 v[224:227], a[120:123], v[16:19], v[224:227]
    v_mfma_f32_16x16x32_bf16 v[228:231], a[120:123], v[44:47], v[228:231]
    v_mfma_f32_16x16x32_bf16 v[232:235], a[120:123], v[72:75], v[232:235]
    v_mfma_f32_16x16x32_bf16 v[236:239], a[120:123], v[100:103], v[236:239]
    v_mfma_f32_16x16x32_bf16 v[240:243], a[176:179], v[16:19], v[240:243]
    v_mfma_f32_16x16x32_bf16 v[244:247], a[176:179], v[44:47], v[244:247]
    v_mfma_f32_16x16x32_bf16 v[248:251], a[176:179], v[72:75], v[248:251]
    v_mfma_f32_16x16x32_bf16 v[252:255], a[176:179], v[100:103], v[252:255]
    s_add_u32 s22, s21, 184320
    s_mov_b32 s20, s22
    buffer_load_dwordx4 v[8:11], v1, s[4:7], s20 offen offset:0
    buffer_load_dwordx4 v[12:15], v1, s[4:7], s20 offen offset:1024
    v_mfma_f32_16x16x32_bf16 v[192:195], a[12:15], v[20:23], v[192:195]
    v_mfma_f32_16x16x32_bf16 v[196:199], a[12:15], v[48:51], v[196:199]
    v_mfma_f32_16x16x32_bf16 v[200:203], a[12:15], v[76:79], v[200:203]
    v_mfma_f32_16x16x32_bf16 v[204:207], a[12:15], v[104:107], v[204:207]
    v_mfma_f32_16x16x32_bf16 v[208:211], a[68:71], v[20:23], v[208:211]
    v_mfma_f32_16x16x32_bf16 v[212:215], a[68:71], v[48:51], v[212:215]
    v_mfma_f32_16x16x32_bf16 v[216:219], a[68:71], v[76:79], v[216:219]
    v_mfma_f32_16x16x32_bf16 v[220:223], a[68:71], v[104:107], v[220:223]
    v_mfma_f32_16x16x32_bf16 v[224:227], a[124:127], v[20:23], v[224:227]
    v_mfma_f32_16x16x32_bf16 v[228:231], a[124:127], v[48:51], v[228:231]
    v_mfma_f32_16x16x32_bf16 v[232:235], a[124:127], v[76:79], v[232:235]
    v_mfma_f32_16x16x32_bf16 v[236:239], a[124:127], v[104:107], v[236:239]
    v_mfma_f32_16x16x32_bf16 v[240:243], a[180:183], v[20:23], v[240:243]
    v_mfma_f32_16x16x32_bf16 v[244:247], a[180:183], v[48:51], v[244:247]
    v_mfma_f32_16x16x32_bf16 v[248:251], a[180:183], v[76:79], v[248:251]
    v_mfma_f32_16x16x32_bf16 v[252:255], a[180:183], v[104:107], v[252:255]
    v_mfma_f32_16x16x32_bf16 v[192:195], a[16:19], v[24:27], v[192:195]
    v_mfma_f32_16x16x32_bf16 v[196:199], a[16:19], v[52:55], v[196:199]
    v_mfma_f32_16x16x32_bf16 v[200:203], a[16:19], v[80:83], v[200:203]
    v_mfma_f32_16x16x32_bf16 v[204:207], a[16:19], v[108:111], v[204:207]
    v_mfma_f32_16x16x32_bf16 v[208:211], a[72:75], v[24:27], v[208:211]
    v_mfma_f32_16x16x32_bf16 v[212:215], a[72:75], v[52:55], v[212:215]
    v_mfma_f32_16x16x32_bf16 v[216:219], a[72:75], v[80:83], v[216:219]
    v_mfma_f32_16x16x32_bf16 v[220:223], a[72:75], v[108:111], v[220:223]
    v_mfma_f32_16x16x32_bf16 v[224:227], a[128:131], v[24:27], v[224:227]
    v_mfma_f32_16x16x32_bf16 v[228:231], a[128:131], v[52:55], v[228:231]
    v_mfma_f32_16x16x32_bf16 v[232:235], a[128:131], v[80:83], v[232:235]
    v_mfma_f32_16x16x32_bf16 v[236:239], a[128:131], v[108:111], v[236:239]
    v_mfma_f32_16x16x32_bf16 v[240:243], a[184:187], v[24:27], v[240:243]
    v_mfma_f32_16x16x32_bf16 v[244:247], a[184:187], v[52:55], v[244:247]
    v_mfma_f32_16x16x32_bf16 v[248:251], a[184:187], v[80:83], v[248:251]
    v_mfma_f32_16x16x32_bf16 v[252:255], a[184:187], v[108:111], v[252:255]
    v_mfma_f32_16x16x32_bf16 v[192:195], a[20:23], v[28:31], v[192:195]
    v_mfma_f32_16x16x32_bf16 v[196:199], a[20:23], v[56:59], v[196:199]
    v_mfma_f32_16x16x32_bf16 v[200:203], a[20:23], v[84:87], v[200:203]
    v_mfma_f32_16x16x32_bf16 v[204:207], a[20:23], v[112:115], v[204:207]
    v_mfma_f32_16x16x32_bf16 v[208:211], a[76:79], v[28:31], v[208:211]
    v_mfma_f32_16x16x32_bf16 v[212:215], a[76:79], v[56:59], v[212:215]
    v_mfma_f32_16x16x32_bf16 v[216:219], a[76:79], v[84:87], v[216:219]
    v_mfma_f32_16x16x32_bf16 v[220:223], a[76:79], v[112:115], v[220:223]
    v_mfma_f32_16x16x32_bf16 v[224:227], a[132:135], v[28:31], v[224:227]
    v_mfma_f32_16x16x32_bf16 v[228:231], a[132:135], v[56:59], v[228:231]
    v_mfma_f32_16x16x32_bf16 v[232:235], a[132:135], v[84:87], v[232:235]
    v_mfma_f32_16x16x32_bf16 v[236:239], a[132:135], v[112:115], v[236:239]
    v_mfma_f32_16x16x32_bf16 v[240:243], a[188:191], v[28:31], v[240:243]
    v_mfma_f32_16x16x32_bf16 v[244:247], a[188:191], v[56:59], v[244:247]
    v_mfma_f32_16x16x32_bf16 v[248:251], a[188:191], v[84:87], v[248:251]
    v_mfma_f32_16x16x32_bf16 v[252:255], a[188:191], v[112:115], v[252:255]
    v_mfma_f32_16x16x32_bf16 v[192:195], a[24:27], v[32:35], v[192:195]
    v_mfma_f32_16x16x32_bf16 v[196:199], a[24:27], v[60:63], v[196:199]
    v_mfma_f32_16x16x32_bf16 v[200:203], a[24:27], v[88:91], v[200:203]
    v_mfma_f32_16x16x32_bf16 v[204:207], a[24:27], v[116:119], v[204:207]
    v_mfma_f32_16x16x32_bf16 v[208:211], a[80:83], v[32:35], v[208:211]
    v_mfma_f32_16x16x32_bf16 v[212:215], a[80:83], v[60:63], v[212:215]
    v_mfma_f32_16x16x32_bf16 v[216:219], a[80:83], v[88:91], v[216:219]
    v_mfma_f32_16x16x32_bf16 v[220:223], a[80:83], v[116:119], v[220:223]
    v_mfma_f32_16x16x32_bf16 v[224:227], a[136:139], v[32:35], v[224:227]
    v_mfma_f32_16x16x32_bf16 v[228:231], a[136:139], v[60:63], v[228:231]
    v_mfma_f32_16x16x32_bf16 v[232:235], a[136:139], v[88:91], v[232:235]
    v_mfma_f32_16x16x32_bf16 v[236:239], a[136:139], v[116:119], v[236:239]
    v_mfma_f32_16x16x32_bf16 v[240:243], a[192:195], v[32:35], v[240:243]
    v_mfma_f32_16x16x32_bf16 v[244:247], a[192:195], v[60:63], v[244:247]
    v_mfma_f32_16x16x32_bf16 v[248:251], a[192:195], v[88:91], v[248:251]
    v_mfma_f32_16x16x32_bf16 v[252:255], a[192:195], v[116:119], v[252:255]
    s_waitcnt vmcnt(0)
    v_mfma_f32_16x16x32_bf16 v[192:195], a[28:31], v[120:123], v[192:195]
    v_mfma_f32_16x16x32_bf16 v[196:199], a[28:31], v[148:151], v[196:199]
    v_mfma_f32_16x16x32_bf16 v[200:203], a[28:31], v[176:179], v[200:203]
    v_mfma_f32_16x16x32_bf16 v[204:207], a[28:31], a[236:239], v[204:207]
    v_mfma_f32_16x16x32_bf16 v[208:211], a[84:87], v[120:123], v[208:211]
    v_mfma_f32_16x16x32_bf16 v[212:215], a[84:87], v[148:151], v[212:215]
    v_mfma_f32_16x16x32_bf16 v[216:219], a[84:87], v[176:179], v[216:219]
    v_mfma_f32_16x16x32_bf16 v[220:223], a[84:87], a[236:239], v[220:223]
    v_mfma_f32_16x16x32_bf16 v[224:227], a[140:143], v[120:123], v[224:227]
    v_mfma_f32_16x16x32_bf16 v[228:231], a[140:143], v[148:151], v[228:231]
    v_mfma_f32_16x16x32_bf16 v[232:235], a[140:143], v[176:179], v[232:235]
    v_mfma_f32_16x16x32_bf16 v[236:239], a[140:143], a[236:239], v[236:239]
    v_mfma_f32_16x16x32_bf16 v[240:243], a[196:199], v[120:123], v[240:243]
    v_mfma_f32_16x16x32_bf16 v[244:247], a[196:199], v[148:151], v[244:247]
    v_mfma_f32_16x16x32_bf16 v[248:251], a[196:199], v[176:179], v[248:251]
    v_mfma_f32_16x16x32_bf16 v[252:255], a[196:199], a[236:239], v[252:255]
    v_mfma_f32_16x16x32_bf16 v[192:195], a[32:35], v[124:127], v[192:195]
    v_mfma_f32_16x16x32_bf16 v[196:199], a[32:35], v[152:155], v[196:199]
    v_mfma_f32_16x16x32_bf16 v[200:203], a[32:35], v[180:183], v[200:203]
    v_mfma_f32_16x16x32_bf16 v[204:207], a[32:35], a[240:243], v[204:207]
    v_mfma_f32_16x16x32_bf16 v[208:211], a[88:91], v[124:127], v[208:211]
    v_mfma_f32_16x16x32_bf16 v[212:215], a[88:91], v[152:155], v[212:215]
    v_mfma_f32_16x16x32_bf16 v[216:219], a[88:91], v[180:183], v[216:219]
    v_mfma_f32_16x16x32_bf16 v[220:223], a[88:91], a[240:243], v[220:223]
    v_mfma_f32_16x16x32_bf16 v[224:227], a[144:147], v[124:127], v[224:227]
    v_mfma_f32_16x16x32_bf16 v[228:231], a[144:147], v[152:155], v[228:231]
    v_mfma_f32_16x16x32_bf16 v[232:235], a[144:147], v[180:183], v[232:235]
    v_mfma_f32_16x16x32_bf16 v[236:239], a[144:147], a[240:243], v[236:239]
    v_mfma_f32_16x16x32_bf16 v[240:243], a[200:203], v[124:127], v[240:243]
    v_mfma_f32_16x16x32_bf16 v[244:247], a[200:203], v[152:155], v[244:247]
    v_mfma_f32_16x16x32_bf16 v[248:251], a[200:203], v[180:183], v[248:251]
    v_mfma_f32_16x16x32_bf16 v[252:255], a[200:203], a[240:243], v[252:255]
    v_mfma_f32_16x16x32_bf16 v[192:195], a[36:39], v[128:131], v[192:195]
    v_mfma_f32_16x16x32_bf16 v[196:199], a[36:39], v[156:159], v[196:199]
    v_mfma_f32_16x16x32_bf16 v[200:203], a[36:39], v[184:187], v[200:203]
    v_mfma_f32_16x16x32_bf16 v[204:207], a[36:39], a[244:247], v[204:207]
    v_mfma_f32_16x16x32_bf16 v[208:211], a[92:95], v[128:131], v[208:211]
    v_mfma_f32_16x16x32_bf16 v[212:215], a[92:95], v[156:159], v[212:215]
    v_mfma_f32_16x16x32_bf16 v[216:219], a[92:95], v[184:187], v[216:219]
    v_mfma_f32_16x16x32_bf16 v[220:223], a[92:95], a[244:247], v[220:223]
    v_mfma_f32_16x16x32_bf16 v[224:227], a[148:151], v[128:131], v[224:227]
    v_mfma_f32_16x16x32_bf16 v[228:231], a[148:151], v[156:159], v[228:231]
    v_mfma_f32_16x16x32_bf16 v[232:235], a[148:151], v[184:187], v[232:235]
    v_mfma_f32_16x16x32_bf16 v[236:239], a[148:151], a[244:247], v[236:239]
    v_mfma_f32_16x16x32_bf16 v[240:243], a[204:207], v[128:131], v[240:243]
    v_mfma_f32_16x16x32_bf16 v[244:247], a[204:207], v[156:159], v[244:247]
    v_mfma_f32_16x16x32_bf16 v[248:251], a[204:207], v[184:187], v[248:251]
    v_mfma_f32_16x16x32_bf16 v[252:255], a[204:207], a[244:247], v[252:255]
    v_mfma_f32_16x16x32_bf16 v[192:195], a[40:43], v[132:135], v[192:195]
    v_mfma_f32_16x16x32_bf16 v[196:199], a[40:43], v[160:163], v[196:199]
    v_mfma_f32_16x16x32_bf16 v[200:203], a[40:43], v[188:191], v[200:203]
    v_mfma_f32_16x16x32_bf16 v[204:207], a[40:43], a[248:251], v[204:207]
    v_mfma_f32_16x16x32_bf16 v[208:211], a[96:99], v[132:135], v[208:211]
    v_mfma_f32_16x16x32_bf16 v[212:215], a[96:99], v[160:163], v[212:215]
    v_mfma_f32_16x16x32_bf16 v[216:219], a[96:99], v[188:191], v[216:219]
    v_mfma_f32_16x16x32_bf16 v[220:223], a[96:99], a[248:251], v[220:223]
    v_mfma_f32_16x16x32_bf16 v[224:227], a[152:155], v[132:135], v[224:227]
    v_mfma_f32_16x16x32_bf16 v[228:231], a[152:155], v[160:163], v[228:231]
    v_mfma_f32_16x16x32_bf16 v[232:235], a[152:155], v[188:191], v[232:235]
    v_mfma_f32_16x16x32_bf16 v[236:239], a[152:155], a[248:251], v[236:239]
    v_mfma_f32_16x16x32_bf16 v[240:243], a[208:211], v[132:135], v[240:243]
    v_mfma_f32_16x16x32_bf16 v[244:247], a[208:211], v[160:163], v[244:247]
    v_mfma_f32_16x16x32_bf16 v[248:251], a[208:211], v[188:191], v[248:251]
    v_mfma_f32_16x16x32_bf16 v[252:255], a[208:211], a[248:251], v[252:255]
    v_mfma_f32_16x16x32_bf16 v[192:195], a[44:47], v[136:139], v[192:195]
    v_mfma_f32_16x16x32_bf16 v[196:199], a[44:47], v[164:167], v[196:199]
    v_mfma_f32_16x16x32_bf16 v[200:203], a[44:47], a[224:227], v[200:203]
    v_mfma_f32_16x16x32_bf16 v[204:207], a[44:47], a[252:255], v[204:207]
    v_mfma_f32_16x16x32_bf16 v[208:211], a[100:103], v[136:139], v[208:211]
    v_mfma_f32_16x16x32_bf16 v[212:215], a[100:103], v[164:167], v[212:215]
    v_mfma_f32_16x16x32_bf16 v[216:219], a[100:103], a[224:227], v[216:219]
    v_mfma_f32_16x16x32_bf16 v[220:223], a[100:103], a[252:255], v[220:223]
    v_mfma_f32_16x16x32_bf16 v[224:227], a[156:159], v[136:139], v[224:227]
    v_mfma_f32_16x16x32_bf16 v[228:231], a[156:159], v[164:167], v[228:231]
    v_mfma_f32_16x16x32_bf16 v[232:235], a[156:159], a[224:227], v[232:235]
    v_mfma_f32_16x16x32_bf16 v[236:239], a[156:159], a[252:255], v[236:239]
    v_mfma_f32_16x16x32_bf16 v[240:243], a[212:215], v[136:139], v[240:243]
    v_mfma_f32_16x16x32_bf16 v[244:247], a[212:215], v[164:167], v[244:247]
    v_mfma_f32_16x16x32_bf16 v[248:251], a[212:215], a[224:227], v[248:251]
    v_mfma_f32_16x16x32_bf16 v[252:255], a[212:215], a[252:255], v[252:255]
    v_mfma_f32_16x16x32_bf16 v[192:195], a[48:51], v[140:143], v[192:195]
    v_mfma_f32_16x16x32_bf16 v[196:199], a[48:51], v[168:171], v[196:199]
    v_mfma_f32_16x16x32_bf16 v[200:203], a[48:51], a[228:231], v[200:203]
    v_mfma_f32_16x16x32_bf16 v[204:207], a[48:51], v[8:11], v[204:207]
    v_mfma_f32_16x16x32_bf16 v[208:211], a[104:107], v[140:143], v[208:211]
    v_mfma_f32_16x16x32_bf16 v[212:215], a[104:107], v[168:171], v[212:215]
    v_mfma_f32_16x16x32_bf16 v[216:219], a[104:107], a[228:231], v[216:219]
    v_mfma_f32_16x16x32_bf16 v[220:223], a[104:107], v[8:11], v[220:223]
    v_mfma_f32_16x16x32_bf16 v[224:227], a[160:163], v[140:143], v[224:227]
    v_mfma_f32_16x16x32_bf16 v[228:231], a[160:163], v[168:171], v[228:231]
    v_mfma_f32_16x16x32_bf16 v[232:235], a[160:163], a[228:231], v[232:235]
    v_mfma_f32_16x16x32_bf16 v[236:239], a[160:163], v[8:11], v[236:239]
    v_mfma_f32_16x16x32_bf16 v[240:243], a[216:219], v[140:143], v[240:243]
    v_mfma_f32_16x16x32_bf16 v[244:247], a[216:219], v[168:171], v[244:247]
    v_mfma_f32_16x16x32_bf16 v[248:251], a[216:219], a[228:231], v[248:251]
    v_mfma_f32_16x16x32_bf16 v[252:255], a[216:219], v[8:11], v[252:255]
    v_mfma_f32_16x16x32_bf16 v[192:195], a[52:55], v[144:147], v[192:195]
    v_mfma_f32_16x16x32_bf16 v[196:199], a[52:55], v[172:175], v[196:199]
    v_mfma_f32_16x16x32_bf16 v[200:203], a[52:55], a[232:235], v[200:203]
    v_mfma_f32_16x16x32_bf16 v[204:207], a[52:55], v[12:15], v[204:207]
    v_mfma_f32_16x16x32_bf16 v[208:211], a[108:111], v[144:147], v[208:211]
    v_mfma_f32_16x16x32_bf16 v[212:215], a[108:111], v[172:175], v[212:215]
    v_mfma_f32_16x16x32_bf16 v[216:219], a[108:111], a[232:235], v[216:219]
    v_mfma_f32_16x16x32_bf16 v[220:223], a[108:111], v[12:15], v[220:223]
    v_mfma_f32_16x16x32_bf16 v[224:227], a[164:167], v[144:147], v[224:227]
    v_mfma_f32_16x16x32_bf16 v[228:231], a[164:167], v[172:175], v[228:231]
    v_mfma_f32_16x16x32_bf16 v[232:235], a[164:167], a[232:235], v[232:235]
    v_mfma_f32_16x16x32_bf16 v[236:239], a[164:167], v[12:15], v[236:239]
    v_mfma_f32_16x16x32_bf16 v[240:243], a[220:223], v[144:147], v[240:243]
    v_mfma_f32_16x16x32_bf16 v[244:247], a[220:223], v[172:175], v[244:247]
    v_mfma_f32_16x16x32_bf16 v[248:251], a[220:223], a[232:235], v[248:251]
    v_mfma_f32_16x16x32_bf16 v[252:255], a[220:223], v[12:15], v[252:255]
    s_nop 7
    v_lshrrev_b32 v2, 4, v0
    v_mul_u32_u24 v2, 1088, v2
    v_and_b32 v3, 15, v0
    v_lshl_add_u32 v2, v3, 3, v2
    s_mul_i32 s22, s3, 17408
    v_add_u32 v2, s22, v2
    s_barrier
    v_add_u32 v3, 0, v2
    ds_write2_b32 v3, v192, v196 offset0:0 offset1:1
    ds_write2_b32 v3, v200, v204 offset0:32 offset1:33
    ds_write2_b32 v3, v193, v197 offset0:68 offset1:69
    ds_write2_b32 v3, v201, v205 offset0:100 offset1:101
    ds_write2_b32 v3, v194, v198 offset0:136 offset1:137
    ds_write2_b32 v3, v202, v206 offset0:168 offset1:169
    ds_write2_b32 v3, v195, v199 offset0:204 offset1:205
    ds_write2_b32 v3, v203, v207 offset0:236 offset1:237
    v_add_u32 v3, 4352, v2
    ds_write2_b32 v3, v208, v212 offset0:0 offset1:1
    ds_write2_b32 v3, v216, v220 offset0:32 offset1:33
    ds_write2_b32 v3, v209, v213 offset0:68 offset1:69
    ds_write2_b32 v3, v217, v221 offset0:100 offset1:101
    ds_write2_b32 v3, v210, v214 offset0:136 offset1:137
    ds_write2_b32 v3, v218, v222 offset0:168 offset1:169
    ds_write2_b32 v3, v211, v215 offset0:204 offset1:205
    ds_write2_b32 v3, v219, v223 offset0:236 offset1:237
    v_add_u32 v3, 8704, v2
    ds_write2_b32 v3, v224, v228 offset0:0 offset1:1
    ds_write2_b32 v3, v232, v236 offset0:32 offset1:33
    ds_write2_b32 v3, v225, v229 offset0:68 offset1:69
    ds_write2_b32 v3, v233, v237 offset0:100 offset1:101
    ds_write2_b32 v3, v226, v230 offset0:136 offset1:137
    ds_write2_b32 v3, v234, v238 offset0:168 offset1:169
    ds_write2_b32 v3, v227, v231 offset0:204 offset1:205
    ds_write2_b32 v3, v235, v239 offset0:236 offset1:237
    v_add_u32 v3, 13056, v2
    ds_write2_b32 v3, v240, v244 offset0:0 offset1:1
    ds_write2_b32 v3, v248, v252 offset0:32 offset1:33
    ds_write2_b32 v3, v241, v245 offset0:68 offset1:69
    ds_write2_b32 v3, v249, v253 offset0:100 offset1:101
    ds_write2_b32 v3, v242, v246 offset0:136 offset1:137
    ds_write2_b32 v3, v250, v254 offset0:168 offset1:169
    ds_write2_b32 v3, v243, v247 offset0:204 offset1:205
    ds_write2_b32 v3, v251, v255 offset0:236 offset1:237
    s_waitcnt lgkmcnt(0)
    s_barrier
    s_lshl_b32 s22, s3, 4
    v_lshrrev_b32 v2, 2, v0
    v_add_u32 v2, s22, v2
    v_and_b32 v3, 3, v0
    v_mul_u32_u24 v4, 272, v2
    v_lshl_add_u32 v4, v3, 6, v4
    ds_read_b128 v[8:11], v4 offset:0
    ds_read_b128 v[12:15], v4 offset:16
    ds_read_b128 v[16:19], v4 offset:32
    ds_read_b128 v[20:23], v4 offset:48
    v_add_u32 v4, 17408, v4
    ds_read_b128 v[24:27], v4 offset:0
    ds_read_b128 v[28:31], v4 offset:16
    ds_read_b128 v[32:35], v4 offset:32
    ds_read_b128 v[36:39], v4 offset:48
    v_add_u32 v4, 17408, v4
    ds_read_b128 v[40:43], v4 offset:0
    ds_read_b128 v[44:47], v4 offset:16
    ds_read_b128 v[48:51], v4 offset:32
    ds_read_b128 v[52:55], v4 offset:48
    v_add_u32 v4, 17408, v4
    ds_read_b128 v[56:59], v4 offset:0
    ds_read_b128 v[60:63], v4 offset:16
    ds_read_b128 v[64:67], v4 offset:32
    ds_read_b128 v[68:71], v4 offset:48
    v_mul_u32_u24 v5, 896, v2
    v_lshl_add_u32 v5, v3, 5, v5
    s_mul_i32 s22, s16, 57344
    s_lshl_b32 s23, s17, 7
    s_add_u32 s22, s22, s23
    s_add_u32 s22, s22, 60129280
    s_waitcnt lgkmcnt(0)
    v_pk_add_f32 v[8:9], v[8:9], v[24:25]
    v_pk_add_f32 v[40:41], v[40:41], v[56:57]
    v_pk_add_f32 v[8:9], v[8:9], v[40:41]
    v_pk_add_f32 v[10:11], v[10:11], v[26:27]
    v_pk_add_f32 v[42:43], v[42:43], v[58:59]
    v_pk_add_f32 v[10:11], v[10:11], v[42:43]
    v_pk_add_f32 v[12:13], v[12:13], v[28:29]
    v_pk_add_f32 v[44:45], v[44:45], v[60:61]
    v_pk_add_f32 v[12:13], v[12:13], v[44:45]
    v_pk_add_f32 v[14:15], v[14:15], v[30:31]
    v_pk_add_f32 v[46:47], v[46:47], v[62:63]
    v_pk_add_f32 v[14:15], v[14:15], v[46:47]
    v_pk_add_f32 v[16:17], v[16:17], v[32:33]
    v_pk_add_f32 v[48:49], v[48:49], v[64:65]
    v_pk_add_f32 v[16:17], v[16:17], v[48:49]
    v_pk_add_f32 v[18:19], v[18:19], v[34:35]
    v_pk_add_f32 v[50:51], v[50:51], v[66:67]
    v_pk_add_f32 v[18:19], v[18:19], v[50:51]
    v_pk_add_f32 v[20:21], v[20:21], v[36:37]
    v_pk_add_f32 v[52:53], v[52:53], v[68:69]
    v_pk_add_f32 v[20:21], v[20:21], v[52:53]
    v_pk_add_f32 v[22:23], v[22:23], v[38:39]
    v_pk_add_f32 v[54:55], v[54:55], v[70:71]
    v_pk_add_f32 v[22:23], v[22:23], v[54:55]
    v_cvt_pk_bf16_f32 v6, v8, v9
    v_lshlrev_b32 v8, 16, v6
    v_and_b32 v9, 0xffff0000, v6
    v_mul_f32 v72, 0xbfb8aa3b, v8
    v_exp_f32 v72, v72
    s_nop 0
    v_add_f32 v72, 1.0, v72
    v_rcp_f32 v72, v72
    s_nop 0
    v_mul_f32 v8, v8, v72
    v_mul_f32 v73, 0xbfb8aa3b, v9
    v_exp_f32 v73, v73
    s_nop 0
    v_add_f32 v73, 1.0, v73
    v_rcp_f32 v73, v73
    s_nop 0
    v_mul_f32 v9, v9, v73
    v_cvt_pk_bf16_f32 v80, v8, v9
    v_cvt_pk_bf16_f32 v6, v10, v11
    v_lshlrev_b32 v10, 16, v6
    v_and_b32 v11, 0xffff0000, v6
    v_mul_f32 v72, 0xbfb8aa3b, v10
    v_exp_f32 v72, v72
    s_nop 0
    v_add_f32 v72, 1.0, v72
    v_rcp_f32 v72, v72
    s_nop 0
    v_mul_f32 v10, v10, v72
    v_mul_f32 v73, 0xbfb8aa3b, v11
    v_exp_f32 v73, v73
    s_nop 0
    v_add_f32 v73, 1.0, v73
    v_rcp_f32 v73, v73
    s_nop 0
    v_mul_f32 v11, v11, v73
    v_cvt_pk_bf16_f32 v81, v10, v11
    v_cvt_pk_bf16_f32 v6, v12, v13
    v_lshlrev_b32 v12, 16, v6
    v_and_b32 v13, 0xffff0000, v6
    v_mul_f32 v72, 0xbfb8aa3b, v12
    v_exp_f32 v72, v72
    s_nop 0
    v_add_f32 v72, 1.0, v72
    v_rcp_f32 v72, v72
    s_nop 0
    v_mul_f32 v12, v12, v72
    v_mul_f32 v73, 0xbfb8aa3b, v13
    v_exp_f32 v73, v73
    s_nop 0
    v_add_f32 v73, 1.0, v73
    v_rcp_f32 v73, v73
    s_nop 0
    v_mul_f32 v13, v13, v73
    v_cvt_pk_bf16_f32 v82, v12, v13
    v_cvt_pk_bf16_f32 v6, v14, v15
    v_lshlrev_b32 v14, 16, v6
    v_and_b32 v15, 0xffff0000, v6
    v_mul_f32 v72, 0xbfb8aa3b, v14
    v_exp_f32 v72, v72
    s_nop 0
    v_add_f32 v72, 1.0, v72
    v_rcp_f32 v72, v72
    s_nop 0
    v_mul_f32 v14, v14, v72
    v_mul_f32 v73, 0xbfb8aa3b, v15
    v_exp_f32 v73, v73
    s_nop 0
    v_add_f32 v73, 1.0, v73
    v_rcp_f32 v73, v73
    s_nop 0
    v_mul_f32 v15, v15, v73
    v_cvt_pk_bf16_f32 v83, v14, v15
    v_cvt_pk_bf16_f32 v6, v16, v17
    v_lshlrev_b32 v16, 16, v6
    v_and_b32 v17, 0xffff0000, v6
    v_mul_f32 v72, 0xbfb8aa3b, v16
    v_exp_f32 v72, v72
    s_nop 0
    v_add_f32 v72, 1.0, v72
    v_rcp_f32 v72, v72
    s_nop 0
    v_mul_f32 v16, v16, v72
    v_mul_f32 v73, 0xbfb8aa3b, v17
    v_exp_f32 v73, v73
    s_nop 0
    v_add_f32 v73, 1.0, v73
    v_rcp_f32 v73, v73
    s_nop 0
    v_mul_f32 v17, v17, v73
    v_cvt_pk_bf16_f32 v84, v16, v17
    v_cvt_pk_bf16_f32 v6, v18, v19
    v_lshlrev_b32 v18, 16, v6
    v_and_b32 v19, 0xffff0000, v6
    v_mul_f32 v72, 0xbfb8aa3b, v18
    v_exp_f32 v72, v72
    s_nop 0
    v_add_f32 v72, 1.0, v72
    v_rcp_f32 v72, v72
    s_nop 0
    v_mul_f32 v18, v18, v72
    v_mul_f32 v73, 0xbfb8aa3b, v19
    v_exp_f32 v73, v73
    s_nop 0
    v_add_f32 v73, 1.0, v73
    v_rcp_f32 v73, v73
    s_nop 0
    v_mul_f32 v19, v19, v73
    v_cvt_pk_bf16_f32 v85, v18, v19
    v_cvt_pk_bf16_f32 v6, v20, v21
    v_lshlrev_b32 v20, 16, v6
    v_and_b32 v21, 0xffff0000, v6
    v_mul_f32 v72, 0xbfb8aa3b, v20
    v_exp_f32 v72, v72
    s_nop 0
    v_add_f32 v72, 1.0, v72
    v_rcp_f32 v72, v72
    s_nop 0
    v_mul_f32 v20, v20, v72
    v_mul_f32 v73, 0xbfb8aa3b, v21
    v_exp_f32 v73, v73
    s_nop 0
    v_add_f32 v73, 1.0, v73
    v_rcp_f32 v73, v73
    s_nop 0
    v_mul_f32 v21, v21, v73
    v_cvt_pk_bf16_f32 v86, v20, v21
    v_cvt_pk_bf16_f32 v6, v22, v23
    v_lshlrev_b32 v22, 16, v6
    v_and_b32 v23, 0xffff0000, v6
    v_mul_f32 v72, 0xbfb8aa3b, v22
    v_exp_f32 v72, v72
    s_nop 0
    v_add_f32 v72, 1.0, v72
    v_rcp_f32 v72, v72
    s_nop 0
    v_mul_f32 v22, v22, v72
    v_mul_f32 v73, 0xbfb8aa3b, v23
    v_exp_f32 v73, v73
    s_nop 0
    v_add_f32 v73, 1.0, v73
    v_rcp_f32 v73, v73
    s_nop 0
    v_mul_f32 v23, v23, v73
    v_cvt_pk_bf16_f32 v87, v22, v23
    buffer_store_dwordx4 v[80:83], v5, s[4:7], s22 offen sc1
    buffer_store_dwordx4 v[84:87], v5, s[4:7], s22 offen offset:16 sc1
    s_waitcnt vmcnt(0)
    s_barrier
    s_cmp_lg_u32 s3, 0
    s_cbranch_scc1 sf_152
    v_mov_b32 v2, 1
    s_lshl_b32 s16, s96, 2
    s_add_u32 s16, s16, 73984000
    v_mov_b32 v3, 0
    s_mov_b64 exec, 1
    buffer_store_dword v2, v3, s[4:7], s16 offen sc1
    s_mov_b64 exec, -1
sf_152:
    s_mov_b32 s93, 0
    s_cmp_lt_u32 s92, 28
    s_cbranch_scc1 k2_so
    s_sub_u32 s32, s92, 28
    s_lshl_b32 s33, s91, 2
    s_add_u32 s32, s32, s33
    s_lshl_b32 s17, s32, 2
    s_add_u32 s17, s17, s3
    s_mul_i32 s22, s17, 147
    s_lshr_b32 s22, s22, 11
    s_mul_i32 s23, s22, 14
    s_sub_u32 s23, s17, s23
    s_mul_i32 s18, s22, 802816
    s_mul_i32 s19, s23, 28672
    s_add_u32 s18, s18, s19
    s_add_u32 s18, s18, 11927552
    s_add_u32 s24, s18, 401408
    s_mov_b32 s20, s18
    buffer_load_dwordx4 a[0:3], v1, s[4:7], s20 offen offset:0
    buffer_load_dwordx4 a[4:7], v1, s[4:7], s20 offen offset:1024
    buffer_load_dwordx4 a[8:11], v1, s[4:7], s20 offen offset:2048
    buffer_load_dwordx4 a[12:15], v1, s[4:7], s20 offen offset:3072
    s_add_u32 s20, s20, 4096
    buffer_load_dwordx4 a[16:19], v1, s[4:7], s20 offen offset:0
    buffer_load_dwordx4 a[20:23], v1, s[4:7], s20 offen offset:1024
    buffer_load_dwordx4 a[24:27], v1, s[4:7], s20 offen offset:2048
    buffer_load_dwordx4 a[28:31], v1, s[4:7], s20 offen offset:3072
    s_add_u32 s20, s20, 4096
    buffer_load_dwordx4 a[32:35], v1, s[4:7], s20 offen offset:0
    buffer_load_dwordx4 a[36:39], v1, s[4:7], s20 offen offset:1024
    buffer_load_dwordx4 a[40:43], v1, s[4:7], s20 offen offset:2048
    buffer_load_dwordx4 a[44:47], v1, s[4:7], s20 offen offset:3072
    s_add_u32 s20, s20, 4096
    buffer_load_dwordx4 a[48:51], v1, s[4:7], s20 offen offset:0
    buffer_load_dwordx4 a[52:55], v1, s[4:7], s20 offen offset:1024
    buffer_load_dwordx4 a[56:59], v1, s[4:7], s20 offen offset:2048
    buffer_load_dwordx4 a[60:63], v1, s[4:7], s20 offen offset:3072
    s_add_u32 s20, s20, 4096
    buffer_load_dwordx4 a[64:67], v1, s[4:7], s20 offen offset:0
    buffer_load_dwordx4 a[68:71], v1, s[4:7], s20 offen offset:1024
    buffer_load_dwordx4 a[72:75], v1, s[4:7], s20 offen offset:2048
    buffer_load_dwordx4 a[76:79], v1, s[4:7], s20 offen offset:3072
    s_add_u32 s20, s20, 4096
    buffer_load_dwordx4 a[80:83], v1, s[4:7], s20 offen offset:0
    buffer_load_dwordx4 a[84:87], v1, s[4:7], s20 offen offset:1024
    buffer_load_dwordx4 a[88:91], v1, s[4:7], s20 offen offset:2048
    buffer_load_dwordx4 a[92:95], v1, s[4:7], s20 offen offset:3072
    s_add_u32 s20, s20, 4096
    buffer_load_dwordx4 a[96:99], v1, s[4:7], s20 offen offset:0
    buffer_load_dwordx4 a[100:103], v1, s[4:7], s20 offen offset:1024
    buffer_load_dwordx4 a[104:107], v1, s[4:7], s20 offen offset:2048
    buffer_load_dwordx4 a[108:111], v1, s[4:7], s20 offen offset:3072
    s_mov_b32 s20, s24
    buffer_load_dwordx4 a[112:115], v1, s[4:7], s20 offen offset:0
    buffer_load_dwordx4 a[116:119], v1, s[4:7], s20 offen offset:1024
    buffer_load_dwordx4 a[120:123], v1, s[4:7], s20 offen offset:2048
    buffer_load_dwordx4 a[124:127], v1, s[4:7], s20 offen offset:3072
    s_add_u32 s20, s20, 4096
    buffer_load_dwordx4 a[128:131], v1, s[4:7], s20 offen offset:0
    buffer_load_dwordx4 a[132:135], v1, s[4:7], s20 offen offset:1024
    buffer_load_dwordx4 a[136:139], v1, s[4:7], s20 offen offset:2048
    buffer_load_dwordx4 a[140:143], v1, s[4:7], s20 offen offset:3072
    s_add_u32 s20, s20, 4096
    buffer_load_dwordx4 a[144:147], v1, s[4:7], s20 offen offset:0
    buffer_load_dwordx4 a[148:151], v1, s[4:7], s20 offen offset:1024
    buffer_load_dwordx4 a[152:155], v1, s[4:7], s20 offen offset:2048
    buffer_load_dwordx4 a[156:159], v1, s[4:7], s20 offen offset:3072
    s_add_u32 s20, s20, 4096
    buffer_load_dwordx4 a[160:163], v1, s[4:7], s20 offen offset:0
    buffer_load_dwordx4 a[164:167], v1, s[4:7], s20 offen offset:1024
    buffer_load_dwordx4 a[168:171], v1, s[4:7], s20 offen offset:2048
    buffer_load_dwordx4 a[172:175], v1, s[4:7], s20 offen offset:3072
    s_add_u32 s20, s20, 4096
    buffer_load_dwordx4 a[176:179], v1, s[4:7], s20 offen offset:0
    buffer_load_dwordx4 a[180:183], v1, s[4:7], s20 offen offset:1024
    buffer_load_dwordx4 a[184:187], v1, s[4:7], s20 offen offset:2048
    buffer_load_dwordx4 a[188:191], v1, s[4:7], s20 offen offset:3072
    s_add_u32 s20, s20, 4096
    buffer_load_dwordx4 a[192:195], v1, s[4:7], s20 offen offset:0
    buffer_load_dwordx4 a[196:199], v1, s[4:7], s20 offen offset:1024
    buffer_load_dwordx4 a[200:203], v1, s[4:7], s20 offen offset:2048
    buffer_load_dwordx4 a[204:207], v1, s[4:7], s20 offen offset:3072
    s_add_u32 s20, s20, 4096
    buffer_load_dwordx4 a[208:211], v1, s[4:7], s20 offen offset:0
    buffer_load_dwordx4 a[212:215], v1, s[4:7], s20 offen offset:1024
    buffer_load_dwordx4 a[216:219], v1, s[4:7], s20 offen offset:2048
    buffer_load_dwordx4 a[220:223], v1, s[4:7], s20 offen offset:3072
    v_and_b32 v2, 8, v0
    v_lshlrev_b32 v2, 10, v2
    v_and_b32 v3, 7, v0
    v_lshl_add_u32 v2, v3, 4, v2
    v_lshrrev_b32 v3, 5, v0
    v_lshl_add_u32 v2, v3, 7, v2
    v_and_b32 v6, 16, v0
    v_lshrrev_b32 v6, 1, v6
    v_add_u32 v2, v2, v6
    v_mul_u32_u24 v3, 114688, v3
    v_and_b32 v6, 31, v0
    v_lshl_add_u32 v3, v6, 4, v3
    s_lshl_b32 s21, s23, 2
    s_lshr_b32 s19, s22, 1
    s_add_u32 s21, s21, s19
    s_lshl_b32 s21, s21, 11
    s_and_b32 s19, s22, 1
    s_lshl_b32 s19, s19, 9
    s_add_u32 s21, s21, s19
    s_add_u32 s21, s21, 63275008
    s_lshr_b32 s26, s23, 1
    s_lshl_b32 s26, s26, 7
    s_lshl_b32 s19, s22, 3
    s_add_u32 s26, s26, s19
    s_and_b32 s19, s23, 1
    s_lshl_b32 s19, s19, 2
    s_add_u32 s26, s26, s19
    s_add_u32 s26, s26, 73994240
    s_mov_b32 s24, 62750720
    s_mov_b32 s27, 1
    s_mov_b32 s31, 0
    s_mov_b32 s23, 0
    v_mov_b32 v7, 0
yw_153:
    s_add_u32 s25, s24, 4096
    s_cmp_ge_u32 s31, s27
    s_cbranch_scc1 ywh_154
    s_sub_u32 s19, s27, 1
    s_max_u32 s19, s19, 1
    s_and_b32 s28, s96, 15
    s_lshl_b32 s28, s28, 7
    s_add_u32 s28, s28, 73990144
    v_mov_b32 v5, 0
    s_mov_b32 s30, 400000
wh_158:
    s_mov_b64 exec, 1
    buffer_load_dword v4, v5, s[4:7], s28 offen sc1
    s_mov_b64 exec, -1
    s_waitcnt vmcnt(0)
    v_readfirstlane_b32 s29, v4
    s_cmp_ge_u32 s29, s19
    s_cbranch_scc1 who_159
    s_add_u32 s29, s29, 2
    s_cmp_ge_u32 s29, s19
    s_cbranch_scc1 whs_160
    s_sleep 48
whs_160:
    s_sleep 6
    s_sub_u32 s30, s30, 1
    s_cmp_lg_u32 s30, 0
    s_cbranch_scc1 wh_158
    s_branch k2_end
who_159:
    s_mov_b32 s31, s29
    s_cmp_ge_u32 s31, s27
    s_cbranch_scc1 ywh_154
    s_mov_b32 s30, 400000
sw_161:
    buffer_load_dwordx2 v[16:17], v2, s[4:7], s24 offen offset:0 sc1
    buffer_load_dwordx2 v[18:19], v2, s[4:7], s24 offen offset:256 sc1
    buffer_load_dwordx2 v[20:21], v2, s[4:7], s24 offen offset:512 sc1
    buffer_load_dwordx2 v[22:23], v2, s[4:7], s24 offen offset:768 sc1
    buffer_load_dwordx2 v[24:25], v2, s[4:7], s24 offen offset:1024 sc1
    buffer_load_dwordx2 v[26:27], v2, s[4:7], s24 offen offset:1280 sc1
    buffer_load_dwordx2 v[28:29], v2, s[4:7], s24 offen offset:1536 sc1
    buffer_load_dwordx2 v[30:31], v2, s[4:7], s24 offen offset:1792 sc1
    buffer_load_dwordx2 v[32:33], v2, s[4:7], s24 offen offset:2048 sc1
    buffer_load_dwordx2 v[34:35], v2, s[4:7], s24 offen offset:2304 sc1
    buffer_load_dwordx2 v[36:37], v2, s[4:7], s24 offen offset:2560 sc1
    buffer_load_dwordx2 v[38:39], v2, s[4:7], s24 offen offset:2816 sc1
    buffer_load_dwordx2 v[40:41], v2, s[4:7], s24 offen offset:3072 sc1
    buffer_load_dwordx2 v[42:43], v2, s[4:7], s24 offen offset:3328 sc1
    buffer_load_dwordx2 v[44:45], v2, s[4:7], s24 offen offset:3584 sc1
    buffer_load_dwordx2 v[46:47], v2, s[4:7], s24 offen offset:3840 sc1
    buffer_load_dwordx2 v[48:49], v2, s[4:7], s25 offen offset:0 sc1
    buffer_load_dwordx2 v[50:51], v2, s[4:7], s25 offen offset:256 sc1
    buffer_load_dwordx2 v[52:53], v2, s[4:7], s25 offen offset:512 sc1
    buffer_load_dwordx2 v[54:55], v2, s[4:7], s25 offen offset:768 sc1
    buffer_load_dwordx2 v[56:57], v2, s[4:7], s25 offen offset:1024 sc1
    buffer_load_dwordx2 v[58:59], v2, s[4:7], s25 offen offset:1280 sc1
    buffer_load_dwordx2 v[60:61], v2, s[4:7], s25 offen offset:1536 sc1
    buffer_load_dwordx2 v[62:63], v2, s[4:7], s25 offen offset:1792 sc1
    buffer_load_dwordx2 v[64:65], v2, s[4:7], s25 offen offset:2048 sc1
    buffer_load_dwordx2 v[66:67], v2, s[4:7], s25 offen offset:2304 sc1
    buffer_load_dwordx2 v[68:69], v2, s[4:7], s25 offen offset:2560 sc1
    buffer_load_dwordx2 v[70:71], v2, s[4:7], s25 offen offset:2816 sc1
    s_waitcnt vmcnt(0)
    v_max_u32 v4, v16, v17
    v_max3_u32 v4, v4, v18, v19
    v_max3_u32 v4, v4, v20, v21
    v_max3_u32 v4, v4, v22, v23
    v_max3_u32 v4, v4, v24, v25
    v_max3_u32 v4, v4, v26, v27
    v_max3_u32 v4, v4, v28, v29
    v_max3_u32 v4, v4, v30, v31
    v_max3_u32 v4, v4, v32, v33
    v_max3_u32 v4, v4, v34, v35
    v_max3_u32 v4, v4, v36, v37
    v_max3_u32 v4, v4, v38, v39
    v_max3_u32 v4, v4, v40, v41
    v_max3_u32 v4, v4, v42, v43
    v_max3_u32 v4, v4, v44, v45
    v_max3_u32 v4, v4, v46, v47
    v_max3_u32 v4, v4, v48, v49
    v_max3_u32 v4, v4, v50, v51
    v_max3_u32 v4, v4, v52, v53
    v_max3_u32 v4, v4, v54, v55
    v_max3_u32 v4, v4, v56, v57
    v_max3_u32 v4, v4, v58, v59
    v_max3_u32 v4, v4, v60, v61
    v_max3_u32 v4, v4, v62, v63
    v_max3_u32 v4, v4, v64, v65
    v_max3_u32 v4, v4, v66, v67
    v_max3_u32 v4, v4, v68, v69
    v_max3_u32 v4, v4, v70, v71
    v_cmp_eq_u32 vcc, -1, v4
    s_cbranch_vccz swo_162
    s_sleep 3
    s_sub_u32 s30, s30, 1
    s_cmp_lg_u32 s30, 0
    s_cbranch_scc1 sw_161
    s_branch k2_end
swo_162:
    s_branch ywg_157
ywh_154:
    buffer_load_dwordx2 v[16:17], v2, s[4:7], s24 offen offset:0 sc1
    buffer_load_dwordx2 v[18:19], v2, s[4:7], s24 offen offset:256 sc1
    buffer_load_dwordx2 v[20:21], v2, s[4:7], s24 offen offset:512 sc1
    buffer_load_dwordx2 v[22:23], v2, s[4:7], s24 offen offset:768 sc1
    buffer_load_dwordx2 v[24:25], v2, s[4:7], s24 offen offset:1024 sc1
    buffer_load_dwordx2 v[26:27], v2, s[4:7], s24 offen offset:1280 sc1
    buffer_load_dwordx2 v[28:29], v2, s[4:7], s24 offen offset:1536 sc1
    buffer_load_dwordx2 v[30:31], v2, s[4:7], s24 offen offset:1792 sc1
    buffer_load_dwordx2 v[32:33], v2, s[4:7], s24 offen offset:2048 sc1
    buffer_load_dwordx2 v[34:35], v2, s[4:7], s24 offen offset:2304 sc1
    buffer_load_dwordx2 v[36:37], v2, s[4:7], s24 offen offset:2560 sc1
    buffer_load_dwordx2 v[38:39], v2, s[4:7], s24 offen offset:2816 sc1
    buffer_load_dwordx2 v[40:41], v2, s[4:7], s24 offen offset:3072 sc1
    buffer_load_dwordx2 v[42:43], v2, s[4:7], s24 offen offset:3328 sc1
    buffer_load_dwordx2 v[44:45], v2, s[4:7], s24 offen offset:3584 sc1
    buffer_load_dwordx2 v[46:47], v2, s[4:7], s24 offen offset:3840 sc1
    buffer_load_dwordx2 v[48:49], v2, s[4:7], s25 offen offset:0 sc1
    buffer_load_dwordx2 v[50:51], v2, s[4:7], s25 offen offset:256 sc1
    buffer_load_dwordx2 v[52:53], v2, s[4:7], s25 offen offset:512 sc1
    buffer_load_dwordx2 v[54:55], v2, s[4:7], s25 offen offset:768 sc1
    buffer_load_dwordx2 v[56:57], v2, s[4:7], s25 offen offset:1024 sc1
    buffer_load_dwordx2 v[58:59], v2, s[4:7], s25 offen offset:1280 sc1
    buffer_load_dwordx2 v[60:61], v2, s[4:7], s25 offen offset:1536 sc1
    buffer_load_dwordx2 v[62:63], v2, s[4:7], s25 offen offset:1792 sc1
    buffer_load_dwordx2 v[64:65], v2, s[4:7], s25 offen offset:2048 sc1
    buffer_load_dwordx2 v[66:67], v2, s[4:7], s25 offen offset:2304 sc1
    buffer_load_dwordx2 v[68:69], v2, s[4:7], s25 offen offset:2560 sc1
    buffer_load_dwordx2 v[70:71], v2, s[4:7], s25 offen offset:2816 sc1
ywg_157:
    s_waitcnt vmcnt(26)
    v_mfma_f32_16x16x32_bf16 v[80:83], v[16:19], a[0:3], 0
    v_mfma_f32_16x16x32_bf16 v[84:87], v[16:19], a[56:59], 0
    v_mfma_f32_16x16x32_bf16 v[88:91], v[16:19], a[112:115], 0
    v_mfma_f32_16x16x32_bf16 v[92:95], v[16:19], a[168:171], 0
    s_waitcnt vmcnt(24)
    v_mfma_f32_16x16x32_bf16 v[80:83], v[20:23], a[4:7], v[80:83]
    v_mfma_f32_16x16x32_bf16 v[84:87], v[20:23], a[60:63], v[84:87]
    v_mfma_f32_16x16x32_bf16 v[88:91], v[20:23], a[116:119], v[88:91]
    v_mfma_f32_16x16x32_bf16 v[92:95], v[20:23], a[172:175], v[92:95]
    s_waitcnt vmcnt(22)
    v_mfma_f32_16x16x32_bf16 v[80:83], v[24:27], a[8:11], v[80:83]
    v_mfma_f32_16x16x32_bf16 v[84:87], v[24:27], a[64:67], v[84:87]
    v_mfma_f32_16x16x32_bf16 v[88:91], v[24:27], a[120:123], v[88:91]
    v_mfma_f32_16x16x32_bf16 v[92:95], v[24:27], a[176:179], v[92:95]
    s_waitcnt vmcnt(20)
    v_mfma_f32_16x16x32_bf16 v[80:83], v[28:31], a[12:15], v[80:83]
    v_mfma_f32_16x16x32_bf16 v[84:87], v[28:31], a[68:71], v[84:87]
    v_mfma_f32_16x16x32_bf16 v[88:91], v[28:31], a[124:127], v[88:91]
    v_mfma_f32_16x16x32_bf16 v[92:95], v[28:31], a[180:183], v[92:95]
    s_waitcnt vmcnt(18)
    v_mfma_f32_16x16x32_bf16 v[80:83], v[32:35], a[16:19], v[80:83]
    v_mfma_f32_16x16x32_bf16 v[84:87], v[32:35], a[72:75], v[84:87]
    v_mfma_f32_16x16x32_bf16 v[88:91], v[32:35], a[128:131], v[88:91]
    v_mfma_f32_16x16x32_bf16 v[92:95], v[32:35], a[184:187], v[92:95]
    s_waitcnt vmcnt(16)
    v_mfma_f32_16x16x32_bf16 v[80:83], v[36:39], a[20:23], v[80:83]
    v_mfma_f32_16x16x32_bf16 v[84:87], v[36:39], a[76:79], v[84:87]
    v_mfma_f32_16x16x32_bf16 v[88:91], v[36:39], a[132:135], v[88:91]
    v_mfma_f32_16x16x32_bf16 v[92:95], v[36:39], a[188:191], v[92:95]
    s_waitcnt vmcnt(14)
    v_mfma_f32_16x16x32_bf16 v[80:83], v[40:43], a[24:27], v[80:83]
    v_mfma_f32_16x16x32_bf16 v[84:87], v[40:43], a[80:83], v[84:87]
    v_mfma_f32_16x16x32_bf16 v[88:91], v[40:43], a[136:139], v[88:91]
    v_mfma_f32_16x16x32_bf16 v[92:95], v[40:43], a[192:195], v[92:95]
    s_waitcnt vmcnt(12)
    v_mfma_f32_16x16x32_bf16 v[80:83], v[44:47], a[28:31], v[80:83]
    v_mfma_f32_16x16x32_bf16 v[84:87], v[44:47], a[84:87], v[84:87]
    v_mfma_f32_16x16x32_bf16 v[88:91], v[44:47], a[140:143], v[88:91]
    v_mfma_f32_16x16x32_bf16 v[92:95], v[44:47], a[196:199], v[92:95]
    s_waitcnt vmcnt(10)
    v_mfma_f32_16x16x32_bf16 v[80:83], v[48:51], a[32:35], v[80:83]
    v_mfma_f32_16x16x32_bf16 v[84:87], v[48:51], a[88:91], v[84:87]
    v_mfma_f32_16x16x32_bf16 v[88:91], v[48:51], a[144:147], v[88:91]
    v_mfma_f32_16x16x32_bf16 v[92:95], v[48:51], a[200:203], v[92:95]
    s_waitcnt vmcnt(8)
    v_mfma_f32_16x16x32_bf16 v[80:83], v[52:55], a[36:39], v[80:83]
    v_mfma_f32_16x16x32_bf16 v[84:87], v[52:55], a[92:95], v[84:87]
    v_mfma_f32_16x16x32_bf16 v[88:91], v[52:55], a[148:151], v[88:91]
    v_mfma_f32_16x16x32_bf16 v[92:95], v[52:55], a[204:207], v[92:95]
    s_waitcnt vmcnt(6)
    v_mfma_f32_16x16x32_bf16 v[80:83], v[56:59], a[40:43], v[80:83]
    v_mfma_f32_16x16x32_bf16 v[84:87], v[56:59], a[96:99], v[84:87]
    v_mfma_f32_16x16x32_bf16 v[88:91], v[56:59], a[152:155], v[88:91]
    v_mfma_f32_16x16x32_bf16 v[92:95], v[56:59], a[208:211], v[92:95]
    s_waitcnt vmcnt(4)
    v_mfma_f32_16x16x32_bf16 v[80:83], v[60:63], a[44:47], v[80:83]
    v_mfma_f32_16x16x32_bf16 v[84:87], v[60:63], a[100:103], v[84:87]
    v_mfma_f32_16x16x32_bf16 v[88:91], v[60:63], a[156:159], v[88:91]
    v_mfma_f32_16x16x32_bf16 v[92:95], v[60:63], a[212:215], v[92:95]
    s_waitcnt vmcnt(2)
    v_mfma_f32_16x16x32_bf16 v[80:83], v[64:67], a[48:51], v[80:83]
    v_mfma_f32_16x16x32_bf16 v[84:87], v[64:67], a[104:107], v[84:87]
    v_mfma_f32_16x16x32_bf16 v[88:91], v[64:67], a[160:163], v[88:91]
    v_mfma_f32_16x16x32_bf16 v[92:95], v[64:67], a[216:219], v[92:95]
    s_waitcnt vmcnt(0)
    v_mfma_f32_16x16x32_bf16 v[80:83], v[68:71], a[52:55], v[80:83]
    v_mfma_f32_16x16x32_bf16 v[84:87], v[68:71], a[108:111], v[84:87]
    v_mfma_f32_16x16x32_bf16 v[88:91], v[68:71], a[164:167], v[88:91]
    v_mfma_f32_16x16x32_bf16 v[92:95], v[68:71], a[220:223], v[92:95]
    s_cmp_eq_u32 s23, 0
    s_cbranch_scc1 ywn_155
    v_mov_b32 v6, s23
    s_mov_b64 exec, 1
    buffer_store_dword v6, v7, s[4:7], s26 offen sc1
    s_mov_b64 exec, -1
    s_mov_b32 s23, 0
    s_add_u32 s26, s26, 896
ywn_155:
    s_nop 7
    v_cvt_pk_bf16_f32 v96, v80, v81
    v_cvt_pk_bf16_f32 v97, v82, v83
    v_cvt_pk_bf16_f32 v98, v88, v89
    v_cvt_pk_bf16_f32 v99, v90, v91
    buffer_store_dwordx4 v[96:99], v3, s[4:7], s21 offen offset:0 sc1
    v_cvt_pk_bf16_f32 v100, v84, v85
    v_cvt_pk_bf16_f32 v101, v86, v87
    v_cvt_pk_bf16_f32 v102, v92, v93
    v_cvt_pk_bf16_f32 v103, v94, v95
    buffer_store_dwordx4 v[100:103], v3, s[4:7], s21 offen offset:1024 sc1
    s_add_u32 s24, s24, 16384
    s_add_u32 s21, s21, 229376
    s_add_u32 s27, s27, 2
    s_lshr_b32 s23, s27, 1
    s_cmp_ge_u32 s31, s27
    s_cbranch_scc1 ywd_156
    s_waitcnt vmcnt(0)
    v_mov_b32 v6, s23
    s_mov_b64 exec, 1
    buffer_store_dword v6, v7, s[4:7], s26 offen sc1
    s_mov_b64 exec, -1
    s_mov_b32 s23, 0
    s_add_u32 s26, s26, 896
ywd_156:
    s_cmp_lt_u32 s27, 64
    s_cbranch_scc1 yw_153
    s_branch k2_end
k2_so:
    s_cmp_ge_u32 s92, 19
    s_cbranch_scc1 k2_ow
    s_mul_i32 s97, s91, 19
    s_add_u32 s97, s97, s92
    s_cmp_ge_u32 s97, 128
    s_cbranch_scc1 k2_end
    s_lshr_b32 s32, s97, 3
    s_and_b32 s33, s97, 7
k2_sitem:
    s_lshl_b32 s16, s33, 2
    s_add_u32 s16, s16, s3
    s_mul_i32 s17, s16, 28672
    s_add_u32 s18, s17, 1835008
    s_mul_i32 s19, s32, 401408
    s_mul_i32 s21, s3, 7168
    s_add_u32 s19, s19, s21
    s_add_u32 s19, s19, 5505024
    s_barrier
    s_add_u32 s22, s21, 0
    s_mov_b32 m0, s22
    s_add_u32 s23, s19, 0
    buffer_load_dwordx4 v1, s[4:7], s23 offen offset:0 lds
    buffer_load_dwordx4 v1, s[4:7], s23 offen offset:1024 lds
    buffer_load_dwordx4 v1, s[4:7], s23 offen offset:2048 lds
    buffer_load_dwordx4 v1, s[4:7], s23 offen offset:3072 lds
    s_add_u32 s22, s21, 4096
    s_mov_b32 m0, s22
    s_add_u32 s23, s19, 4096
    buffer_load_dwordx4 v1, s[4:7], s23 offen offset:0 lds
    buffer_load_dwordx4 v1, s[4:7], s23 offen offset:1024 lds
    buffer_load_dwordx4 v1, s[4:7], s23 offen offset:2048 lds
    s_add_u32 s22, s21, 28672
    s_mov_b32 m0, s22
    s_add_u32 s23, s19, 28672
    buffer_load_dwordx4 v1, s[4:7], s23 offen offset:0 lds
    buffer_load_dwordx4 v1, s[4:7], s23 offen offset:1024 lds
    buffer_load_dwordx4 v1, s[4:7], s23 offen offset:2048 lds
    buffer_load_dwordx4 v1, s[4:7], s23 offen offset:3072 lds
    s_add_u32 s22, s21, 32768
    s_mov_b32 m0, s22
    s_add_u32 s23, s19, 32768
    buffer_load_dwordx4 v1, s[4:7], s23 offen offset:0 lds
    buffer_load_dwordx4 v1, s[4:7], s23 offen offset:1024 lds
    buffer_load_dwordx4 v1, s[4:7], s23 offen offset:2048 lds
    s_add_u32 s22, s21, 57344
    s_mov_b32 m0, s22
    s_add_u32 s23, s19, 57344
    buffer_load_dwordx4 v1, s[4:7], s23 offen offset:0 lds
    buffer_load_dwordx4 v1, s[4:7], s23 offen offset:1024 lds
    buffer_load_dwordx4 v1, s[4:7], s23 offen offset:2048 lds
    buffer_load_dwordx4 v1, s[4:7], s23 offen offset:3072 lds
    s_add_u32 s22, s21, 61440
    s_mov_b32 m0, s22
    s_add_u32 s23, s19, 61440
    buffer_load_dwordx4 v1, s[4:7], s23 offen offset:0 lds
    buffer_load_dwordx4 v1, s[4:7], s23 offen offset:1024 lds
    buffer_load_dwordx4 v1, s[4:7], s23 offen offset:2048 lds
    s_mov_b32 s20, s18
    buffer_load_dwordx4 a[0:3], v1, s[4:7], s20 offen offset:0
    buffer_load_dwordx4 a[4:7], v1, s[4:7], s20 offen offset:1024
    buffer_load_dwordx4 a[8:11], v1, s[4:7], s20 offen offset:2048
    buffer_load_dwordx4 a[12:15], v1, s[4:7], s20 offen offset:3072
    s_add_u32 s20, s20, 4096
    buffer_load_dwordx4 a[16:19], v1, s[4:7], s20 offen offset:0
    buffer_load_dwordx4 a[20:23], v1, s[4:7], s20 offen offset:1024
    buffer_load_dwordx4 a[24:27], v1, s[4:7], s20 offen offset:2048
    buffer_load_dwordx4 a[28:31], v1, s[4:7], s20 offen offset:3072
    s_add_u32 s20, s20, 4096
    buffer_load_dwordx4 a[32:35], v1, s[4:7], s20 offen offset:0
    buffer_load_dwordx4 a[36:39], v1, s[4:7], s20 offen offset:1024
    buffer_load_dwordx4 a[40:43], v1, s[4:7], s20 offen offset:2048
    buffer_load_dwordx4 a[44:47], v1, s[4:7], s20 offen offset:3072
    s_add_u32 s20, s20, 4096
    buffer_load_dwordx4 a[48:51], v1, s[4:7], s20 offen offset:0
    buffer_load_dwordx4 a[52:55], v1, s[4:7], s20 offen offset:1024
    buffer_load_dwordx4 a[56:59], v1, s[4:7], s20 offen offset:2048
    buffer_load_dwordx4 a[60:63], v1, s[4:7], s20 offen offset:3072
    s_add_u32 s20, s20, 4096
    buffer_load_dwordx4 a[64:67], v1, s[4:7], s20 offen offset:0
    buffer_load_dwordx4 a[68:71], v1, s[4:7], s20 offen offset:1024
    buffer_load_dwordx4 a[72:75], v1, s[4:7], s20 offen offset:2048
    buffer_load_dwordx4 a[76:79], v1, s[4:7], s20 offen offset:3072
    s_add_u32 s20, s20, 4096
    buffer_load_dwordx4 a[80:83], v1, s[4:7], s20 offen offset:0
    buffer_load_dwordx4 a[84:87], v1, s[4:7], s20 offen offset:1024
    buffer_load_dwordx4 a[88:91], v1, s[4:7], s20 offen offset:2048
    buffer_load_dwordx4 a[92:95], v1, s[4:7], s20 offen offset:3072
    s_add_u32 s20, s20, 4096
    buffer_load_dwordx4 a[96:99], v1, s[4:7], s20 offen offset:0
    buffer_load_dwordx4 a[100:103], v1, s[4:7], s20 offen offset:1024
    buffer_load_dwordx4 a[104:107], v1, s[4:7], s20 offen offset:2048
    buffer_load_dwordx4 a[108:111], v1, s[4:7], s20 offen offset:3072
    v_lshrrev_b32 v3, 4, v0
    v_and_b32 v2, 1, v3
    v_lshlrev_b32 v2, 9, v2
    v_lshrrev_b32 v3, 1, v3
    v_lshl_add_u32 v2, v3, 8, v2
    v_and_b32 v3, 15, v0
    v_lshl_add_u32 v2, v3, 4, v2
    s_add_u32 s20, s18, 0
    buffer_load_dwordx4 v[144:147], v2, s[4:7], s20 offen offset:0
    buffer_load_dwordx4 v[148:151], v2, s[4:7], s20 offen offset:1024
    buffer_load_dwordx4 v[152:155], v2, s[4:7], s20 offen offset:2048
    buffer_load_dwordx4 v[156:159], v2, s[4:7], s20 offen offset:3072
    s_add_u32 s20, s18, 4096
    buffer_load_dwordx4 v[160:163], v2, s[4:7], s20 offen offset:0
    buffer_load_dwordx4 v[164:167], v2, s[4:7], s20 offen offset:1024
    buffer_load_dwordx4 v[168:171], v2, s[4:7], s20 offen offset:2048
    buffer_load_dwordx4 v[172:175], v2, s[4:7], s20 offen offset:3072
    s_add_u32 s20, s18, 8192
    buffer_load_dwordx4 v[176:179], v2, s[4:7], s20 offen offset:0
    buffer_load_dwordx4 v[180:183], v2, s[4:7], s20 offen offset:1024
    buffer_load_dwordx4 v[184:187], v2, s[4:7], s20 offen offset:2048
    buffer_load_dwordx4 v[188:191], v2, s[4:7], s20 offen offset:3072
    s_add_u32 s20, s18, 12288
    buffer_load_dwordx4 v[192:195], v2, s[4:7], s20 offen offset:0
    buffer_load_dwordx4 v[196:199], v2, s[4:7], s20 offen offset:1024
    buffer_load_dwordx4 v[200:203], v2, s[4:7], s20 offen offset:2048
    buffer_load_dwordx4 v[204:207], v2, s[4:7], s20 offen offset:3072
    s_add_u32 s20, s18, 16384
    buffer_load_dwordx4 v[208:211], v2, s[4:7], s20 offen offset:0
    buffer_load_dwordx4 v[212:215], v2, s[4:7], s20 offen offset:1024
    buffer_load_dwordx4 v[216:219], v2, s[4:7], s20 offen offset:2048
    buffer_load_dwordx4 v[220:223], v2, s[4:7], s20 offen offset:3072
    s_add_u32 s20, s18, 20480
    buffer_load_dwordx4 v[224:227], v2, s[4:7], s20 offen offset:0
    buffer_load_dwordx4 v[228:231], v2, s[4:7], s20 offen offset:1024
    buffer_load_dwordx4 v[232:235], v2, s[4:7], s20 offen offset:2048
    buffer_load_dwordx4 v[236:239], v2, s[4:7], s20 offen offset:3072
    s_add_u32 s20, s18, 24576
    buffer_load_dwordx4 v[240:243], v2, s[4:7], s20 offen offset:0
    buffer_load_dwordx4 v[244:247], v2, s[4:7], s20 offen offset:1024
    buffer_load_dwordx4 v[248:251], v2, s[4:7], s20 offen offset:2048
    buffer_load_dwordx4 v[252:255], v2, s[4:7], s20 offen offset:3072
    s_waitcnt vmcnt(0)
    v_permlane32_swap_b32 v144, v146
    v_permlane32_swap_b32 v145, v147
    v_permlane32_swap_b32 v148, v150
    v_permlane32_swap_b32 v149, v151
    v_permlane32_swap_b32 v152, v154
    v_permlane32_swap_b32 v153, v155
    v_permlane32_swap_b32 v156, v158
    v_permlane32_swap_b32 v157, v159
    v_permlane32_swap_b32 v160, v162
    v_permlane32_swap_b32 v161, v163
    v_permlane32_swap_b32 v164, v166
    v_permlane32_swap_b32 v165, v167
    v_permlane32_swap_b32 v168, v170
    v_permlane32_swap_b32 v169, v171
    v_permlane32_swap_b32 v172, v174
    v_permlane32_swap_b32 v173, v175
    v_permlane32_swap_b32 v176, v178
    v_permlane32_swap_b32 v177, v179
    v_permlane32_swap_b32 v180, v182
    v_permlane32_swap_b32 v181, v183
    v_permlane32_swap_b32 v184, v186
    v_permlane32_swap_b32 v185, v187
    v_permlane32_swap_b32 v188, v190
    v_permlane32_swap_b32 v189, v191
    v_permlane32_swap_b32 v192, v194
    v_permlane32_swap_b32 v193, v195
    v_permlane32_swap_b32 v196, v198
    v_permlane32_swap_b32 v197, v199
    v_permlane32_swap_b32 v200, v202
    v_permlane32_swap_b32 v201, v203
    v_permlane32_swap_b32 v204, v206
    v_permlane32_swap_b32 v205, v207
    v_permlane32_swap_b32 v208, v210
    v_permlane32_swap_b32 v209, v211
    v_permlane32_swap_b32 v212, v214
    v_permlane32_swap_b32 v213, v215
    v_permlane32_swap_b32 v216, v218
    v_permlane32_swap_b32 v217, v219
    v_permlane32_swap_b32 v220, v222
    v_permlane32_swap_b32 v221, v223
    v_permlane32_swap_b32 v224, v226
    v_permlane32_swap_b32 v225, v227
    v_permlane32_swap_b32 v228, v230
    v_permlane32_swap_b32 v229, v231
    v_permlane32_swap_b32 v232, v234
    v_permlane32_swap_b32 v233, v235
    v_permlane32_swap_b32 v236, v238
    v_permlane32_swap_b32 v237, v239
    v_permlane32_swap_b32 v240, v242
    v_permlane32_swap_b32 v241, v243
    v_permlane32_swap_b32 v244, v246
    v_permlane32_swap_b32 v245, v247
    v_permlane32_swap_b32 v248, v250
    v_permlane32_swap_b32 v249, v251
    v_permlane32_swap_b32 v252, v254
    v_permlane32_swap_b32 v253, v255
    v_accvgpr_write_b32 a112, v144
    v_accvgpr_write_b32 a113, v145
    v_accvgpr_write_b32 a114, v146
    v_accvgpr_write_b32 a115, v147
    v_accvgpr_write_b32 a116, v148
    v_accvgpr_write_b32 a117, v149
    v_accvgpr_write_b32 a118, v150
    v_accvgpr_write_b32 a119, v151
    v_accvgpr_write_b32 a120, v152
    v_accvgpr_write_b32 a121, v153
    v_accvgpr_write_b32 a122, v154
    v_accvgpr_write_b32 a123, v155
    v_accvgpr_write_b32 a124, v156
    v_accvgpr_write_b32 a125, v157
    v_accvgpr_write_b32 a126, v158
    v_accvgpr_write_b32 a127, v159
    v_accvgpr_write_b32 a128, v160
    v_accvgpr_write_b32 a129, v161
    v_accvgpr_write_b32 a130, v162
    v_accvgpr_write_b32 a131, v163
    v_accvgpr_write_b32 a132, v164
    v_accvgpr_write_b32 a133, v165
    v_accvgpr_write_b32 a134, v166
    v_accvgpr_write_b32 a135, v167
    v_accvgpr_write_b32 a136, v168
    v_accvgpr_write_b32 a137, v169
    v_accvgpr_write_b32 a138, v170
    v_accvgpr_write_b32 a139, v171
    v_accvgpr_write_b32 a140, v172
    v_accvgpr_write_b32 a141, v173
    v_accvgpr_write_b32 a142, v174
    v_accvgpr_write_b32 a143, v175
    v_accvgpr_write_b32 a144, v176
    v_accvgpr_write_b32 a145, v177
    v_accvgpr_write_b32 a146, v178
    v_accvgpr_write_b32 a147, v179
    v_accvgpr_write_b32 a148, v180
    v_accvgpr_write_b32 a149, v181
    v_accvgpr_write_b32 a150, v182
    v_accvgpr_write_b32 a151, v183
    v_accvgpr_write_b32 a152, v184
    v_accvgpr_write_b32 a153, v185
    v_accvgpr_write_b32 a154, v186
    v_accvgpr_write_b32 a155, v187
    v_accvgpr_write_b32 a156, v188
    v_accvgpr_write_b32 a157, v189
    v_accvgpr_write_b32 a158, v190
    v_accvgpr_write_b32 a159, v191
    v_accvgpr_write_b32 a160, v192
    v_accvgpr_write_b32 a161, v193
    v_accvgpr_write_b32 a162, v194
    v_accvgpr_write_b32 a163, v195
    v_accvgpr_write_b32 a164, v196
    v_accvgpr_write_b32 a165, v197
    v_accvgpr_write_b32 a166, v198
    v_accvgpr_write_b32 a167, v199
    v_accvgpr_write_b32 a168, v200
    v_accvgpr_write_b32 a169, v201
    v_accvgpr_write_b32 a170, v202
    v_accvgpr_write_b32 a171, v203
    v_accvgpr_write_b32 a172, v204
    v_accvgpr_write_b32 a173, v205
    v_accvgpr_write_b32 a174, v206
    v_accvgpr_write_b32 a175, v207
    v_accvgpr_write_b32 a176, v208
    v_accvgpr_write_b32 a177, v209
    v_accvgpr_write_b32 a178, v210
    v_accvgpr_write_b32 a179, v211
    v_accvgpr_write_b32 a180, v212
    v_accvgpr_write_b32 a181, v213
    v_accvgpr_write_b32 a182, v214
    v_accvgpr_write_b32 a183, v215
    v_accvgpr_write_b32 a184, v216
    v_accvgpr_write_b32 a185, v217
    v_accvgpr_write_b32 a186, v218
    v_accvgpr_write_b32 a187, v219
    v_accvgpr_write_b32 a188, v220
    v_accvgpr_write_b32 a189, v221
    v_accvgpr_write_b32 a190, v222
    v_accvgpr_write_b32 a191, v223
    v_accvgpr_write_b32 a192, v224
    v_accvgpr_write_b32 a193, v225
    v_accvgpr_write_b32 a194, v226
    v_accvgpr_write_b32 a195, v227
    v_accvgpr_write_b32 a196, v228
    v_accvgpr_write_b32 a197, v229
    v_accvgpr_write_b32 a198, v230
    v_accvgpr_write_b32 a199, v231
    v_accvgpr_write_b32 a200, v232
    v_accvgpr_write_b32 a201, v233
    v_accvgpr_write_b32 a202, v234
    v_accvgpr_write_b32 a203, v235
    v_accvgpr_write_b32 a204, v236
    v_accvgpr_write_b32 a205, v237
    v_accvgpr_write_b32 a206, v238
    v_accvgpr_write_b32 a207, v239
    v_accvgpr_write_b32 a208, v240
    v_accvgpr_write_b32 a209, v241
    v_accvgpr_write_b32 a210, v242
    v_accvgpr_write_b32 a211, v243
    v_accvgpr_write_b32 a212, v244
    v_accvgpr_write_b32 a213, v245
    v_accvgpr_write_b32 a214, v246
    v_accvgpr_write_b32 a215, v247
    v_accvgpr_write_b32 a216, v248
    v_accvgpr_write_b32 a217, v249
    v_accvgpr_write_b32 a218, v250
    v_accvgpr_write_b32 a219, v251
    v_accvgpr_write_b32 a220, v252
    v_accvgpr_write_b32 a221, v253
    v_accvgpr_write_b32 a222, v254
    v_accvgpr_write_b32 a223, v255
    s_waitcnt vmcnt(0)
    s_barrier
    s_add_u32 s22, s21, 86016
    s_mov_b32 m0, s22
    s_add_u32 s23, s19, 86016
    buffer_load_dwordx4 v1, s[4:7], s23 offen offset:0 lds
    buffer_load_dwordx4 v1, s[4:7], s23 offen offset:1024 lds
    buffer_load_dwordx4 v1, s[4:7], s23 offen offset:2048 lds
    buffer_load_dwordx4 v1, s[4:7], s23 offen offset:3072 lds
    s_add_u32 s22, s21, 90112
    s_mov_b32 m0, s22
    s_add_u32 s23, s19, 90112
    buffer_load_dwordx4 v1, s[4:7], s23 offen offset:0 lds
    buffer_load_dwordx4 v1, s[4:7], s23 offen offset:1024 lds
    buffer_load_dwordx4 v1, s[4:7], s23 offen offset:2048 lds
    ds_read_b128 v[56:59], v1 offset:0
    ds_read_b128 v[60:63], v1 offset:1024
    ds_read_b128 v[64:67], v1 offset:2048
    ds_read_b128 v[68:71], v1 offset:3072
    ds_read_b128 v[72:75], v1 offset:4096
    ds_read_b128 v[76:79], v1 offset:5120
    ds_read_b128 v[80:83], v1 offset:6144
    ds_read_b128 v[84:87], v1 offset:7168
    ds_read_b128 v[88:91], v1 offset:8192
    ds_read_b128 v[92:95], v1 offset:9216
    ds_read_b128 v[96:99], v1 offset:10240
    ds_read_b128 v[100:103], v1 offset:11264
    ds_read_b128 v[104:107], v1 offset:12288
    ds_read_b128 v[108:111], v1 offset:13312
    s_waitcnt lgkmcnt(13)
    v_mfma_f32_16x16x32_bf16 v[16:19], v[56:59], a[0:3], 0
    v_mfma_f32_16x16x32_bf16 v[20:23], v[56:59], a[56:59], 0
    s_waitcnt lgkmcnt(12)
    v_mfma_f32_16x16x32_bf16 v[16:19], v[60:63], a[4:7], v[16:19]
    v_mfma_f32_16x16x32_bf16 v[20:23], v[60:63], a[60:63], v[20:23]
    s_waitcnt lgkmcnt(11)
    v_mfma_f32_16x16x32_bf16 v[16:19], v[64:67], a[8:11], v[16:19]
    v_mfma_f32_16x16x32_bf16 v[20:23], v[64:67], a[64:67], v[20:23]
    s_waitcnt lgkmcnt(10)
    v_mfma_f32_16x16x32_bf16 v[16:19], v[68:71], a[12:15], v[16:19]
    v_mfma_f32_16x16x32_bf16 v[20:23], v[68:71], a[68:71], v[20:23]
    s_waitcnt lgkmcnt(9)
    v_mfma_f32_16x16x32_bf16 v[16:19], v[72:75], a[16:19], v[16:19]
    v_mfma_f32_16x16x32_bf16 v[20:23], v[72:75], a[72:75], v[20:23]
    s_waitcnt lgkmcnt(8)
    v_mfma_f32_16x16x32_bf16 v[16:19], v[76:79], a[20:23], v[16:19]
    v_mfma_f32_16x16x32_bf16 v[20:23], v[76:79], a[76:79], v[20:23]
    s_waitcnt lgkmcnt(7)
    v_mfma_f32_16x16x32_bf16 v[16:19], v[80:83], a[24:27], v[16:19]
    v_mfma_f32_16x16x32_bf16 v[20:23], v[80:83], a[80:83], v[20:23]
    s_waitcnt lgkmcnt(6)
    v_mfma_f32_16x16x32_bf16 v[16:19], v[84:87], a[28:31], v[16:19]
    v_mfma_f32_16x16x32_bf16 v[20:23], v[84:87], a[84:87], v[20:23]
    s_waitcnt lgkmcnt(5)
    v_mfma_f32_16x16x32_bf16 v[16:19], v[88:91], a[32:35], v[16:19]
    v_mfma_f32_16x16x32_bf16 v[20:23], v[88:91], a[88:91], v[20:23]
    s_waitcnt lgkmcnt(4)
    v_mfma_f32_16x16x32_bf16 v[16:19], v[92:95], a[36:39], v[16:19]
    v_mfma_f32_16x16x32_bf16 v[20:23], v[92:95], a[92:95], v[20:23]
    s_waitcnt lgkmcnt(3)
    v_mfma_f32_16x16x32_bf16 v[16:19], v[96:99], a[40:43], v[16:19]
    v_mfma_f32_16x16x32_bf16 v[20:23], v[96:99], a[96:99], v[20:23]
    s_waitcnt lgkmcnt(2)
    v_mfma_f32_16x16x32_bf16 v[16:19], v[100:103], a[44:47], v[16:19]
    v_mfma_f32_16x16x32_bf16 v[20:23], v[100:103], a[100:103], v[20:23]
    s_waitcnt lgkmcnt(1)
    v_mfma_f32_16x16x32_bf16 v[16:19], v[104:107], a[48:51], v[16:19]
    v_mfma_f32_16x16x32_bf16 v[20:23], v[104:107], a[104:107], v[20:23]
    s_waitcnt lgkmcnt(0)
    v_mfma_f32_16x16x32_bf16 v[16:19], v[108:111], a[52:55], v[16:19]
    v_mfma_f32_16x16x32_bf16 v[20:23], v[108:111], a[108:111], v[20:23]
    ds_read_b128 v[56:59], v1 offset:14336
    ds_read_b128 v[60:63], v1 offset:15360
    ds_read_b128 v[64:67], v1 offset:16384
    ds_read_b128 v[68:71], v1 offset:17408
    ds_read_b128 v[72:75], v1 offset:18432
    ds_read_b128 v[76:79], v1 offset:19456
    ds_read_b128 v[80:83], v1 offset:20480
    ds_read_b128 v[84:87], v1 offset:21504
    ds_read_b128 v[88:91], v1 offset:22528
    ds_read_b128 v[92:95], v1 offset:23552
    ds_read_b128 v[96:99], v1 offset:24576
    ds_read_b128 v[100:103], v1 offset:25600
    ds_read_b128 v[104:107], v1 offset:26624
    ds_read_b128 v[108:111], v1 offset:27648
    s_waitcnt lgkmcnt(13)
    v_mfma_f32_16x16x32_bf16 v[24:27], v[56:59], a[0:3], 0
    v_mfma_f32_16x16x32_bf16 v[28:31], v[56:59], a[56:59], 0
    s_waitcnt lgkmcnt(12)
    v_mfma_f32_16x16x32_bf16 v[24:27], v[60:63], a[4:7], v[24:27]
    v_mfma_f32_16x16x32_bf16 v[28:31], v[60:63], a[60:63], v[28:31]
    s_waitcnt lgkmcnt(11)
    v_mfma_f32_16x16x32_bf16 v[24:27], v[64:67], a[8:11], v[24:27]
    v_mfma_f32_16x16x32_bf16 v[28:31], v[64:67], a[64:67], v[28:31]
    s_waitcnt lgkmcnt(10)
    v_mfma_f32_16x16x32_bf16 v[24:27], v[68:71], a[12:15], v[24:27]
    v_mfma_f32_16x16x32_bf16 v[28:31], v[68:71], a[68:71], v[28:31]
    s_waitcnt lgkmcnt(9)
    v_mfma_f32_16x16x32_bf16 v[24:27], v[72:75], a[16:19], v[24:27]
    v_mfma_f32_16x16x32_bf16 v[28:31], v[72:75], a[72:75], v[28:31]
    s_waitcnt lgkmcnt(8)
    v_mfma_f32_16x16x32_bf16 v[24:27], v[76:79], a[20:23], v[24:27]
    v_mfma_f32_16x16x32_bf16 v[28:31], v[76:79], a[76:79], v[28:31]
    s_waitcnt lgkmcnt(7)
    v_mfma_f32_16x16x32_bf16 v[24:27], v[80:83], a[24:27], v[24:27]
    v_mfma_f32_16x16x32_bf16 v[28:31], v[80:83], a[80:83], v[28:31]
    s_waitcnt lgkmcnt(6)
    v_mfma_f32_16x16x32_bf16 v[24:27], v[84:87], a[28:31], v[24:27]
    v_mfma_f32_16x16x32_bf16 v[28:31], v[84:87], a[84:87], v[28:31]
    s_waitcnt lgkmcnt(5)
    v_mfma_f32_16x16x32_bf16 v[24:27], v[88:91], a[32:35], v[24:27]
    v_mfma_f32_16x16x32_bf16 v[28:31], v[88:91], a[88:91], v[28:31]
    s_waitcnt lgkmcnt(4)
    v_mfma_f32_16x16x32_bf16 v[24:27], v[92:95], a[36:39], v[24:27]
    v_mfma_f32_16x16x32_bf16 v[28:31], v[92:95], a[92:95], v[28:31]
    s_waitcnt lgkmcnt(3)
    v_mfma_f32_16x16x32_bf16 v[24:27], v[96:99], a[40:43], v[24:27]
    v_mfma_f32_16x16x32_bf16 v[28:31], v[96:99], a[96:99], v[28:31]
    s_waitcnt lgkmcnt(2)
    v_mfma_f32_16x16x32_bf16 v[24:27], v[100:103], a[44:47], v[24:27]
    v_mfma_f32_16x16x32_bf16 v[28:31], v[100:103], a[100:103], v[28:31]
    s_waitcnt lgkmcnt(1)
    v_mfma_f32_16x16x32_bf16 v[24:27], v[104:107], a[48:51], v[24:27]
    v_mfma_f32_16x16x32_bf16 v[28:31], v[104:107], a[104:107], v[28:31]
    s_waitcnt lgkmcnt(0)
    v_mfma_f32_16x16x32_bf16 v[24:27], v[108:111], a[52:55], v[24:27]
    v_mfma_f32_16x16x32_bf16 v[28:31], v[108:111], a[108:111], v[28:31]
    s_nop 7
    v_cvt_pk_bf16_f32 v144, v16, v24
    v_cvt_pk_bf16_f32 v145, v17, v25
    v_cvt_pk_bf16_f32 v146, v18, v26
    v_cvt_pk_bf16_f32 v147, v19, v27
    v_cvt_pk_bf16_f32 v148, v20, v28
    v_cvt_pk_bf16_f32 v149, v21, v29
    v_cvt_pk_bf16_f32 v150, v22, v30
    v_cvt_pk_bf16_f32 v151, v23, v31
    s_nop 1
    v_mfma_f32_16x16x32_bf16 v[32:35], a[112:115], v[144:147], 0
    v_mfma_f32_16x16x32_bf16 v[36:39], a[112:115], v[148:151], 0
    v_mfma_f32_16x16x32_bf16 v[40:43], a[168:171], v[148:151], 0
    s_barrier
    s_add_u32 s22, s21, 0
    s_mov_b32 m0, s22
    s_add_u32 s23, s19, 114688
    buffer_load_dwordx4 v1, s[4:7], s23 offen offset:0 lds
    buffer_load_dwordx4 v1, s[4:7], s23 offen offset:1024 lds
    buffer_load_dwordx4 v1, s[4:7], s23 offen offset:2048 lds
    buffer_load_dwordx4 v1, s[4:7], s23 offen offset:3072 lds
    s_add_u32 s22, s21, 4096
    s_mov_b32 m0, s22
    s_add_u32 s23, s19, 118784
    buffer_load_dwordx4 v1, s[4:7], s23 offen offset:0 lds
    buffer_load_dwordx4 v1, s[4:7], s23 offen offset:1024 lds
    buffer_load_dwordx4 v1, s[4:7], s23 offen offset:2048 lds
    ds_read_b128 v[56:59], v1 offset:28672
    ds_read_b128 v[60:63], v1 offset:29696
    ds_read_b128 v[64:67], v1 offset:30720
    ds_read_b128 v[68:71], v1 offset:31744
    ds_read_b128 v[72:75], v1 offset:32768
    ds_read_b128 v[76:79], v1 offset:33792
    ds_read_b128 v[80:83], v1 offset:34816
    ds_read_b128 v[84:87], v1 offset:35840
    ds_read_b128 v[88:91], v1 offset:36864
    ds_read_b128 v[92:95], v1 offset:37888
    ds_read_b128 v[96:99], v1 offset:38912
    ds_read_b128 v[100:103], v1 offset:39936
    ds_read_b128 v[104:107], v1 offset:40960
    ds_read_b128 v[108:111], v1 offset:41984
    s_waitcnt lgkmcnt(13)
    v_mfma_f32_16x16x32_bf16 v[16:19], v[56:59], a[0:3], 0
    v_mfma_f32_16x16x32_bf16 v[20:23], v[56:59], a[56:59], 0
    s_waitcnt lgkmcnt(12)
    v_mfma_f32_16x16x32_bf16 v[16:19], v[60:63], a[4:7], v[16:19]
    v_mfma_f32_16x16x32_bf16 v[20:23], v[60:63], a[60:63], v[20:23]
    s_waitcnt lgkmcnt(11)
    v_mfma_f32_16x16x32_bf16 v[16:19], v[64:67], a[8:11], v[16:19]
    v_mfma_f32_16x16x32_bf16 v[20:23], v[64:67], a[64:67], v[20:23]
    s_waitcnt lgkmcnt(10)
    v_mfma_f32_16x16x32_bf16 v[16:19], v[68:71], a[12:15], v[16:19]
    v_mfma_f32_16x16x32_bf16 v[20:23], v[68:71], a[68:71], v[20:23]
    s_waitcnt lgkmcnt(9)
    v_mfma_f32_16x16x32_bf16 v[16:19], v[72:75], a[16:19], v[16:19]
    v_mfma_f32_16x16x32_bf16 v[20:23], v[72:75], a[72:75], v[20:23]
    s_waitcnt lgkmcnt(8)
    v_mfma_f32_16x16x32_bf16 v[16:19], v[76:79], a[20:23], v[16:19]
    v_mfma_f32_16x16x32_bf16 v[20:23], v[76:79], a[76:79], v[20:23]
    s_waitcnt lgkmcnt(7)
    v_mfma_f32_16x16x32_bf16 v[16:19], v[80:83], a[24:27], v[16:19]
    v_mfma_f32_16x16x32_bf16 v[20:23], v[80:83], a[80:83], v[20:23]
    s_waitcnt lgkmcnt(6)
    v_mfma_f32_16x16x32_bf16 v[16:19], v[84:87], a[28:31], v[16:19]
    v_mfma_f32_16x16x32_bf16 v[20:23], v[84:87], a[84:87], v[20:23]
    s_waitcnt lgkmcnt(5)
    v_mfma_f32_16x16x32_bf16 v[16:19], v[88:91], a[32:35], v[16:19]
    v_mfma_f32_16x16x32_bf16 v[20:23], v[88:91], a[88:91], v[20:23]
    s_waitcnt lgkmcnt(4)
    v_mfma_f32_16x16x32_bf16 v[16:19], v[92:95], a[36:39], v[16:19]
    v_mfma_f32_16x16x32_bf16 v[20:23], v[92:95], a[92:95], v[20:23]
    s_waitcnt lgkmcnt(3)
    v_mfma_f32_16x16x32_bf16 v[16:19], v[96:99], a[40:43], v[16:19]
    v_mfma_f32_16x16x32_bf16 v[20:23], v[96:99], a[96:99], v[20:23]
    s_waitcnt lgkmcnt(2)
    v_mfma_f32_16x16x32_bf16 v[16:19], v[100:103], a[44:47], v[16:19]
    v_mfma_f32_16x16x32_bf16 v[20:23], v[100:103], a[100:103], v[20:23]
    s_waitcnt lgkmcnt(1)
    v_mfma_f32_16x16x32_bf16 v[16:19], v[104:107], a[48:51], v[16:19]
    v_mfma_f32_16x16x32_bf16 v[20:23], v[104:107], a[104:107], v[20:23]
    s_waitcnt lgkmcnt(0)
    v_mfma_f32_16x16x32_bf16 v[16:19], v[108:111], a[52:55], v[16:19]
    v_mfma_f32_16x16x32_bf16 v[20:23], v[108:111], a[108:111], v[20:23]
    ds_read_b128 v[56:59], v1 offset:43008
    ds_read_b128 v[60:63], v1 offset:44032
    ds_read_b128 v[64:67], v1 offset:45056
    ds_read_b128 v[68:71], v1 offset:46080
    ds_read_b128 v[72:75], v1 offset:47104
    ds_read_b128 v[76:79], v1 offset:48128
    ds_read_b128 v[80:83], v1 offset:49152
    ds_read_b128 v[84:87], v1 offset:50176
    ds_read_b128 v[88:91], v1 offset:51200
    ds_read_b128 v[92:95], v1 offset:52224
    ds_read_b128 v[96:99], v1 offset:53248
    ds_read_b128 v[100:103], v1 offset:54272
    ds_read_b128 v[104:107], v1 offset:55296
    ds_read_b128 v[108:111], v1 offset:56320
    s_waitcnt lgkmcnt(13)
    v_mfma_f32_16x16x32_bf16 v[24:27], v[56:59], a[0:3], 0
    v_mfma_f32_16x16x32_bf16 v[28:31], v[56:59], a[56:59], 0
    s_waitcnt lgkmcnt(12)
    v_mfma_f32_16x16x32_bf16 v[24:27], v[60:63], a[4:7], v[24:27]
    v_mfma_f32_16x16x32_bf16 v[28:31], v[60:63], a[60:63], v[28:31]
    s_waitcnt lgkmcnt(11)
    v_mfma_f32_16x16x32_bf16 v[24:27], v[64:67], a[8:11], v[24:27]
    v_mfma_f32_16x16x32_bf16 v[28:31], v[64:67], a[64:67], v[28:31]
    s_waitcnt lgkmcnt(10)
    v_mfma_f32_16x16x32_bf16 v[24:27], v[68:71], a[12:15], v[24:27]
    v_mfma_f32_16x16x32_bf16 v[28:31], v[68:71], a[68:71], v[28:31]
    s_waitcnt lgkmcnt(9)
    v_mfma_f32_16x16x32_bf16 v[24:27], v[72:75], a[16:19], v[24:27]
    v_mfma_f32_16x16x32_bf16 v[28:31], v[72:75], a[72:75], v[28:31]
    s_waitcnt lgkmcnt(8)
    v_mfma_f32_16x16x32_bf16 v[24:27], v[76:79], a[20:23], v[24:27]
    v_mfma_f32_16x16x32_bf16 v[28:31], v[76:79], a[76:79], v[28:31]
    s_waitcnt lgkmcnt(7)
    v_mfma_f32_16x16x32_bf16 v[24:27], v[80:83], a[24:27], v[24:27]
    v_mfma_f32_16x16x32_bf16 v[28:31], v[80:83], a[80:83], v[28:31]
    s_waitcnt lgkmcnt(6)
    v_mfma_f32_16x16x32_bf16 v[24:27], v[84:87], a[28:31], v[24:27]
    v_mfma_f32_16x16x32_bf16 v[28:31], v[84:87], a[84:87], v[28:31]
    s_waitcnt lgkmcnt(5)
    v_mfma_f32_16x16x32_bf16 v[24:27], v[88:91], a[32:35], v[24:27]
    v_mfma_f32_16x16x32_bf16 v[28:31], v[88:91], a[88:91], v[28:31]
    s_waitcnt lgkmcnt(4)
    v_mfma_f32_16x16x32_bf16 v[24:27], v[92:95], a[36:39], v[24:27]
    v_mfma_f32_16x16x32_bf16 v[28:31], v[92:95], a[92:95], v[28:31]
    s_waitcnt lgkmcnt(3)
    v_mfma_f32_16x16x32_bf16 v[24:27], v[96:99], a[40:43], v[24:27]
    v_mfma_f32_16x16x32_bf16 v[28:31], v[96:99], a[96:99], v[28:31]
    s_waitcnt lgkmcnt(2)
    v_mfma_f32_16x16x32_bf16 v[24:27], v[100:103], a[44:47], v[24:27]
    v_mfma_f32_16x16x32_bf16 v[28:31], v[100:103], a[100:103], v[28:31]
    s_waitcnt lgkmcnt(1)
    v_mfma_f32_16x16x32_bf16 v[24:27], v[104:107], a[48:51], v[24:27]
    v_mfma_f32_16x16x32_bf16 v[28:31], v[104:107], a[104:107], v[28:31]
    s_waitcnt lgkmcnt(0)
    v_mfma_f32_16x16x32_bf16 v[24:27], v[108:111], a[52:55], v[24:27]
    v_mfma_f32_16x16x32_bf16 v[28:31], v[108:111], a[108:111], v[28:31]
    s_nop 7
    v_cvt_pk_bf16_f32 v152, v16, v24
    v_cvt_pk_bf16_f32 v153, v17, v25
    v_cvt_pk_bf16_f32 v154, v18, v26
    v_cvt_pk_bf16_f32 v155, v19, v27
    v_cvt_pk_bf16_f32 v156, v20, v28
    v_cvt_pk_bf16_f32 v157, v21, v29
    v_cvt_pk_bf16_f32 v158, v22, v30
    v_cvt_pk_bf16_f32 v159, v23, v31
    s_nop 1
    v_mfma_f32_16x16x32_bf16 v[32:35], a[116:119], v[152:155], v[32:35]
    v_mfma_f32_16x16x32_bf16 v[36:39], a[116:119], v[156:159], v[36:39]
    v_mfma_f32_16x16x32_bf16 v[40:43], a[172:175], v[156:159], v[40:43]
    s_barrier
    s_add_u32 s22, s21, 28672
    s_mov_b32 m0, s22
    s_add_u32 s23, s19, 143360
    buffer_load_dwordx4 v1, s[4:7], s23 offen offset:0 lds
    buffer_load_dwordx4 v1, s[4:7], s23 offen offset:1024 lds
    buffer_load_dwordx4 v1, s[4:7], s23 offen offset:2048 lds
    buffer_load_dwordx4 v1, s[4:7], s23 offen offset:3072 lds
    s_add_u32 s22, s21, 32768
    s_mov_b32 m0, s22
    s_add_u32 s23, s19, 147456
    buffer_load_dwordx4 v1, s[4:7], s23 offen offset:0 lds
    buffer_load_dwordx4 v1, s[4:7], s23 offen offset:1024 lds
    buffer_load_dwordx4 v1, s[4:7], s23 offen offset:2048 lds
    v_add_u32 v2, 57344, v1
    ds_read_b128 v[56:59], v2 offset:0
    ds_read_b128 v[60:63], v2 offset:1024
    ds_read_b128 v[64:67], v2 offset:2048
    ds_read_b128 v[68:71], v2 offset:3072
    ds_read_b128 v[72:75], v2 offset:4096
    ds_read_b128 v[76:79], v2 offset:5120
    ds_read_b128 v[80:83], v2 offset:6144
    ds_read_b128 v[84:87], v2 offset:7168
    ds_read_b128 v[88:91], v2 offset:8192
    ds_read_b128 v[92:95], v2 offset:9216
    ds_read_b128 v[96:99], v2 offset:10240
    ds_read_b128 v[100:103], v2 offset:11264
    ds_read_b128 v[104:107], v2 offset:12288
    ds_read_b128 v[108:111], v2 offset:13312
    s_waitcnt lgkmcnt(13)
    v_mfma_f32_16x16x32_bf16 v[16:19], v[56:59], a[0:3], 0
    v_mfma_f32_16x16x32_bf16 v[20:23], v[56:59], a[56:59], 0
    s_waitcnt lgkmcnt(12)
    v_mfma_f32_16x16x32_bf16 v[16:19], v[60:63], a[4:7], v[16:19]
    v_mfma_f32_16x16x32_bf16 v[20:23], v[60:63], a[60:63], v[20:23]
    s_waitcnt lgkmcnt(11)
    v_mfma_f32_16x16x32_bf16 v[16:19], v[64:67], a[8:11], v[16:19]
    v_mfma_f32_16x16x32_bf16 v[20:23], v[64:67], a[64:67], v[20:23]
    s_waitcnt lgkmcnt(10)
    v_mfma_f32_16x16x32_bf16 v[16:19], v[68:71], a[12:15], v[16:19]
    v_mfma_f32_16x16x32_bf16 v[20:23], v[68:71], a[68:71], v[20:23]
    s_waitcnt lgkmcnt(9)
    v_mfma_f32_16x16x32_bf16 v[16:19], v[72:75], a[16:19], v[16:19]
    v_mfma_f32_16x16x32_bf16 v[20:23], v[72:75], a[72:75], v[20:23]
    s_waitcnt lgkmcnt(8)
    v_mfma_f32_16x16x32_bf16 v[16:19], v[76:79], a[20:23], v[16:19]
    v_mfma_f32_16x16x32_bf16 v[20:23], v[76:79], a[76:79], v[20:23]
    s_waitcnt lgkmcnt(7)
    v_mfma_f32_16x16x32_bf16 v[16:19], v[80:83], a[24:27], v[16:19]
    v_mfma_f32_16x16x32_bf16 v[20:23], v[80:83], a[80:83], v[20:23]
    s_waitcnt lgkmcnt(6)
    v_mfma_f32_16x16x32_bf16 v[16:19], v[84:87], a[28:31], v[16:19]
    v_mfma_f32_16x16x32_bf16 v[20:23], v[84:87], a[84:87], v[20:23]
    s_waitcnt lgkmcnt(5)
    v_mfma_f32_16x16x32_bf16 v[16:19], v[88:91], a[32:35], v[16:19]
    v_mfma_f32_16x16x32_bf16 v[20:23], v[88:91], a[88:91], v[20:23]
    s_waitcnt lgkmcnt(4)
    v_mfma_f32_16x16x32_bf16 v[16:19], v[92:95], a[36:39], v[16:19]
    v_mfma_f32_16x16x32_bf16 v[20:23], v[92:95], a[92:95], v[20:23]
    s_waitcnt lgkmcnt(3)
    v_mfma_f32_16x16x32_bf16 v[16:19], v[96:99], a[40:43], v[16:19]
    v_mfma_f32_16x16x32_bf16 v[20:23], v[96:99], a[96:99], v[20:23]
    s_waitcnt lgkmcnt(2)
    v_mfma_f32_16x16x32_bf16 v[16:19], v[100:103], a[44:47], v[16:19]
    v_mfma_f32_16x16x32_bf16 v[20:23], v[100:103], a[100:103], v[20:23]
    s_waitcnt lgkmcnt(1)
    v_mfma_f32_16x16x32_bf16 v[16:19], v[104:107], a[48:51], v[16:19]
    v_mfma_f32_16x16x32_bf16 v[20:23], v[104:107], a[104:107], v[20:23]
    s_waitcnt lgkmcnt(0)
    v_mfma_f32_16x16x32_bf16 v[16:19], v[108:111], a[52:55], v[16:19]
    v_mfma_f32_16x16x32_bf16 v[20:23], v[108:111], a[108:111], v[20:23]
    ds_read_b128 v[56:59], v2 offset:14336
    ds_read_b128 v[60:63], v2 offset:15360
    ds_read_b128 v[64:67], v2 offset:16384
    ds_read_b128 v[68:71], v2 offset:17408
    ds_read_b128 v[72:75], v2 offset:18432
    ds_read_b128 v[76:79], v2 offset:19456
    ds_read_b128 v[80:83], v2 offset:20480
    ds_read_b128 v[84:87], v2 offset:21504
    ds_read_b128 v[88:91], v2 offset:22528
    ds_read_b128 v[92:95], v2 offset:23552
    ds_read_b128 v[96:99], v2 offset:24576
    ds_read_b128 v[100:103], v2 offset:25600
    ds_read_b128 v[104:107], v2 offset:26624
    ds_read_b128 v[108:111], v2 offset:27648
    s_waitcnt lgkmcnt(13)
    v_mfma_f32_16x16x32_bf16 v[24:27], v[56:59], a[0:3], 0
    v_mfma_f32_16x16x32_bf16 v[28:31], v[56:59], a[56:59], 0
    s_waitcnt lgkmcnt(12)
    v_mfma_f32_16x16x32_bf16 v[24:27], v[60:63], a[4:7], v[24:27]
    v_mfma_f32_16x16x32_bf16 v[28:31], v[60:63], a[60:63], v[28:31]
    s_waitcnt lgkmcnt(11)
    v_mfma_f32_16x16x32_bf16 v[24:27], v[64:67], a[8:11], v[24:27]
    v_mfma_f32_16x16x32_bf16 v[28:31], v[64:67], a[64:67], v[28:31]
    s_waitcnt lgkmcnt(10)
    v_mfma_f32_16x16x32_bf16 v[24:27], v[68:71], a[12:15], v[24:27]
    v_mfma_f32_16x16x32_bf16 v[28:31], v[68:71], a[68:71], v[28:31]
    s_waitcnt lgkmcnt(9)
    v_mfma_f32_16x16x32_bf16 v[24:27], v[72:75], a[16:19], v[24:27]
    v_mfma_f32_16x16x32_bf16 v[28:31], v[72:75], a[72:75], v[28:31]
    s_waitcnt lgkmcnt(8)
    v_mfma_f32_16x16x32_bf16 v[24:27], v[76:79], a[20:23], v[24:27]
    v_mfma_f32_16x16x32_bf16 v[28:31], v[76:79], a[76:79], v[28:31]
    s_waitcnt lgkmcnt(7)
    v_mfma_f32_16x16x32_bf16 v[24:27], v[80:83], a[24:27], v[24:27]
    v_mfma_f32_16x16x32_bf16 v[28:31], v[80:83], a[80:83], v[28:31]
    s_waitcnt lgkmcnt(6)
    v_mfma_f32_16x16x32_bf16 v[24:27], v[84:87], a[28:31], v[24:27]
    v_mfma_f32_16x16x32_bf16 v[28:31], v[84:87], a[84:87], v[28:31]
    s_waitcnt lgkmcnt(5)
    v_mfma_f32_16x16x32_bf16 v[24:27], v[88:91], a[32:35], v[24:27]
    v_mfma_f32_16x16x32_bf16 v[28:31], v[88:91], a[88:91], v[28:31]
    s_waitcnt lgkmcnt(4)
    v_mfma_f32_16x16x32_bf16 v[24:27], v[92:95], a[36:39], v[24:27]
    v_mfma_f32_16x16x32_bf16 v[28:31], v[92:95], a[92:95], v[28:31]
    s_waitcnt lgkmcnt(3)
    v_mfma_f32_16x16x32_bf16 v[24:27], v[96:99], a[40:43], v[24:27]
    v_mfma_f32_16x16x32_bf16 v[28:31], v[96:99], a[96:99], v[28:31]
    s_waitcnt lgkmcnt(2)
    v_mfma_f32_16x16x32_bf16 v[24:27], v[100:103], a[44:47], v[24:27]
    v_mfma_f32_16x16x32_bf16 v[28:31], v[100:103], a[100:103], v[28:31]
    s_waitcnt lgkmcnt(1)
    v_mfma_f32_16x16x32_bf16 v[24:27], v[104:107], a[48:51], v[24:27]
    v_mfma_f32_16x16x32_bf16 v[28:31], v[104:107], a[104:107], v[28:31]
    s_waitcnt lgkmcnt(0)
    v_mfma_f32_16x16x32_bf16 v[24:27], v[108:111], a[52:55], v[24:27]
    v_mfma_f32_16x16x32_bf16 v[28:31], v[108:111], a[108:111], v[28:31]
    s_nop 7
    v_cvt_pk_bf16_f32 v160, v16, v24
    v_cvt_pk_bf16_f32 v161, v17, v25
    v_cvt_pk_bf16_f32 v162, v18, v26
    v_cvt_pk_bf16_f32 v163, v19, v27
    v_cvt_pk_bf16_f32 v164, v20, v28
    v_cvt_pk_bf16_f32 v165, v21, v29
    v_cvt_pk_bf16_f32 v166, v22, v30
    v_cvt_pk_bf16_f32 v167, v23, v31
    s_nop 1
    v_mfma_f32_16x16x32_bf16 v[32:35], a[120:123], v[160:163], v[32:35]
    v_mfma_f32_16x16x32_bf16 v[36:39], a[120:123], v[164:167], v[36:39]
    v_mfma_f32_16x16x32_bf16 v[40:43], a[176:179], v[164:167], v[40:43]
    s_waitcnt vmcnt(14)
    s_barrier
    s_add_u32 s22, s21, 57344
    s_mov_b32 m0, s22
    s_add_u32 s23, s19, 172032
    buffer_load_dwordx4 v1, s[4:7], s23 offen offset:0 lds
    buffer_load_dwordx4 v1, s[4:7], s23 offen offset:1024 lds
    buffer_load_dwordx4 v1, s[4:7], s23 offen offset:2048 lds
    buffer_load_dwordx4 v1, s[4:7], s23 offen offset:3072 lds
    s_add_u32 s22, s21, 61440
    s_mov_b32 m0, s22
    s_add_u32 s23, s19, 176128
    buffer_load_dwordx4 v1, s[4:7], s23 offen offset:0 lds
    buffer_load_dwordx4 v1, s[4:7], s23 offen offset:1024 lds
    buffer_load_dwordx4 v1, s[4:7], s23 offen offset:2048 lds
    v_add_u32 v2, 86016, v1
    ds_read_b128 v[56:59], v2 offset:0
    ds_read_b128 v[60:63], v2 offset:1024
    ds_read_b128 v[64:67], v2 offset:2048
    ds_read_b128 v[68:71], v2 offset:3072
    ds_read_b128 v[72:75], v2 offset:4096
    ds_read_b128 v[76:79], v2 offset:5120
    ds_read_b128 v[80:83], v2 offset:6144
    ds_read_b128 v[84:87], v2 offset:7168
    ds_read_b128 v[88:91], v2 offset:8192
    ds_read_b128 v[92:95], v2 offset:9216
    ds_read_b128 v[96:99], v2 offset:10240
    ds_read_b128 v[100:103], v2 offset:11264
    ds_read_b128 v[104:107], v2 offset:12288
    ds_read_b128 v[108:111], v2 offset:13312
    s_waitcnt lgkmcnt(13)
    v_mfma_f32_16x16x32_bf16 v[16:19], v[56:59], a[0:3], 0
    v_mfma_f32_16x16x32_bf16 v[20:23], v[56:59], a[56:59], 0
    s_waitcnt lgkmcnt(12)
    v_mfma_f32_16x16x32_bf16 v[16:19], v[60:63], a[4:7], v[16:19]
    v_mfma_f32_16x16x32_bf16 v[20:23], v[60:63], a[60:63], v[20:23]
    s_waitcnt lgkmcnt(11)
    v_mfma_f32_16x16x32_bf16 v[16:19], v[64:67], a[8:11], v[16:19]
    v_mfma_f32_16x16x32_bf16 v[20:23], v[64:67], a[64:67], v[20:23]
    s_waitcnt lgkmcnt(10)
    v_mfma_f32_16x16x32_bf16 v[16:19], v[68:71], a[12:15], v[16:19]
    v_mfma_f32_16x16x32_bf16 v[20:23], v[68:71], a[68:71], v[20:23]
    s_waitcnt lgkmcnt(9)
    v_mfma_f32_16x16x32_bf16 v[16:19], v[72:75], a[16:19], v[16:19]
    v_mfma_f32_16x16x32_bf16 v[20:23], v[72:75], a[72:75], v[20:23]
    s_waitcnt lgkmcnt(8)
    v_mfma_f32_16x16x32_bf16 v[16:19], v[76:79], a[20:23], v[16:19]
    v_mfma_f32_16x16x32_bf16 v[20:23], v[76:79], a[76:79], v[20:23]
    s_waitcnt lgkmcnt(7)
    v_mfma_f32_16x16x32_bf16 v[16:19], v[80:83], a[24:27], v[16:19]
    v_mfma_f32_16x16x32_bf16 v[20:23], v[80:83], a[80:83], v[20:23]
    s_waitcnt lgkmcnt(6)
    v_mfma_f32_16x16x32_bf16 v[16:19], v[84:87], a[28:31], v[16:19]
    v_mfma_f32_16x16x32_bf16 v[20:23], v[84:87], a[84:87], v[20:23]
    s_waitcnt lgkmcnt(5)
    v_mfma_f32_16x16x32_bf16 v[16:19], v[88:91], a[32:35], v[16:19]
    v_mfma_f32_16x16x32_bf16 v[20:23], v[88:91], a[88:91], v[20:23]
    s_waitcnt lgkmcnt(4)
    v_mfma_f32_16x16x32_bf16 v[16:19], v[92:95], a[36:39], v[16:19]
    v_mfma_f32_16x16x32_bf16 v[20:23], v[92:95], a[92:95], v[20:23]
    s_waitcnt lgkmcnt(3)
    v_mfma_f32_16x16x32_bf16 v[16:19], v[96:99], a[40:43], v[16:19]
    v_mfma_f32_16x16x32_bf16 v[20:23], v[96:99], a[96:99], v[20:23]
    s_waitcnt lgkmcnt(2)
    v_mfma_f32_16x16x32_bf16 v[16:19], v[100:103], a[44:47], v[16:19]
    v_mfma_f32_16x16x32_bf16 v[20:23], v[100:103], a[100:103], v[20:23]
    s_waitcnt lgkmcnt(1)
    v_mfma_f32_16x16x32_bf16 v[16:19], v[104:107], a[48:51], v[16:19]
    v_mfma_f32_16x16x32_bf16 v[20:23], v[104:107], a[104:107], v[20:23]
    s_waitcnt lgkmcnt(0)
    v_mfma_f32_16x16x32_bf16 v[16:19], v[108:111], a[52:55], v[16:19]
    v_mfma_f32_16x16x32_bf16 v[20:23], v[108:111], a[108:111], v[20:23]
    ds_read_b128 v[56:59], v2 offset:14336
    ds_read_b128 v[60:63], v2 offset:15360
    ds_read_b128 v[64:67], v2 offset:16384
    ds_read_b128 v[68:71], v2 offset:17408
    ds_read_b128 v[72:75], v2 offset:18432
    ds_read_b128 v[76:79], v2 offset:19456
    ds_read_b128 v[80:83], v2 offset:20480
    ds_read_b128 v[84:87], v2 offset:21504
    ds_read_b128 v[88:91], v2 offset:22528
    ds_read_b128 v[92:95], v2 offset:23552
    ds_read_b128 v[96:99], v2 offset:24576
    ds_read_b128 v[100:103], v2 offset:25600
    ds_read_b128 v[104:107], v2 offset:26624
    ds_read_b128 v[108:111], v2 offset:27648
    s_waitcnt lgkmcnt(13)
    v_mfma_f32_16x16x32_bf16 v[24:27], v[56:59], a[0:3], 0
    v_mfma_f32_16x16x32_bf16 v[28:31], v[56:59], a[56:59], 0
    s_waitcnt lgkmcnt(12)
    v_mfma_f32_16x16x32_bf16 v[24:27], v[60:63], a[4:7], v[24:27]
    v_mfma_f32_16x16x32_bf16 v[28:31], v[60:63], a[60:63], v[28:31]
    s_waitcnt lgkmcnt(11)
    v_mfma_f32_16x16x32_bf16 v[24:27], v[64:67], a[8:11], v[24:27]
    v_mfma_f32_16x16x32_bf16 v[28:31], v[64:67], a[64:67], v[28:31]
    s_waitcnt lgkmcnt(10)
    v_mfma_f32_16x16x32_bf16 v[24:27], v[68:71], a[12:15], v[24:27]
    v_mfma_f32_16x16x32_bf16 v[28:31], v[68:71], a[68:71], v[28:31]
    s_waitcnt lgkmcnt(9)
    v_mfma_f32_16x16x32_bf16 v[24:27], v[72:75], a[16:19], v[24:27]
    v_mfma_f32_16x16x32_bf16 v[28:31], v[72:75], a[72:75], v[28:31]
    s_waitcnt lgkmcnt(8)
    v_mfma_f32_16x16x32_bf16 v[24:27], v[76:79], a[20:23], v[24:27]
    v_mfma_f32_16x16x32_bf16 v[28:31], v[76:79], a[76:79], v[28:31]
    s_waitcnt lgkmcnt(7)
    v_mfma_f32_16x16x32_bf16 v[24:27], v[80:83], a[24:27], v[24:27]
    v_mfma_f32_16x16x32_bf16 v[28:31], v[80:83], a[80:83], v[28:31]
    s_waitcnt lgkmcnt(6)
    v_mfma_f32_16x16x32_bf16 v[24:27], v[84:87], a[28:31], v[24:27]
    v_mfma_f32_16x16x32_bf16 v[28:31], v[84:87], a[84:87], v[28:31]
    s_waitcnt lgkmcnt(5)
    v_mfma_f32_16x16x32_bf16 v[24:27], v[88:91], a[32:35], v[24:27]
    v_mfma_f32_16x16x32_bf16 v[28:31], v[88:91], a[88:91], v[28:31]
    s_waitcnt lgkmcnt(4)
    v_mfma_f32_16x16x32_bf16 v[24:27], v[92:95], a[36:39], v[24:27]
    v_mfma_f32_16x16x32_bf16 v[28:31], v[92:95], a[92:95], v[28:31]
    s_waitcnt lgkmcnt(3)
    v_mfma_f32_16x16x32_bf16 v[24:27], v[96:99], a[40:43], v[24:27]
    v_mfma_f32_16x16x32_bf16 v[28:31], v[96:99], a[96:99], v[28:31]
    s_waitcnt lgkmcnt(2)
    v_mfma_f32_16x16x32_bf16 v[24:27], v[100:103], a[44:47], v[24:27]
    v_mfma_f32_16x16x32_bf16 v[28:31], v[100:103], a[100:103], v[28:31]
    s_waitcnt lgkmcnt(1)
    v_mfma_f32_16x16x32_bf16 v[24:27], v[104:107], a[48:51], v[24:27]
    v_mfma_f32_16x16x32_bf16 v[28:31], v[104:107], a[104:107], v[28:31]
    s_waitcnt lgkmcnt(0)
    v_mfma_f32_16x16x32_bf16 v[24:27], v[108:111], a[52:55], v[24:27]
    v_mfma_f32_16x16x32_bf16 v[28:31], v[108:111], a[108:111], v[28:31]
    s_nop 7
    v_cvt_pk_bf16_f32 v168, v16, v24
    v_cvt_pk_bf16_f32 v169, v17, v25
    v_cvt_pk_bf16_f32 v170, v18, v26
    v_cvt_pk_bf16_f32 v171, v19, v27
    v_cvt_pk_bf16_f32 v172, v20, v28
    v_cvt_pk_bf16_f32 v173, v21, v29
    v_cvt_pk_bf16_f32 v174, v22, v30
    v_cvt_pk_bf16_f32 v175, v23, v31
    s_nop 1
    v_mfma_f32_16x16x32_bf16 v[32:35], a[124:127], v[168:171], v[32:35]
    v_mfma_f32_16x16x32_bf16 v[36:39], a[124:127], v[172:175], v[36:39]
    v_mfma_f32_16x16x32_bf16 v[40:43], a[180:183], v[172:175], v[40:43]
    s_waitcnt vmcnt(14)
    s_barrier
    s_add_u32 s22, s21, 86016
    s_mov_b32 m0, s22
    s_add_u32 s23, s19, 200704
    buffer_load_dwordx4 v1, s[4:7], s23 offen offset:0 lds
    buffer_load_dwordx4 v1, s[4:7], s23 offen offset:1024 lds
    buffer_load_dwordx4 v1, s[4:7], s23 offen offset:2048 lds
    buffer_load_dwordx4 v1, s[4:7], s23 offen offset:3072 lds
    s_add_u32 s22, s21, 90112
    s_mov_b32 m0, s22
    s_add_u32 s23, s19, 204800
    buffer_load_dwordx4 v1, s[4:7], s23 offen offset:0 lds
    buffer_load_dwordx4 v1, s[4:7], s23 offen offset:1024 lds
    buffer_load_dwordx4 v1, s[4:7], s23 offen offset:2048 lds
    ds_read_b128 v[56:59], v1 offset:0
    ds_read_b128 v[60:63], v1 offset:1024
    ds_read_b128 v[64:67], v1 offset:2048
    ds_read_b128 v[68:71], v1 offset:3072
    ds_read_b128 v[72:75], v1 offset:4096
    ds_read_b128 v[76:79], v1 offset:5120
    ds_read_b128 v[80:83], v1 offset:6144
    ds_read_b128 v[84:87], v1 offset:7168
    ds_read_b128 v[88:91], v1 offset:8192
    ds_read_b128 v[92:95], v1 offset:9216
    ds_read_b128 v[96:99], v1 offset:10240
    ds_read_b128 v[100:103], v1 offset:11264
    ds_read_b128 v[104:107], v1 offset:12288
    ds_read_b128 v[108:111], v1 offset:13312
    s_waitcnt lgkmcnt(13)
    v_mfma_f32_16x16x32_bf16 v[16:19], v[56:59], a[0:3], 0
    v_mfma_f32_16x16x32_bf16 v[20:23], v[56:59], a[56:59], 0
    s_waitcnt lgkmcnt(12)
    v_mfma_f32_16x16x32_bf16 v[16:19], v[60:63], a[4:7], v[16:19]
    v_mfma_f32_16x16x32_bf16 v[20:23], v[60:63], a[60:63], v[20:23]
    s_waitcnt lgkmcnt(11)
    v_mfma_f32_16x16x32_bf16 v[16:19], v[64:67], a[8:11], v[16:19]
    v_mfma_f32_16x16x32_bf16 v[20:23], v[64:67], a[64:67], v[20:23]
    s_waitcnt lgkmcnt(10)
    v_mfma_f32_16x16x32_bf16 v[16:19], v[68:71], a[12:15], v[16:19]
    v_mfma_f32_16x16x32_bf16 v[20:23], v[68:71], a[68:71], v[20:23]
    s_waitcnt lgkmcnt(9)
    v_mfma_f32_16x16x32_bf16 v[16:19], v[72:75], a[16:19], v[16:19]
    v_mfma_f32_16x16x32_bf16 v[20:23], v[72:75], a[72:75], v[20:23]
    s_waitcnt lgkmcnt(8)
    v_mfma_f32_16x16x32_bf16 v[16:19], v[76:79], a[20:23], v[16:19]
    v_mfma_f32_16x16x32_bf16 v[20:23], v[76:79], a[76:79], v[20:23]
    s_waitcnt lgkmcnt(7)
    v_mfma_f32_16x16x32_bf16 v[16:19], v[80:83], a[24:27], v[16:19]
    v_mfma_f32_16x16x32_bf16 v[20:23], v[80:83], a[80:83], v[20:23]
    s_waitcnt lgkmcnt(6)
    v_mfma_f32_16x16x32_bf16 v[16:19], v[84:87], a[28:31], v[16:19]
    v_mfma_f32_16x16x32_bf16 v[20:23], v[84:87], a[84:87], v[20:23]
    s_waitcnt lgkmcnt(5)
    v_mfma_f32_16x16x32_bf16 v[16:19], v[88:91], a[32:35], v[16:19]
    v_mfma_f32_16x16x32_bf16 v[20:23], v[88:91], a[88:91], v[20:23]
    s_waitcnt lgkmcnt(4)
    v_mfma_f32_16x16x32_bf16 v[16:19], v[92:95], a[36:39], v[16:19]
    v_mfma_f32_16x16x32_bf16 v[20:23], v[92:95], a[92:95], v[20:23]
    s_waitcnt lgkmcnt(3)
    v_mfma_f32_16x16x32_bf16 v[16:19], v[96:99], a[40:43], v[16:19]
    v_mfma_f32_16x16x32_bf16 v[20:23], v[96:99], a[96:99], v[20:23]
    s_waitcnt lgkmcnt(2)
    v_mfma_f32_16x16x32_bf16 v[16:19], v[100:103], a[44:47], v[16:19]
    v_mfma_f32_16x16x32_bf16 v[20:23], v[100:103], a[100:103], v[20:23]
    s_waitcnt lgkmcnt(1)
    v_mfma_f32_16x16x32_bf16 v[16:19], v[104:107], a[48:51], v[16:19]
    v_mfma_f32_16x16x32_bf16 v[20:23], v[104:107], a[104:107], v[20:23]
    s_waitcnt lgkmcnt(0)
    v_mfma_f32_16x16x32_bf16 v[16:19], v[108:111], a[52:55], v[16:19]
    v_mfma_f32_16x16x32_bf16 v[20:23], v[108:111], a[108:111], v[20:23]
    ds_read_b128 v[56:59], v1 offset:14336
    ds_read_b128 v[60:63], v1 offset:15360
    ds_read_b128 v[64:67], v1 offset:16384
    ds_read_b128 v[68:71], v1 offset:17408
    ds_read_b128 v[72:75], v1 offset:18432
    ds_read_b128 v[76:79], v1 offset:19456
    ds_read_b128 v[80:83], v1 offset:20480
    ds_read_b128 v[84:87], v1 offset:21504
    ds_read_b128 v[88:91], v1 offset:22528
    ds_read_b128 v[92:95], v1 offset:23552
    ds_read_b128 v[96:99], v1 offset:24576
    ds_read_b128 v[100:103], v1 offset:25600
    ds_read_b128 v[104:107], v1 offset:26624
    ds_read_b128 v[108:111], v1 offset:27648
    s_waitcnt lgkmcnt(13)
    v_mfma_f32_16x16x32_bf16 v[24:27], v[56:59], a[0:3], 0
    v_mfma_f32_16x16x32_bf16 v[28:31], v[56:59], a[56:59], 0
    s_waitcnt lgkmcnt(12)
    v_mfma_f32_16x16x32_bf16 v[24:27], v[60:63], a[4:7], v[24:27]
    v_mfma_f32_16x16x32_bf16 v[28:31], v[60:63], a[60:63], v[28:31]
    s_waitcnt lgkmcnt(11)
    v_mfma_f32_16x16x32_bf16 v[24:27], v[64:67], a[8:11], v[24:27]
    v_mfma_f32_16x16x32_bf16 v[28:31], v[64:67], a[64:67], v[28:31]
    s_waitcnt lgkmcnt(10)
    v_mfma_f32_16x16x32_bf16 v[24:27], v[68:71], a[12:15], v[24:27]
    v_mfma_f32_16x16x32_bf16 v[28:31], v[68:71], a[68:71], v[28:31]
    s_waitcnt lgkmcnt(9)
    v_mfma_f32_16x16x32_bf16 v[24:27], v[72:75], a[16:19], v[24:27]
    v_mfma_f32_16x16x32_bf16 v[28:31], v[72:75], a[72:75], v[28:31]
    s_waitcnt lgkmcnt(8)
    v_mfma_f32_16x16x32_bf16 v[24:27], v[76:79], a[20:23], v[24:27]
    v_mfma_f32_16x16x32_bf16 v[28:31], v[76:79], a[76:79], v[28:31]
    s_waitcnt lgkmcnt(7)
    v_mfma_f32_16x16x32_bf16 v[24:27], v[80:83], a[24:27], v[24:27]
    v_mfma_f32_16x16x32_bf16 v[28:31], v[80:83], a[80:83], v[28:31]
    s_waitcnt lgkmcnt(6)
    v_mfma_f32_16x16x32_bf16 v[24:27], v[84:87], a[28:31], v[24:27]
    v_mfma_f32_16x16x32_bf16 v[28:31], v[84:87], a[84:87], v[28:31]
    s_waitcnt lgkmcnt(5)
    v_mfma_f32_16x16x32_bf16 v[24:27], v[88:91], a[32:35], v[24:27]
    v_mfma_f32_16x16x32_bf16 v[28:31], v[88:91], a[88:91], v[28:31]
    s_waitcnt lgkmcnt(4)
    v_mfma_f32_16x16x32_bf16 v[24:27], v[92:95], a[36:39], v[24:27]
    v_mfma_f32_16x16x32_bf16 v[28:31], v[92:95], a[92:95], v[28:31]
    s_waitcnt lgkmcnt(3)
    v_mfma_f32_16x16x32_bf16 v[24:27], v[96:99], a[40:43], v[24:27]
    v_mfma_f32_16x16x32_bf16 v[28:31], v[96:99], a[96:99], v[28:31]
    s_waitcnt lgkmcnt(2)
    v_mfma_f32_16x16x32_bf16 v[24:27], v[100:103], a[44:47], v[24:27]
    v_mfma_f32_16x16x32_bf16 v[28:31], v[100:103], a[100:103], v[28:31]
    s_waitcnt lgkmcnt(1)
    v_mfma_f32_16x16x32_bf16 v[24:27], v[104:107], a[48:51], v[24:27]
    v_mfma_f32_16x16x32_bf16 v[28:31], v[104:107], a[104:107], v[28:31]
    s_waitcnt lgkmcnt(0)
    v_mfma_f32_16x16x32_bf16 v[24:27], v[108:111], a[52:55], v[24:27]
    v_mfma_f32_16x16x32_bf16 v[28:31], v[108:111], a[108:111], v[28:31]
    s_nop 7
    v_cvt_pk_bf16_f32 v176, v16, v24
    v_cvt_pk_bf16_f32 v177, v17, v25
    v_cvt_pk_bf16_f32 v178, v18, v26
    v_cvt_pk_bf16_f32 v179, v19, v27
    v_cvt_pk_bf16_f32 v180, v20, v28
    v_cvt_pk_bf16_f32 v181, v21, v29
    v_cvt_pk_bf16_f32 v182, v22, v30
    v_cvt_pk_bf16_f32 v183, v23, v31
    s_nop 1
    v_mfma_f32_16x16x32_bf16 v[32:35], a[128:131], v[176:179], v[32:35]
    v_mfma_f32_16x16x32_bf16 v[36:39], a[128:131], v[180:183], v[36:39]
    v_mfma_f32_16x16x32_bf16 v[40:43], a[184:187], v[180:183], v[40:43]
    s_waitcnt vmcnt(14)
    s_barrier
    s_add_u32 s22, s21, 0
    s_mov_b32 m0, s22
    s_add_u32 s23, s19, 229376
    buffer_load_dwordx4 v1, s[4:7], s23 offen offset:0 lds
    buffer_load_dwordx4 v1, s[4:7], s23 offen offset:1024 lds
    buffer_load_dwordx4 v1, s[4:7], s23 offen offset:2048 lds
    buffer_load_dwordx4 v1, s[4:7], s23 offen offset:3072 lds
    s_add_u32 s22, s21, 4096
    s_mov_b32 m0, s22
    s_add_u32 s23, s19, 233472
    buffer_load_dwordx4 v1, s[4:7], s23 offen offset:0 lds
    buffer_load_dwordx4 v1, s[4:7], s23 offen offset:1024 lds
    buffer_load_dwordx4 v1, s[4:7], s23 offen offset:2048 lds
    ds_read_b128 v[56:59], v1 offset:28672
    ds_read_b128 v[60:63], v1 offset:29696
    ds_read_b128 v[64:67], v1 offset:30720
    ds_read_b128 v[68:71], v1 offset:31744
    ds_read_b128 v[72:75], v1 offset:32768
    ds_read_b128 v[76:79], v1 offset:33792
    ds_read_b128 v[80:83], v1 offset:34816
    ds_read_b128 v[84:87], v1 offset:35840
    ds_read_b128 v[88:91], v1 offset:36864
    ds_read_b128 v[92:95], v1 offset:37888
    ds_read_b128 v[96:99], v1 offset:38912
    ds_read_b128 v[100:103], v1 offset:39936
    ds_read_b128 v[104:107], v1 offset:40960
    ds_read_b128 v[108:111], v1 offset:41984
    s_waitcnt lgkmcnt(13)
    v_mfma_f32_16x16x32_bf16 v[16:19], v[56:59], a[0:3], 0
    v_mfma_f32_16x16x32_bf16 v[20:23], v[56:59], a[56:59], 0
    s_waitcnt lgkmcnt(12)
    v_mfma_f32_16x16x32_bf16 v[16:19], v[60:63], a[4:7], v[16:19]
    v_mfma_f32_16x16x32_bf16 v[20:23], v[60:63], a[60:63], v[20:23]
    s_waitcnt lgkmcnt(11)
    v_mfma_f32_16x16x32_bf16 v[16:19], v[64:67], a[8:11], v[16:19]
    v_mfma_f32_16x16x32_bf16 v[20:23], v[64:67], a[64:67], v[20:23]
    s_waitcnt lgkmcnt(10)
    v_mfma_f32_16x16x32_bf16 v[16:19], v[68:71], a[12:15], v[16:19]
    v_mfma_f32_16x16x32_bf16 v[20:23], v[68:71], a[68:71], v[20:23]
    s_waitcnt lgkmcnt(9)
    v_mfma_f32_16x16x32_bf16 v[16:19], v[72:75], a[16:19], v[16:19]
    v_mfma_f32_16x16x32_bf16 v[20:23], v[72:75], a[72:75], v[20:23]
    s_waitcnt lgkmcnt(8)
    v_mfma_f32_16x16x32_bf16 v[16:19], v[76:79], a[20:23], v[16:19]
    v_mfma_f32_16x16x32_bf16 v[20:23], v[76:79], a[76:79], v[20:23]
    s_waitcnt lgkmcnt(7)
    v_mfma_f32_16x16x32_bf16 v[16:19], v[80:83], a[24:27], v[16:19]
    v_mfma_f32_16x16x32_bf16 v[20:23], v[80:83], a[80:83], v[20:23]
    s_waitcnt lgkmcnt(6)
    v_mfma_f32_16x16x32_bf16 v[16:19], v[84:87], a[28:31], v[16:19]
    v_mfma_f32_16x16x32_bf16 v[20:23], v[84:87], a[84:87], v[20:23]
    s_waitcnt lgkmcnt(5)
    v_mfma_f32_16x16x32_bf16 v[16:19], v[88:91], a[32:35], v[16:19]
    v_mfma_f32_16x16x32_bf16 v[20:23], v[88:91], a[88:91], v[20:23]
    s_waitcnt lgkmcnt(4)
    v_mfma_f32_16x16x32_bf16 v[16:19], v[92:95], a[36:39], v[16:19]
    v_mfma_f32_16x16x32_bf16 v[20:23], v[92:95], a[92:95], v[20:23]
    s_waitcnt lgkmcnt(3)
    v_mfma_f32_16x16x32_bf16 v[16:19], v[96:99], a[40:43], v[16:19]
    v_mfma_f32_16x16x32_bf16 v[20:23], v[96:99], a[96:99], v[20:23]
    s_waitcnt lgkmcnt(2)
    v_mfma_f32_16x16x32_bf16 v[16:19], v[100:103], a[44:47], v[16:19]
    v_mfma_f32_16x16x32_bf16 v[20:23], v[100:103], a[100:103], v[20:23]
    s_waitcnt lgkmcnt(1)
    v_mfma_f32_16x16x32_bf16 v[16:19], v[104:107], a[48:51], v[16:19]
    v_mfma_f32_16x16x32_bf16 v[20:23], v[104:107], a[104:107], v[20:23]
    s_waitcnt lgkmcnt(0)
    v_mfma_f32_16x16x32_bf16 v[16:19], v[108:111], a[52:55], v[16:19]
    v_mfma_f32_16x16x32_bf16 v[20:23], v[108:111], a[108:111], v[20:23]
    ds_read_b128 v[56:59], v1 offset:43008
    ds_read_b128 v[60:63], v1 offset:44032
    ds_read_b128 v[64:67], v1 offset:45056
    ds_read_b128 v[68:71], v1 offset:46080
    ds_read_b128 v[72:75], v1 offset:47104
    ds_read_b128 v[76:79], v1 offset:48128
    ds_read_b128 v[80:83], v1 offset:49152
    ds_read_b128 v[84:87], v1 offset:50176
    ds_read_b128 v[88:91], v1 offset:51200
    ds_read_b128 v[92:95], v1 offset:52224
    ds_read_b128 v[96:99], v1 offset:53248
    ds_read_b128 v[100:103], v1 offset:54272
    ds_read_b128 v[104:107], v1 offset:55296
    ds_read_b128 v[108:111], v1 offset:56320
    s_waitcnt lgkmcnt(13)
    v_mfma_f32_16x16x32_bf16 v[24:27], v[56:59], a[0:3], 0
    v_mfma_f32_16x16x32_bf16 v[28:31], v[56:59], a[56:59], 0
    s_waitcnt lgkmcnt(12)
    v_mfma_f32_16x16x32_bf16 v[24:27], v[60:63], a[4:7], v[24:27]
    v_mfma_f32_16x16x32_bf16 v[28:31], v[60:63], a[60:63], v[28:31]
    s_waitcnt lgkmcnt(11)
    v_mfma_f32_16x16x32_bf16 v[24:27], v[64:67], a[8:11], v[24:27]
    v_mfma_f32_16x16x32_bf16 v[28:31], v[64:67], a[64:67], v[28:31]
    s_waitcnt lgkmcnt(10)
    v_mfma_f32_16x16x32_bf16 v[24:27], v[68:71], a[12:15], v[24:27]
    v_mfma_f32_16x16x32_bf16 v[28:31], v[68:71], a[68:71], v[28:31]
    s_waitcnt lgkmcnt(9)
    v_mfma_f32_16x16x32_bf16 v[24:27], v[72:75], a[16:19], v[24:27]
    v_mfma_f32_16x16x32_bf16 v[28:31], v[72:75], a[72:75], v[28:31]
    s_waitcnt lgkmcnt(8)
    v_mfma_f32_16x16x32_bf16 v[24:27], v[76:79], a[20:23], v[24:27]
    v_mfma_f32_16x16x32_bf16 v[28:31], v[76:79], a[76:79], v[28:31]
    s_waitcnt lgkmcnt(7)
    v_mfma_f32_16x16x32_bf16 v[24:27], v[80:83], a[24:27], v[24:27]
    v_mfma_f32_16x16x32_bf16 v[28:31], v[80:83], a[80:83], v[28:31]
    s_waitcnt lgkmcnt(6)
    v_mfma_f32_16x16x32_bf16 v[24:27], v[84:87], a[28:31], v[24:27]
    v_mfma_f32_16x16x32_bf16 v[28:31], v[84:87], a[84:87], v[28:31]
    s_waitcnt lgkmcnt(5)
    v_mfma_f32_16x16x32_bf16 v[24:27], v[88:91], a[32:35], v[24:27]
    v_mfma_f32_16x16x32_bf16 v[28:31], v[88:91], a[88:91], v[28:31]
    s_waitcnt lgkmcnt(4)
    v_mfma_f32_16x16x32_bf16 v[24:27], v[92:95], a[36:39], v[24:27]
    v_mfma_f32_16x16x32_bf16 v[28:31], v[92:95], a[92:95], v[28:31]
    s_waitcnt lgkmcnt(3)
    v_mfma_f32_16x16x32_bf16 v[24:27], v[96:99], a[40:43], v[24:27]
    v_mfma_f32_16x16x32_bf16 v[28:31], v[96:99], a[96:99], v[28:31]
    s_waitcnt lgkmcnt(2)
    v_mfma_f32_16x16x32_bf16 v[24:27], v[100:103], a[44:47], v[24:27]
    v_mfma_f32_16x16x32_bf16 v[28:31], v[100:103], a[100:103], v[28:31]
    s_waitcnt lgkmcnt(1)
    v_mfma_f32_16x16x32_bf16 v[24:27], v[104:107], a[48:51], v[24:27]
    v_mfma_f32_16x16x32_bf16 v[28:31], v[104:107], a[104:107], v[28:31]
    s_waitcnt lgkmcnt(0)
    v_mfma_f32_16x16x32_bf16 v[24:27], v[108:111], a[52:55], v[24:27]
    v_mfma_f32_16x16x32_bf16 v[28:31], v[108:111], a[108:111], v[28:31]
    s_nop 7
    v_cvt_pk_bf16_f32 v184, v16, v24
    v_cvt_pk_bf16_f32 v185, v17, v25
    v_cvt_pk_bf16_f32 v186, v18, v26
    v_cvt_pk_bf16_f32 v187, v19, v27
    v_cvt_pk_bf16_f32 v188, v20, v28
    v_cvt_pk_bf16_f32 v189, v21, v29
    v_cvt_pk_bf16_f32 v190, v22, v30
    v_cvt_pk_bf16_f32 v191, v23, v31
    s_nop 1
    v_mfma_f32_16x16x32_bf16 v[32:35], a[132:135], v[184:187], v[32:35]
    v_mfma_f32_16x16x32_bf16 v[36:39], a[132:135], v[188:191], v[36:39]
    v_mfma_f32_16x16x32_bf16 v[40:43], a[188:191], v[188:191], v[40:43]
    s_waitcnt vmcnt(14)
    s_barrier
    s_add_u32 s22, s21, 28672
    s_mov_b32 m0, s22
    s_add_u32 s23, s19, 258048
    buffer_load_dwordx4 v1, s[4:7], s23 offen offset:0 lds
    buffer_load_dwordx4 v1, s[4:7], s23 offen offset:1024 lds
    buffer_load_dwordx4 v1, s[4:7], s23 offen offset:2048 lds
    buffer_load_dwordx4 v1, s[4:7], s23 offen offset:3072 lds
    s_add_u32 s22, s21, 32768
    s_mov_b32 m0, s22
    s_add_u32 s23, s19, 262144
    buffer_load_dwordx4 v1, s[4:7], s23 offen offset:0 lds
    buffer_load_dwordx4 v1, s[4:7], s23 offen offset:1024 lds
    buffer_load_dwordx4 v1, s[4:7], s23 offen offset:2048 lds
    v_add_u32 v2, 57344, v1
    ds_read_b128 v[56:59], v2 offset:0
    ds_read_b128 v[60:63], v2 offset:1024
    ds_read_b128 v[64:67], v2 offset:2048
    ds_read_b128 v[68:71], v2 offset:3072
    ds_read_b128 v[72:75], v2 offset:4096
    ds_read_b128 v[76:79], v2 offset:5120
    ds_read_b128 v[80:83], v2 offset:6144
    ds_read_b128 v[84:87], v2 offset:7168
    ds_read_b128 v[88:91], v2 offset:8192
    ds_read_b128 v[92:95], v2 offset:9216
    ds_read_b128 v[96:99], v2 offset:10240
    ds_read_b128 v[100:103], v2 offset:11264
    ds_read_b128 v[104:107], v2 offset:12288
    ds_read_b128 v[108:111], v2 offset:13312
    s_waitcnt lgkmcnt(13)
    v_mfma_f32_16x16x32_bf16 v[16:19], v[56:59], a[0:3], 0
    v_mfma_f32_16x16x32_bf16 v[20:23], v[56:59], a[56:59], 0
    s_waitcnt lgkmcnt(12)
    v_mfma_f32_16x16x32_bf16 v[16:19], v[60:63], a[4:7], v[16:19]
    v_mfma_f32_16x16x32_bf16 v[20:23], v[60:63], a[60:63], v[20:23]
    s_waitcnt lgkmcnt(11)
    v_mfma_f32_16x16x32_bf16 v[16:19], v[64:67], a[8:11], v[16:19]
    v_mfma_f32_16x16x32_bf16 v[20:23], v[64:67], a[64:67], v[20:23]
    s_waitcnt lgkmcnt(10)
    v_mfma_f32_16x16x32_bf16 v[16:19], v[68:71], a[12:15], v[16:19]
    v_mfma_f32_16x16x32_bf16 v[20:23], v[68:71], a[68:71], v[20:23]
    s_waitcnt lgkmcnt(9)
    v_mfma_f32_16x16x32_bf16 v[16:19], v[72:75], a[16:19], v[16:19]
    v_mfma_f32_16x16x32_bf16 v[20:23], v[72:75], a[72:75], v[20:23]
    s_waitcnt lgkmcnt(8)
    v_mfma_f32_16x16x32_bf16 v[16:19], v[76:79], a[20:23], v[16:19]
    v_mfma_f32_16x16x32_bf16 v[20:23], v[76:79], a[76:79], v[20:23]
    s_waitcnt lgkmcnt(7)
    v_mfma_f32_16x16x32_bf16 v[16:19], v[80:83], a[24:27], v[16:19]
    v_mfma_f32_16x16x32_bf16 v[20:23], v[80:83], a[80:83], v[20:23]
    s_waitcnt lgkmcnt(6)
    v_mfma_f32_16x16x32_bf16 v[16:19], v[84:87], a[28:31], v[16:19]
    v_mfma_f32_16x16x32_bf16 v[20:23], v[84:87], a[84:87], v[20:23]
    s_waitcnt lgkmcnt(5)
    v_mfma_f32_16x16x32_bf16 v[16:19], v[88:91], a[32:35], v[16:19]
    v_mfma_f32_16x16x32_bf16 v[20:23], v[88:91], a[88:91], v[20:23]
    s_waitcnt lgkmcnt(4)
    v_mfma_f32_16x16x32_bf16 v[16:19], v[92:95], a[36:39], v[16:19]
    v_mfma_f32_16x16x32_bf16 v[20:23], v[92:95], a[92:95], v[20:23]
    s_waitcnt lgkmcnt(3)
    v_mfma_f32_16x16x32_bf16 v[16:19], v[96:99], a[40:43], v[16:19]
    v_mfma_f32_16x16x32_bf16 v[20:23], v[96:99], a[96:99], v[20:23]
    s_waitcnt lgkmcnt(2)
    v_mfma_f32_16x16x32_bf16 v[16:19], v[100:103], a[44:47], v[16:19]
    v_mfma_f32_16x16x32_bf16 v[20:23], v[100:103], a[100:103], v[20:23]
    s_waitcnt lgkmcnt(1)
    v_mfma_f32_16x16x32_bf16 v[16:19], v[104:107], a[48:51], v[16:19]
    v_mfma_f32_16x16x32_bf16 v[20:23], v[104:107], a[104:107], v[20:23]
    s_waitcnt lgkmcnt(0)
    v_mfma_f32_16x16x32_bf16 v[16:19], v[108:111], a[52:55], v[16:19]
    v_mfma_f32_16x16x32_bf16 v[20:23], v[108:111], a[108:111], v[20:23]
    ds_read_b128 v[56:59], v2 offset:14336
    ds_read_b128 v[60:63], v2 offset:15360
    ds_read_b128 v[64:67], v2 offset:16384
    ds_read_b128 v[68:71], v2 offset:17408
    ds_read_b128 v[72:75], v2 offset:18432
    ds_read_b128 v[76:79], v2 offset:19456
    ds_read_b128 v[80:83], v2 offset:20480
    ds_read_b128 v[84:87], v2 offset:21504
    ds_read_b128 v[88:91], v2 offset:22528
    ds_read_b128 v[92:95], v2 offset:23552
    ds_read_b128 v[96:99], v2 offset:24576
    ds_read_b128 v[100:103], v2 offset:25600
    ds_read_b128 v[104:107], v2 offset:26624
    ds_read_b128 v[108:111], v2 offset:27648
    s_waitcnt lgkmcnt(13)
    v_mfma_f32_16x16x32_bf16 v[24:27], v[56:59], a[0:3], 0
    v_mfma_f32_16x16x32_bf16 v[28:31], v[56:59], a[56:59], 0
    s_waitcnt lgkmcnt(12)
    v_mfma_f32_16x16x32_bf16 v[24:27], v[60:63], a[4:7], v[24:27]
    v_mfma_f32_16x16x32_bf16 v[28:31], v[60:63], a[60:63], v[28:31]
    s_waitcnt lgkmcnt(11)
    v_mfma_f32_16x16x32_bf16 v[24:27], v[64:67], a[8:11], v[24:27]
    v_mfma_f32_16x16x32_bf16 v[28:31], v[64:67], a[64:67], v[28:31]
    s_waitcnt lgkmcnt(10)
    v_mfma_f32_16x16x32_bf16 v[24:27], v[68:71], a[12:15], v[24:27]
    v_mfma_f32_16x16x32_bf16 v[28:31], v[68:71], a[68:71], v[28:31]
    s_waitcnt lgkmcnt(9)
    v_mfma_f32_16x16x32_bf16 v[24:27], v[72:75], a[16:19], v[24:27]
    v_mfma_f32_16x16x32_bf16 v[28:31], v[72:75], a[72:75], v[28:31]
    s_waitcnt lgkmcnt(8)
    v_mfma_f32_16x16x32_bf16 v[24:27], v[76:79], a[20:23], v[24:27]
    v_mfma_f32_16x16x32_bf16 v[28:31], v[76:79], a[76:79], v[28:31]
    s_waitcnt lgkmcnt(7)
    v_mfma_f32_16x16x32_bf16 v[24:27], v[80:83], a[24:27], v[24:27]
    v_mfma_f32_16x16x32_bf16 v[28:31], v[80:83], a[80:83], v[28:31]
    s_waitcnt lgkmcnt(6)
    v_mfma_f32_16x16x32_bf16 v[24:27], v[84:87], a[28:31], v[24:27]
    v_mfma_f32_16x16x32_bf16 v[28:31], v[84:87], a[84:87], v[28:31]
    s_waitcnt lgkmcnt(5)
    v_mfma_f32_16x16x32_bf16 v[24:27], v[88:91], a[32:35], v[24:27]
    v_mfma_f32_16x16x32_bf16 v[28:31], v[88:91], a[88:91], v[28:31]
    s_waitcnt lgkmcnt(4)
    v_mfma_f32_16x16x32_bf16 v[24:27], v[92:95], a[36:39], v[24:27]
    v_mfma_f32_16x16x32_bf16 v[28:31], v[92:95], a[92:95], v[28:31]
    s_waitcnt lgkmcnt(3)
    v_mfma_f32_16x16x32_bf16 v[24:27], v[96:99], a[40:43], v[24:27]
    v_mfma_f32_16x16x32_bf16 v[28:31], v[96:99], a[96:99], v[28:31]
    s_waitcnt lgkmcnt(2)
    v_mfma_f32_16x16x32_bf16 v[24:27], v[100:103], a[44:47], v[24:27]
    v_mfma_f32_16x16x32_bf16 v[28:31], v[100:103], a[100:103], v[28:31]
    s_waitcnt lgkmcnt(1)
    v_mfma_f32_16x16x32_bf16 v[24:27], v[104:107], a[48:51], v[24:27]
    v_mfma_f32_16x16x32_bf16 v[28:31], v[104:107], a[104:107], v[28:31]
    s_waitcnt lgkmcnt(0)
    v_mfma_f32_16x16x32_bf16 v[24:27], v[108:111], a[52:55], v[24:27]
    v_mfma_f32_16x16x32_bf16 v[28:31], v[108:111], a[108:111], v[28:31]
    s_nop 7
    v_cvt_pk_bf16_f32 v192, v16, v24
    v_cvt_pk_bf16_f32 v193, v17, v25
    v_cvt_pk_bf16_f32 v194, v18, v26
    v_cvt_pk_bf16_f32 v195, v19, v27
    v_cvt_pk_bf16_f32 v196, v20, v28
    v_cvt_pk_bf16_f32 v197, v21, v29
    v_cvt_pk_bf16_f32 v198, v22, v30
    v_cvt_pk_bf16_f32 v199, v23, v31
    s_nop 1
    v_mfma_f32_16x16x32_bf16 v[32:35], a[136:139], v[192:195], v[32:35]
    v_mfma_f32_16x16x32_bf16 v[36:39], a[136:139], v[196:199], v[36:39]
    v_mfma_f32_16x16x32_bf16 v[40:43], a[192:195], v[196:199], v[40:43]
    s_waitcnt vmcnt(14)
    s_barrier
    s_add_u32 s22, s21, 57344
    s_mov_b32 m0, s22
    s_add_u32 s23, s19, 286720
    buffer_load_dwordx4 v1, s[4:7], s23 offen offset:0 lds
    buffer_load_dwordx4 v1, s[4:7], s23 offen offset:1024 lds
    buffer_load_dwordx4 v1, s[4:7], s23 offen offset:2048 lds
    buffer_load_dwordx4 v1, s[4:7], s23 offen offset:3072 lds
    s_add_u32 s22, s21, 61440
    s_mov_b32 m0, s22
    s_add_u32 s23, s19, 290816
    buffer_load_dwordx4 v1, s[4:7], s23 offen offset:0 lds
    buffer_load_dwordx4 v1, s[4:7], s23 offen offset:1024 lds
    buffer_load_dwordx4 v1, s[4:7], s23 offen offset:2048 lds
    v_add_u32 v2, 86016, v1
    ds_read_b128 v[56:59], v2 offset:0
    ds_read_b128 v[60:63], v2 offset:1024
    ds_read_b128 v[64:67], v2 offset:2048
    ds_read_b128 v[68:71], v2 offset:3072
    ds_read_b128 v[72:75], v2 offset:4096
    ds_read_b128 v[76:79], v2 offset:5120
    ds_read_b128 v[80:83], v2 offset:6144
    ds_read_b128 v[84:87], v2 offset:7168
    ds_read_b128 v[88:91], v2 offset:8192
    ds_read_b128 v[92:95], v2 offset:9216
    ds_read_b128 v[96:99], v2 offset:10240
    ds_read_b128 v[100:103], v2 offset:11264
    ds_read_b128 v[104:107], v2 offset:12288
    ds_read_b128 v[108:111], v2 offset:13312
    s_waitcnt lgkmcnt(13)
    v_mfma_f32_16x16x32_bf16 v[16:19], v[56:59], a[0:3], 0
    v_mfma_f32_16x16x32_bf16 v[20:23], v[56:59], a[56:59], 0
    s_waitcnt lgkmcnt(12)
    v_mfma_f32_16x16x32_bf16 v[16:19], v[60:63], a[4:7], v[16:19]
    v_mfma_f32_16x16x32_bf16 v[20:23], v[60:63], a[60:63], v[20:23]
    s_waitcnt lgkmcnt(11)
    v_mfma_f32_16x16x32_bf16 v[16:19], v[64:67], a[8:11], v[16:19]
    v_mfma_f32_16x16x32_bf16 v[20:23], v[64:67], a[64:67], v[20:23]
    s_waitcnt lgkmcnt(10)
    v_mfma_f32_16x16x32_bf16 v[16:19], v[68:71], a[12:15], v[16:19]
    v_mfma_f32_16x16x32_bf16 v[20:23], v[68:71], a[68:71], v[20:23]
    s_waitcnt lgkmcnt(9)
    v_mfma_f32_16x16x32_bf16 v[16:19], v[72:75], a[16:19], v[16:19]
    v_mfma_f32_16x16x32_bf16 v[20:23], v[72:75], a[72:75], v[20:23]
    s_waitcnt lgkmcnt(8)
    v_mfma_f32_16x16x32_bf16 v[16:19], v[76:79], a[20:23], v[16:19]
    v_mfma_f32_16x16x32_bf16 v[20:23], v[76:79], a[76:79], v[20:23]
    s_waitcnt lgkmcnt(7)
    v_mfma_f32_16x16x32_bf16 v[16:19], v[80:83], a[24:27], v[16:19]
    v_mfma_f32_16x16x32_bf16 v[20:23], v[80:83], a[80:83], v[20:23]
    s_waitcnt lgkmcnt(6)
    v_mfma_f32_16x16x32_bf16 v[16:19], v[84:87], a[28:31], v[16:19]
    v_mfma_f32_16x16x32_bf16 v[20:23], v[84:87], a[84:87], v[20:23]
    s_waitcnt lgkmcnt(5)
    v_mfma_f32_16x16x32_bf16 v[16:19], v[88:91], a[32:35], v[16:19]
    v_mfma_f32_16x16x32_bf16 v[20:23], v[88:91], a[88:91], v[20:23]
    s_waitcnt lgkmcnt(4)
    v_mfma_f32_16x16x32_bf16 v[16:19], v[92:95], a[36:39], v[16:19]
    v_mfma_f32_16x16x32_bf16 v[20:23], v[92:95], a[92:95], v[20:23]
    s_waitcnt lgkmcnt(3)
    v_mfma_f32_16x16x32_bf16 v[16:19], v[96:99], a[40:43], v[16:19]
    v_mfma_f32_16x16x32_bf16 v[20:23], v[96:99], a[96:99], v[20:23]
    s_waitcnt lgkmcnt(2)
    v_mfma_f32_16x16x32_bf16 v[16:19], v[100:103], a[44:47], v[16:19]
    v_mfma_f32_16x16x32_bf16 v[20:23], v[100:103], a[100:103], v[20:23]
    s_waitcnt lgkmcnt(1)
    v_mfma_f32_16x16x32_bf16 v[16:19], v[104:107], a[48:51], v[16:19]
    v_mfma_f32_16x16x32_bf16 v[20:23], v[104:107], a[104:107], v[20:23]
    s_waitcnt lgkmcnt(0)
    v_mfma_f32_16x16x32_bf16 v[16:19], v[108:111], a[52:55], v[16:19]
    v_mfma_f32_16x16x32_bf16 v[20:23], v[108:111], a[108:111], v[20:23]
    ds_read_b128 v[56:59], v2 offset:14336
    ds_read_b128 v[60:63], v2 offset:15360
    ds_read_b128 v[64:67], v2 offset:16384
    ds_read_b128 v[68:71], v2 offset:17408
    ds_read_b128 v[72:75], v2 offset:18432
    ds_read_b128 v[76:79], v2 offset:19456
    ds_read_b128 v[80:83], v2 offset:20480
    ds_read_b128 v[84:87], v2 offset:21504
    ds_read_b128 v[88:91], v2 offset:22528
    ds_read_b128 v[92:95], v2 offset:23552
    ds_read_b128 v[96:99], v2 offset:24576
    ds_read_b128 v[100:103], v2 offset:25600
    ds_read_b128 v[104:107], v2 offset:26624
    ds_read_b128 v[108:111], v2 offset:27648
    s_waitcnt lgkmcnt(13)
    v_mfma_f32_16x16x32_bf16 v[24:27], v[56:59], a[0:3], 0
    v_mfma_f32_16x16x32_bf16 v[28:31], v[56:59], a[56:59], 0
    s_waitcnt lgkmcnt(12)
    v_mfma_f32_16x16x32_bf16 v[24:27], v[60:63], a[4:7], v[24:27]
    v_mfma_f32_16x16x32_bf16 v[28:31], v[60:63], a[60:63], v[28:31]
    s_waitcnt lgkmcnt(11)
    v_mfma_f32_16x16x32_bf16 v[24:27], v[64:67], a[8:11], v[24:27]
    v_mfma_f32_16x16x32_bf16 v[28:31], v[64:67], a[64:67], v[28:31]
    s_waitcnt lgkmcnt(10)
    v_mfma_f32_16x16x32_bf16 v[24:27], v[68:71], a[12:15], v[24:27]
    v_mfma_f32_16x16x32_bf16 v[28:31], v[68:71], a[68:71], v[28:31]
    s_waitcnt lgkmcnt(9)
    v_mfma_f32_16x16x32_bf16 v[24:27], v[72:75], a[16:19], v[24:27]
    v_mfma_f32_16x16x32_bf16 v[28:31], v[72:75], a[72:75], v[28:31]
    s_waitcnt lgkmcnt(8)
    v_mfma_f32_16x16x32_bf16 v[24:27], v[76:79], a[20:23], v[24:27]
    v_mfma_f32_16x16x32_bf16 v[28:31], v[76:79], a[76:79], v[28:31]
    s_waitcnt lgkmcnt(7)
    v_mfma_f32_16x16x32_bf16 v[24:27], v[80:83], a[24:27], v[24:27]
    v_mfma_f32_16x16x32_bf16 v[28:31], v[80:83], a[80:83], v[28:31]
    s_waitcnt lgkmcnt(6)
    v_mfma_f32_16x16x32_bf16 v[24:27], v[84:87], a[28:31], v[24:27]
    v_mfma_f32_16x16x32_bf16 v[28:31], v[84:87], a[84:87], v[28:31]
    s_waitcnt lgkmcnt(5)
    v_mfma_f32_16x16x32_bf16 v[24:27], v[88:91], a[32:35], v[24:27]
    v_mfma_f32_16x16x32_bf16 v[28:31], v[88:91], a[88:91], v[28:31]
    s_waitcnt lgkmcnt(4)
    v_mfma_f32_16x16x32_bf16 v[24:27], v[92:95], a[36:39], v[24:27]
    v_mfma_f32_16x16x32_bf16 v[28:31], v[92:95], a[92:95], v[28:31]
    s_waitcnt lgkmcnt(3)
    v_mfma_f32_16x16x32_bf16 v[24:27], v[96:99], a[40:43], v[24:27]
    v_mfma_f32_16x16x32_bf16 v[28:31], v[96:99], a[96:99], v[28:31]
    s_waitcnt lgkmcnt(2)
    v_mfma_f32_16x16x32_bf16 v[24:27], v[100:103], a[44:47], v[24:27]
    v_mfma_f32_16x16x32_bf16 v[28:31], v[100:103], a[100:103], v[28:31]
    s_waitcnt lgkmcnt(1)
    v_mfma_f32_16x16x32_bf16 v[24:27], v[104:107], a[48:51], v[24:27]
    v_mfma_f32_16x16x32_bf16 v[28:31], v[104:107], a[104:107], v[28:31]
    s_waitcnt lgkmcnt(0)
    v_mfma_f32_16x16x32_bf16 v[24:27], v[108:111], a[52:55], v[24:27]
    v_mfma_f32_16x16x32_bf16 v[28:31], v[108:111], a[108:111], v[28:31]
    s_nop 7
    v_cvt_pk_bf16_f32 v200, v16, v24
    v_cvt_pk_bf16_f32 v201, v17, v25
    v_cvt_pk_bf16_f32 v202, v18, v26
    v_cvt_pk_bf16_f32 v203, v19, v27
    v_cvt_pk_bf16_f32 v204, v20, v28
    v_cvt_pk_bf16_f32 v205, v21, v29
    v_cvt_pk_bf16_f32 v206, v22, v30
    v_cvt_pk_bf16_f32 v207, v23, v31
    s_nop 1
    v_mfma_f32_16x16x32_bf16 v[32:35], a[140:143], v[200:203], v[32:35]
    v_mfma_f32_16x16x32_bf16 v[36:39], a[140:143], v[204:207], v[36:39]
    v_mfma_f32_16x16x32_bf16 v[40:43], a[196:199], v[204:207], v[40:43]
    s_waitcnt vmcnt(14)
    s_barrier
    s_add_u32 s22, s21, 86016
    s_mov_b32 m0, s22
    s_add_u32 s23, s19, 315392
    buffer_load_dwordx4 v1, s[4:7], s23 offen offset:0 lds
    buffer_load_dwordx4 v1, s[4:7], s23 offen offset:1024 lds
    buffer_load_dwordx4 v1, s[4:7], s23 offen offset:2048 lds
    buffer_load_dwordx4 v1, s[4:7], s23 offen offset:3072 lds
    s_add_u32 s22, s21, 90112
    s_mov_b32 m0, s22
    s_add_u32 s23, s19, 319488
    buffer_load_dwordx4 v1, s[4:7], s23 offen offset:0 lds
    buffer_load_dwordx4 v1, s[4:7], s23 offen offset:1024 lds
    buffer_load_dwordx4 v1, s[4:7], s23 offen offset:2048 lds
    ds_read_b128 v[56:59], v1 offset:0
    ds_read_b128 v[60:63], v1 offset:1024
    ds_read_b128 v[64:67], v1 offset:2048
    ds_read_b128 v[68:71], v1 offset:3072
    ds_read_b128 v[72:75], v1 offset:4096
    ds_read_b128 v[76:79], v1 offset:5120
    ds_read_b128 v[80:83], v1 offset:6144
    ds_read_b128 v[84:87], v1 offset:7168
    ds_read_b128 v[88:91], v1 offset:8192
    ds_read_b128 v[92:95], v1 offset:9216
    ds_read_b128 v[96:99], v1 offset:10240
    ds_read_b128 v[100:103], v1 offset:11264
    ds_read_b128 v[104:107], v1 offset:12288
    ds_read_b128 v[108:111], v1 offset:13312
    s_waitcnt lgkmcnt(13)
    v_mfma_f32_16x16x32_bf16 v[16:19], v[56:59], a[0:3], 0
    v_mfma_f32_16x16x32_bf16 v[20:23], v[56:59], a[56:59], 0
    s_waitcnt lgkmcnt(12)
    v_mfma_f32_16x16x32_bf16 v[16:19], v[60:63], a[4:7], v[16:19]
    v_mfma_f32_16x16x32_bf16 v[20:23], v[60:63], a[60:63], v[20:23]
    s_waitcnt lgkmcnt(11)
    v_mfma_f32_16x16x32_bf16 v[16:19], v[64:67], a[8:11], v[16:19]
    v_mfma_f32_16x16x32_bf16 v[20:23], v[64:67], a[64:67], v[20:23]
    s_waitcnt lgkmcnt(10)
    v_mfma_f32_16x16x32_bf16 v[16:19], v[68:71], a[12:15], v[16:19]
    v_mfma_f32_16x16x32_bf16 v[20:23], v[68:71], a[68:71], v[20:23]
    s_waitcnt lgkmcnt(9)
    v_mfma_f32_16x16x32_bf16 v[16:19], v[72:75], a[16:19], v[16:19]
    v_mfma_f32_16x16x32_bf16 v[20:23], v[72:75], a[72:75], v[20:23]
    s_waitcnt lgkmcnt(8)
    v_mfma_f32_16x16x32_bf16 v[16:19], v[76:79], a[20:23], v[16:19]
    v_mfma_f32_16x16x32_bf16 v[20:23], v[76:79], a[76:79], v[20:23]
    s_waitcnt lgkmcnt(7)
    v_mfma_f32_16x16x32_bf16 v[16:19], v[80:83], a[24:27], v[16:19]
    v_mfma_f32_16x16x32_bf16 v[20:23], v[80:83], a[80:83], v[20:23]
    s_waitcnt lgkmcnt(6)
    v_mfma_f32_16x16x32_bf16 v[16:19], v[84:87], a[28:31], v[16:19]
    v_mfma_f32_16x16x32_bf16 v[20:23], v[84:87], a[84:87], v[20:23]
    s_waitcnt lgkmcnt(5)
    v_mfma_f32_16x16x32_bf16 v[16:19], v[88:91], a[32:35], v[16:19]
    v_mfma_f32_16x16x32_bf16 v[20:23], v[88:91], a[88:91], v[20:23]
    s_waitcnt lgkmcnt(4)
    v_mfma_f32_16x16x32_bf16 v[16:19], v[92:95], a[36:39], v[16:19]
    v_mfma_f32_16x16x32_bf16 v[20:23], v[92:95], a[92:95], v[20:23]
    s_waitcnt lgkmcnt(3)
    v_mfma_f32_16x16x32_bf16 v[16:19], v[96:99], a[40:43], v[16:19]
    v_mfma_f32_16x16x32_bf16 v[20:23], v[96:99], a[96:99], v[20:23]
    s_waitcnt lgkmcnt(2)
    v_mfma_f32_16x16x32_bf16 v[16:19], v[100:103], a[44:47], v[16:19]
    v_mfma_f32_16x16x32_bf16 v[20:23], v[100:103], a[100:103], v[20:23]
    s_waitcnt lgkmcnt(1)
    v_mfma_f32_16x16x32_bf16 v[16:19], v[104:107], a[48:51], v[16:19]
    v_mfma_f32_16x16x32_bf16 v[20:23], v[104:107], a[104:107], v[20:23]
    s_waitcnt lgkmcnt(0)
    v_mfma_f32_16x16x32_bf16 v[16:19], v[108:111], a[52:55], v[16:19]
    v_mfma_f32_16x16x32_bf16 v[20:23], v[108:111], a[108:111], v[20:23]
    ds_read_b128 v[56:59], v1 offset:14336
    ds_read_b128 v[60:63], v1 offset:15360
    ds_read_b128 v[64:67], v1 offset:16384
    ds_read_b128 v[68:71], v1 offset:17408
    ds_read_b128 v[72:75], v1 offset:18432
    ds_read_b128 v[76:79], v1 offset:19456
    ds_read_b128 v[80:83], v1 offset:20480
    ds_read_b128 v[84:87], v1 offset:21504
    ds_read_b128 v[88:91], v1 offset:22528
    ds_read_b128 v[92:95], v1 offset:23552
    ds_read_b128 v[96:99], v1 offset:24576
    ds_read_b128 v[100:103], v1 offset:25600
    ds_read_b128 v[104:107], v1 offset:26624
    ds_read_b128 v[108:111], v1 offset:27648
    s_waitcnt lgkmcnt(13)
    v_mfma_f32_16x16x32_bf16 v[24:27], v[56:59], a[0:3], 0
    v_mfma_f32_16x16x32_bf16 v[28:31], v[56:59], a[56:59], 0
    s_waitcnt lgkmcnt(12)
    v_mfma_f32_16x16x32_bf16 v[24:27], v[60:63], a[4:7], v[24:27]
    v_mfma_f32_16x16x32_bf16 v[28:31], v[60:63], a[60:63], v[28:31]
    s_waitcnt lgkmcnt(11)
    v_mfma_f32_16x16x32_bf16 v[24:27], v[64:67], a[8:11], v[24:27]
    v_mfma_f32_16x16x32_bf16 v[28:31], v[64:67], a[64:67], v[28:31]
    s_waitcnt lgkmcnt(10)
    v_mfma_f32_16x16x32_bf16 v[24:27], v[68:71], a[12:15], v[24:27]
    v_mfma_f32_16x16x32_bf16 v[28:31], v[68:71], a[68:71], v[28:31]
    s_waitcnt lgkmcnt(9)
    v_mfma_f32_16x16x32_bf16 v[24:27], v[72:75], a[16:19], v[24:27]
    v_mfma_f32_16x16x32_bf16 v[28:31], v[72:75], a[72:75], v[28:31]
    s_waitcnt lgkmcnt(8)
    v_mfma_f32_16x16x32_bf16 v[24:27], v[76:79], a[20:23], v[24:27]
    v_mfma_f32_16x16x32_bf16 v[28:31], v[76:79], a[76:79], v[28:31]
    s_waitcnt lgkmcnt(7)
    v_mfma_f32_16x16x32_bf16 v[24:27], v[80:83], a[24:27], v[24:27]
    v_mfma_f32_16x16x32_bf16 v[28:31], v[80:83], a[80:83], v[28:31]
    s_waitcnt lgkmcnt(6)
    v_mfma_f32_16x16x32_bf16 v[24:27], v[84:87], a[28:31], v[24:27]
    v_mfma_f32_16x16x32_bf16 v[28:31], v[84:87], a[84:87], v[28:31]
    s_waitcnt lgkmcnt(5)
    v_mfma_f32_16x16x32_bf16 v[24:27], v[88:91], a[32:35], v[24:27]
    v_mfma_f32_16x16x32_bf16 v[28:31], v[88:91], a[88:91], v[28:31]
    s_waitcnt lgkmcnt(4)
    v_mfma_f32_16x16x32_bf16 v[24:27], v[92:95], a[36:39], v[24:27]
    v_mfma_f32_16x16x32_bf16 v[28:31], v[92:95], a[92:95], v[28:31]
    s_waitcnt lgkmcnt(3)
    v_mfma_f32_16x16x32_bf16 v[24:27], v[96:99], a[40:43], v[24:27]
    v_mfma_f32_16x16x32_bf16 v[28:31], v[96:99], a[96:99], v[28:31]
    s_waitcnt lgkmcnt(2)
    v_mfma_f32_16x16x32_bf16 v[24:27], v[100:103], a[44:47], v[24:27]
    v_mfma_f32_16x16x32_bf16 v[28:31], v[100:103], a[100:103], v[28:31]
    s_waitcnt lgkmcnt(1)
    v_mfma_f32_16x16x32_bf16 v[24:27], v[104:107], a[48:51], v[24:27]
    v_mfma_f32_16x16x32_bf16 v[28:31], v[104:107], a[104:107], v[28:31]
    s_waitcnt lgkmcnt(0)
    v_mfma_f32_16x16x32_bf16 v[24:27], v[108:111], a[52:55], v[24:27]
    v_mfma_f32_16x16x32_bf16 v[28:31], v[108:111], a[108:111], v[28:31]
    s_nop 7
    v_cvt_pk_bf16_f32 v208, v16, v24
    v_cvt_pk_bf16_f32 v209, v17, v25
    v_cvt_pk_bf16_f32 v210, v18, v26
    v_cvt_pk_bf16_f32 v211, v19, v27
    v_cvt_pk_bf16_f32 v212, v20, v28
    v_cvt_pk_bf16_f32 v213, v21, v29
    v_cvt_pk_bf16_f32 v214, v22, v30
    v_cvt_pk_bf16_f32 v215, v23, v31
    s_nop 1
    v_mfma_f32_16x16x32_bf16 v[32:35], a[144:147], v[208:211], v[32:35]
    v_mfma_f32_16x16x32_bf16 v[36:39], a[144:147], v[212:215], v[36:39]
    v_mfma_f32_16x16x32_bf16 v[40:43], a[200:203], v[212:215], v[40:43]
    s_waitcnt vmcnt(14)
    s_barrier
    s_add_u32 s22, s21, 0
    s_mov_b32 m0, s22
    s_add_u32 s23, s19, 344064
    buffer_load_dwordx4 v1, s[4:7], s23 offen offset:0 lds
    buffer_load_dwordx4 v1, s[4:7], s23 offen offset:1024 lds
    buffer_load_dwordx4 v1, s[4:7], s23 offen offset:2048 lds
    buffer_load_dwordx4 v1, s[4:7], s23 offen offset:3072 lds
    s_add_u32 s22, s21, 4096
    s_mov_b32 m0, s22
    s_add_u32 s23, s19, 348160
    buffer_load_dwordx4 v1, s[4:7], s23 offen offset:0 lds
    buffer_load_dwordx4 v1, s[4:7], s23 offen offset:1024 lds
    buffer_load_dwordx4 v1, s[4:7], s23 offen offset:2048 lds
    ds_read_b128 v[56:59], v1 offset:28672
    ds_read_b128 v[60:63], v1 offset:29696
    ds_read_b128 v[64:67], v1 offset:30720
    ds_read_b128 v[68:71], v1 offset:31744
    ds_read_b128 v[72:75], v1 offset:32768
    ds_read_b128 v[76:79], v1 offset:33792
    ds_read_b128 v[80:83], v1 offset:34816
    ds_read_b128 v[84:87], v1 offset:35840
    ds_read_b128 v[88:91], v1 offset:36864
    ds_read_b128 v[92:95], v1 offset:37888
    ds_read_b128 v[96:99], v1 offset:38912
    ds_read_b128 v[100:103], v1 offset:39936
    ds_read_b128 v[104:107], v1 offset:40960
    ds_read_b128 v[108:111], v1 offset:41984
    s_waitcnt lgkmcnt(13)
    v_mfma_f32_16x16x32_bf16 v[16:19], v[56:59], a[0:3], 0
    v_mfma_f32_16x16x32_bf16 v[20:23], v[56:59], a[56:59], 0
    s_waitcnt lgkmcnt(12)
    v_mfma_f32_16x16x32_bf16 v[16:19], v[60:63], a[4:7], v[16:19]
    v_mfma_f32_16x16x32_bf16 v[20:23], v[60:63], a[60:63], v[20:23]
    s_waitcnt lgkmcnt(11)
    v_mfma_f32_16x16x32_bf16 v[16:19], v[64:67], a[8:11], v[16:19]
    v_mfma_f32_16x16x32_bf16 v[20:23], v[64:67], a[64:67], v[20:23]
    s_waitcnt lgkmcnt(10)
    v_mfma_f32_16x16x32_bf16 v[16:19], v[68:71], a[12:15], v[16:19]
    v_mfma_f32_16x16x32_bf16 v[20:23], v[68:71], a[68:71], v[20:23]
    s_waitcnt lgkmcnt(9)
    v_mfma_f32_16x16x32_bf16 v[16:19], v[72:75], a[16:19], v[16:19]
    v_mfma_f32_16x16x32_bf16 v[20:23], v[72:75], a[72:75], v[20:23]
    s_waitcnt lgkmcnt(8)
    v_mfma_f32_16x16x32_bf16 v[16:19], v[76:79], a[20:23], v[16:19]
    v_mfma_f32_16x16x32_bf16 v[20:23], v[76:79], a[76:79], v[20:23]
    s_waitcnt lgkmcnt(7)
    v_mfma_f32_16x16x32_bf16 v[16:19], v[80:83], a[24:27], v[16:19]
    v_mfma_f32_16x16x32_bf16 v[20:23], v[80:83], a[80:83], v[20:23]
    s_waitcnt lgkmcnt(6)
    v_mfma_f32_16x16x32_bf16 v[16:19], v[84:87], a[28:31], v[16:19]
    v_mfma_f32_16x16x32_bf16 v[20:23], v[84:87], a[84:87], v[20:23]
    s_waitcnt lgkmcnt(5)
    v_mfma_f32_16x16x32_bf16 v[16:19], v[88:91], a[32:35], v[16:19]
    v_mfma_f32_16x16x32_bf16 v[20:23], v[88:91], a[88:91], v[20:23]
    s_waitcnt lgkmcnt(4)
    v_mfma_f32_16x16x32_bf16 v[16:19], v[92:95], a[36:39], v[16:19]
    v_mfma_f32_16x16x32_bf16 v[20:23], v[92:95], a[92:95], v[20:23]
    s_waitcnt lgkmcnt(3)
    v_mfma_f32_16x16x32_bf16 v[16:19], v[96:99], a[40:43], v[16:19]
    v_mfma_f32_16x16x32_bf16 v[20:23], v[96:99], a[96:99], v[20:23]
    s_waitcnt lgkmcnt(2)
    v_mfma_f32_16x16x32_bf16 v[16:19], v[100:103], a[44:47], v[16:19]
    v_mfma_f32_16x16x32_bf16 v[20:23], v[100:103], a[100:103], v[20:23]
    s_waitcnt lgkmcnt(1)
    v_mfma_f32_16x16x32_bf16 v[16:19], v[104:107], a[48:51], v[16:19]
    v_mfma_f32_16x16x32_bf16 v[20:23], v[104:107], a[104:107], v[20:23]
    s_waitcnt lgkmcnt(0)
    v_mfma_f32_16x16x32_bf16 v[16:19], v[108:111], a[52:55], v[16:19]
    v_mfma_f32_16x16x32_bf16 v[20:23], v[108:111], a[108:111], v[20:23]
    ds_read_b128 v[56:59], v1 offset:43008
    ds_read_b128 v[60:63], v1 offset:44032
    ds_read_b128 v[64:67], v1 offset:45056
    ds_read_b128 v[68:71], v1 offset:46080
    ds_read_b128 v[72:75], v1 offset:47104
    ds_read_b128 v[76:79], v1 offset:48128
    ds_read_b128 v[80:83], v1 offset:49152
    ds_read_b128 v[84:87], v1 offset:50176
    ds_read_b128 v[88:91], v1 offset:51200
    ds_read_b128 v[92:95], v1 offset:52224
    ds_read_b128 v[96:99], v1 offset:53248
    ds_read_b128 v[100:103], v1 offset:54272
    ds_read_b128 v[104:107], v1 offset:55296
    ds_read_b128 v[108:111], v1 offset:56320
    s_waitcnt lgkmcnt(13)
    v_mfma_f32_16x16x32_bf16 v[24:27], v[56:59], a[0:3], 0
    v_mfma_f32_16x16x32_bf16 v[28:31], v[56:59], a[56:59], 0
    s_waitcnt lgkmcnt(12)
    v_mfma_f32_16x16x32_bf16 v[24:27], v[60:63], a[4:7], v[24:27]
    v_mfma_f32_16x16x32_bf16 v[28:31], v[60:63], a[60:63], v[28:31]
    s_waitcnt lgkmcnt(11)
    v_mfma_f32_16x16x32_bf16 v[24:27], v[64:67], a[8:11], v[24:27]
    v_mfma_f32_16x16x32_bf16 v[28:31], v[64:67], a[64:67], v[28:31]
    s_waitcnt lgkmcnt(10)
    v_mfma_f32_16x16x32_bf16 v[24:27], v[68:71], a[12:15], v[24:27]
    v_mfma_f32_16x16x32_bf16 v[28:31], v[68:71], a[68:71], v[28:31]
    s_waitcnt lgkmcnt(9)
    v_mfma_f32_16x16x32_bf16 v[24:27], v[72:75], a[16:19], v[24:27]
    v_mfma_f32_16x16x32_bf16 v[28:31], v[72:75], a[72:75], v[28:31]
    s_waitcnt lgkmcnt(8)
    v_mfma_f32_16x16x32_bf16 v[24:27], v[76:79], a[20:23], v[24:27]
    v_mfma_f32_16x16x32_bf16 v[28:31], v[76:79], a[76:79], v[28:31]
    s_waitcnt lgkmcnt(7)
    v_mfma_f32_16x16x32_bf16 v[24:27], v[80:83], a[24:27], v[24:27]
    v_mfma_f32_16x16x32_bf16 v[28:31], v[80:83], a[80:83], v[28:31]
    s_waitcnt lgkmcnt(6)
    v_mfma_f32_16x16x32_bf16 v[24:27], v[84:87], a[28:31], v[24:27]
    v_mfma_f32_16x16x32_bf16 v[28:31], v[84:87], a[84:87], v[28:31]
    s_waitcnt lgkmcnt(5)
    v_mfma_f32_16x16x32_bf16 v[24:27], v[88:91], a[32:35], v[24:27]
    v_mfma_f32_16x16x32_bf16 v[28:31], v[88:91], a[88:91], v[28:31]
    s_waitcnt lgkmcnt(4)
    v_mfma_f32_16x16x32_bf16 v[24:27], v[92:95], a[36:39], v[24:27]
    v_mfma_f32_16x16x32_bf16 v[28:31], v[92:95], a[92:95], v[28:31]
    s_waitcnt lgkmcnt(3)
    v_mfma_f32_16x16x32_bf16 v[24:27], v[96:99], a[40:43], v[24:27]
    v_mfma_f32_16x16x32_bf16 v[28:31], v[96:99], a[96:99], v[28:31]
    s_waitcnt lgkmcnt(2)
    v_mfma_f32_16x16x32_bf16 v[24:27], v[100:103], a[44:47], v[24:27]
    v_mfma_f32_16x16x32_bf16 v[28:31], v[100:103], a[100:103], v[28:31]
    s_waitcnt lgkmcnt(1)
    v_mfma_f32_16x16x32_bf16 v[24:27], v[104:107], a[48:51], v[24:27]
    v_mfma_f32_16x16x32_bf16 v[28:31], v[104:107], a[104:107], v[28:31]
    s_waitcnt lgkmcnt(0)
    v_mfma_f32_16x16x32_bf16 v[24:27], v[108:111], a[52:55], v[24:27]
    v_mfma_f32_16x16x32_bf16 v[28:31], v[108:111], a[108:111], v[28:31]
    s_nop 7
    v_cvt_pk_bf16_f32 v216, v16, v24
    v_cvt_pk_bf16_f32 v217, v17, v25
    v_cvt_pk_bf16_f32 v218, v18, v26
    v_cvt_pk_bf16_f32 v219, v19, v27
    v_cvt_pk_bf16_f32 v220, v20, v28
    v_cvt_pk_bf16_f32 v221, v21, v29
    v_cvt_pk_bf16_f32 v222, v22, v30
    v_cvt_pk_bf16_f32 v223, v23, v31
    s_nop 1
    v_mfma_f32_16x16x32_bf16 v[32:35], a[148:151], v[216:219], v[32:35]
    v_mfma_f32_16x16x32_bf16 v[36:39], a[148:151], v[220:223], v[36:39]
    v_mfma_f32_16x16x32_bf16 v[40:43], a[204:207], v[220:223], v[40:43]
    s_waitcnt vmcnt(14)
    s_barrier
    s_add_u32 s22, s21, 28672
    s_mov_b32 m0, s22
    s_add_u32 s23, s19, 372736
    buffer_load_dwordx4 v1, s[4:7], s23 offen offset:0 lds
    buffer_load_dwordx4 v1, s[4:7], s23 offen offset:1024 lds
    buffer_load_dwordx4 v1, s[4:7], s23 offen offset:2048 lds
    buffer_load_dwordx4 v1, s[4:7], s23 offen offset:3072 lds
    s_add_u32 s22, s21, 32768
    s_mov_b32 m0, s22
    s_add_u32 s23, s19, 376832
    buffer_load_dwordx4 v1, s[4:7], s23 offen offset:0 lds
    buffer_load_dwordx4 v1, s[4:7], s23 offen offset:1024 lds
    buffer_load_dwordx4 v1, s[4:7], s23 offen offset:2048 lds
    v_add_u32 v2, 57344, v1
    ds_read_b128 v[56:59], v2 offset:0
    ds_read_b128 v[60:63], v2 offset:1024
    ds_read_b128 v[64:67], v2 offset:2048
    ds_read_b128 v[68:71], v2 offset:3072
    ds_read_b128 v[72:75], v2 offset:4096
    ds_read_b128 v[76:79], v2 offset:5120
    ds_read_b128 v[80:83], v2 offset:6144
    ds_read_b128 v[84:87], v2 offset:7168
    ds_read_b128 v[88:91], v2 offset:8192
    ds_read_b128 v[92:95], v2 offset:9216
    ds_read_b128 v[96:99], v2 offset:10240
    ds_read_b128 v[100:103], v2 offset:11264
    ds_read_b128 v[104:107], v2 offset:12288
    ds_read_b128 v[108:111], v2 offset:13312
    s_waitcnt lgkmcnt(13)
    v_mfma_f32_16x16x32_bf16 v[16:19], v[56:59], a[0:3], 0
    v_mfma_f32_16x16x32_bf16 v[20:23], v[56:59], a[56:59], 0
    s_waitcnt lgkmcnt(12)
    v_mfma_f32_16x16x32_bf16 v[16:19], v[60:63], a[4:7], v[16:19]
    v_mfma_f32_16x16x32_bf16 v[20:23], v[60:63], a[60:63], v[20:23]
    s_waitcnt lgkmcnt(11)
    v_mfma_f32_16x16x32_bf16 v[16:19], v[64:67], a[8:11], v[16:19]
    v_mfma_f32_16x16x32_bf16 v[20:23], v[64:67], a[64:67], v[20:23]
    s_waitcnt lgkmcnt(10)
    v_mfma_f32_16x16x32_bf16 v[16:19], v[68:71], a[12:15], v[16:19]
    v_mfma_f32_16x16x32_bf16 v[20:23], v[68:71], a[68:71], v[20:23]
    s_waitcnt lgkmcnt(9)
    v_mfma_f32_16x16x32_bf16 v[16:19], v[72:75], a[16:19], v[16:19]
    v_mfma_f32_16x16x32_bf16 v[20:23], v[72:75], a[72:75], v[20:23]
    s_waitcnt lgkmcnt(8)
    v_mfma_f32_16x16x32_bf16 v[16:19], v[76:79], a[20:23], v[16:19]
    v_mfma_f32_16x16x32_bf16 v[20:23], v[76:79], a[76:79], v[20:23]
    s_waitcnt lgkmcnt(7)
    v_mfma_f32_16x16x32_bf16 v[16:19], v[80:83], a[24:27], v[16:19]
    v_mfma_f32_16x16x32_bf16 v[20:23], v[80:83], a[80:83], v[20:23]
    s_waitcnt lgkmcnt(6)
    v_mfma_f32_16x16x32_bf16 v[16:19], v[84:87], a[28:31], v[16:19]
    v_mfma_f32_16x16x32_bf16 v[20:23], v[84:87], a[84:87], v[20:23]
    s_waitcnt lgkmcnt(5)
    v_mfma_f32_16x16x32_bf16 v[16:19], v[88:91], a[32:35], v[16:19]
    v_mfma_f32_16x16x32_bf16 v[20:23], v[88:91], a[88:91], v[20:23]
    s_waitcnt lgkmcnt(4)
    v_mfma_f32_16x16x32_bf16 v[16:19], v[92:95], a[36:39], v[16:19]
    v_mfma_f32_16x16x32_bf16 v[20:23], v[92:95], a[92:95], v[20:23]
    s_waitcnt lgkmcnt(3)
    v_mfma_f32_16x16x32_bf16 v[16:19], v[96:99], a[40:43], v[16:19]
    v_mfma_f32_16x16x32_bf16 v[20:23], v[96:99], a[96:99], v[20:23]
    s_waitcnt lgkmcnt(2)
    v_mfma_f32_16x16x32_bf16 v[16:19], v[100:103], a[44:47], v[16:19]
    v_mfma_f32_16x16x32_bf16 v[20:23], v[100:103], a[100:103], v[20:23]
    s_waitcnt lgkmcnt(1)
    v_mfma_f32_16x16x32_bf16 v[16:19], v[104:107], a[48:51], v[16:19]
    v_mfma_f32_16x16x32_bf16 v[20:23], v[104:107], a[104:107], v[20:23]
    s_waitcnt lgkmcnt(0)
    v_mfma_f32_16x16x32_bf16 v[16:19], v[108:111], a[52:55], v[16:19]
    v_mfma_f32_16x16x32_bf16 v[20:23], v[108:111], a[108:111], v[20:23]
    ds_read_b128 v[56:59], v2 offset:14336
    ds_read_b128 v[60:63], v2 offset:15360
    ds_read_b128 v[64:67], v2 offset:16384
    ds_read_b128 v[68:71], v2 offset:17408
    ds_read_b128 v[72:75], v2 offset:18432
    ds_read_b128 v[76:79], v2 offset:19456
    ds_read_b128 v[80:83], v2 offset:20480
    ds_read_b128 v[84:87], v2 offset:21504
    ds_read_b128 v[88:91], v2 offset:22528
    ds_read_b128 v[92:95], v2 offset:23552
    ds_read_b128 v[96:99], v2 offset:24576
    ds_read_b128 v[100:103], v2 offset:25600
    ds_read_b128 v[104:107], v2 offset:26624
    ds_read_b128 v[108:111], v2 offset:27648
    s_waitcnt lgkmcnt(13)
    v_mfma_f32_16x16x32_bf16 v[24:27], v[56:59], a[0:3], 0
    v_mfma_f32_16x16x32_bf16 v[28:31], v[56:59], a[56:59], 0
    s_waitcnt lgkmcnt(12)
    v_mfma_f32_16x16x32_bf16 v[24:27], v[60:63], a[4:7], v[24:27]
    v_mfma_f32_16x16x32_bf16 v[28:31], v[60:63], a[60:63], v[28:31]
    s_waitcnt lgkmcnt(11)
    v_mfma_f32_16x16x32_bf16 v[24:27], v[64:67], a[8:11], v[24:27]
    v_mfma_f32_16x16x32_bf16 v[28:31], v[64:67], a[64:67], v[28:31]
    s_waitcnt lgkmcnt(10)
    v_mfma_f32_16x16x32_bf16 v[24:27], v[68:71], a[12:15], v[24:27]
    v_mfma_f32_16x16x32_bf16 v[28:31], v[68:71], a[68:71], v[28:31]
    s_waitcnt lgkmcnt(9)
    v_mfma_f32_16x16x32_bf16 v[24:27], v[72:75], a[16:19], v[24:27]
    v_mfma_f32_16x16x32_bf16 v[28:31], v[72:75], a[72:75], v[28:31]
    s_waitcnt lgkmcnt(8)
    v_mfma_f32_16x16x32_bf16 v[24:27], v[76:79], a[20:23], v[24:27]
    v_mfma_f32_16x16x32_bf16 v[28:31], v[76:79], a[76:79], v[28:31]
    s_waitcnt lgkmcnt(7)
    v_mfma_f32_16x16x32_bf16 v[24:27], v[80:83], a[24:27], v[24:27]
    v_mfma_f32_16x16x32_bf16 v[28:31], v[80:83], a[80:83], v[28:31]
    s_waitcnt lgkmcnt(6)
    v_mfma_f32_16x16x32_bf16 v[24:27], v[84:87], a[28:31], v[24:27]
    v_mfma_f32_16x16x32_bf16 v[28:31], v[84:87], a[84:87], v[28:31]
    s_waitcnt lgkmcnt(5)
    v_mfma_f32_16x16x32_bf16 v[24:27], v[88:91], a[32:35], v[24:27]
    v_mfma_f32_16x16x32_bf16 v[28:31], v[88:91], a[88:91], v[28:31]
    s_waitcnt lgkmcnt(4)
    v_mfma_f32_16x16x32_bf16 v[24:27], v[92:95], a[36:39], v[24:27]
    v_mfma_f32_16x16x32_bf16 v[28:31], v[92:95], a[92:95], v[28:31]
    s_waitcnt lgkmcnt(3)
    v_mfma_f32_16x16x32_bf16 v[24:27], v[96:99], a[40:43], v[24:27]
    v_mfma_f32_16x16x32_bf16 v[28:31], v[96:99], a[96:99], v[28:31]
    s_waitcnt lgkmcnt(2)
    v_mfma_f32_16x16x32_bf16 v[24:27], v[100:103], a[44:47], v[24:27]
    v_mfma_f32_16x16x32_bf16 v[28:31], v[100:103], a[100:103], v[28:31]
    s_waitcnt lgkmcnt(1)
    v_mfma_f32_16x16x32_bf16 v[24:27], v[104:107], a[48:51], v[24:27]
    v_mfma_f32_16x16x32_bf16 v[28:31], v[104:107], a[104:107], v[28:31]
    s_waitcnt lgkmcnt(0)
    v_mfma_f32_16x16x32_bf16 v[24:27], v[108:111], a[52:55], v[24:27]
    v_mfma_f32_16x16x32_bf16 v[28:31], v[108:111], a[108:111], v[28:31]
    s_nop 7
    v_cvt_pk_bf16_f32 v224, v16, v24
    v_cvt_pk_bf16_f32 v225, v17, v25
    v_cvt_pk_bf16_f32 v226, v18, v26
    v_cvt_pk_bf16_f32 v227, v19, v27
    v_cvt_pk_bf16_f32 v228, v20, v28
    v_cvt_pk_bf16_f32 v229, v21, v29
    v_cvt_pk_bf16_f32 v230, v22, v30
    v_cvt_pk_bf16_f32 v231, v23, v31
    s_nop 1
    v_mfma_f32_16x16x32_bf16 v[32:35], a[152:155], v[224:227], v[32:35]
    v_mfma_f32_16x16x32_bf16 v[36:39], a[152:155], v[228:231], v[36:39]
    v_mfma_f32_16x16x32_bf16 v[40:43], a[208:211], v[228:231], v[40:43]
    s_waitcnt vmcnt(14)
    s_barrier
    v_add_u32 v2, 86016, v1
    ds_read_b128 v[56:59], v2 offset:0
    ds_read_b128 v[60:63], v2 offset:1024
    ds_read_b128 v[64:67], v2 offset:2048
    ds_read_b128 v[68:71], v2 offset:3072
    ds_read_b128 v[72:75], v2 offset:4096
    ds_read_b128 v[76:79], v2 offset:5120
    ds_read_b128 v[80:83], v2 offset:6144
    ds_read_b128 v[84:87], v2 offset:7168
    ds_read_b128 v[88:91], v2 offset:8192
    ds_read_b128 v[92:95], v2 offset:9216
    ds_read_b128 v[96:99], v2 offset:10240
    ds_read_b128 v[100:103], v2 offset:11264
    ds_read_b128 v[104:107], v2 offset:12288
    ds_read_b128 v[108:111], v2 offset:13312
    s_waitcnt lgkmcnt(13)
    v_mfma_f32_16x16x32_bf16 v[16:19], v[56:59], a[0:3], 0
    v_mfma_f32_16x16x32_bf16 v[20:23], v[56:59], a[56:59], 0
    s_waitcnt lgkmcnt(12)
    v_mfma_f32_16x16x32_bf16 v[16:19], v[60:63], a[4:7], v[16:19]
    v_mfma_f32_16x16x32_bf16 v[20:23], v[60:63], a[60:63], v[20:23]
    s_waitcnt lgkmcnt(11)
    v_mfma_f32_16x16x32_bf16 v[16:19], v[64:67], a[8:11], v[16:19]
    v_mfma_f32_16x16x32_bf16 v[20:23], v[64:67], a[64:67], v[20:23]
    s_waitcnt lgkmcnt(10)
    v_mfma_f32_16x16x32_bf16 v[16:19], v[68:71], a[12:15], v[16:19]
    v_mfma_f32_16x16x32_bf16 v[20:23], v[68:71], a[68:71], v[20:23]
    s_waitcnt lgkmcnt(9)
    v_mfma_f32_16x16x32_bf16 v[16:19], v[72:75], a[16:19], v[16:19]
    v_mfma_f32_16x16x32_bf16 v[20:23], v[72:75], a[72:75], v[20:23]
    s_waitcnt lgkmcnt(8)
    v_mfma_f32_16x16x32_bf16 v[16:19], v[76:79], a[20:23], v[16:19]
    v_mfma_f32_16x16x32_bf16 v[20:23], v[76:79], a[76:79], v[20:23]
    s_waitcnt lgkmcnt(7)
    v_mfma_f32_16x16x32_bf16 v[16:19], v[80:83], a[24:27], v[16:19]
    v_mfma_f32_16x16x32_bf16 v[20:23], v[80:83], a[80:83], v[20:23]
    s_waitcnt lgkmcnt(6)
    v_mfma_f32_16x16x32_bf16 v[16:19], v[84:87], a[28:31], v[16:19]
    v_mfma_f32_16x16x32_bf16 v[20:23], v[84:87], a[84:87], v[20:23]
    s_waitcnt lgkmcnt(5)
    v_mfma_f32_16x16x32_bf16 v[16:19], v[88:91], a[32:35], v[16:19]
    v_mfma_f32_16x16x32_bf16 v[20:23], v[88:91], a[88:91], v[20:23]
    s_waitcnt lgkmcnt(4)
    v_mfma_f32_16x16x32_bf16 v[16:19], v[92:95], a[36:39], v[16:19]
    v_mfma_f32_16x16x32_bf16 v[20:23], v[92:95], a[92:95], v[20:23]
    s_waitcnt lgkmcnt(3)
    v_mfma_f32_16x16x32_bf16 v[16:19], v[96:99], a[40:43], v[16:19]
    v_mfma_f32_16x16x32_bf16 v[20:23], v[96:99], a[96:99], v[20:23]
    s_waitcnt lgkmcnt(2)
    v_mfma_f32_16x16x32_bf16 v[16:19], v[100:103], a[44:47], v[16:19]
    v_mfma_f32_16x16x32_bf16 v[20:23], v[100:103], a[100:103], v[20:23]
    s_waitcnt lgkmcnt(1)
    v_mfma_f32_16x16x32_bf16 v[16:19], v[104:107], a[48:51], v[16:19]
    v_mfma_f32_16x16x32_bf16 v[20:23], v[104:107], a[104:107], v[20:23]
    s_waitcnt lgkmcnt(0)
    v_mfma_f32_16x16x32_bf16 v[16:19], v[108:111], a[52:55], v[16:19]
    v_mfma_f32_16x16x32_bf16 v[20:23], v[108:111], a[108:111], v[20:23]
    ds_read_b128 v[56:59], v2 offset:14336
    ds_read_b128 v[60:63], v2 offset:15360
    ds_read_b128 v[64:67], v2 offset:16384
    ds_read_b128 v[68:71], v2 offset:17408
    ds_read_b128 v[72:75], v2 offset:18432
    ds_read_b128 v[76:79], v2 offset:19456
    ds_read_b128 v[80:83], v2 offset:20480
    ds_read_b128 v[84:87], v2 offset:21504
    ds_read_b128 v[88:91], v2 offset:22528
    ds_read_b128 v[92:95], v2 offset:23552
    ds_read_b128 v[96:99], v2 offset:24576
    ds_read_b128 v[100:103], v2 offset:25600
    ds_read_b128 v[104:107], v2 offset:26624
    ds_read_b128 v[108:111], v2 offset:27648
    s_waitcnt lgkmcnt(13)
    v_mfma_f32_16x16x32_bf16 v[24:27], v[56:59], a[0:3], 0
    v_mfma_f32_16x16x32_bf16 v[28:31], v[56:59], a[56:59], 0
    s_waitcnt lgkmcnt(12)
    v_mfma_f32_16x16x32_bf16 v[24:27], v[60:63], a[4:7], v[24:27]
    v_mfma_f32_16x16x32_bf16 v[28:31], v[60:63], a[60:63], v[28:31]
    s_waitcnt lgkmcnt(11)
    v_mfma_f32_16x16x32_bf16 v[24:27], v[64:67], a[8:11], v[24:27]
    v_mfma_f32_16x16x32_bf16 v[28:31], v[64:67], a[64:67], v[28:31]
    s_waitcnt lgkmcnt(10)
    v_mfma_f32_16x16x32_bf16 v[24:27], v[68:71], a[12:15], v[24:27]
    v_mfma_f32_16x16x32_bf16 v[28:31], v[68:71], a[68:71], v[28:31]
    s_waitcnt lgkmcnt(9)
    v_mfma_f32_16x16x32_bf16 v[24:27], v[72:75], a[16:19], v[24:27]
    v_mfma_f32_16x16x32_bf16 v[28:31], v[72:75], a[72:75], v[28:31]
    s_waitcnt lgkmcnt(8)
    v_mfma_f32_16x16x32_bf16 v[24:27], v[76:79], a[20:23], v[24:27]
    v_mfma_f32_16x16x32_bf16 v[28:31], v[76:79], a[76:79], v[28:31]
    s_waitcnt lgkmcnt(7)
    v_mfma_f32_16x16x32_bf16 v[24:27], v[80:83], a[24:27], v[24:27]
    v_mfma_f32_16x16x32_bf16 v[28:31], v[80:83], a[80:83], v[28:31]
    s_waitcnt lgkmcnt(6)
    v_mfma_f32_16x16x32_bf16 v[24:27], v[84:87], a[28:31], v[24:27]
    v_mfma_f32_16x16x32_bf16 v[28:31], v[84:87], a[84:87], v[28:31]
    s_waitcnt lgkmcnt(5)
    v_mfma_f32_16x16x32_bf16 v[24:27], v[88:91], a[32:35], v[24:27]
    v_mfma_f32_16x16x32_bf16 v[28:31], v[88:91], a[88:91], v[28:31]
    s_waitcnt lgkmcnt(4)
    v_mfma_f32_16x16x32_bf16 v[24:27], v[92:95], a[36:39], v[24:27]
    v_mfma_f32_16x16x32_bf16 v[28:31], v[92:95], a[92:95], v[28:31]
    s_waitcnt lgkmcnt(3)
    v_mfma_f32_16x16x32_bf16 v[24:27], v[96:99], a[40:43], v[24:27]
    v_mfma_f32_16x16x32_bf16 v[28:31], v[96:99], a[96:99], v[28:31]
    s_waitcnt lgkmcnt(2)
    v_mfma_f32_16x16x32_bf16 v[24:27], v[100:103], a[44:47], v[24:27]
    v_mfma_f32_16x16x32_bf16 v[28:31], v[100:103], a[100:103], v[28:31]
    s_waitcnt lgkmcnt(1)
    v_mfma_f32_16x16x32_bf16 v[24:27], v[104:107], a[48:51], v[24:27]
    v_mfma_f32_16x16x32_bf16 v[28:31], v[104:107], a[104:107], v[28:31]
    s_waitcnt lgkmcnt(0)
    v_mfma_f32_16x16x32_bf16 v[24:27], v[108:111], a[52:55], v[24:27]
    v_mfma_f32_16x16x32_bf16 v[28:31], v[108:111], a[108:111], v[28:31]
    s_nop 7
    v_cvt_pk_bf16_f32 v232, v16, v24
    v_cvt_pk_bf16_f32 v233, v17, v25
    v_cvt_pk_bf16_f32 v234, v18, v26
    v_cvt_pk_bf16_f32 v235, v19, v27
    v_cvt_pk_bf16_f32 v236, v20, v28
    v_cvt_pk_bf16_f32 v237, v21, v29
    v_cvt_pk_bf16_f32 v238, v22, v30
    v_cvt_pk_bf16_f32 v239, v23, v31
    s_nop 1
    v_mfma_f32_16x16x32_bf16 v[32:35], a[156:159], v[232:235], v[32:35]
    v_mfma_f32_16x16x32_bf16 v[36:39], a[156:159], v[236:239], v[36:39]
    v_mfma_f32_16x16x32_bf16 v[40:43], a[212:215], v[236:239], v[40:43]
    s_waitcnt vmcnt(7)
    s_barrier
    ds_read_b128 v[56:59], v1 offset:0
    ds_read_b128 v[60:63], v1 offset:1024
    ds_read_b128 v[64:67], v1 offset:2048
    ds_read_b128 v[68:71], v1 offset:3072
    ds_read_b128 v[72:75], v1 offset:4096
    ds_read_b128 v[76:79], v1 offset:5120
    ds_read_b128 v[80:83], v1 offset:6144
    ds_read_b128 v[84:87], v1 offset:7168
    ds_read_b128 v[88:91], v1 offset:8192
    ds_read_b128 v[92:95], v1 offset:9216
    ds_read_b128 v[96:99], v1 offset:10240
    ds_read_b128 v[100:103], v1 offset:11264
    ds_read_b128 v[104:107], v1 offset:12288
    ds_read_b128 v[108:111], v1 offset:13312
    s_waitcnt lgkmcnt(13)
    v_mfma_f32_16x16x32_bf16 v[16:19], v[56:59], a[0:3], 0
    v_mfma_f32_16x16x32_bf16 v[20:23], v[56:59], a[56:59], 0
    s_waitcnt lgkmcnt(12)
    v_mfma_f32_16x16x32_bf16 v[16:19], v[60:63], a[4:7], v[16:19]
    v_mfma_f32_16x16x32_bf16 v[20:23], v[60:63], a[60:63], v[20:23]
    s_waitcnt lgkmcnt(11)
    v_mfma_f32_16x16x32_bf16 v[16:19], v[64:67], a[8:11], v[16:19]
    v_mfma_f32_16x16x32_bf16 v[20:23], v[64:67], a[64:67], v[20:23]
    s_waitcnt lgkmcnt(10)
    v_mfma_f32_16x16x32_bf16 v[16:19], v[68:71], a[12:15], v[16:19]
    v_mfma_f32_16x16x32_bf16 v[20:23], v[68:71], a[68:71], v[20:23]
    s_waitcnt lgkmcnt(9)
    v_mfma_f32_16x16x32_bf16 v[16:19], v[72:75], a[16:19], v[16:19]
    v_mfma_f32_16x16x32_bf16 v[20:23], v[72:75], a[72:75], v[20:23]
    s_waitcnt lgkmcnt(8)
    v_mfma_f32_16x16x32_bf16 v[16:19], v[76:79], a[20:23], v[16:19]
    v_mfma_f32_16x16x32_bf16 v[20:23], v[76:79], a[76:79], v[20:23]
    s_waitcnt lgkmcnt(7)
    v_mfma_f32_16x16x32_bf16 v[16:19], v[80:83], a[24:27], v[16:19]
    v_mfma_f32_16x16x32_bf16 v[20:23], v[80:83], a[80:83], v[20:23]
    s_waitcnt lgkmcnt(6)
    v_mfma_f32_16x16x32_bf16 v[16:19], v[84:87], a[28:31], v[16:19]
    v_mfma_f32_16x16x32_bf16 v[20:23], v[84:87], a[84:87], v[20:23]
    s_waitcnt lgkmcnt(5)
    v_mfma_f32_16x16x32_bf16 v[16:19], v[88:91], a[32:35], v[16:19]
    v_mfma_f32_16x16x32_bf16 v[20:23], v[88:91], a[88:91], v[20:23]
    s_waitcnt lgkmcnt(4)
    v_mfma_f32_16x16x32_bf16 v[16:19], v[92:95], a[36:39], v[16:19]
    v_mfma_f32_16x16x32_bf16 v[20:23], v[92:95], a[92:95], v[20:23]
    s_waitcnt lgkmcnt(3)
    v_mfma_f32_16x16x32_bf16 v[16:19], v[96:99], a[40:43], v[16:19]
    v_mfma_f32_16x16x32_bf16 v[20:23], v[96:99], a[96:99], v[20:23]
    s_waitcnt lgkmcnt(2)
    v_mfma_f32_16x16x32_bf16 v[16:19], v[100:103], a[44:47], v[16:19]
    v_mfma_f32_16x16x32_bf16 v[20:23], v[100:103], a[100:103], v[20:23]
    s_waitcnt lgkmcnt(1)
    v_mfma_f32_16x16x32_bf16 v[16:19], v[104:107], a[48:51], v[16:19]
    v_mfma_f32_16x16x32_bf16 v[20:23], v[104:107], a[104:107], v[20:23]
    s_waitcnt lgkmcnt(0)
    v_mfma_f32_16x16x32_bf16 v[16:19], v[108:111], a[52:55], v[16:19]
    v_mfma_f32_16x16x32_bf16 v[20:23], v[108:111], a[108:111], v[20:23]
    ds_read_b128 v[56:59], v1 offset:14336
    ds_read_b128 v[60:63], v1 offset:15360
    ds_read_b128 v[64:67], v1 offset:16384
    ds_read_b128 v[68:71], v1 offset:17408
    ds_read_b128 v[72:75], v1 offset:18432
    ds_read_b128 v[76:79], v1 offset:19456
    ds_read_b128 v[80:83], v1 offset:20480
    ds_read_b128 v[84:87], v1 offset:21504
    ds_read_b128 v[88:91], v1 offset:22528
    ds_read_b128 v[92:95], v1 offset:23552
    ds_read_b128 v[96:99], v1 offset:24576
    ds_read_b128 v[100:103], v1 offset:25600
    ds_read_b128 v[104:107], v1 offset:26624
    ds_read_b128 v[108:111], v1 offset:27648
    s_waitcnt lgkmcnt(13)
    v_mfma_f32_16x16x32_bf16 v[24:27], v[56:59], a[0:3], 0
    v_mfma_f32_16x16x32_bf16 v[28:31], v[56:59], a[56:59], 0
    s_waitcnt lgkmcnt(12)
    v_mfma_f32_16x16x32_bf16 v[24:27], v[60:63], a[4:7], v[24:27]
    v_mfma_f32_16x16x32_bf16 v[28:31], v[60:63], a[60:63], v[28:31]
    s_waitcnt lgkmcnt(11)
    v_mfma_f32_16x16x32_bf16 v[24:27], v[64:67], a[8:11], v[24:27]
    v_mfma_f32_16x16x32_bf16 v[28:31], v[64:67], a[64:67], v[28:31]
    s_waitcnt lgkmcnt(10)
    v_mfma_f32_16x16x32_bf16 v[24:27], v[68:71], a[12:15], v[24:27]
    v_mfma_f32_16x16x32_bf16 v[28:31], v[68:71], a[68:71], v[28:31]
    s_waitcnt lgkmcnt(9)
    v_mfma_f32_16x16x32_bf16 v[24:27], v[72:75], a[16:19], v[24:27]
    v_mfma_f32_16x16x32_bf16 v[28:31], v[72:75], a[72:75], v[28:31]
    s_waitcnt lgkmcnt(8)
    v_mfma_f32_16x16x32_bf16 v[24:27], v[76:79], a[20:23], v[24:27]
    v_mfma_f32_16x16x32_bf16 v[28:31], v[76:79], a[76:79], v[28:31]
    s_waitcnt lgkmcnt(7)
    v_mfma_f32_16x16x32_bf16 v[24:27], v[80:83], a[24:27], v[24:27]
    v_mfma_f32_16x16x32_bf16 v[28:31], v[80:83], a[80:83], v[28:31]
    s_waitcnt lgkmcnt(6)
    v_mfma_f32_16x16x32_bf16 v[24:27], v[84:87], a[28:31], v[24:27]
    v_mfma_f32_16x16x32_bf16 v[28:31], v[84:87], a[84:87], v[28:31]
    s_waitcnt lgkmcnt(5)
    v_mfma_f32_16x16x32_bf16 v[24:27], v[88:91], a[32:35], v[24:27]
    v_mfma_f32_16x16x32_bf16 v[28:31], v[88:91], a[88:91], v[28:31]
    s_waitcnt lgkmcnt(4)
    v_mfma_f32_16x16x32_bf16 v[24:27], v[92:95], a[36:39], v[24:27]
    v_mfma_f32_16x16x32_bf16 v[28:31], v[92:95], a[92:95], v[28:31]
    s_waitcnt lgkmcnt(3)
    v_mfma_f32_16x16x32_bf16 v[24:27], v[96:99], a[40:43], v[24:27]
    v_mfma_f32_16x16x32_bf16 v[28:31], v[96:99], a[96:99], v[28:31]
    s_waitcnt lgkmcnt(2)
    v_mfma_f32_16x16x32_bf16 v[24:27], v[100:103], a[44:47], v[24:27]
    v_mfma_f32_16x16x32_bf16 v[28:31], v[100:103], a[100:103], v[28:31]
    s_waitcnt lgkmcnt(1)
    v_mfma_f32_16x16x32_bf16 v[24:27], v[104:107], a[48:51], v[24:27]
    v_mfma_f32_16x16x32_bf16 v[28:31], v[104:107], a[104:107], v[28:31]
    s_waitcnt lgkmcnt(0)
    v_mfma_f32_16x16x32_bf16 v[24:27], v[108:111], a[52:55], v[24:27]
    v_mfma_f32_16x16x32_bf16 v[28:31], v[108:111], a[108:111], v[28:31]
    s_nop 7
    v_cvt_pk_bf16_f32 v240, v16, v24
    v_cvt_pk_bf16_f32 v241, v17, v25
    v_cvt_pk_bf16_f32 v242, v18, v26
    v_cvt_pk_bf16_f32 v243, v19, v27
    v_cvt_pk_bf16_f32 v244, v20, v28
    v_cvt_pk_bf16_f32 v245, v21, v29
    v_cvt_pk_bf16_f32 v246, v22, v30
    v_cvt_pk_bf16_f32 v247, v23, v31
    s_nop 1
    v_mfma_f32_16x16x32_bf16 v[32:35], a[160:163], v[240:243], v[32:35]
    v_mfma_f32_16x16x32_bf16 v[36:39], a[160:163], v[244:247], v[36:39]
    v_mfma_f32_16x16x32_bf16 v[40:43], a[216:219], v[244:247], v[40:43]
    s_waitcnt vmcnt(0)
    s_barrier
    ds_read_b128 v[56:59], v1 offset:28672
    ds_read_b128 v[60:63], v1 offset:29696
    ds_read_b128 v[64:67], v1 offset:30720
    ds_read_b128 v[68:71], v1 offset:31744
    ds_read_b128 v[72:75], v1 offset:32768
    ds_read_b128 v[76:79], v1 offset:33792
    ds_read_b128 v[80:83], v1 offset:34816
    ds_read_b128 v[84:87], v1 offset:35840
    ds_read_b128 v[88:91], v1 offset:36864
    ds_read_b128 v[92:95], v1 offset:37888
    ds_read_b128 v[96:99], v1 offset:38912
    ds_read_b128 v[100:103], v1 offset:39936
    ds_read_b128 v[104:107], v1 offset:40960
    ds_read_b128 v[108:111], v1 offset:41984
    s_waitcnt lgkmcnt(13)
    v_mfma_f32_16x16x32_bf16 v[16:19], v[56:59], a[0:3], 0
    v_mfma_f32_16x16x32_bf16 v[20:23], v[56:59], a[56:59], 0
    s_waitcnt lgkmcnt(12)
    v_mfma_f32_16x16x32_bf16 v[16:19], v[60:63], a[4:7], v[16:19]
    v_mfma_f32_16x16x32_bf16 v[20:23], v[60:63], a[60:63], v[20:23]
    s_waitcnt lgkmcnt(11)
    v_mfma_f32_16x16x32_bf16 v[16:19], v[64:67], a[8:11], v[16:19]
    v_mfma_f32_16x16x32_bf16 v[20:23], v[64:67], a[64:67], v[20:23]
    s_waitcnt lgkmcnt(10)
    v_mfma_f32_16x16x32_bf16 v[16:19], v[68:71], a[12:15], v[16:19]
    v_mfma_f32_16x16x32_bf16 v[20:23], v[68:71], a[68:71], v[20:23]
    s_waitcnt lgkmcnt(9)
    v_mfma_f32_16x16x32_bf16 v[16:19], v[72:75], a[16:19], v[16:19]
    v_mfma_f32_16x16x32_bf16 v[20:23], v[72:75], a[72:75], v[20:23]
    s_waitcnt lgkmcnt(8)
    v_mfma_f32_16x16x32_bf16 v[16:19], v[76:79], a[20:23], v[16:19]
    v_mfma_f32_16x16x32_bf16 v[20:23], v[76:79], a[76:79], v[20:23]
    s_waitcnt lgkmcnt(7)
    v_mfma_f32_16x16x32_bf16 v[16:19], v[80:83], a[24:27], v[16:19]
    v_mfma_f32_16x16x32_bf16 v[20:23], v[80:83], a[80:83], v[20:23]
    s_waitcnt lgkmcnt(6)
    v_mfma_f32_16x16x32_bf16 v[16:19], v[84:87], a[28:31], v[16:19]
    v_mfma_f32_16x16x32_bf16 v[20:23], v[84:87], a[84:87], v[20:23]
    s_waitcnt lgkmcnt(5)
    v_mfma_f32_16x16x32_bf16 v[16:19], v[88:91], a[32:35], v[16:19]
    v_mfma_f32_16x16x32_bf16 v[20:23], v[88:91], a[88:91], v[20:23]
    s_waitcnt lgkmcnt(4)
    v_mfma_f32_16x16x32_bf16 v[16:19], v[92:95], a[36:39], v[16:19]
    v_mfma_f32_16x16x32_bf16 v[20:23], v[92:95], a[92:95], v[20:23]
    s_waitcnt lgkmcnt(3)
    v_mfma_f32_16x16x32_bf16 v[16:19], v[96:99], a[40:43], v[16:19]
    v_mfma_f32_16x16x32_bf16 v[20:23], v[96:99], a[96:99], v[20:23]
    s_waitcnt lgkmcnt(2)
    v_mfma_f32_16x16x32_bf16 v[16:19], v[100:103], a[44:47], v[16:19]
    v_mfma_f32_16x16x32_bf16 v[20:23], v[100:103], a[100:103], v[20:23]
    s_waitcnt lgkmcnt(1)
    v_mfma_f32_16x16x32_bf16 v[16:19], v[104:107], a[48:51], v[16:19]
    v_mfma_f32_16x16x32_bf16 v[20:23], v[104:107], a[104:107], v[20:23]
    s_waitcnt lgkmcnt(0)
    v_mfma_f32_16x16x32_bf16 v[16:19], v[108:111], a[52:55], v[16:19]
    v_mfma_f32_16x16x32_bf16 v[20:23], v[108:111], a[108:111], v[20:23]
    ds_read_b128 v[56:59], v1 offset:43008
    ds_read_b128 v[60:63], v1 offset:44032
    ds_read_b128 v[64:67], v1 offset:45056
    ds_read_b128 v[68:71], v1 offset:46080
    ds_read_b128 v[72:75], v1 offset:47104
    ds_read_b128 v[76:79], v1 offset:48128
    ds_read_b128 v[80:83], v1 offset:49152
    ds_read_b128 v[84:87], v1 offset:50176
    ds_read_b128 v[88:91], v1 offset:51200
    ds_read_b128 v[92:95], v1 offset:52224
    ds_read_b128 v[96:99], v1 offset:53248
    ds_read_b128 v[100:103], v1 offset:54272
    ds_read_b128 v[104:107], v1 offset:55296
    ds_read_b128 v[108:111], v1 offset:56320
    s_waitcnt lgkmcnt(13)
    v_mfma_f32_16x16x32_bf16 v[24:27], v[56:59], a[0:3], 0
    v_mfma_f32_16x16x32_bf16 v[28:31], v[56:59], a[56:59], 0
    s_waitcnt lgkmcnt(12)
    v_mfma_f32_16x16x32_bf16 v[24:27], v[60:63], a[4:7], v[24:27]
    v_mfma_f32_16x16x32_bf16 v[28:31], v[60:63], a[60:63], v[28:31]
    s_waitcnt lgkmcnt(11)
    v_mfma_f32_16x16x32_bf16 v[24:27], v[64:67], a[8:11], v[24:27]
    v_mfma_f32_16x16x32_bf16 v[28:31], v[64:67], a[64:67], v[28:31]
    s_waitcnt lgkmcnt(10)
    v_mfma_f32_16x16x32_bf16 v[24:27], v[68:71], a[12:15], v[24:27]
    v_mfma_f32_16x16x32_bf16 v[28:31], v[68:71], a[68:71], v[28:31]
    s_waitcnt lgkmcnt(9)
    v_mfma_f32_16x16x32_bf16 v[24:27], v[72:75], a[16:19], v[24:27]
    v_mfma_f32_16x16x32_bf16 v[28:31], v[72:75], a[72:75], v[28:31]
    s_waitcnt lgkmcnt(8)
    v_mfma_f32_16x16x32_bf16 v[24:27], v[76:79], a[20:23], v[24:27]
    v_mfma_f32_16x16x32_bf16 v[28:31], v[76:79], a[76:79], v[28:31]
    s_waitcnt lgkmcnt(7)
    v_mfma_f32_16x16x32_bf16 v[24:27], v[80:83], a[24:27], v[24:27]
    v_mfma_f32_16x16x32_bf16 v[28:31], v[80:83], a[80:83], v[28:31]
    s_waitcnt lgkmcnt(6)
    v_mfma_f32_16x16x32_bf16 v[24:27], v[84:87], a[28:31], v[24:27]
    v_mfma_f32_16x16x32_bf16 v[28:31], v[84:87], a[84:87], v[28:31]
    s_waitcnt lgkmcnt(5)
    v_mfma_f32_16x16x32_bf16 v[24:27], v[88:91], a[32:35], v[24:27]
    v_mfma_f32_16x16x32_bf16 v[28:31], v[88:91], a[88:91], v[28:31]
    s_waitcnt lgkmcnt(4)
    v_mfma_f32_16x16x32_bf16 v[24:27], v[92:95], a[36:39], v[24:27]
    v_mfma_f32_16x16x32_bf16 v[28:31], v[92:95], a[92:95], v[28:31]
    s_waitcnt lgkmcnt(3)
    v_mfma_f32_16x16x32_bf16 v[24:27], v[96:99], a[40:43], v[24:27]
    v_mfma_f32_16x16x32_bf16 v[28:31], v[96:99], a[96:99], v[28:31]
    s_waitcnt lgkmcnt(2)
    v_mfma_f32_16x16x32_bf16 v[24:27], v[100:103], a[44:47], v[24:27]
    v_mfma_f32_16x16x32_bf16 v[28:31], v[100:103], a[100:103], v[28:31]
    s_waitcnt lgkmcnt(1)
    v_mfma_f32_16x16x32_bf16 v[24:27], v[104:107], a[48:51], v[24:27]
    v_mfma_f32_16x16x32_bf16 v[28:31], v[104:107], a[104:107], v[28:31]
    s_waitcnt lgkmcnt(0)
    v_mfma_f32_16x16x32_bf16 v[24:27], v[108:111], a[52:55], v[24:27]
    v_mfma_f32_16x16x32_bf16 v[28:31], v[108:111], a[108:111], v[28:31]
    s_nop 7
    v_cvt_pk_bf16_f32 v248, v16, v24
    v_cvt_pk_bf16_f32 v249, v17, v25
    v_cvt_pk_bf16_f32 v250, v18, v26
    v_cvt_pk_bf16_f32 v251, v19, v27
    v_cvt_pk_bf16_f32 v252, v20, v28
    v_cvt_pk_bf16_f32 v253, v21, v29
    v_cvt_pk_bf16_f32 v254, v22, v30
    v_cvt_pk_bf16_f32 v255, v23, v31
    s_nop 1
    v_mfma_f32_16x16x32_bf16 v[32:35], a[164:167], v[248:251], v[32:35]
    v_mfma_f32_16x16x32_bf16 v[36:39], a[164:167], v[252:255], v[36:39]
    v_mfma_f32_16x16x32_bf16 v[40:43], a[220:223], v[252:255], v[40:43]
    v_lshrrev_b32 v3, 4, v0
    v_lshlrev_b32 v2, 7, v3
    v_and_b32 v4, 7, v0
    v_lshl_add_u32 v2, v4, 4, v2
    s_lshl_b32 s17, s16, 13
    s_add_u32 s17, s17, 62750720
    s_add_u32 s18, s17, 4096
    s_max_u32 s27, s16, 2
    s_sub_u32 s27, s27, 1
    s_and_b32 s28, s96, 15
    s_lshl_b32 s28, s28, 7
    s_add_u32 s28, s28, 73990144
    v_mov_b32 v5, 0
    s_mov_b32 s30, 400000
wh_163:
    s_mov_b64 exec, 1
    buffer_load_dword v4, v5, s[4:7], s28 offen sc1
    s_mov_b64 exec, -1
    s_waitcnt vmcnt(0)
    v_readfirstlane_b32 s29, v4
    s_cmp_ge_u32 s29, s27
    s_cbranch_scc1 who_164
    s_add_u32 s29, s29, 2
    s_cmp_ge_u32 s29, s27
    s_cbranch_scc1 whs_165
    s_sleep 48
whs_165:
    s_sleep 6
    s_sub_u32 s30, s30, 1
    s_cmp_lg_u32 s30, 0
    s_cbranch_scc1 wh_163
    s_branch k2_end
who_164:
    s_mov_b32 s30, 400000
sw_166:
    buffer_load_dwordx4 v[56:59], v2, s[4:7], s17 offen offset:0 sc1
    buffer_load_dwordx4 v[60:63], v2, s[4:7], s17 offen offset:512 sc1
    buffer_load_dwordx4 v[64:67], v2, s[4:7], s17 offen offset:1024 sc1
    buffer_load_dwordx4 v[68:71], v2, s[4:7], s17 offen offset:1536 sc1
    buffer_load_dwordx4 v[72:75], v2, s[4:7], s17 offen offset:2048 sc1
    buffer_load_dwordx4 v[76:79], v2, s[4:7], s17 offen offset:2560 sc1
    buffer_load_dwordx4 v[80:83], v2, s[4:7], s17 offen offset:3072 sc1
    buffer_load_dwordx4 v[84:87], v2, s[4:7], s17 offen offset:3584 sc1
    buffer_load_dwordx4 v[88:91], v2, s[4:7], s18 offen offset:0 sc1
    buffer_load_dwordx4 v[92:95], v2, s[4:7], s18 offen offset:512 sc1
    buffer_load_dwordx4 v[96:99], v2, s[4:7], s18 offen offset:1024 sc1
    buffer_load_dwordx4 v[100:103], v2, s[4:7], s18 offen offset:1536 sc1
    buffer_load_dwordx4 v[104:107], v2, s[4:7], s18 offen offset:2048 sc1
    buffer_load_dwordx4 v[108:111], v2, s[4:7], s18 offen offset:2560 sc1
    s_waitcnt vmcnt(0)
    v_max_u32 v4, v56, v57
    v_max3_u32 v4, v4, v58, v59
    v_max3_u32 v4, v4, v60, v61
    v_max3_u32 v4, v4, v62, v63
    v_max3_u32 v4, v4, v64, v65
    v_max3_u32 v4, v4, v66, v67
    v_max3_u32 v4, v4, v68, v69
    v_max3_u32 v4, v4, v70, v71
    v_max3_u32 v4, v4, v72, v73
    v_max3_u32 v4, v4, v74, v75
    v_max3_u32 v4, v4, v76, v77
    v_max3_u32 v4, v4, v78, v79
    v_max3_u32 v4, v4, v80, v81
    v_max3_u32 v4, v4, v82, v83
    v_max3_u32 v4, v4, v84, v85
    v_max3_u32 v4, v4, v86, v87
    v_max3_u32 v4, v4, v88, v89
    v_max3_u32 v4, v4, v90, v91
    v_max3_u32 v4, v4, v92, v93
    v_max3_u32 v4, v4, v94, v95
    v_max3_u32 v4, v4, v96, v97
    v_max3_u32 v4, v4, v98, v99
    v_max3_u32 v4, v4, v100, v101
    v_max3_u32 v4, v4, v102, v103
    v_max3_u32 v4, v4, v104, v105
    v_max3_u32 v4, v4, v106, v107
    v_max3_u32 v4, v4, v108, v109
    v_max3_u32 v4, v4, v110, v111
    v_cmp_eq_u32 vcc, -1, v4
    s_cbranch_vccz swo_167
    s_sleep 3
    s_sub_u32 s30, s30, 1
    s_cmp_lg_u32 s30, 0
    s_cbranch_scc1 sw_166
    s_branch k2_end
swo_167:
    v_mfma_f32_16x16x32_bf16 v[44:47], v[56:59], v[144:147], 0
    v_mfma_f32_16x16x32_bf16 v[48:51], v[56:59], v[148:151], 0
    v_mfma_f32_16x16x32_bf16 v[44:47], v[60:63], v[152:155], v[44:47]
    v_mfma_f32_16x16x32_bf16 v[48:51], v[60:63], v[156:159], v[48:51]
    v_mfma_f32_16x16x32_bf16 v[44:47], v[64:67], v[160:163], v[44:47]
    v_mfma_f32_16x16x32_bf16 v[48:51], v[64:67], v[164:167], v[48:51]
    v_mfma_f32_16x16x32_bf16 v[44:47], v[68:71], v[168:171], v[44:47]
    v_mfma_f32_16x16x32_bf16 v[48:51], v[68:71], v[172:175], v[48:51]
    v_mfma_f32_16x16x32_bf16 v[44:47], v[72:75], v[176:179], v[44:47]
    v_mfma_f32_16x16x32_bf16 v[48:51], v[72:75], v[180:183], v[48:51]
    v_mfma_f32_16x16x32_bf16 v[44:47], v[76:79], v[184:187], v[44:47]
    v_mfma_f32_16x16x32_bf16 v[48:51], v[76:79], v[188:191], v[48:51]
    v_mfma_f32_16x16x32_bf16 v[44:47], v[80:83], v[192:195], v[44:47]
    v_mfma_f32_16x16x32_bf16 v[48:51], v[80:83], v[196:199], v[48:51]
    v_mfma_f32_16x16x32_bf16 v[44:47], v[84:87], v[200:203], v[44:47]
    v_mfma_f32_16x16x32_bf16 v[48:51], v[84:87], v[204:207], v[48:51]
    v_mfma_f32_16x16x32_bf16 v[44:47], v[88:91], v[208:211], v[44:47]
    v_mfma_f32_16x16x32_bf16 v[48:51], v[88:91], v[212:215], v[48:51]
    v_mfma_f32_16x16x32_bf16 v[44:47], v[92:95], v[216:219], v[44:47]
    v_mfma_f32_16x16x32_bf16 v[48:51], v[92:95], v[220:223], v[48:51]
    v_mfma_f32_16x16x32_bf16 v[44:47], v[96:99], v[224:227], v[44:47]
    v_mfma_f32_16x16x32_bf16 v[48:51], v[96:99], v[228:231], v[48:51]
    v_mfma_f32_16x16x32_bf16 v[44:47], v[100:103], v[232:235], v[44:47]
    v_mfma_f32_16x16x32_bf16 v[48:51], v[100:103], v[236:239], v[48:51]
    v_mfma_f32_16x16x32_bf16 v[44:47], v[104:107], v[240:243], v[44:47]
    v_mfma_f32_16x16x32_bf16 v[48:51], v[104:107], v[244:247], v[48:51]
    v_mfma_f32_16x16x32_bf16 v[44:47], v[108:111], v[248:251], v[44:47]
    v_mfma_f32_16x16x32_bf16 v[48:51], v[108:111], v[252:255], v[48:51]
    v_and_b32 v4, 15, v0
    v_lshlrev_b32 v5, 2, v3
    v_sub_u32 v4, v4, v5
    v_mov_b32 v5, 0xff800000
    s_nop 5
    v_cmp_le_i32 vcc, 0, v4
    s_nop 1
    v_cndmask_b32 v32, v5, v32, vcc
    v_cmp_le_i32 vcc, 1, v4
    s_nop 1
    v_cndmask_b32 v33, v5, v33, vcc
    v_cmp_le_i32 vcc, 2, v4
    s_nop 1
    v_cndmask_b32 v34, v5, v34, vcc
    v_cmp_le_i32 vcc, 3, v4
    s_nop 1
    v_cndmask_b32 v35, v5, v35, vcc
    v_cmp_le_i32 vcc, 0, v4
    s_nop 1
    v_cndmask_b32 v40, v5, v40, vcc
    v_cmp_le_i32 vcc, 1, v4
    s_nop 1
    v_cndmask_b32 v41, v5, v41, vcc
    v_cmp_le_i32 vcc, 2, v4
    s_nop 1
    v_cndmask_b32 v42, v5, v42, vcc
    v_cmp_le_i32 vcc, 3, v4
    s_nop 1
    v_cndmask_b32 v43, v5, v43, vcc
    s_mov_b32 s31, 0x3fb8aa3b
    v_and_b32 v6, 8, v0
    v_lshlrev_b32 v6, 7, v6
    v_and_b32 v7, 7, v0
    v_lshl_add_u32 v6, v7, 4, v6
    v_lshrrev_b32 v7, 1, v6
    v_and_b32 v7, 0x200, v7
    v_and_b32 v8, 0x70, v6
    v_or_b32 v7, v7, v8
    v_and_b32 v8, 1, v3
    v_lshl_add_u32 v7, v8, 7, v7
    v_lshl_add_u32 v6, v8, 3, v6
    v_lshrrev_b32 v8, 1, v3
    v_lshl_add_u32 v6, v8, 8, v6
    s_lshr_b32 s17, s32, 1
    s_lshl_b32 s18, s16, 3
    s_add_u32 s17, s17, s18
    s_lshl_b32 s17, s17, 12
    s_and_b32 s18, s32, 1
    s_lshl_b32 s19, s18, 7
    s_add_u32 s17, s17, s19
    s_add_u32 s17, s17, 70615040
    s_lshr_b32 s19, s32, 2
    s_lshl_b32 s21, s16, 2
    s_add_u32 s19, s19, s21
    s_lshl_b32 s19, s19, 11
    s_lshl_b32 s18, s18, 3
    s_add_u32 s19, s19, s18
    s_and_b32 s18, s32, 2
    s_lshl_b32 s18, s18, 7
    s_add_u32 s19, s19, s18
    s_add_u32 s19, s19, 72712192
    v_max3_f32 v9, v44, v45, v46
    v_max3_f32 v9, v9, v47, v32
    v_max3_f32 v9, v9, v33, v34
    v_max_f32 v9, v9, v35
    v_mov_b32 v10, v9
    s_nop 1
    v_permlane16_swap_b32 v9, v10
    s_nop 0
    v_max_f32 v9, v9, v10
    v_mov_b32 v10, v9
    s_nop 1
    v_permlane32_swap_b32 v9, v10
    s_nop 0
    v_max_f32 v9, v9, v10
    v_sub_f32 v44, v44, v9
    v_sub_f32 v45, v45, v9
    v_sub_f32 v46, v46, v9
    v_sub_f32 v47, v47, v9
    v_sub_f32 v32, v32, v9
    v_sub_f32 v33, v33, v9
    v_sub_f32 v34, v34, v9
    v_sub_f32 v35, v35, v9
    v_exp_f32 v44, v44
    v_exp_f32 v45, v45
    v_exp_f32 v46, v46
    v_exp_f32 v47, v47
    v_exp_f32 v32, v32
    v_exp_f32 v33, v33
    v_exp_f32 v34, v34
    v_exp_f32 v35, v35
    s_nop 0
    v_add_f32 v9, v44, v45
    v_add_f32 v10, v46, v47
    v_add_f32 v9, v9, v10
    v_mul_f32 v9, 0.5, v9
    v_add_f32 v9, v9, v32
    v_add_f32 v9, v9, v33
    v_add_f32 v9, v9, v34
    v_add_f32 v9, v9, v35
    v_mov_b32 v10, v9
    s_nop 1
    v_permlane16_swap_b32 v9, v10
    s_nop 0
    v_add_f32 v9, v9, v10
    v_mov_b32 v10, v9
    s_nop 1
    v_permlane32_swap_b32 v9, v10
    s_nop 0
    v_add_f32 v9, v9, v10
    v_rcp_f32 v9, v9
    s_nop 0
    v_mul_f32 v44, v44, v9
    v_mul_f32 v45, v45, v9
    v_mul_f32 v46, v46, v9
    v_mul_f32 v47, v47, v9
    v_mul_f32 v32, v32, v9
    v_mul_f32 v33, v33, v9
    v_mul_f32 v34, v34, v9
    v_mul_f32 v35, v35, v9
    v_cvt_pk_bf16_f32 v12, v32, v33
    v_cvt_pk_bf16_f32 v13, v34, v35
    buffer_store_dwordx2 v[12:13], v6, s[4:7], s17 offen offset:0 sc1
    s_nop 1
    v_mov_b32 v12, 0
    v_mov_b32 v13, 0
    buffer_store_dwordx2 v[12:13], v6, s[4:7], s17 offen offset:512 sc1
    s_nop 1
    v_cvt_pk_bf16_f32 v14, v44, v45
    v_cvt_pk_bf16_f32 v15, v46, v47
    s_mov_b32 exec_hi, 0
    buffer_store_dwordx2 v[14:15], v7, s[4:7], s19 offen offset:0 sc1
    s_mov_b32 exec_hi, -1
    s_nop 1
    v_max3_f32 v9, v48, v49, v50
    v_max3_f32 v9, v9, v51, v36
    v_max3_f32 v9, v9, v37, v38
    v_max3_f32 v9, v9, v39, v40
    v_max3_f32 v9, v9, v41, v42
    v_max_f32 v9, v9, v43
    v_mov_b32 v10, v9
    s_nop 1
    v_permlane16_swap_b32 v9, v10
    s_nop 0
    v_max_f32 v9, v9, v10
    v_mov_b32 v10, v9
    s_nop 1
    v_permlane32_swap_b32 v9, v10
    s_nop 0
    v_max_f32 v9, v9, v10
    v_sub_f32 v48, v48, v9
    v_sub_f32 v49, v49, v9
    v_sub_f32 v50, v50, v9
    v_sub_f32 v51, v51, v9
    v_sub_f32 v36, v36, v9
    v_sub_f32 v37, v37, v9
    v_sub_f32 v38, v38, v9
    v_sub_f32 v39, v39, v9
    v_sub_f32 v40, v40, v9
    v_sub_f32 v41, v41, v9
    v_sub_f32 v42, v42, v9
    v_sub_f32 v43, v43, v9
    v_exp_f32 v48, v48
    v_exp_f32 v49, v49
    v_exp_f32 v50, v50
    v_exp_f32 v51, v51
    v_exp_f32 v36, v36
    v_exp_f32 v37, v37
    v_exp_f32 v38, v38
    v_exp_f32 v39, v39
    v_exp_f32 v40, v40
    v_exp_f32 v41, v41
    v_exp_f32 v42, v42
    v_exp_f32 v43, v43
    s_nop 0
    v_add_f32 v9, v48, v49
    v_add_f32 v10, v50, v51
    v_add_f32 v9, v9, v10
    v_mul_f32 v9, 0.5, v9
    v_add_f32 v9, v9, v36
    v_add_f32 v9, v9, v37
    v_add_f32 v9, v9, v38
    v_add_f32 v9, v9, v39
    v_add_f32 v9, v9, v40
    v_add_f32 v9, v9, v41
    v_add_f32 v9, v9, v42
    v_add_f32 v9, v9, v43
    v_mov_b32 v10, v9
    s_nop 1
    v_permlane16_swap_b32 v9, v10
    s_nop 0
    v_add_f32 v9, v9, v10
    v_mov_b32 v10, v9
    s_nop 1
    v_permlane32_swap_b32 v9, v10
    s_nop 0
    v_add_f32 v9, v9, v10
    v_rcp_f32 v9, v9
    s_nop 0
    v_mul_f32 v48, v48, v9
    v_mul_f32 v49, v49, v9
    v_mul_f32 v50, v50, v9
    v_mul_f32 v51, v51, v9
    v_mul_f32 v36, v36, v9
    v_mul_f32 v37, v37, v9
    v_mul_f32 v38, v38, v9
    v_mul_f32 v39, v39, v9
    v_mul_f32 v40, v40, v9
    v_mul_f32 v41, v41, v9
    v_mul_f32 v42, v42, v9
    v_mul_f32 v43, v43, v9
    v_cvt_pk_bf16_f32 v12, v36, v37
    v_cvt_pk_bf16_f32 v13, v38, v39
    buffer_store_dwordx2 v[12:13], v6, s[4:7], s17 offen offset:2048 sc1
    s_nop 1
    v_cvt_pk_bf16_f32 v12, v40, v41
    v_cvt_pk_bf16_f32 v13, v42, v43
    buffer_store_dwordx2 v[12:13], v6, s[4:7], s17 offen offset:2560 sc1
    s_nop 1
    v_cvt_pk_bf16_f32 v14, v48, v49
    v_cvt_pk_bf16_f32 v15, v50, v51
    s_mov_b32 exec_hi, 0
    buffer_store_dwordx2 v[14:15], v7, s[4:7], s19 offen offset:1024 sc1
    s_mov_b32 exec_hi, -1
    s_nop 1
    s_waitcnt vmcnt(0)
    v_mov_b32 v12, 1
    s_lshl_b32 s17, s16, 6
    s_lshl_b32 s18, s32, 2
    s_add_u32 s17, s17, s18
    s_add_u32 s17, s17, 73973760
    v_mov_b32 v13, 0
    buffer_store_dword v12, v13, s[4:7], s17 offen sc1
    s_add_u32 s93, s93, 1
    s_add_u32 s33, s33, 8
    s_cmp_lt_u32 s33, 16
    s_cbranch_scc1 k2_sitem
    s_branch k2_end
k2_ow:
    s_cmp_lg_u32 s3, 0
    s_cbranch_scc1 wfl_168
    v_mbcnt_lo_u32_b32 v2, -1, 0
    v_mbcnt_hi_u32_b32 v2, -1, v2
    v_min_u32 v2, 55, v2
    v_lshlrev_b32 v2, 4, v2
    s_mov_b32 s16, 73984000
    s_mov_b32 s30, 400000
sw_169:
    buffer_load_dwordx4 v[4:7], v2, s[4:7], s16 offen sc1
    s_waitcnt vmcnt(0)
    v_min_u32 v4, v4, v5
    v_min3_u32 v4, v4, v6, v7
    v_cmp_eq_u32 vcc, 0, v4
    s_cbranch_vccz swo_170
    s_sleep 16
    s_sub_u32 s30, s30, 1
    s_cmp_lg_u32 s30, 0
    s_cbranch_scc1 sw_169
    s_branch k2_end
swo_170:
wfl_168:
    s_barrier
    s_sub_u32 s34, s92, 19
    s_mov_b32 s35, s91
k2_oitem:
    v_and_b32 v3, 8, v0
    v_cmp_eq_u32 vcc, 0, v3
    v_mov_b32 v2, 0xeeee
    v_mov_b32 v3, 0x4444
    v_cndmask_b32 v2, v2, v3, vcc
    s_lshl_b32 s16, s34, 3
    s_lshl_b32 s17, s3, 1
    s_add_u32 s16, s16, s17
    s_mul_i32 s18, s16, 14
    s_lshl_b32 s17, s35, 1
    s_add_u32 s18, s18, s17
    s_lshl_b32 s18, s18, 12
    s_add_u32 s18, s18, 23166976
    s_lshl_b32 s19, s34, 12
    s_add_u32 s18, s18, s19
    s_add_u32 s19, s18, 0
    buffer_load_dwordx4 v[16:19], v1, s[4:7], s19 offen offset:0
    buffer_load_dwordx4 v[20:23], v1, s[4:7], s19 offen offset:1024
    buffer_load_dwordx4 v[24:27], v1, s[4:7], s19 offen offset:2048
    buffer_load_dwordx4 v[28:31], v1, s[4:7], s19 offen offset:3072
    s_add_u32 s19, s18, 4096
    buffer_load_dwordx4 v[48:51], v1, s[4:7], s19 offen offset:0
    buffer_load_dwordx4 v[52:55], v1, s[4:7], s19 offen offset:1024
    buffer_load_dwordx4 v[56:59], v1, s[4:7], s19 offen offset:2048
    buffer_load_dwordx4 v[60:63], v1, s[4:7], s19 offen offset:3072
    s_add_u32 s19, s18, 57344
    buffer_load_dwordx4 v[32:35], v1, s[4:7], s19 offen offset:0
    buffer_load_dwordx4 v[36:39], v1, s[4:7], s19 offen offset:1024
    buffer_load_dwordx4 v[40:43], v1, s[4:7], s19 offen offset:2048
    buffer_load_dwordx4 v[44:47], v1, s[4:7], s19 offen offset:3072
    s_add_u32 s19, s18, 61440
    buffer_load_dwordx4 v[64:67], v1, s[4:7], s19 offen offset:0
    buffer_load_dwordx4 v[68:71], v1, s[4:7], s19 offen offset:1024
    buffer_load_dwordx4 v[72:75], v1, s[4:7], s19 offen offset:2048
    buffer_load_dwordx4 v[76:79], v1, s[4:7], s19 offen offset:3072
    s_lshl_b32 s22, s3, 3
    v_lshrrev_b32 v4, 3, v0
    v_add_u32 v4, s22, v4
    v_and_b32 v5, 7, v0
    v_mul_u32_u24 v6, 896, v4
    v_lshl_add_u32 v6, v5, 4, v6
    s_mul_i32 s22, s34, 28672
    s_lshl_b32 s23, s35, 7
    s_add_u32 s22, s22, s23
    s_add_u32 s23, s22, 60129280
    buffer_load_dwordx4 v[208:211], v6, s[8:11], s22 offen
    buffer_load_dwordx4 v[212:215], v6, s[4:7], s23 offen
    v_mov_b64 v[144:145], 0
    v_mov_b64 v[146:147], 0
    v_mov_b64 v[148:149], 0
    v_mov_b64 v[150:151], 0
    v_mov_b64 v[152:153], 0
    v_mov_b64 v[154:155], 0
    v_mov_b64 v[156:157], 0
    v_mov_b64 v[158:159], 0
    v_mov_b64 v[160:161], 0
    v_mov_b64 v[162:163], 0
    v_mov_b64 v[164:165], 0
    v_mov_b64 v[166:167], 0
    v_mov_b64 v[168:169], 0
    v_mov_b64 v[170:171], 0
    v_mov_b64 v[172:173], 0
    v_mov_b64 v[174:175], 0
    v_mov_b64 v[176:177], 0
    v_mov_b64 v[178:179], 0
    v_mov_b64 v[180:181], 0
    v_mov_b64 v[182:183], 0
    v_mov_b64 v[184:185], 0
    v_mov_b64 v[186:187], 0
    v_mov_b64 v[188:189], 0
    v_mov_b64 v[190:191], 0
    v_mov_b64 v[192:193], 0
    v_mov_b64 v[194:195], 0
    v_mov_b64 v[196:197], 0
    v_mov_b64 v[198:199], 0
    v_mov_b64 v[200:201], 0
    v_mov_b64 v[202:203], 0
    v_mov_b64 v[204:205], 0
    v_mov_b64 v[206:207], 0
    v_mov_b64 v[128:129], 0
    v_mov_b64 v[130:131], 0
    v_mov_b64 v[132:133], 0
    v_mov_b64 v[134:135], 0
    v_mov_b64 v[136:137], 0
    v_mov_b64 v[138:139], 0
    v_mov_b64 v[140:141], 0
    v_mov_b64 v[142:143], 0
    s_cmp_lg_u32 s3, 0
    s_cbranch_scc1 ow_171
    v_mov_b32 v11, v4
    v_mov_b32 v12, v5
    s_and_b32 s27, s34, 62
    s_and_b32 s28, s96, 15
    s_lshl_b32 s28, s28, 7
    s_add_u32 s28, s28, 73990144
    v_mov_b32 v5, 0
    s_mov_b32 s30, 400000
wh_172:
    s_mov_b64 exec, 1
    buffer_load_dword v4, v5, s[4:7], s28 offen sc1
    s_mov_b64 exec, -1
    s_waitcnt vmcnt(0)
    v_readfirstlane_b32 s29, v4
    s_cmp_ge_u32 s29, s27
    s_cbranch_scc1 who_173
    s_add_u32 s29, s29, 2
    s_cmp_ge_u32 s29, s27
    s_cbranch_scc1 whs_174
    s_sleep 48
whs_174:
    s_sleep 6
    s_sub_u32 s30, s30, 1
    s_cmp_lg_u32 s30, 0
    s_cbranch_scc1 wh_172
    s_branch k2_end
who_173:
    v_mov_b32 v4, v11
    v_mov_b32 v5, v12
    v_and_b32 v7, 15, v0
    v_lshlrev_b32 v7, 2, v7
    s_lshl_b32 s19, s34, 6
    s_add_u32 s19, s19, 73973760
    v_add_u32 v7, s19, v7
    v_mov_b32 v8, 1
    s_lshr_b32 s19, s34, 1
    s_mul_i32 s19, s19, 7
    s_add_u32 s19, s19, s35
    s_lshl_b32 s19, s19, 7
    s_add_u32 s19, s19, 73994240
    v_and_b32 v9, 15, v0
    v_lshlrev_b32 v9, 2, v9
    v_add_u32 v9, s19, v9
    v_cmp_lt_u32 vcc, 15, v0
    s_nop 1
    v_cndmask_b32 v7, v7, v9, vcc
    s_mov_b32 exec_hi, 0
    s_mov_b64 vcc, 0
    s_mov_b32 s30, 400000
sw_175:
    buffer_load_dword v9, v7, s[4:7], 0 offen sc1
    s_waitcnt vmcnt(0)
    v_cmp_gt_u32 vcc, v8, v9
    s_cbranch_vccz swo_176
    s_sleep 4
    s_cmp_gt_u32 s30, 399984
    s_cbranch_scc1 swb_177
    s_sleep 100
swb_177:
    s_sub_u32 s30, s30, 1
    s_cmp_lg_u32 s30, 0
    s_cbranch_scc1 sw_175
    s_branch ow_171f
swo_176:
    s_mov_b32 exec_hi, -1
    s_branch ow_171
ow_171f:
    s_mov_b32 exec_hi, -1
    s_branch k2_end
ow_171:
    s_barrier
    s_lshl_b32 s18, s16, 12
    s_add_u32 s18, s18, 70615040
    s_add_u32 s19, s18, 4096
    buffer_load_dwordx4 v[96:99], v1, s[4:7], s18 offen offset:0
    buffer_load_dwordx4 v[104:107], v1, s[4:7], s18 offen offset:1024
    buffer_load_dwordx4 v[112:115], v1, s[4:7], s18 offen offset:2048
    buffer_load_dwordx4 v[120:123], v1, s[4:7], s18 offen offset:3072
    buffer_load_dwordx4 v[100:103], v1, s[4:7], s19 offen offset:0
    buffer_load_dwordx4 v[108:111], v1, s[4:7], s19 offen offset:1024
    buffer_load_dwordx4 v[116:119], v1, s[4:7], s19 offen offset:2048
    buffer_load_dwordx4 v[124:127], v1, s[4:7], s19 offen offset:3072
    v_lshrrev_b32 v7, 4, v0
    v_lshlrev_b32 v7, 7, v7
    v_and_b32 v8, 7, v0
    v_lshl_add_u32 v7, v8, 4, v7
    s_lshl_b32 s18, s34, 2
    s_add_u32 s18, s18, s3
    s_lshl_b32 s18, s18, 11
    s_add_u32 s18, s18, 72712192
    s_mov_b32 exec_lo, 0x00ff00ff
    s_mov_b32 exec_hi, 0x00ff00ff
    buffer_load_dwordx4 v[128:131], v7, s[4:7], s18 offen offset:0
    buffer_load_dwordx4 v[132:135], v7, s[4:7], s18 offen offset:512
    buffer_load_dwordx4 v[136:139], v7, s[4:7], s18 offen offset:1024
    buffer_load_dwordx4 v[140:143], v7, s[4:7], s18 offen offset:1536
    s_mov_b64 exec, -1
    s_mul_i32 s18, s34, 14
    s_add_u32 s18, s18, s17
    s_lshl_b32 s18, s18, 2
    s_add_u32 s18, s18, s3
    s_lshl_b32 s18, s18, 11
    s_add_u32 s18, s18, 63275008
    s_add_u32 s19, s18, 8192
    buffer_load_dwordx4 v[80:83], v1, s[4:7], s18 offen offset:0
    buffer_load_dwordx4 v[84:87], v1, s[4:7], s18 offen offset:1024
    buffer_load_dwordx4 v[88:91], v1, s[4:7], s19 offen offset:0
    buffer_load_dwordx4 v[92:95], v1, s[4:7], s19 offen offset:1024
    s_waitcnt vmcnt(8)
    v_smfmac_f32_16x16x64_bf16 v[144:147], v[96:99], v[16:23], v2
    v_smfmac_f32_16x16x64_bf16 v[148:151], v[96:99], v[24:31], v2
    v_smfmac_f32_16x16x64_bf16 v[152:155], v[96:99], v[48:55], v2
    v_smfmac_f32_16x16x64_bf16 v[156:159], v[96:99], v[56:63], v2
    v_smfmac_f32_16x16x64_bf16 v[144:147], v[100:103], v[32:39], v2
    v_smfmac_f32_16x16x64_bf16 v[148:151], v[100:103], v[40:47], v2
    v_smfmac_f32_16x16x64_bf16 v[152:155], v[100:103], v[64:71], v2
    v_smfmac_f32_16x16x64_bf16 v[156:159], v[100:103], v[72:79], v2
    v_smfmac_f32_16x16x64_bf16 v[160:163], v[104:107], v[16:23], v2
    v_smfmac_f32_16x16x64_bf16 v[164:167], v[104:107], v[24:31], v2
    v_smfmac_f32_16x16x64_bf16 v[168:171], v[104:107], v[48:55], v2
    v_smfmac_f32_16x16x64_bf16 v[172:175], v[104:107], v[56:63], v2
    v_smfmac_f32_16x16x64_bf16 v[160:163], v[108:111], v[32:39], v2
    v_smfmac_f32_16x16x64_bf16 v[164:167], v[108:111], v[40:47], v2
    v_smfmac_f32_16x16x64_bf16 v[168:171], v[108:111], v[64:71], v2
    v_smfmac_f32_16x16x64_bf16 v[172:175], v[108:111], v[72:79], v2
    v_smfmac_f32_16x16x64_bf16 v[176:179], v[112:115], v[16:23], v2
    v_smfmac_f32_16x16x64_bf16 v[180:183], v[112:115], v[24:31], v2
    v_smfmac_f32_16x16x64_bf16 v[184:187], v[112:115], v[48:55], v2
    v_smfmac_f32_16x16x64_bf16 v[188:191], v[112:115], v[56:63], v2
    v_smfmac_f32_16x16x64_bf16 v[176:179], v[116:119], v[32:39], v2
    v_smfmac_f32_16x16x64_bf16 v[180:183], v[116:119], v[40:47], v2
    v_smfmac_f32_16x16x64_bf16 v[184:187], v[116:119], v[64:71], v2
    v_smfmac_f32_16x16x64_bf16 v[188:191], v[116:119], v[72:79], v2
    v_smfmac_f32_16x16x64_bf16 v[192:195], v[120:123], v[16:23], v2
    v_smfmac_f32_16x16x64_bf16 v[196:199], v[120:123], v[24:31], v2
    v_smfmac_f32_16x16x64_bf16 v[200:203], v[120:123], v[48:55], v2
    v_smfmac_f32_16x16x64_bf16 v[204:207], v[120:123], v[56:63], v2
    v_smfmac_f32_16x16x64_bf16 v[192:195], v[124:127], v[32:39], v2
    v_smfmac_f32_16x16x64_bf16 v[196:199], v[124:127], v[40:47], v2
    v_smfmac_f32_16x16x64_bf16 v[200:203], v[124:127], v[64:71], v2
    v_smfmac_f32_16x16x64_bf16 v[204:207], v[124:127], v[72:79], v2
    s_waitcnt vmcnt(0)
    v_mfma_f32_16x16x32_bf16 v[144:147], v[128:131], v[80:83], v[144:147]
    v_mfma_f32_16x16x32_bf16 v[148:151], v[128:131], v[84:87], v[148:151]
    v_mfma_f32_16x16x32_bf16 v[152:155], v[128:131], v[88:91], v[152:155]
    v_mfma_f32_16x16x32_bf16 v[156:159], v[128:131], v[92:95], v[156:159]
    v_mfma_f32_16x16x32_bf16 v[160:163], v[132:135], v[80:83], v[160:163]
    v_mfma_f32_16x16x32_bf16 v[164:167], v[132:135], v[84:87], v[164:167]
    v_mfma_f32_16x16x32_bf16 v[168:171], v[132:135], v[88:91], v[168:171]
    v_mfma_f32_16x16x32_bf16 v[172:175], v[132:135], v[92:95], v[172:175]
    v_mfma_f32_16x16x32_bf16 v[176:179], v[136:139], v[80:83], v[176:179]
    v_mfma_f32_16x16x32_bf16 v[180:183], v[136:139], v[84:87], v[180:183]
    v_mfma_f32_16x16x32_bf16 v[184:187], v[136:139], v[88:91], v[184:187]
    v_mfma_f32_16x16x32_bf16 v[188:191], v[136:139], v[92:95], v[188:191]
    v_mfma_f32_16x16x32_bf16 v[192:195], v[140:143], v[80:83], v[192:195]
    v_mfma_f32_16x16x32_bf16 v[196:199], v[140:143], v[84:87], v[196:199]
    v_mfma_f32_16x16x32_bf16 v[200:203], v[140:143], v[88:91], v[200:203]
    v_mfma_f32_16x16x32_bf16 v[204:207], v[140:143], v[92:95], v[204:207]
    v_lshrrev_b32 v7, 5, v0
    v_mul_u32_u24 v7, 8704, v7
    v_and_b32 v8, 16, v0
    v_mul_u32_u24 v8, 68, v8
    v_add_u32 v7, v7, v8
    v_and_b32 v8, 15, v0
    v_lshl_add_u32 v7, v8, 3, v7
    s_mul_i32 s18, s3, 17408
    v_add_u32 v7, s18, v7
    s_barrier
    v_add_u32 v8, 0, v7
    ds_write2_b32 v8, v144, v148 offset0:0 offset1:1
    ds_write2_b32 v8, v152, v156 offset0:32 offset1:33
    ds_write2_b32 v8, v145, v149 offset0:68 offset1:69
    ds_write2_b32 v8, v153, v157 offset0:100 offset1:101
    ds_write2_b32 v8, v146, v150 offset0:136 offset1:137
    ds_write2_b32 v8, v154, v158 offset0:168 offset1:169
    ds_write2_b32 v8, v147, v151 offset0:204 offset1:205
    ds_write2_b32 v8, v155, v159 offset0:236 offset1:237
    v_add_u32 v8, 2176, v7
    ds_write2_b32 v8, v160, v164 offset0:0 offset1:1
    ds_write2_b32 v8, v168, v172 offset0:32 offset1:33
    ds_write2_b32 v8, v161, v165 offset0:68 offset1:69
    ds_write2_b32 v8, v169, v173 offset0:100 offset1:101
    ds_write2_b32 v8, v162, v166 offset0:136 offset1:137
    ds_write2_b32 v8, v170, v174 offset0:168 offset1:169
    ds_write2_b32 v8, v163, v167 offset0:204 offset1:205
    ds_write2_b32 v8, v171, v175 offset0:236 offset1:237
    v_add_u32 v8, 4352, v7
    ds_write2_b32 v8, v176, v180 offset0:0 offset1:1
    ds_write2_b32 v8, v184, v188 offset0:32 offset1:33
    ds_write2_b32 v8, v177, v181 offset0:68 offset1:69
    ds_write2_b32 v8, v185, v189 offset0:100 offset1:101
    ds_write2_b32 v8, v178, v182 offset0:136 offset1:137
    ds_write2_b32 v8, v186, v190 offset0:168 offset1:169
    ds_write2_b32 v8, v179, v183 offset0:204 offset1:205
    ds_write2_b32 v8, v187, v191 offset0:236 offset1:237
    v_add_u32 v8, 6528, v7
    ds_write2_b32 v8, v192, v196 offset0:0 offset1:1
    ds_write2_b32 v8, v200, v204 offset0:32 offset1:33
    ds_write2_b32 v8, v193, v197 offset0:68 offset1:69
    ds_write2_b32 v8, v201, v205 offset0:100 offset1:101
    ds_write2_b32 v8, v194, v198 offset0:136 offset1:137
    ds_write2_b32 v8, v202, v206 offset0:168 offset1:169
    ds_write2_b32 v8, v195, v199 offset0:204 offset1:205
    ds_write2_b32 v8, v203, v207 offset0:236 offset1:237
    s_waitcnt lgkmcnt(0)
    s_barrier
    v_mul_u32_u24 v7, 272, v4
    v_lshl_add_u32 v7, v5, 5, v7
    ds_read_b128 v[16:19], v7 offset:0
    ds_read_b128 v[20:23], v7 offset:16
    ds_read_b128 v[24:27], v7 offset:8704
    ds_read_b128 v[28:31], v7 offset:8720
    v_add_u32 v7, 17408, v7
    ds_read_b128 v[32:35], v7 offset:0
    ds_read_b128 v[36:39], v7 offset:16
    ds_read_b128 v[40:43], v7 offset:8704
    ds_read_b128 v[44:47], v7 offset:8720
    v_add_u32 v7, 17408, v7
    ds_read_b128 v[48:51], v7 offset:0
    ds_read_b128 v[52:55], v7 offset:16
    ds_read_b128 v[56:59], v7 offset:8704
    ds_read_b128 v[60:63], v7 offset:8720
    v_add_u32 v7, 17408, v7
    ds_read_b128 v[64:67], v7 offset:0
    ds_read_b128 v[68:71], v7 offset:16
    ds_read_b128 v[72:75], v7 offset:8704
    ds_read_b128 v[76:79], v7 offset:8720
    s_waitcnt lgkmcnt(0)
    v_pk_add_f32 v[16:17], v[16:17], v[24:25]
    v_pk_add_f32 v[18:19], v[18:19], v[26:27]
    v_pk_add_f32 v[20:21], v[20:21], v[28:29]
    v_pk_add_f32 v[22:23], v[22:23], v[30:31]
    v_pk_add_f32 v[32:33], v[32:33], v[40:41]
    v_pk_add_f32 v[34:35], v[34:35], v[42:43]
    v_pk_add_f32 v[36:37], v[36:37], v[44:45]
    v_pk_add_f32 v[38:39], v[38:39], v[46:47]
    v_pk_add_f32 v[48:49], v[48:49], v[56:57]
    v_pk_add_f32 v[50:51], v[50:51], v[58:59]
    v_pk_add_f32 v[52:53], v[52:53], v[60:61]
    v_pk_add_f32 v[54:55], v[54:55], v[62:63]
    v_pk_add_f32 v[64:65], v[64:65], v[72:73]
    v_pk_add_f32 v[66:67], v[66:67], v[74:75]
    v_pk_add_f32 v[68:69], v[68:69], v[76:77]
    v_pk_add_f32 v[70:71], v[70:71], v[78:79]
    v_pk_add_f32 v[16:17], v[16:17], v[32:33]
    v_pk_add_f32 v[18:19], v[18:19], v[34:35]
    v_pk_add_f32 v[20:21], v[20:21], v[36:37]
    v_pk_add_f32 v[22:23], v[22:23], v[38:39]
    v_pk_add_f32 v[48:49], v[48:49], v[64:65]
    v_pk_add_f32 v[50:51], v[50:51], v[66:67]
    v_pk_add_f32 v[52:53], v[52:53], v[68:69]
    v_pk_add_f32 v[54:55], v[54:55], v[70:71]
    v_pk_add_f32 v[16:17], v[16:17], v[48:49]
    v_pk_add_f32 v[18:19], v[18:19], v[50:51]
    v_pk_add_f32 v[20:21], v[20:21], v[52:53]
    v_pk_add_f32 v[22:23], v[22:23], v[54:55]
    v_cvt_pk_bf16_f32 v8, v16, v17
    v_lshlrev_b32 v16, 16, v8
    v_and_b32 v17, 0xffff0000, v8
    v_lshlrev_b32 v9, 16, v212
    v_and_b32 v10, 0xffff0000, v212
    v_mul_f32 v16, v16, v9
    v_mul_f32 v17, v17, v10
    v_cvt_pk_bf16_f32 v8, v16, v17
    v_lshlrev_b32 v16, 16, v8
    v_and_b32 v17, 0xffff0000, v8
    v_lshlrev_b32 v9, 16, v208
    v_and_b32 v10, 0xffff0000, v208
    v_add_f32 v16, v16, v9
    v_add_f32 v17, v17, v10
    v_cvt_pk_bf16_f32 v24, v16, v17
    v_cvt_pk_bf16_f32 v8, v18, v19
    v_lshlrev_b32 v18, 16, v8
    v_and_b32 v19, 0xffff0000, v8
    v_lshlrev_b32 v9, 16, v213
    v_and_b32 v10, 0xffff0000, v213
    v_mul_f32 v18, v18, v9
    v_mul_f32 v19, v19, v10
    v_cvt_pk_bf16_f32 v8, v18, v19
    v_lshlrev_b32 v18, 16, v8
    v_and_b32 v19, 0xffff0000, v8
    v_lshlrev_b32 v9, 16, v209
    v_and_b32 v10, 0xffff0000, v209
    v_add_f32 v18, v18, v9
    v_add_f32 v19, v19, v10
    v_cvt_pk_bf16_f32 v25, v18, v19
    v_cvt_pk_bf16_f32 v8, v20, v21
    v_lshlrev_b32 v20, 16, v8
    v_and_b32 v21, 0xffff0000, v8
    v_lshlrev_b32 v9, 16, v214
    v_and_b32 v10, 0xffff0000, v214
    v_mul_f32 v20, v20, v9
    v_mul_f32 v21, v21, v10
    v_cvt_pk_bf16_f32 v8, v20, v21
    v_lshlrev_b32 v20, 16, v8
    v_and_b32 v21, 0xffff0000, v8
    v_lshlrev_b32 v9, 16, v210
    v_and_b32 v10, 0xffff0000, v210
    v_add_f32 v20, v20, v9
    v_add_f32 v21, v21, v10
    v_cvt_pk_bf16_f32 v26, v20, v21
    v_cvt_pk_bf16_f32 v8, v22, v23
    v_lshlrev_b32 v22, 16, v8
    v_and_b32 v23, 0xffff0000, v8
    v_lshlrev_b32 v9, 16, v215
    v_and_b32 v10, 0xffff0000, v215
    v_mul_f32 v22, v22, v9
    v_mul_f32 v23, v23, v10
    v_cvt_pk_bf16_f32 v8, v22, v23
    v_lshlrev_b32 v22, 16, v8
    v_and_b32 v23, 0xffff0000, v8
    v_lshlrev_b32 v9, 16, v211
    v_and_b32 v10, 0xffff0000, v211
    v_add_f32 v22, v22, v9
    v_add_f32 v23, v23, v10
    v_cvt_pk_bf16_f32 v27, v22, v23
    buffer_store_dwordx4 v[24:27], v6, s[12:15], s22 offen
    s_add_u32 s93, s93, 1
    s_add_u32 s34, s34, 9
    s_cmp_lt_u32 s34, 64
    s_cbranch_scc1 k2_oitem
k2_end:
    s_endpgm
.section .rodata,"a"
.p2align 6
.amdhsa_kernel k2_kernel
  .amdhsa_next_free_vgpr 512
  .amdhsa_next_free_sgpr 100
  .amdhsa_accum_offset 256
  .amdhsa_group_segment_fixed_size 0
  .amdhsa_kernarg_size 112
  .amdhsa_user_sgpr_count 2
  .amdhsa_user_sgpr_kernarg_segment_ptr 1
  .amdhsa_system_sgpr_workgroup_id_x 1
  .amdhsa_float_denorm_mode_32 3
  .amdhsa_float_denorm_mode_16_64 3
.end_amdhsa_kernel
```
